```python
import torch

def _softmax(x, axis=-1):
    return torch.softmax(x, dim=axis)
def _gelu(x):
    return torch.nn.functional.gelu(x, approximate="tanh")
def _silu(x):
    return torch.nn.functional.silu(x)
def _sigmoid(x):
    return torch.sigmoid(x)
def _layernorm(x, axis=-1, eps=1e-5):
    m = x.mean(dim=axis, keepdim=True)
    v = x.var(dim=axis, keepdim=True, unbiased=False)
    return (x - m) / torch.sqrt(v + eps)
def _scatter_add(tgt, idx, src, axis=0):
    return tgt.clone().index_add_(axis, idx, src)
def _segment_sum(src, seg, n):
    out = torch.zeros((n,) + src.shape[1:], dtype=src.dtype)
    return out.index_add_(0, seg, src)
def _pad(x, pw):
    flat = tuple(v for pair in reversed(pw) for v in pair)
    return torch.nn.functional.pad(x, flat)

kernel_name = 'concat_heads__mha_block_cached__mha_block_cached__near_ridge'

def setup_inputs():

    _w = (lambda a: (lambda t: t.to(torch.bfloat16) if t.is_floating_point() else t)(torch.as_tensor(a)))
    def _A_setup():
        B, Sq, D = 16, 192, 640
        H, Sk, Dh = 32, 512, 128
        return {
            "x": _w((lambda *s: torch.randn(*s, dtype=torch.bfloat16) * 0.8)(B, Sq, D)),
            "k_cache": _w((lambda *s: torch.randn(*s, dtype=torch.bfloat16) * 0.8)(B, H, Sk, Dh)),
            "v_cache": _w((lambda *s: torch.randn(*s, dtype=torch.bfloat16) * 0.05)(B, H, Sk, Dh)),
            "wq": _w((lambda *s: torch.randn(*s, dtype=torch.bfloat16) * 0.8)(D, H * Dh) * (D ** -0.5)),
            "wo": _w((lambda *s: torch.randn(*s, dtype=torch.bfloat16) * 0.05)(H * Dh, D) * ((H * Dh) ** -0.5)),
        }
    _A_in = _A_setup()

    def _B_setup():
        B, Sq, D = 16, 192, 640
        H, Sk, Dh = 32, 512, 128
        return {
            "x": _w((lambda *s: torch.randn(*s, dtype=torch.bfloat16) * 0.8)(B, Sq, D)),
            "k_cache": _w((lambda *s: torch.randn(*s, dtype=torch.bfloat16) * 0.8)(B, H, Sk, Dh)),
            "v_cache": _w((lambda *s: torch.randn(*s, dtype=torch.bfloat16) * 0.05)(B, H, Sk, Dh)),
            "wq": _w((lambda *s: torch.randn(*s, dtype=torch.bfloat16) * 0.8)(D, H * Dh) * (D ** -0.5)),
            "wo": _w((lambda *s: torch.randn(*s, dtype=torch.bfloat16) * 0.05)(H * Dh, D) * ((H * Dh) ** -0.5)),
        }
    _B_in = _B_setup()

    return {
        "A_x": _A_in["x"],
        "A_k_cache": _A_in["k_cache"],
        "A_v_cache": _A_in["v_cache"],
        "A_wq": _A_in["wq"],
        "A_wo": _A_in["wo"],
        "B_x": _B_in["x"],
        "B_k_cache": _B_in["k_cache"],
        "B_v_cache": _B_in["v_cache"],
        "B_wq": _B_in["wq"],
        "B_wo": _B_in["wo"],
    }

def reference(A_x, A_k_cache, A_v_cache, A_wq, A_wo, B_x, B_k_cache, B_v_cache, B_wq, B_wo):
    def _A_ref(x, k_cache, v_cache, wq, wo):
        B, Sq, D = x.shape
        H, Dh = 32, 128
        q = (lambda x, *d: x.permute(*d))((x @ wq).reshape(B, Sq, H, Dh), 0, 2, 1, 3)
        scores = torch.einsum("bhqd,bhkd->bhqk", q, k_cache) * (Dh ** -0.5)
        p = _softmax(scores, axis=-1)
        o = torch.einsum("bhqk,bhkd->bhqd", p, v_cache)
        return (lambda x, *d: x.permute(*d))(o, 0, 2, 1, 3).reshape(B, Sq, H * Dh) @ wo

    def _B_ref(x, k_cache, v_cache, wq, wo):
        B, Sq, D = x.shape
        H, Dh = 32, 128
        q = (lambda x, *d: x.permute(*d))((x @ wq).reshape(B, Sq, H, Dh), 0, 2, 1, 3)
        scores = torch.einsum("bhqd,bhkd->bhqk", q, k_cache) * (Dh ** -0.5)
        p = _softmax(scores, axis=-1)
        o = torch.einsum("bhqk,bhkd->bhqd", p, v_cache)
        return (lambda x, *d: x.permute(*d))(o, 0, 2, 1, 3).reshape(B, Sq, H * Dh) @ wo

    a = _A_ref(A_x, A_k_cache, A_v_cache, A_wq, A_wo)
    b = _B_ref(B_x, B_k_cache, B_v_cache, B_wq, B_wo)
    return torch.concatenate([a, b], axis=-1)
```

```asm
; @launch grid=(256,1,1) block=(256,1,1) lds=163840
.amdgcn_target "amdgcn-amd-amdhsa--gfx950"
.text
.globl concat_heads__mha_block_cached__mha_block_cached__near_ridge_kernel
.p2align 8
.type concat_heads__mha_block_cached__mha_block_cached__near_ridge_kernel,@function
concat_heads__mha_block_cached__mha_block_cached__near_ridge_kernel:
    s_cmp_ge_u32 s2, 256
    s_cbranch_scc1 L_end
    s_bfe_u32 s5, s2, 0x10002
    s_mul_i32 s7, s5, 40
    s_add_u32 s78, s0, s7
    s_addc_u32 s79, s1, 0
    s_load_dwordx8 s[56:63], s[78:79], 0
    s_load_dwordx2 s[94:95], s[78:79], 32
    s_load_dwordx4 s[88:91], s[0:1], 88
    s_load_dwordx2 s[92:93], s[0:1], 80
    s_getpc_b64 s[96:97]
L_pc:
    s_lshr_b32 s68, s2, 3
    s_lshl_b32 s68, s68, 11
    v_lshrrev_b32 v11, 6, v0
    v_and_b32 v12, 3, v0
    v_lshlrev_b32 v11, 9, v11
    v_lshl_add_u32 v11, v12, 7, v11
    v_add_u32 v11, s68, v11
    v_min_u32 v11, L_att-L_pc, v11
    v_mov_b32 v13, s97
    v_add_co_u32 v12, vcc, s96, v11
    s_nop 1
    v_addc_co_u32 v13, vcc, 0, v13, vcc
    global_load_dword v253, v[12:13], off
    s_and_b32 s3, s2, 7
    s_lshr_b32 s4, s2, 6
    s_lshl_b32 s3, s3, 2
    s_add_u32 s3, s3, s4
    s_lshr_b32 s4, s2, 3
    s_and_b32 s4, s4, 7
    s_lshr_b32 s5, s3, 4
    s_and_b32 s6, s3, 15
    v_lshrrev_b32 v2, 6, v0
    v_and_b32 v1, 63, v0
    v_readfirstlane_b32 s46, v2
    v_lshlrev_b32 v223, 4, v1
    v_lshrrev_b32 v2, 4, v1
    v_and_b32 v3, 7, v1
    v_lshrrev_b32 v5, 3, v1
    v_and_b32 v4, 1, v2
    v_lshlrev_b32 v4, 1, v4
    v_xor_b32 v4, v4, v3
    v_lshlrev_b32 v4, 4, v4
    v_lshl_add_u32 v198, v5, 13, v4
    v_xor_b32 v199, 64, v198
    v_add_u32 v199, 64512, v199
    v_add_u32 v200, 129024, v198
    v_add_u32 v201, 129024, v199
    v_xor_b32 v4, v2, v3
    v_lshlrev_b32 v4, 4, v4
    v_mul_u32_u24 v6, 1280, v5
    v_add_u32 v202, v6, v4
    v_xor_b32 v203, 64, v202
    v_add_u32 v203, 9216, v203
    v_add_u32 v204, 18432, v202
    v_add_u32 v205, 18432, v203
    s_lshr_b32 s70, s46, 1
    s_and_b32 s71, s46, 1
    s_lshl_b32 s39, s46, 12
    s_mul_i32 s40, s46, 6144
    s_lshl_b32 s7, s4, 2
    s_add_u32 s7, s7, s70
    s_lshl_b32 s37, s71, 18
    s_lshl_b32 s43, s7, 8
    s_add_u32 s37, s37, s43
    s_mul_i32 s38, s6, 245760
    s_mul_i32 s43, s46, 61440
    s_add_u32 s38, s38, s43
    s_add_u32 s68, s3, s4
    s_and_b32 s68, s68, 3
    s_mov_b32 s69, 0x20
    s_cmp_eq_u32 s68, 1
    s_cselect_b32 s69, 0x30, s69
    s_cmp_eq_u32 s68, 2
    s_cselect_b32 s69, 0x1, s69
    s_cmp_eq_u32 s68, 3
    s_cselect_b32 s69, 0x1, s69
    s_bfe_u32 s43, s69, 0x40000
    s_lshl_b32 s44, s43, 19
    s_lshl_b32 s43, s43, 7
    s_add_u32 s84, s44, s37
    s_add_u32 s86, s43, s38
    s_add_u32 s85, s84, 128
    s_add_u32 s87, s86, 40960
    s_bfe_u32 s43, s69, 0x40004
    s_lshl_b32 s44, s43, 19
    s_lshl_b32 s43, s43, 7
    s_add_u32 s100, s44, s37
    s_add_u32 s98, s43, s38
    s_add_u32 s101, s100, 128
    s_add_u32 s99, s98, 40960
    s_waitcnt lgkmcnt(0)
    s_mov_b32 s20, s62
    s_and_b32 s21, s63, 0xffff
    s_mov_b32 s22, 5242880
    s_mov_b32 s23, 0x20000
    s_mov_b32 s16, s56
    s_and_b32 s17, s57, 0xffff
    s_mov_b32 s18, 3932160
    s_mov_b32 s19, 0x20000
    s_add_u32 m0, s39, 0
    s_nop 0
    buffer_load_dwordx4 v198, s[20:23], s84 offen sc1 lds
    buffer_load_dwordx4 v199, s[20:23], s84 offen offset:1024 sc1 lds
    buffer_load_dwordx4 v200, s[20:23], s84 offen offset:2048 sc1 lds
    buffer_load_dwordx4 v201, s[20:23], s84 offen offset:3072 sc1 lds
    s_add_u32 m0, s40, 98304
    s_nop 0
    buffer_load_dwordx4 v202, s[16:19], s86 offen sc1 lds
    buffer_load_dwordx4 v203, s[16:19], s86 offen offset:1024 sc1 lds
    buffer_load_dwordx4 v204, s[16:19], s86 offen offset:2048 sc1 lds
    buffer_load_dwordx4 v205, s[16:19], s86 offen offset:3072 sc1 lds
    s_add_u32 m0, s40, 102400
    s_nop 0
    buffer_load_dwordx4 v202, s[16:19], s87 offen sc1 lds
    buffer_load_dwordx4 v203, s[16:19], s87 offen offset:1024 sc1 lds
    s_add_u32 m0, s39, 16384
    s_nop 0
    buffer_load_dwordx4 v198, s[20:23], s85 offen sc1 lds
    buffer_load_dwordx4 v199, s[20:23], s85 offen offset:1024 sc1 lds
    buffer_load_dwordx4 v200, s[20:23], s85 offen offset:2048 sc1 lds
    buffer_load_dwordx4 v201, s[20:23], s85 offen offset:3072 sc1 lds
    s_add_u32 m0, s39, 32768
    s_nop 0
    buffer_load_dwordx4 v198, s[20:23], s100 offen sc1 lds
    buffer_load_dwordx4 v199, s[20:23], s100 offen offset:1024 sc1 lds
    buffer_load_dwordx4 v200, s[20:23], s100 offen offset:2048 sc1 lds
    buffer_load_dwordx4 v201, s[20:23], s100 offen offset:3072 sc1 lds
    s_add_u32 m0, s40, 122880
    s_nop 0
    buffer_load_dwordx4 v202, s[16:19], s98 offen sc1 lds
    buffer_load_dwordx4 v203, s[16:19], s98 offen offset:1024 sc1 lds
    buffer_load_dwordx4 v204, s[16:19], s98 offen offset:2048 sc1 lds
    buffer_load_dwordx4 v205, s[16:19], s98 offen offset:3072 sc1 lds
    s_add_u32 m0, s40, 126976
    s_nop 0
    buffer_load_dwordx4 v202, s[16:19], s99 offen sc1 lds
    buffer_load_dwordx4 v203, s[16:19], s99 offen offset:1024 sc1 lds
    s_mul_i32 s68, s6, 327680
    s_lshl_b32 s69, s4, 10
    s_add_u32 s68, s68, s69
    s_mul_i32 s69, s46, 81920
    s_add_u32 s68, s68, s69
    v_lshlrev_b32 v3, 7, v3
    v_lshl_add_u32 v6, v5, 13, v3
    v_and_b32 v4, 1, v5
    v_lshl_add_u32 v4, v4, 13, v3
    s_add_u32 s69, s68, 65536
    buffer_load_dword v254, v6, s[20:23], s68 offen
    buffer_load_dword v255, v4, s[20:23], s69 offen
    s_lshr_b32 s68, s2, 3
    s_lshl_b32 s68, s68, 2
    s_add_u32 s68, s68, s46
    s_lshl_b32 s64, s68, 8
    s_mov_b32 s28, s94
    s_and_b32 s29, s95, 0xffff
    s_mov_b32 s30, 5242880
    s_mov_b32 s31, 0x20000
    s_lshl_b32 s68, s6, 3
    s_add_u32 s68, s68, s4
    s_mul_i32 s47, s68, 40960
    s_mul_i32 s43, s46, 10240
    s_add_u32 s47, s47, s43
    s_mov_b32 s8, s58
    s_and_b32 s9, s59, 0xffff
    s_mov_b32 s10, 67108864
    s_mov_b32 s11, 0x20000
    s_mov_b32 s12, s60
    s_and_b32 s13, s61, 0xffff
    s_mov_b32 s14, 67108864
    s_mov_b32 s15, 0x20000
    s_mov_b32 s63, s101
    s_mov_b32 s24, s90
    s_and_b32 s25, s91, 0xffff
    s_mov_b32 s26, 50331648
    s_mov_b32 s27, 0x20000
    s_mov_b32 s80, s88
    s_and_b32 s81, s89, 0xffff
    s_mov_b32 s82, 256
    s_mov_b32 s83, 0x20000
    s_add_u32 s68, s90, 50331648
    s_addc_u32 s69, s91, 0
    s_mov_b32 s32, s68
    s_and_b32 s33, s69, 0xffff
    s_mov_b32 s34, 10485760
    s_mov_b32 s35, 0x20000
    s_lshl_b32 s65, s3, 2
    s_lshl_b32 s66, s5, 6
    v_cmp_eq_u32 vcc, 0, v0
    v_mov_b32 v10, 0x1000
    v_mov_b32 v224, 0x3f803f80
    v_cndmask_b32 v250, v10, 0, vcc
    v_and_b32 v10, 15, v0
    v_cmp_eq_u32 vcc, 0, v10
    s_nop 1
    v_cndmask_b32 v224, 0, v224, vcc
    v_mov_b32 v225, v224
    v_mov_b32 v226, v224
    v_mov_b32 v227, v224
    s_lshl_b32 s36, s6, 5
    s_add_u32 s36, s36, s7
    s_lshl_b32 s36, s36, 17
    s_lshl_b32 s43, s71, 12
    s_lshr_b32 s62, s2, 3
    s_lshl_b32 s44, s2, 1
    s_add_u32 s62, s62, s44
    s_and_b32 s62, s62, 15
    s_lshl_b32 s62, s62, 13
    s_add_u32 s62, s62, s43
    s_mul_i32 s41, s3, 1572864
    s_mul_i32 s43, s71, 786432
    s_add_u32 s41, s41, s43
    s_lshr_b32 s43, s4, 1
    s_mul_i32 s43, s43, 196608
    s_add_u32 s41, s41, s43
    s_and_b32 s43, s4, 1
    s_mul_i32 s43, s43, 49152
    s_add_u32 s41, s41, s43
    s_mul_i32 s43, s70, 24576
    s_add_u32 s41, s41, s43
    s_lshl_b32 s68, s6, 3
    s_add_u32 s68, s68, s4
    s_lshr_b32 s43, s68, 1
    s_and_b32 s44, s43, 0x33
    s_and_b32 s69, s43, 4
    s_lshl_b32 s69, s69, 1
    s_or_b32 s44, s44, s69
    s_and_b32 s69, s43, 8
    s_lshr_b32 s69, s69, 1
    s_or_b32 s44, s44, s69
    s_mul_i32 s48, s44, 20480
    s_and_b32 s43, s68, 1
    s_lshl_b32 s43, s43, 11
    s_add_u32 s48, s48, s43
    s_mul_i32 s43, s5, 5242880
    s_add_u32 s48, s48, s43
    s_lshl_b32 s43, s70, 12
    s_add_u32 s48, s48, s43
    s_lshl_b32 s43, s71, 10
    s_add_u32 s48, s48, s43
    s_mul_i32 s43, s70, 1290240
    s_add_u32 s49, s48, s43
    s_add_u32 s68, s3, s4
    s_and_b32 s68, s68, 3
    s_mov_b32 s50, 0x98754361
    s_cmp_eq_u32 s68, 1
    s_cselect_b32 s50, 0x98654721, s50
    s_cmp_eq_u32 s68, 2
    s_cselect_b32 s50, 0x97658324, s50
    s_cmp_eq_u32 s68, 3
    s_cselect_b32 s50, 0x87694325, s50
    s_mov_b32 s45, 0x3e0293ee
    s_mov_b32 s51, 0x53800000
    s_mov_b32 s52, 0x42200000
    s_mov_b32 s7, 0xbe0293ee
    s_mov_b32 s42, 0
    v_lshrrev_b32 v2, 4, v1
    v_and_b32 v3, 15, v1
    v_xor_b32 v4, v2, v3
    v_lshlrev_b32 v4, 4, v4
    v_lshl_add_u32 v192, v2, 8, v4
    v_xor_b32 v193, 64, v192
    v_xor_b32 v194, 128, v192
    v_xor_b32 v195, 192, v192
    v_lshlrev_b32 v5, 1, v2
    v_xor_b32 v5, v5, v3
    v_lshlrev_b32 v5, 4, v5
    v_lshl_add_u32 v196, v2, 8, v5
    v_xor_b32 v197, 128, v196
    s_lshl_b32 s69, s70, 13
    s_mul_i32 s68, s71, 12288
    s_add_u32 s68, s68, 98304
    v_bfe_u32 v8, v1, 2, 2
    v_and_b32 v9, 3, v1
    v_lshl_add_u32 v4, v3, 8, v4
    v_add_u32 v4, 16384, v4
    v_add_u32 v206, s69, v4
    v_xor_b32 v207, 64, v206
    v_xor_b32 v208, 128, v206
    v_xor_b32 v209, 192, v206
    v_lshl_add_u32 v5, v2, 2, v8
    v_lshlrev_b32 v4, 8, v5
    v_and_b32 v6, 7, v5
    v_lshl_add_u32 v4, v6, 5, v4
    v_lshl_add_u32 v4, v9, 3, v4
    v_add_u32 v4, 98304, v4
    v_add_u32 v210, s69, v4
    v_xor_b32 v211, 32, v210
    v_xor_b32 v212, 64, v210
    v_xor_b32 v213, 96, v210
    v_xor_b32 v214, 128, v210
    v_xor_b32 v215, 160, v210
    v_xor_b32 v216, 192, v210
    v_xor_b32 v217, 224, v210
    v_lshl_add_u32 v4, v2, 3, v8
    v_lshlrev_b32 v4, 7, v4
    v_and_b32 v5, 2, v8
    v_and_b32 v7, 1, v2
    v_lshl_add_u32 v5, v7, 2, v5
    v_xor_b32 v5, v5, v9
    v_lshl_add_u32 v4, v5, 4, v4
    v_add_u32 v218, s69, v4
    v_xor_b32 v219, 64, v218
    v_lshrrev_b32 v5, 1, v3
    v_xor_b32 v5, v5, v2
    v_lshlrev_b32 v5, 4, v5
    v_lshl_add_u32 v4, v3, 7, v5
    v_xor_b32 v5, 64, v4
    v_add_u32 v220, s68, v4
    v_add_u32 v221, s68, v5
    s_lshl_b32 s68, s70, 2
    s_lshl_b32 s69, s71, 3
    s_add_u32 s69, s69, 65536
    v_lshrrev_b32 v4, 1, v2
    v_lshlrev_b32 v4, 12, v4
    v_lshl_add_u32 v4, v6, 7, v4
    v_add_u32 v4, s69, v4
    v_add_u32 v5, s68, v9
    v_lshrrev_b32 v6, 1, v6
    v_xor_b32 v5, v5, v6
    v_lshl_add_u32 v222, v5, 4, v4
    s_waitcnt vmcnt(16)
    s_barrier
    ds_read_b64_tr_b16 a[192:193], v218
    ds_read_b64_tr_b16 a[194:195], v218 offset:512
    ds_read_b128 a[200:203], v220
    ds_read_b64_tr_b16 a[196:197], v218 offset:4096
    ds_read_b64_tr_b16 a[198:199], v218 offset:4608
    ds_read_b128 a[204:207], v221
    ds_read_b128 a[208:211], v220 offset:2048
    ds_read_b128 a[212:215], v221 offset:2048
    ds_read_b128 a[216:219], v220 offset:4096
    ds_read_b128 a[220:223], v221 offset:4096
    ds_read_b128 a[224:227], v220 offset:6144
    ds_read_b128 a[228:231], v221 offset:6144
    ds_read_b128 a[232:235], v220 offset:8192
    ds_read_b128 a[236:239], v221 offset:8192
    ds_read_b128 a[240:243], v220 offset:10240
    ds_read_b128 a[244:247], v221 offset:10240
    s_waitcnt lgkmcnt(13)
    v_mfma_f32_16x16x32_bf16 v[0:3], a[192:195], a[200:203], 0
    s_waitcnt lgkmcnt(10)
    v_mfma_f32_16x16x32_bf16 v[0:3], a[196:199], a[204:207], v[0:3]
    s_waitcnt lgkmcnt(9)
    v_mfma_f32_16x16x32_bf16 v[8:11], a[192:195], a[208:211], 0
    s_waitcnt lgkmcnt(8)
    v_mfma_f32_16x16x32_bf16 v[8:11], a[196:199], a[212:215], v[8:11]
    s_waitcnt lgkmcnt(7)
    v_mfma_f32_16x16x32_bf16 v[64:67], a[192:195], a[216:219], 0
    s_waitcnt lgkmcnt(6)
    ds_read_b64_tr_b16 a[248:249], v218 offset:8
    v_mfma_f32_16x16x32_bf16 v[64:67], a[196:199], a[220:223], v[64:67]
    s_waitcnt lgkmcnt(6)
    ds_read_b64_tr_b16 a[250:251], v218 offset:520
    v_mfma_f32_16x16x32_bf16 v[72:75], a[192:195], a[224:227], 0
    s_waitcnt lgkmcnt(5)
    ds_read_b64_tr_b16 a[252:253], v218 offset:4104
    v_mfma_f32_16x16x32_bf16 v[72:75], a[196:199], a[228:231], v[72:75]
    ds_read_b64_tr_b16 a[254:255], v218 offset:4616
    v_mfma_f32_16x16x32_bf16 v[128:131], a[192:195], a[232:235], 0
    s_waitcnt lgkmcnt(4)
    s_add_u32 m0, s39, 49152
    v_mfma_f32_16x16x32_bf16 v[128:131], a[196:199], a[236:239], v[128:131]
    buffer_load_dwordx4 v198, s[20:23], s63 offen lds
    v_mfma_f32_16x16x32_bf16 v[136:139], a[192:195], a[240:243], 0
    v_mfma_f32_16x16x32_bf16 v[136:139], a[196:199], a[244:247], v[136:139]
    s_waitcnt lgkmcnt(2)
    v_mfma_f32_16x16x32_bf16 v[4:7], a[248:251], a[200:203], 0
    s_waitcnt lgkmcnt(0)
    ds_read_b64_tr_b16 a[192:193], v219
    v_mfma_f32_16x16x32_bf16 v[4:7], a[252:255], a[204:207], v[4:7]
    buffer_load_dwordx4 v199, s[20:23], s63 offen offset:1024 lds
    v_mfma_f32_16x16x32_bf16 v[12:15], a[248:251], a[208:211], 0
    ds_read_b64_tr_b16 a[194:195], v219 offset:512
    v_mfma_f32_16x16x32_bf16 v[12:15], a[252:255], a[212:215], v[12:15]
    ds_read_b64_tr_b16 a[196:197], v219 offset:4096
    v_mfma_f32_16x16x32_bf16 v[68:71], a[248:251], a[216:219], 0
    ds_read_b64_tr_b16 a[198:199], v219 offset:4608
    v_mfma_f32_16x16x32_bf16 v[68:71], a[252:255], a[220:223], v[68:71]
    buffer_load_dwordx4 v200, s[20:23], s63 offen offset:2048 lds
    v_mfma_f32_16x16x32_bf16 v[76:79], a[248:251], a[224:227], 0
    v_mfma_f32_16x16x32_bf16 v[76:79], a[252:255], a[228:231], v[76:79]
    v_mfma_f32_16x16x32_bf16 v[132:135], a[248:251], a[232:235], 0
    v_mfma_f32_16x16x32_bf16 v[132:135], a[252:255], a[236:239], v[132:135]
    buffer_load_dwordx4 v201, s[20:23], s63 offen offset:3072 lds
    v_mfma_f32_16x16x32_bf16 v[140:143], a[248:251], a[240:243], 0
    v_mfma_f32_16x16x32_bf16 v[140:143], a[252:255], a[244:247], v[140:143]
    s_waitcnt lgkmcnt(1)
    v_mfma_f32_16x16x32_bf16 v[16:19], a[192:195], a[200:203], 0
    s_waitcnt lgkmcnt(0)
    ds_read_b64_tr_b16 a[248:249], v219 offset:8
    v_mfma_f32_16x16x32_bf16 v[16:19], a[196:199], a[204:207], v[16:19]
    v_mfma_f32_16x16x32_bf16 v[24:27], a[192:195], a[208:211], 0
    s_bfe_u32 s95, s50, 0x40000
    ds_read_b64_tr_b16 a[250:251], v219 offset:520
    v_mfma_f32_16x16x32_bf16 v[24:27], a[196:199], a[212:215], v[24:27]
    s_lshl_b32 s67, s95, 19
    ds_read_b64_tr_b16 a[252:253], v219 offset:4104
    v_mfma_f32_16x16x32_bf16 v[80:83], a[192:195], a[216:219], 0
    s_add_u32 s67, s67, s37
    ds_read_b64_tr_b16 a[254:255], v219 offset:4616
    v_mfma_f32_16x16x32_bf16 v[80:83], a[196:199], a[220:223], v[80:83]
    s_lshl_b32 s95, s95, 7
    v_mfma_f32_16x16x32_bf16 v[88:91], a[192:195], a[224:227], 0
    s_add_u32 s95, s95, s38
    v_mfma_f32_16x16x32_bf16 v[88:91], a[196:199], a[228:231], v[88:91]
    s_add_u32 s63, s67, 128
    v_mfma_f32_16x16x32_bf16 v[144:147], a[192:195], a[232:235], 0
    v_mfma_f32_16x16x32_bf16 v[144:147], a[196:199], a[236:239], v[144:147]
    v_mfma_f32_16x16x32_bf16 v[152:155], a[192:195], a[240:243], 0
    v_mfma_f32_16x16x32_bf16 v[152:155], a[196:199], a[244:247], v[152:155]
    s_waitcnt lgkmcnt(1)
    s_waitcnt vmcnt(16) lgkmcnt(0)
    s_barrier
    v_mfma_f32_16x16x32_bf16 v[20:23], a[248:251], a[200:203], 0
    s_add_u32 m0, s39, 0
    ds_read_b64_tr_b16 a[192:193], v218 offset:16384
    v_mfma_f32_16x16x32_bf16 v[20:23], a[252:255], a[204:207], v[20:23]
    buffer_load_dwordx4 v198, s[20:23], s67 offen lds
    v_mfma_f32_16x16x32_bf16 v[28:31], a[248:251], a[208:211], 0
    ds_read_b64_tr_b16 a[194:195], v218 offset:16896
    v_mfma_f32_16x16x32_bf16 v[28:31], a[252:255], a[212:215], v[28:31]
    ds_read_b64_tr_b16 a[196:197], v218 offset:20480
    v_mfma_f32_16x16x32_bf16 v[84:87], a[248:251], a[216:219], 0
    ds_read_b64_tr_b16 a[198:199], v218 offset:20992
    v_mfma_f32_16x16x32_bf16 v[84:87], a[252:255], a[220:223], v[84:87]
    buffer_load_dwordx4 v199, s[20:23], s67 offen offset:1024 lds
    v_mfma_f32_16x16x32_bf16 v[92:95], a[248:251], a[224:227], 0
    v_mfma_f32_16x16x32_bf16 v[92:95], a[252:255], a[228:231], v[92:95]
    v_mfma_f32_16x16x32_bf16 v[148:151], a[248:251], a[232:235], 0
    v_mfma_f32_16x16x32_bf16 v[148:151], a[252:255], a[236:239], v[148:151]
    buffer_load_dwordx4 v200, s[20:23], s67 offen offset:2048 lds
    v_mfma_f32_16x16x32_bf16 v[156:159], a[248:251], a[240:243], 0
    v_mfma_f32_16x16x32_bf16 v[156:159], a[252:255], a[244:247], v[156:159]
    s_waitcnt lgkmcnt(1)
    v_mfma_f32_16x16x32_bf16 v[32:35], a[192:195], a[200:203], 0
    s_waitcnt lgkmcnt(0)
    ds_read_b64_tr_b16 a[248:249], v218 offset:16392
    v_mfma_f32_16x16x32_bf16 v[32:35], a[196:199], a[204:207], v[32:35]
    buffer_load_dwordx4 v201, s[20:23], s67 offen offset:3072 lds
    v_mfma_f32_16x16x32_bf16 v[40:43], a[192:195], a[208:211], 0
    ds_read_b64_tr_b16 a[250:251], v218 offset:16904
    v_mfma_f32_16x16x32_bf16 v[40:43], a[196:199], a[212:215], v[40:43]
    ds_read_b64_tr_b16 a[252:253], v218 offset:20488
    v_mfma_f32_16x16x32_bf16 v[96:99], a[192:195], a[216:219], 0
    s_add_u32 m0, s40, 98304
    ds_read_b64_tr_b16 a[254:255], v218 offset:21000
    v_mfma_f32_16x16x32_bf16 v[96:99], a[196:199], a[220:223], v[96:99]
    buffer_load_dwordx4 v202, s[16:19], s95 offen lds
    v_mfma_f32_16x16x32_bf16 v[104:107], a[192:195], a[224:227], 0
    v_mfma_f32_16x16x32_bf16 v[104:107], a[196:199], a[228:231], v[104:107]
    v_mfma_f32_16x16x32_bf16 v[160:163], a[192:195], a[232:235], 0
    v_mfma_f32_16x16x32_bf16 v[160:163], a[196:199], a[236:239], v[160:163]
    buffer_load_dwordx4 v203, s[16:19], s95 offen offset:1024 lds
    v_mfma_f32_16x16x32_bf16 v[168:171], a[192:195], a[240:243], 0
    v_mfma_f32_16x16x32_bf16 v[168:171], a[196:199], a[244:247], v[168:171]
    s_waitcnt lgkmcnt(1)
    v_mfma_f32_16x16x32_bf16 v[36:39], a[248:251], a[200:203], 0
    s_waitcnt lgkmcnt(0)
    ds_read_b64_tr_b16 a[192:193], v219 offset:16384
    v_mfma_f32_16x16x32_bf16 v[36:39], a[252:255], a[204:207], v[36:39]
    buffer_load_dwordx4 v204, s[16:19], s95 offen offset:2048 lds
    v_mfma_f32_16x16x32_bf16 v[44:47], a[248:251], a[208:211], 0
    ds_read_b64_tr_b16 a[194:195], v219 offset:16896
    v_mfma_f32_16x16x32_bf16 v[44:47], a[252:255], a[212:215], v[44:47]
    ds_read_b64_tr_b16 a[196:197], v219 offset:20480
    v_mfma_f32_16x16x32_bf16 v[100:103], a[248:251], a[216:219], 0
    ds_read_b64_tr_b16 a[198:199], v219 offset:20992
    v_mfma_f32_16x16x32_bf16 v[100:103], a[252:255], a[220:223], v[100:103]
    s_add_u32 s44, s95, 40960
    buffer_load_dwordx4 v205, s[16:19], s95 offen offset:3072 lds
    v_mfma_f32_16x16x32_bf16 v[108:111], a[248:251], a[224:227], 0
    s_add_u32 m0, s40, 102400
    v_mfma_f32_16x16x32_bf16 v[108:111], a[252:255], a[228:231], v[108:111]
    buffer_load_dwordx4 v202, s[16:19], s44 offen lds
    v_mfma_f32_16x16x32_bf16 v[164:167], a[248:251], a[232:235], 0
    v_mfma_f32_16x16x32_bf16 v[164:167], a[252:255], a[236:239], v[164:167]
    s_add_u32 s54, s47, 0
    buffer_load_dwordx4 v203, s[16:19], s44 offen offset:1024 lds
    v_mfma_f32_16x16x32_bf16 v[172:175], a[248:251], a[240:243], 0
    s_add_u32 m0, s39, 65536
    v_mfma_f32_16x16x32_bf16 v[172:175], a[252:255], a[244:247], v[172:175]
    s_waitcnt lgkmcnt(1)
    buffer_load_dwordx4 v202, s[28:31], s54 offen nt lds
    s_add_u32 s54, s47, 128
    v_mfma_f32_16x16x32_bf16 v[48:51], a[192:195], a[200:203], 0
    s_waitcnt lgkmcnt(0)
    s_add_u32 m0, s39, 66560
    ds_read_b64_tr_b16 a[248:249], v219 offset:16392
    v_mfma_f32_16x16x32_bf16 v[48:51], a[196:199], a[204:207], v[48:51]
    buffer_load_dwordx4 v202, s[28:31], s54 offen nt lds
    s_add_u32 s54, s47, 256
    v_mfma_f32_16x16x32_bf16 v[56:59], a[192:195], a[208:211], 0
    s_add_u32 m0, s39, 67584
    ds_read_b64_tr_b16 a[250:251], v219 offset:16904
    v_mfma_f32_16x16x32_bf16 v[56:59], a[196:199], a[212:215], v[56:59]
    ds_read_b64_tr_b16 a[252:253], v219 offset:20488
    buffer_load_dwordx4 v202, s[28:31], s54 offen nt lds
    s_add_u32 s54, s47, 384
    v_mfma_f32_16x16x32_bf16 v[112:115], a[192:195], a[216:219], 0
    s_add_u32 m0, s39, 68608
    ds_read_b64_tr_b16 a[254:255], v219 offset:21000
    v_mfma_f32_16x16x32_bf16 v[112:115], a[196:199], a[220:223], v[112:115]
    buffer_load_dwordx4 v202, s[28:31], s54 offen nt lds
    v_mfma_f32_16x16x32_bf16 v[120:123], a[192:195], a[224:227], 0
    v_mfma_f32_16x16x32_bf16 v[120:123], a[196:199], a[228:231], v[120:123]
    s_add_u32 s54, s47, 512
    v_mfma_f32_16x16x32_bf16 v[176:179], a[192:195], a[232:235], 0
    s_add_u32 m0, s39, 81920
    v_mfma_f32_16x16x32_bf16 v[176:179], a[196:199], a[236:239], v[176:179]
    buffer_load_dwordx4 v202, s[28:31], s54 offen nt lds
    v_mfma_f32_16x16x32_bf16 v[184:187], a[192:195], a[240:243], 0
    v_mfma_f32_16x16x32_bf16 v[184:187], a[196:199], a[244:247], v[184:187]
    s_waitcnt lgkmcnt(1)
    s_waitcnt vmcnt(21) lgkmcnt(0)
    s_barrier
    v_mfma_f32_16x16x32_bf16 v[52:55], a[248:251], a[200:203], 0
    ds_read_b64_tr_b16 a[192:193], v218 offset:32768
    v_mfma_f32_16x16x32_bf16 v[52:55], a[252:255], a[204:207], v[52:55]
    ds_read_b64_tr_b16 a[194:195], v218 offset:33280
    v_mfma_f32_16x16x32_bf16 v[60:63], a[248:251], a[208:211], 0
    ds_read_b128 a[200:203], v220 offset:24576
    v_mfma_f32_16x16x32_bf16 v[60:63], a[252:255], a[212:215], v[60:63]
    ds_read_b64_tr_b16 a[196:197], v218 offset:36864
    v_mfma_f32_16x16x32_bf16 v[116:119], a[248:251], a[216:219], 0
    ds_read_b64_tr_b16 a[198:199], v218 offset:37376
    v_mfma_f32_16x16x32_bf16 v[116:119], a[252:255], a[220:223], v[116:119]
    ds_read_b128 a[204:207], v221 offset:24576
    v_mfma_f32_16x16x32_bf16 v[124:127], a[248:251], a[224:227], 0
    ds_read_b128 a[208:211], v220 offset:26624
    v_mfma_f32_16x16x32_bf16 v[124:127], a[252:255], a[228:231], v[124:127]
    ds_read_b128 a[212:215], v221 offset:26624
    v_mfma_f32_16x16x32_bf16 v[180:183], a[248:251], a[232:235], 0
    ds_read_b128 a[216:219], v220 offset:28672
    v_mfma_f32_16x16x32_bf16 v[180:183], a[252:255], a[236:239], v[180:183]
    ds_read_b128 a[220:223], v221 offset:28672
    v_mfma_f32_16x16x32_bf16 v[188:191], a[248:251], a[240:243], 0
    ds_read_b128 a[224:227], v220 offset:30720
    v_mfma_f32_16x16x32_bf16 v[188:191], a[252:255], a[244:247], v[188:191]
    s_waitcnt lgkmcnt(7)
    ds_read_b128 a[228:231], v221 offset:30720
    v_mfma_f32_16x16x32_bf16 v[0:3], a[192:195], a[200:203], v[0:3]
    s_waitcnt lgkmcnt(6)
    ds_read_b128 a[232:235], v220 offset:32768
    v_mfma_f32_16x16x32_bf16 v[0:3], a[196:199], a[204:207], v[0:3]
    s_waitcnt lgkmcnt(6)
    ds_read_b128 a[236:239], v221 offset:32768
    v_mfma_f32_16x16x32_bf16 v[8:11], a[192:195], a[208:211], v[8:11]
    s_waitcnt lgkmcnt(6)
    ds_read_b128 a[240:243], v220 offset:34816
    v_mfma_f32_16x16x32_bf16 v[8:11], a[196:199], a[212:215], v[8:11]
    s_waitcnt lgkmcnt(6)
    ds_read_b128 a[244:247], v221 offset:34816
    v_mfma_f32_16x16x32_bf16 v[64:67], a[192:195], a[216:219], v[64:67]
    s_waitcnt lgkmcnt(6)
    ds_read_b64_tr_b16 a[248:249], v218 offset:32776
    v_mfma_f32_16x16x32_bf16 v[64:67], a[196:199], a[220:223], v[64:67]
    s_waitcnt lgkmcnt(6)
    ds_read_b64_tr_b16 a[250:251], v218 offset:33288
    v_mfma_f32_16x16x32_bf16 v[72:75], a[192:195], a[224:227], v[72:75]
    s_waitcnt lgkmcnt(6)
    ds_read_b64_tr_b16 a[252:253], v218 offset:36872
    v_mfma_f32_16x16x32_bf16 v[72:75], a[196:199], a[228:231], v[72:75]
    s_waitcnt lgkmcnt(6)
    ds_read_b64_tr_b16 a[254:255], v218 offset:37384
    v_mfma_f32_16x16x32_bf16 v[128:131], a[192:195], a[232:235], v[128:131]
    s_waitcnt lgkmcnt(6)
    s_add_u32 m0, s39, 16384
    v_mfma_f32_16x16x32_bf16 v[128:131], a[196:199], a[236:239], v[128:131]
    s_waitcnt lgkmcnt(5)
    buffer_load_dwordx4 v198, s[20:23], s63 offen lds
    v_mfma_f32_16x16x32_bf16 v[136:139], a[192:195], a[240:243], v[136:139]
    s_waitcnt lgkmcnt(4)
    v_mfma_f32_16x16x32_bf16 v[136:139], a[196:199], a[244:247], v[136:139]
    s_waitcnt lgkmcnt(2)
    v_mfma_f32_16x16x32_bf16 v[4:7], a[248:251], a[200:203], v[4:7]
    s_waitcnt lgkmcnt(0)
    ds_read_b64_tr_b16 a[192:193], v219 offset:32768
    v_mfma_f32_16x16x32_bf16 v[4:7], a[252:255], a[204:207], v[4:7]
    buffer_load_dwordx4 v199, s[20:23], s63 offen offset:1024 lds
    v_mfma_f32_16x16x32_bf16 v[12:15], a[248:251], a[208:211], v[12:15]
    ds_read_b64_tr_b16 a[194:195], v219 offset:33280
    v_mfma_f32_16x16x32_bf16 v[12:15], a[252:255], a[212:215], v[12:15]
    ds_read_b64_tr_b16 a[196:197], v219 offset:36864
    v_mfma_f32_16x16x32_bf16 v[68:71], a[248:251], a[216:219], v[68:71]
    ds_read_b64_tr_b16 a[198:199], v219 offset:37376
    v_mfma_f32_16x16x32_bf16 v[68:71], a[252:255], a[220:223], v[68:71]
    buffer_load_dwordx4 v200, s[20:23], s63 offen offset:2048 lds
    v_mfma_f32_16x16x32_bf16 v[76:79], a[248:251], a[224:227], v[76:79]
    v_mfma_f32_16x16x32_bf16 v[76:79], a[252:255], a[228:231], v[76:79]
    v_mfma_f32_16x16x32_bf16 v[132:135], a[248:251], a[232:235], v[132:135]
    v_mfma_f32_16x16x32_bf16 v[132:135], a[252:255], a[236:239], v[132:135]
    buffer_load_dwordx4 v201, s[20:23], s63 offen offset:3072 lds
    v_mfma_f32_16x16x32_bf16 v[140:143], a[248:251], a[240:243], v[140:143]
    v_mfma_f32_16x16x32_bf16 v[140:143], a[252:255], a[244:247], v[140:143]
    s_waitcnt lgkmcnt(1)
    v_mfma_f32_16x16x32_bf16 v[16:19], a[192:195], a[200:203], v[16:19]
    s_waitcnt lgkmcnt(0)
    ds_read_b64_tr_b16 a[248:249], v219 offset:32776
    v_mfma_f32_16x16x32_bf16 v[16:19], a[196:199], a[204:207], v[16:19]
    v_mfma_f32_16x16x32_bf16 v[24:27], a[192:195], a[208:211], v[24:27]
    s_bfe_u32 s95, s50, 0x40004
    ds_read_b64_tr_b16 a[250:251], v219 offset:33288
    v_mfma_f32_16x16x32_bf16 v[24:27], a[196:199], a[212:215], v[24:27]
    s_lshl_b32 s67, s95, 19
    ds_read_b64_tr_b16 a[252:253], v219 offset:36872
    v_mfma_f32_16x16x32_bf16 v[80:83], a[192:195], a[216:219], v[80:83]
    s_add_u32 s67, s67, s37
    ds_read_b64_tr_b16 a[254:255], v219 offset:37384
    v_mfma_f32_16x16x32_bf16 v[80:83], a[196:199], a[220:223], v[80:83]
    s_lshl_b32 s95, s95, 7
    v_mfma_f32_16x16x32_bf16 v[88:91], a[192:195], a[224:227], v[88:91]
    s_add_u32 s95, s95, s38
    v_mfma_f32_16x16x32_bf16 v[88:91], a[196:199], a[228:231], v[88:91]
    s_add_u32 s63, s67, 128
    v_mfma_f32_16x16x32_bf16 v[144:147], a[192:195], a[232:235], v[144:147]
    v_mfma_f32_16x16x32_bf16 v[144:147], a[196:199], a[236:239], v[144:147]
    v_mfma_f32_16x16x32_bf16 v[152:155], a[192:195], a[240:243], v[152:155]
    v_mfma_f32_16x16x32_bf16 v[152:155], a[196:199], a[244:247], v[152:155]
    s_waitcnt lgkmcnt(1)
    s_waitcnt vmcnt(19) lgkmcnt(0)
    s_barrier
    v_mfma_f32_16x16x32_bf16 v[20:23], a[248:251], a[200:203], v[20:23]
    s_add_u32 m0, s39, 32768
    ds_read_b64_tr_b16 a[192:193], v218 offset:49152
    v_mfma_f32_16x16x32_bf16 v[20:23], a[252:255], a[204:207], v[20:23]
    buffer_load_dwordx4 v198, s[20:23], s67 offen lds
    v_mfma_f32_16x16x32_bf16 v[28:31], a[248:251], a[208:211], v[28:31]
    ds_read_b64_tr_b16 a[194:195], v218 offset:49664
    v_mfma_f32_16x16x32_bf16 v[28:31], a[252:255], a[212:215], v[28:31]
    ds_read_b64_tr_b16 a[196:197], v218 offset:53248
    v_mfma_f32_16x16x32_bf16 v[84:87], a[248:251], a[216:219], v[84:87]
    ds_read_b64_tr_b16 a[198:199], v218 offset:53760
    v_mfma_f32_16x16x32_bf16 v[84:87], a[252:255], a[220:223], v[84:87]
    buffer_load_dwordx4 v199, s[20:23], s67 offen offset:1024 lds
    v_mfma_f32_16x16x32_bf16 v[92:95], a[248:251], a[224:227], v[92:95]
    v_mfma_f32_16x16x32_bf16 v[92:95], a[252:255], a[228:231], v[92:95]
    v_mfma_f32_16x16x32_bf16 v[148:151], a[248:251], a[232:235], v[148:151]
    v_mfma_f32_16x16x32_bf16 v[148:151], a[252:255], a[236:239], v[148:151]
    buffer_load_dwordx4 v200, s[20:23], s67 offen offset:2048 lds
    v_mfma_f32_16x16x32_bf16 v[156:159], a[248:251], a[240:243], v[156:159]
    v_mfma_f32_16x16x32_bf16 v[156:159], a[252:255], a[244:247], v[156:159]
    s_waitcnt lgkmcnt(1)
    v_mfma_f32_16x16x32_bf16 v[32:35], a[192:195], a[200:203], v[32:35]
    s_waitcnt lgkmcnt(0)
    ds_read_b64_tr_b16 a[248:249], v218 offset:49160
    v_mfma_f32_16x16x32_bf16 v[32:35], a[196:199], a[204:207], v[32:35]
    buffer_load_dwordx4 v201, s[20:23], s67 offen offset:3072 lds
    v_mfma_f32_16x16x32_bf16 v[40:43], a[192:195], a[208:211], v[40:43]
    ds_read_b64_tr_b16 a[250:251], v218 offset:49672
    v_mfma_f32_16x16x32_bf16 v[40:43], a[196:199], a[212:215], v[40:43]
    ds_read_b64_tr_b16 a[252:253], v218 offset:53256
    v_mfma_f32_16x16x32_bf16 v[96:99], a[192:195], a[216:219], v[96:99]
    s_add_u32 m0, s40, 122880
    ds_read_b64_tr_b16 a[254:255], v218 offset:53768
    v_mfma_f32_16x16x32_bf16 v[96:99], a[196:199], a[220:223], v[96:99]
    buffer_load_dwordx4 v202, s[16:19], s95 offen lds
    v_mfma_f32_16x16x32_bf16 v[104:107], a[192:195], a[224:227], v[104:107]
    v_mfma_f32_16x16x32_bf16 v[104:107], a[196:199], a[228:231], v[104:107]
    v_mfma_f32_16x16x32_bf16 v[160:163], a[192:195], a[232:235], v[160:163]
    v_mfma_f32_16x16x32_bf16 v[160:163], a[196:199], a[236:239], v[160:163]
    buffer_load_dwordx4 v203, s[16:19], s95 offen offset:1024 lds
    v_mfma_f32_16x16x32_bf16 v[168:171], a[192:195], a[240:243], v[168:171]
    v_mfma_f32_16x16x32_bf16 v[168:171], a[196:199], a[244:247], v[168:171]
    s_waitcnt lgkmcnt(1)
    v_mfma_f32_16x16x32_bf16 v[36:39], a[248:251], a[200:203], v[36:39]
    s_waitcnt lgkmcnt(0)
    ds_read_b64_tr_b16 a[192:193], v219 offset:49152
    v_mfma_f32_16x16x32_bf16 v[36:39], a[252:255], a[204:207], v[36:39]
    buffer_load_dwordx4 v204, s[16:19], s95 offen offset:2048 lds
    v_mfma_f32_16x16x32_bf16 v[44:47], a[248:251], a[208:211], v[44:47]
    ds_read_b64_tr_b16 a[194:195], v219 offset:49664
    v_mfma_f32_16x16x32_bf16 v[44:47], a[252:255], a[212:215], v[44:47]
    ds_read_b64_tr_b16 a[196:197], v219 offset:53248
    v_mfma_f32_16x16x32_bf16 v[100:103], a[248:251], a[216:219], v[100:103]
    ds_read_b64_tr_b16 a[198:199], v219 offset:53760
    v_mfma_f32_16x16x32_bf16 v[100:103], a[252:255], a[220:223], v[100:103]
    s_add_u32 s43, s95, 40960
    buffer_load_dwordx4 v205, s[16:19], s95 offen offset:3072 lds
    v_mfma_f32_16x16x32_bf16 v[108:111], a[248:251], a[224:227], v[108:111]
    s_add_u32 m0, s40, 126976
    v_mfma_f32_16x16x32_bf16 v[108:111], a[252:255], a[228:231], v[108:111]
    buffer_load_dwordx4 v202, s[16:19], s43 offen lds
    v_mfma_f32_16x16x32_bf16 v[164:167], a[248:251], a[232:235], v[164:167]
    v_mfma_f32_16x16x32_bf16 v[164:167], a[252:255], a[236:239], v[164:167]
    s_add_u32 s54, s47, 640
    buffer_load_dwordx4 v203, s[16:19], s43 offen offset:1024 lds
    v_mfma_f32_16x16x32_bf16 v[172:175], a[248:251], a[240:243], v[172:175]
    s_add_u32 m0, s39, 82944
    v_mfma_f32_16x16x32_bf16 v[172:175], a[252:255], a[244:247], v[172:175]
    s_waitcnt lgkmcnt(1)
    buffer_load_dwordx4 v202, s[28:31], s54 offen nt lds
    s_add_u32 s54, s47, 768
    v_mfma_f32_16x16x32_bf16 v[48:51], a[192:195], a[200:203], v[48:51]
    s_waitcnt lgkmcnt(0)
    s_add_u32 m0, s39, 83968
    ds_read_b64_tr_b16 a[248:249], v219 offset:49160
    v_mfma_f32_16x16x32_bf16 v[48:51], a[196:199], a[204:207], v[48:51]
    buffer_load_dwordx4 v202, s[28:31], s54 offen nt lds
    s_add_u32 s54, s47, 896
    v_mfma_f32_16x16x32_bf16 v[56:59], a[192:195], a[208:211], v[56:59]
    s_add_u32 m0, s39, 84992
    ds_read_b64_tr_b16 a[250:251], v219 offset:49672
    v_mfma_f32_16x16x32_bf16 v[56:59], a[196:199], a[212:215], v[56:59]
    ds_read_b64_tr_b16 a[252:253], v219 offset:53256
    buffer_load_dwordx4 v202, s[28:31], s54 offen nt lds
    s_add_u32 s54, s47, 1024
    v_mfma_f32_16x16x32_bf16 v[112:115], a[192:195], a[216:219], v[112:115]
    s_add_u32 m0, s39, 147456
    ds_read_b64_tr_b16 a[254:255], v219 offset:53768
    v_mfma_f32_16x16x32_bf16 v[112:115], a[196:199], a[220:223], v[112:115]
    buffer_load_dwordx4 v202, s[28:31], s54 offen nt lds
    v_mfma_f32_16x16x32_bf16 v[120:123], a[192:195], a[224:227], v[120:123]
    v_mfma_f32_16x16x32_bf16 v[120:123], a[196:199], a[228:231], v[120:123]
    s_add_u32 s54, s47, 1152
    v_mfma_f32_16x16x32_bf16 v[176:179], a[192:195], a[232:235], v[176:179]
    s_add_u32 m0, s39, 148480
    v_mfma_f32_16x16x32_bf16 v[176:179], a[196:199], a[236:239], v[176:179]
    buffer_load_dwordx4 v202, s[28:31], s54 offen nt lds
    v_mfma_f32_16x16x32_bf16 v[184:187], a[192:195], a[240:243], v[184:187]
    v_mfma_f32_16x16x32_bf16 v[184:187], a[196:199], a[244:247], v[184:187]
    s_waitcnt lgkmcnt(1)
    s_waitcnt vmcnt(24) lgkmcnt(0)
    s_barrier
    v_mfma_f32_16x16x32_bf16 v[52:55], a[248:251], a[200:203], v[52:55]
    ds_read_b64_tr_b16 a[192:193], v218
    v_mfma_f32_16x16x32_bf16 v[52:55], a[252:255], a[204:207], v[52:55]
    ds_read_b64_tr_b16 a[194:195], v218 offset:512
    v_mfma_f32_16x16x32_bf16 v[60:63], a[248:251], a[208:211], v[60:63]
    ds_read_b128 a[200:203], v220
    v_mfma_f32_16x16x32_bf16 v[60:63], a[252:255], a[212:215], v[60:63]
    ds_read_b64_tr_b16 a[196:197], v218 offset:4096
    v_mfma_f32_16x16x32_bf16 v[116:119], a[248:251], a[216:219], v[116:119]
    ds_read_b64_tr_b16 a[198:199], v218 offset:4608
    v_mfma_f32_16x16x32_bf16 v[116:119], a[252:255], a[220:223], v[116:119]
    ds_read_b128 a[204:207], v221
    v_mfma_f32_16x16x32_bf16 v[124:127], a[248:251], a[224:227], v[124:127]
    ds_read_b128 a[208:211], v220 offset:2048
    v_mfma_f32_16x16x32_bf16 v[124:127], a[252:255], a[228:231], v[124:127]
    ds_read_b128 a[212:215], v221 offset:2048
    v_mfma_f32_16x16x32_bf16 v[180:183], a[248:251], a[232:235], v[180:183]
    ds_read_b128 a[216:219], v220 offset:4096
    v_mfma_f32_16x16x32_bf16 v[180:183], a[252:255], a[236:239], v[180:183]
    ds_read_b128 a[220:223], v221 offset:4096
    v_mfma_f32_16x16x32_bf16 v[188:191], a[248:251], a[240:243], v[188:191]
    ds_read_b128 a[224:227], v220 offset:6144
    v_mfma_f32_16x16x32_bf16 v[188:191], a[252:255], a[244:247], v[188:191]
    s_waitcnt lgkmcnt(7)
    ds_read_b128 a[228:231], v221 offset:6144
    v_mfma_f32_16x16x32_bf16 v[0:3], a[192:195], a[200:203], v[0:3]
    s_waitcnt lgkmcnt(6)
    ds_read_b128 a[232:235], v220 offset:8192
    v_mfma_f32_16x16x32_bf16 v[0:3], a[196:199], a[204:207], v[0:3]
    s_waitcnt lgkmcnt(6)
    ds_read_b128 a[236:239], v221 offset:8192
    v_mfma_f32_16x16x32_bf16 v[8:11], a[192:195], a[208:211], v[8:11]
    s_waitcnt lgkmcnt(6)
    ds_read_b128 a[240:243], v220 offset:10240
    v_mfma_f32_16x16x32_bf16 v[8:11], a[196:199], a[212:215], v[8:11]
    s_waitcnt lgkmcnt(6)
    ds_read_b128 a[244:247], v221 offset:10240
    v_mfma_f32_16x16x32_bf16 v[64:67], a[192:195], a[216:219], v[64:67]
    s_waitcnt lgkmcnt(6)
    ds_read_b64_tr_b16 a[248:249], v218 offset:8
    v_mfma_f32_16x16x32_bf16 v[64:67], a[196:199], a[220:223], v[64:67]
    s_waitcnt lgkmcnt(6)
    ds_read_b64_tr_b16 a[250:251], v218 offset:520
    v_mfma_f32_16x16x32_bf16 v[72:75], a[192:195], a[224:227], v[72:75]
    s_waitcnt lgkmcnt(6)
    ds_read_b64_tr_b16 a[252:253], v218 offset:4104
    v_mfma_f32_16x16x32_bf16 v[72:75], a[196:199], a[228:231], v[72:75]
    s_waitcnt lgkmcnt(6)
    ds_read_b64_tr_b16 a[254:255], v218 offset:4616
    v_mfma_f32_16x16x32_bf16 v[128:131], a[192:195], a[232:235], v[128:131]
    s_waitcnt lgkmcnt(6)
    s_add_u32 m0, s39, 49152
    v_mfma_f32_16x16x32_bf16 v[128:131], a[196:199], a[236:239], v[128:131]
    s_waitcnt lgkmcnt(5)
    buffer_load_dwordx4 v198, s[20:23], s63 offen lds
    v_mfma_f32_16x16x32_bf16 v[136:139], a[192:195], a[240:243], v[136:139]
    s_waitcnt lgkmcnt(4)
    v_mfma_f32_16x16x32_bf16 v[136:139], a[196:199], a[244:247], v[136:139]
    s_waitcnt lgkmcnt(2)
    v_mfma_f32_16x16x32_bf16 v[4:7], a[248:251], a[200:203], v[4:7]
    s_waitcnt lgkmcnt(0)
    ds_read_b64_tr_b16 a[192:193], v219
    v_mfma_f32_16x16x32_bf16 v[4:7], a[252:255], a[204:207], v[4:7]
    buffer_load_dwordx4 v199, s[20:23], s63 offen offset:1024 lds
    v_mfma_f32_16x16x32_bf16 v[12:15], a[248:251], a[208:211], v[12:15]
    ds_read_b64_tr_b16 a[194:195], v219 offset:512
    v_mfma_f32_16x16x32_bf16 v[12:15], a[252:255], a[212:215], v[12:15]
    ds_read_b64_tr_b16 a[196:197], v219 offset:4096
    v_mfma_f32_16x16x32_bf16 v[68:71], a[248:251], a[216:219], v[68:71]
    ds_read_b64_tr_b16 a[198:199], v219 offset:4608
    v_mfma_f32_16x16x32_bf16 v[68:71], a[252:255], a[220:223], v[68:71]
    buffer_load_dwordx4 v200, s[20:23], s63 offen offset:2048 lds
    v_mfma_f32_16x16x32_bf16 v[76:79], a[248:251], a[224:227], v[76:79]
    v_mfma_f32_16x16x32_bf16 v[76:79], a[252:255], a[228:231], v[76:79]
    v_mfma_f32_16x16x32_bf16 v[132:135], a[248:251], a[232:235], v[132:135]
    v_mfma_f32_16x16x32_bf16 v[132:135], a[252:255], a[236:239], v[132:135]
    buffer_load_dwordx4 v201, s[20:23], s63 offen offset:3072 lds
    v_mfma_f32_16x16x32_bf16 v[140:143], a[248:251], a[240:243], v[140:143]
    v_mfma_f32_16x16x32_bf16 v[140:143], a[252:255], a[244:247], v[140:143]
    s_waitcnt lgkmcnt(1)
    v_mfma_f32_16x16x32_bf16 v[16:19], a[192:195], a[200:203], v[16:19]
    s_waitcnt lgkmcnt(0)
    ds_read_b64_tr_b16 a[248:249], v219 offset:8
    v_mfma_f32_16x16x32_bf16 v[16:19], a[196:199], a[204:207], v[16:19]
    v_mfma_f32_16x16x32_bf16 v[24:27], a[192:195], a[208:211], v[24:27]
    s_bfe_u32 s95, s50, 0x40008
    ds_read_b64_tr_b16 a[250:251], v219 offset:520
    v_mfma_f32_16x16x32_bf16 v[24:27], a[196:199], a[212:215], v[24:27]
    s_lshl_b32 s67, s95, 19
    ds_read_b64_tr_b16 a[252:253], v219 offset:4104
    v_mfma_f32_16x16x32_bf16 v[80:83], a[192:195], a[216:219], v[80:83]
    s_add_u32 s67, s67, s37
    ds_read_b64_tr_b16 a[254:255], v219 offset:4616
    v_mfma_f32_16x16x32_bf16 v[80:83], a[196:199], a[220:223], v[80:83]
    s_lshl_b32 s95, s95, 7
    v_mfma_f32_16x16x32_bf16 v[88:91], a[192:195], a[224:227], v[88:91]
    s_add_u32 s95, s95, s38
    v_mfma_f32_16x16x32_bf16 v[88:91], a[196:199], a[228:231], v[88:91]
    s_add_u32 s63, s67, 128
    v_mfma_f32_16x16x32_bf16 v[144:147], a[192:195], a[232:235], v[144:147]
    v_mfma_f32_16x16x32_bf16 v[144:147], a[196:199], a[236:239], v[144:147]
    v_mfma_f32_16x16x32_bf16 v[152:155], a[192:195], a[240:243], v[152:155]
    v_mfma_f32_16x16x32_bf16 v[152:155], a[196:199], a[244:247], v[152:155]
    s_waitcnt lgkmcnt(1)
    s_waitcnt vmcnt(19) lgkmcnt(0)
    s_barrier
    v_mfma_f32_16x16x32_bf16 v[20:23], a[248:251], a[200:203], v[20:23]
    s_add_u32 m0, s39, 0
    ds_read_b64_tr_b16 a[192:193], v218 offset:16384
    v_mfma_f32_16x16x32_bf16 v[20:23], a[252:255], a[204:207], v[20:23]
    buffer_load_dwordx4 v198, s[20:23], s67 offen lds
    v_mfma_f32_16x16x32_bf16 v[28:31], a[248:251], a[208:211], v[28:31]
    ds_read_b64_tr_b16 a[194:195], v218 offset:16896
    v_mfma_f32_16x16x32_bf16 v[28:31], a[252:255], a[212:215], v[28:31]
    ds_read_b64_tr_b16 a[196:197], v218 offset:20480
    v_mfma_f32_16x16x32_bf16 v[84:87], a[248:251], a[216:219], v[84:87]
    ds_read_b64_tr_b16 a[198:199], v218 offset:20992
    v_mfma_f32_16x16x32_bf16 v[84:87], a[252:255], a[220:223], v[84:87]
    buffer_load_dwordx4 v199, s[20:23], s67 offen offset:1024 lds
    v_mfma_f32_16x16x32_bf16 v[92:95], a[248:251], a[224:227], v[92:95]
    v_mfma_f32_16x16x32_bf16 v[92:95], a[252:255], a[228:231], v[92:95]
    v_mfma_f32_16x16x32_bf16 v[148:151], a[248:251], a[232:235], v[148:151]
    v_mfma_f32_16x16x32_bf16 v[148:151], a[252:255], a[236:239], v[148:151]
    buffer_load_dwordx4 v200, s[20:23], s67 offen offset:2048 lds
    v_mfma_f32_16x16x32_bf16 v[156:159], a[248:251], a[240:243], v[156:159]
    v_mfma_f32_16x16x32_bf16 v[156:159], a[252:255], a[244:247], v[156:159]
    s_waitcnt lgkmcnt(1)
    v_mfma_f32_16x16x32_bf16 v[32:35], a[192:195], a[200:203], v[32:35]
    s_waitcnt lgkmcnt(0)
    ds_read_b64_tr_b16 a[248:249], v218 offset:16392
    v_mfma_f32_16x16x32_bf16 v[32:35], a[196:199], a[204:207], v[32:35]
    buffer_load_dwordx4 v201, s[20:23], s67 offen offset:3072 lds
    v_mfma_f32_16x16x32_bf16 v[40:43], a[192:195], a[208:211], v[40:43]
    ds_read_b64_tr_b16 a[250:251], v218 offset:16904
    v_mfma_f32_16x16x32_bf16 v[40:43], a[196:199], a[212:215], v[40:43]
    ds_read_b64_tr_b16 a[252:253], v218 offset:20488
    v_mfma_f32_16x16x32_bf16 v[96:99], a[192:195], a[216:219], v[96:99]
    s_add_u32 m0, s40, 98304
    ds_read_b64_tr_b16 a[254:255], v218 offset:21000
    v_mfma_f32_16x16x32_bf16 v[96:99], a[196:199], a[220:223], v[96:99]
    buffer_load_dwordx4 v202, s[16:19], s95 offen lds
    v_mfma_f32_16x16x32_bf16 v[104:107], a[192:195], a[224:227], v[104:107]
    v_mfma_f32_16x16x32_bf16 v[104:107], a[196:199], a[228:231], v[104:107]
    v_mfma_f32_16x16x32_bf16 v[160:163], a[192:195], a[232:235], v[160:163]
    v_mfma_f32_16x16x32_bf16 v[160:163], a[196:199], a[236:239], v[160:163]
    buffer_load_dwordx4 v203, s[16:19], s95 offen offset:1024 lds
    v_mfma_f32_16x16x32_bf16 v[168:171], a[192:195], a[240:243], v[168:171]
    v_mfma_f32_16x16x32_bf16 v[168:171], a[196:199], a[244:247], v[168:171]
    s_waitcnt lgkmcnt(1)
    v_mfma_f32_16x16x32_bf16 v[36:39], a[248:251], a[200:203], v[36:39]
    s_waitcnt lgkmcnt(0)
    ds_read_b64_tr_b16 a[192:193], v219 offset:16384
    v_mfma_f32_16x16x32_bf16 v[36:39], a[252:255], a[204:207], v[36:39]
    buffer_load_dwordx4 v204, s[16:19], s95 offen offset:2048 lds
    v_mfma_f32_16x16x32_bf16 v[44:47], a[248:251], a[208:211], v[44:47]
    ds_read_b64_tr_b16 a[194:195], v219 offset:16896
    v_mfma_f32_16x16x32_bf16 v[44:47], a[252:255], a[212:215], v[44:47]
    ds_read_b64_tr_b16 a[196:197], v219 offset:20480
    v_mfma_f32_16x16x32_bf16 v[100:103], a[248:251], a[216:219], v[100:103]
    ds_read_b64_tr_b16 a[198:199], v219 offset:20992
    v_mfma_f32_16x16x32_bf16 v[100:103], a[252:255], a[220:223], v[100:103]
    buffer_load_dwordx4 v205, s[16:19], s95 offen offset:3072 lds
    v_mfma_f32_16x16x32_bf16 v[108:111], a[248:251], a[224:227], v[108:111]
    v_mfma_f32_16x16x32_bf16 v[108:111], a[252:255], a[228:231], v[108:111]
    s_add_u32 s44, s95, 40960
    v_mfma_f32_16x16x32_bf16 v[164:167], a[248:251], a[232:235], v[164:167]
    s_add_u32 m0, s40, 102400
    v_mfma_f32_16x16x32_bf16 v[164:167], a[252:255], a[236:239], v[164:167]
    buffer_load_dwordx4 v202, s[16:19], s44 offen lds
    v_mfma_f32_16x16x32_bf16 v[172:175], a[248:251], a[240:243], v[172:175]
    v_mfma_f32_16x16x32_bf16 v[172:175], a[252:255], a[244:247], v[172:175]
    s_waitcnt lgkmcnt(1)
    v_mfma_f32_16x16x32_bf16 v[48:51], a[192:195], a[200:203], v[48:51]
    s_waitcnt lgkmcnt(0)
    ds_read_b64_tr_b16 a[248:249], v219 offset:16392
    v_mfma_f32_16x16x32_bf16 v[48:51], a[196:199], a[204:207], v[48:51]
    buffer_load_dwordx4 v203, s[16:19], s44 offen offset:1024 lds
    v_mfma_f32_16x16x32_bf16 v[56:59], a[192:195], a[208:211], v[56:59]
    ds_read_b64_tr_b16 a[250:251], v219 offset:16904
    v_mfma_f32_16x16x32_bf16 v[56:59], a[196:199], a[212:215], v[56:59]
    ds_read_b64_tr_b16 a[252:253], v219 offset:20488
    v_mfma_f32_16x16x32_bf16 v[112:115], a[192:195], a[216:219], v[112:115]
    ds_read_b64_tr_b16 a[254:255], v219 offset:21000
    v_mfma_f32_16x16x32_bf16 v[112:115], a[196:199], a[220:223], v[112:115]
    v_mfma_f32_16x16x32_bf16 v[120:123], a[192:195], a[224:227], v[120:123]
    v_mfma_f32_16x16x32_bf16 v[120:123], a[196:199], a[228:231], v[120:123]
    v_mfma_f32_16x16x32_bf16 v[176:179], a[192:195], a[232:235], v[176:179]
    v_mfma_f32_16x16x32_bf16 v[176:179], a[196:199], a[236:239], v[176:179]
    v_mfma_f32_16x16x32_bf16 v[184:187], a[192:195], a[240:243], v[184:187]
    v_mfma_f32_16x16x32_bf16 v[184:187], a[196:199], a[244:247], v[184:187]
    s_waitcnt lgkmcnt(1)
    s_waitcnt vmcnt(14) lgkmcnt(0)
    s_barrier
    v_mfma_f32_16x16x32_bf16 v[52:55], a[248:251], a[200:203], v[52:55]
    ds_read_b64_tr_b16 a[192:193], v218 offset:32768
    v_mfma_f32_16x16x32_bf16 v[52:55], a[252:255], a[204:207], v[52:55]
    ds_read_b64_tr_b16 a[194:195], v218 offset:33280
    v_mfma_f32_16x16x32_bf16 v[60:63], a[248:251], a[208:211], v[60:63]
    ds_read_b128 a[200:203], v220 offset:24576
    v_mfma_f32_16x16x32_bf16 v[60:63], a[252:255], a[212:215], v[60:63]
    ds_read_b64_tr_b16 a[196:197], v218 offset:36864
    v_mfma_f32_16x16x32_bf16 v[116:119], a[248:251], a[216:219], v[116:119]
    ds_read_b64_tr_b16 a[198:199], v218 offset:37376
    v_mfma_f32_16x16x32_bf16 v[116:119], a[252:255], a[220:223], v[116:119]
    ds_read_b128 a[204:207], v221 offset:24576
    v_mfma_f32_16x16x32_bf16 v[124:127], a[248:251], a[224:227], v[124:127]
    ds_read_b128 a[208:211], v220 offset:26624
    v_mfma_f32_16x16x32_bf16 v[124:127], a[252:255], a[228:231], v[124:127]
    ds_read_b128 a[212:215], v221 offset:26624
    v_mfma_f32_16x16x32_bf16 v[180:183], a[248:251], a[232:235], v[180:183]
    ds_read_b128 a[216:219], v220 offset:28672
    v_mfma_f32_16x16x32_bf16 v[180:183], a[252:255], a[236:239], v[180:183]
    ds_read_b128 a[220:223], v221 offset:28672
    v_mfma_f32_16x16x32_bf16 v[188:191], a[248:251], a[240:243], v[188:191]
    ds_read_b128 a[224:227], v220 offset:30720
    v_mfma_f32_16x16x32_bf16 v[188:191], a[252:255], a[244:247], v[188:191]
    s_waitcnt lgkmcnt(7)
    ds_read_b128 a[228:231], v221 offset:30720
    v_mfma_f32_16x16x32_bf16 v[0:3], a[192:195], a[200:203], v[0:3]
    s_waitcnt lgkmcnt(6)
    ds_read_b128 a[232:235], v220 offset:32768
    v_mfma_f32_16x16x32_bf16 v[0:3], a[196:199], a[204:207], v[0:3]
    s_waitcnt lgkmcnt(6)
    ds_read_b128 a[236:239], v221 offset:32768
    v_mfma_f32_16x16x32_bf16 v[8:11], a[192:195], a[208:211], v[8:11]
    s_waitcnt lgkmcnt(6)
    ds_read_b128 a[240:243], v220 offset:34816
    v_mfma_f32_16x16x32_bf16 v[8:11], a[196:199], a[212:215], v[8:11]
    s_waitcnt lgkmcnt(6)
    ds_read_b128 a[244:247], v221 offset:34816
    v_mfma_f32_16x16x32_bf16 v[64:67], a[192:195], a[216:219], v[64:67]
    s_waitcnt lgkmcnt(6)
    ds_read_b64_tr_b16 a[248:249], v218 offset:32776
    v_mfma_f32_16x16x32_bf16 v[64:67], a[196:199], a[220:223], v[64:67]
    s_waitcnt lgkmcnt(6)
    ds_read_b64_tr_b16 a[250:251], v218 offset:33288
    v_mfma_f32_16x16x32_bf16 v[72:75], a[192:195], a[224:227], v[72:75]
    s_waitcnt lgkmcnt(6)
    ds_read_b64_tr_b16 a[252:253], v218 offset:36872
    v_mfma_f32_16x16x32_bf16 v[72:75], a[196:199], a[228:231], v[72:75]
    s_waitcnt lgkmcnt(6)
    ds_read_b64_tr_b16 a[254:255], v218 offset:37384
    v_mfma_f32_16x16x32_bf16 v[128:131], a[192:195], a[232:235], v[128:131]
    s_waitcnt lgkmcnt(6)
    s_add_u32 m0, s39, 16384
    v_mfma_f32_16x16x32_bf16 v[128:131], a[196:199], a[236:239], v[128:131]
    s_waitcnt lgkmcnt(5)
    buffer_load_dwordx4 v198, s[20:23], s63 offen lds
    v_mfma_f32_16x16x32_bf16 v[136:139], a[192:195], a[240:243], v[136:139]
    s_waitcnt lgkmcnt(4)
    ds_read_b64_tr_b16 a[0:1], v222
    v_mfma_f32_16x16x32_bf16 v[136:139], a[196:199], a[244:247], v[136:139]
    s_waitcnt lgkmcnt(3)
    ds_read_b64_tr_b16 a[2:3], v222 offset:8192
    v_mfma_f32_16x16x32_bf16 v[4:7], a[248:251], a[200:203], v[4:7]
    s_waitcnt lgkmcnt(2)
    ds_read_b64_tr_b16 a[192:193], v219 offset:32768
    v_mfma_f32_16x16x32_bf16 v[4:7], a[252:255], a[204:207], v[4:7]
    buffer_load_dwordx4 v199, s[20:23], s63 offen offset:1024 lds
    v_mfma_f32_16x16x32_bf16 v[12:15], a[248:251], a[208:211], v[12:15]
    ds_read_b64_tr_b16 a[194:195], v219 offset:33280
    v_mfma_f32_16x16x32_bf16 v[12:15], a[252:255], a[212:215], v[12:15]
    ds_read_b64_tr_b16 a[196:197], v219 offset:36864
    v_mfma_f32_16x16x32_bf16 v[68:71], a[248:251], a[216:219], v[68:71]
    ds_read_b64_tr_b16 a[198:199], v219 offset:37376
    v_mfma_f32_16x16x32_bf16 v[68:71], a[252:255], a[220:223], v[68:71]
    buffer_load_dwordx4 v200, s[20:23], s63 offen offset:2048 lds
    v_mfma_f32_16x16x32_bf16 v[76:79], a[248:251], a[224:227], v[76:79]
    ds_read_b64_tr_b16 a[4:5], v222 offset:1024
    v_mfma_f32_16x16x32_bf16 v[76:79], a[252:255], a[228:231], v[76:79]
    ds_read_b64_tr_b16 a[6:7], v222 offset:9216
    v_mfma_f32_16x16x32_bf16 v[132:135], a[248:251], a[232:235], v[132:135]
    v_mfma_f32_16x16x32_bf16 v[132:135], a[252:255], a[236:239], v[132:135]
    buffer_load_dwordx4 v201, s[20:23], s63 offen offset:3072 lds
    v_mfma_f32_16x16x32_bf16 v[140:143], a[248:251], a[240:243], v[140:143]
    ds_read_b64_tr_b16 a[8:9], v222 offset:2048
    v_mfma_f32_16x16x32_bf16 v[140:143], a[252:255], a[244:247], v[140:143]
    s_waitcnt lgkmcnt(4)
    ds_read_b64_tr_b16 a[10:11], v222 offset:10240
    v_mfma_f32_16x16x32_bf16 v[16:19], a[192:195], a[200:203], v[16:19]
    s_waitcnt lgkmcnt(4)
    ds_read_b64_tr_b16 a[248:249], v219 offset:32776
    v_mfma_f32_16x16x32_bf16 v[16:19], a[196:199], a[204:207], v[16:19]
    v_mfma_f32_16x16x32_bf16 v[24:27], a[192:195], a[208:211], v[24:27]
    s_bfe_u32 s95, s50, 0x4000c
    ds_read_b64_tr_b16 a[250:251], v219 offset:33288
    v_mfma_f32_16x16x32_bf16 v[24:27], a[196:199], a[212:215], v[24:27]
    s_lshl_b32 s67, s95, 19
    ds_read_b64_tr_b16 a[252:253], v219 offset:36872
    v_mfma_f32_16x16x32_bf16 v[80:83], a[192:195], a[216:219], v[80:83]
    s_add_u32 s67, s67, s37
    ds_read_b64_tr_b16 a[254:255], v219 offset:37384
    v_mfma_f32_16x16x32_bf16 v[80:83], a[196:199], a[220:223], v[80:83]
    s_lshl_b32 s95, s95, 7
    v_mfma_f32_16x16x32_bf16 v[88:91], a[192:195], a[224:227], v[88:91]
    s_add_u32 s95, s95, s38
    ds_read_b64_tr_b16 a[12:13], v222 offset:3072
    v_mfma_f32_16x16x32_bf16 v[88:91], a[196:199], a[228:231], v[88:91]
    s_add_u32 s63, s67, 128
    ds_read_b64_tr_b16 a[14:15], v222 offset:11264
    v_mfma_f32_16x16x32_bf16 v[144:147], a[192:195], a[232:235], v[144:147]
    v_mfma_f32_16x16x32_bf16 v[144:147], a[196:199], a[236:239], v[144:147]
    v_mfma_f32_16x16x32_bf16 v[152:155], a[192:195], a[240:243], v[152:155]
    ds_read_b64_tr_b16 a[16:17], v222 offset:16384
    v_mfma_f32_16x16x32_bf16 v[152:155], a[196:199], a[244:247], v[152:155]
    s_waitcnt lgkmcnt(4)
    s_waitcnt vmcnt(14) lgkmcnt(0)
    s_barrier
    v_mfma_f32_16x16x32_bf16 v[20:23], a[248:251], a[200:203], v[20:23]
    s_add_u32 m0, s39, 32768
    ds_read_b64_tr_b16 a[192:193], v218 offset:49152
    v_mfma_f32_16x16x32_bf16 v[20:23], a[252:255], a[204:207], v[20:23]
    buffer_load_dwordx4 v198, s[20:23], s67 offen lds
    v_mfma_f32_16x16x32_bf16 v[28:31], a[248:251], a[208:211], v[28:31]
    ds_read_b64_tr_b16 a[194:195], v218 offset:49664
    v_mfma_f32_16x16x32_bf16 v[28:31], a[252:255], a[212:215], v[28:31]
    ds_read_b64_tr_b16 a[196:197], v218 offset:53248
    v_mfma_f32_16x16x32_bf16 v[84:87], a[248:251], a[216:219], v[84:87]
    ds_read_b64_tr_b16 a[198:199], v218 offset:53760
    v_mfma_f32_16x16x32_bf16 v[84:87], a[252:255], a[220:223], v[84:87]
    buffer_load_dwordx4 v199, s[20:23], s67 offen offset:1024 lds
    v_mfma_f32_16x16x32_bf16 v[92:95], a[248:251], a[224:227], v[92:95]
    ds_read_b64_tr_b16 a[18:19], v222 offset:24576
    v_mfma_f32_16x16x32_bf16 v[92:95], a[252:255], a[228:231], v[92:95]
    ds_read_b64_tr_b16 a[20:21], v222 offset:17408
    v_mfma_f32_16x16x32_bf16 v[148:151], a[248:251], a[232:235], v[148:151]
    v_mfma_f32_16x16x32_bf16 v[148:151], a[252:255], a[236:239], v[148:151]
    buffer_load_dwordx4 v200, s[20:23], s67 offen offset:2048 lds
    v_mfma_f32_16x16x32_bf16 v[156:159], a[248:251], a[240:243], v[156:159]
    ds_read_b64_tr_b16 a[22:23], v222 offset:25600
    v_mfma_f32_16x16x32_bf16 v[156:159], a[252:255], a[244:247], v[156:159]
    s_waitcnt lgkmcnt(4)
    ds_read_b64_tr_b16 a[24:25], v222 offset:18432
    v_mfma_f32_16x16x32_bf16 v[32:35], a[192:195], a[200:203], v[32:35]
    s_waitcnt lgkmcnt(4)
    ds_read_b64_tr_b16 a[248:249], v218 offset:49160
    v_mfma_f32_16x16x32_bf16 v[32:35], a[196:199], a[204:207], v[32:35]
    buffer_load_dwordx4 v201, s[20:23], s67 offen offset:3072 lds
    v_mfma_f32_16x16x32_bf16 v[40:43], a[192:195], a[208:211], v[40:43]
    ds_read_b64_tr_b16 a[250:251], v218 offset:49672
    v_mfma_f32_16x16x32_bf16 v[40:43], a[196:199], a[212:215], v[40:43]
    ds_read_b64_tr_b16 a[252:253], v218 offset:53256
    v_mfma_f32_16x16x32_bf16 v[96:99], a[192:195], a[216:219], v[96:99]
    s_add_u32 m0, s40, 122880
    ds_read_b64_tr_b16 a[254:255], v218 offset:53768
    v_mfma_f32_16x16x32_bf16 v[96:99], a[196:199], a[220:223], v[96:99]
    buffer_load_dwordx4 v202, s[16:19], s95 offen lds
    v_mfma_f32_16x16x32_bf16 v[104:107], a[192:195], a[224:227], v[104:107]
    ds_read_b64_tr_b16 a[26:27], v222 offset:26624
    v_mfma_f32_16x16x32_bf16 v[104:107], a[196:199], a[228:231], v[104:107]
    ds_read_b64_tr_b16 a[28:29], v222 offset:19456
    v_mfma_f32_16x16x32_bf16 v[160:163], a[192:195], a[232:235], v[160:163]
    v_mfma_f32_16x16x32_bf16 v[160:163], a[196:199], a[236:239], v[160:163]
    buffer_load_dwordx4 v203, s[16:19], s95 offen offset:1024 lds
    v_mfma_f32_16x16x32_bf16 v[168:171], a[192:195], a[240:243], v[168:171]
    ds_read_b64_tr_b16 a[30:31], v222 offset:27648
    v_mfma_f32_16x16x32_bf16 v[168:171], a[196:199], a[244:247], v[168:171]
    s_waitcnt lgkmcnt(4)
    v_mfma_f32_16x16x32_bf16 v[36:39], a[248:251], a[200:203], v[36:39]
    s_waitcnt lgkmcnt(3)
    ds_read_b64_tr_b16 a[192:193], v219 offset:49152
    v_mfma_f32_16x16x32_bf16 v[36:39], a[252:255], a[204:207], v[36:39]
    buffer_load_dwordx4 v204, s[16:19], s95 offen offset:2048 lds
    v_mfma_f32_16x16x32_bf16 v[44:47], a[248:251], a[208:211], v[44:47]
    ds_read_b64_tr_b16 a[194:195], v219 offset:49664
    v_mfma_f32_16x16x32_bf16 v[44:47], a[252:255], a[212:215], v[44:47]
    ds_read_b64_tr_b16 a[196:197], v219 offset:53248
    v_mfma_f32_16x16x32_bf16 v[100:103], a[248:251], a[216:219], v[100:103]
    ds_read_b64_tr_b16 a[198:199], v219 offset:53760
    v_mfma_f32_16x16x32_bf16 v[100:103], a[252:255], a[220:223], v[100:103]
    buffer_load_dwordx4 v205, s[16:19], s95 offen offset:3072 lds
    v_add_u32 v222, 49152, v222
    v_mfma_f32_16x16x32_bf16 v[108:111], a[248:251], a[224:227], v[108:111]
    ds_read_b64_tr_b16 a[32:33], v222 offset:32768
    v_mfma_f32_16x16x32_bf16 v[108:111], a[252:255], a[228:231], v[108:111]
    s_add_u32 s43, s95, 40960
    ds_read_b64_tr_b16 a[34:35], v222 offset:40960
    v_mfma_f32_16x16x32_bf16 v[164:167], a[248:251], a[232:235], v[164:167]
    s_add_u32 m0, s40, 126976
    v_mfma_f32_16x16x32_bf16 v[164:167], a[252:255], a[236:239], v[164:167]
    buffer_load_dwordx4 v202, s[16:19], s43 offen lds
    v_mfma_f32_16x16x32_bf16 v[172:175], a[248:251], a[240:243], v[172:175]
    ds_read_b64_tr_b16 a[36:37], v222 offset:33792
    v_mfma_f32_16x16x32_bf16 v[172:175], a[252:255], a[244:247], v[172:175]
    s_waitcnt lgkmcnt(4)
    ds_read_b64_tr_b16 a[38:39], v222 offset:41984
    v_mfma_f32_16x16x32_bf16 v[48:51], a[192:195], a[200:203], v[48:51]
    s_waitcnt lgkmcnt(4)
    ds_read_b64_tr_b16 a[248:249], v219 offset:49160
    v_mfma_f32_16x16x32_bf16 v[48:51], a[196:199], a[204:207], v[48:51]
    buffer_load_dwordx4 v203, s[16:19], s43 offen offset:1024 lds
    v_mfma_f32_16x16x32_bf16 v[56:59], a[192:195], a[208:211], v[56:59]
    ds_read_b64_tr_b16 a[250:251], v219 offset:49672
    v_mfma_f32_16x16x32_bf16 v[56:59], a[196:199], a[212:215], v[56:59]
    ds_read_b64_tr_b16 a[252:253], v219 offset:53256
    v_mfma_f32_16x16x32_bf16 v[112:115], a[192:195], a[216:219], v[112:115]
    s_add_u32 s55, s48, 0
    ds_read_b64_tr_b16 a[254:255], v219 offset:53768
    v_mfma_f32_16x16x32_bf16 v[112:115], a[196:199], a[220:223], v[112:115]
    buffer_store_dwordx4 a[0:3], v223, s[32:35], s55 offen sc1
    v_mfma_f32_16x16x32_bf16 v[120:123], a[192:195], a[224:227], v[120:123]
    v_mfma_f32_16x16x32_bf16 v[120:123], a[196:199], a[228:231], v[120:123]
    v_mfma_f32_16x16x32_bf16 v[176:179], a[192:195], a[232:235], v[176:179]
    s_add_u32 s55, s48, 8192
    v_mfma_f32_16x16x32_bf16 v[176:179], a[196:199], a[236:239], v[176:179]
    buffer_store_dwordx4 a[4:7], v223, s[32:35], s55 offen sc1
    v_mfma_f32_16x16x32_bf16 v[184:187], a[192:195], a[240:243], v[184:187]
    v_mfma_f32_16x16x32_bf16 v[184:187], a[196:199], a[244:247], v[184:187]
    s_waitcnt lgkmcnt(1)
    s_waitcnt vmcnt(16) lgkmcnt(0)
    s_barrier
    v_mfma_f32_16x16x32_bf16 v[52:55], a[248:251], a[200:203], v[52:55]
    ds_read_b64_tr_b16 a[192:193], v218
    v_mfma_f32_16x16x32_bf16 v[52:55], a[252:255], a[204:207], v[52:55]
    ds_read_b64_tr_b16 a[194:195], v218 offset:512
    v_mfma_f32_16x16x32_bf16 v[60:63], a[248:251], a[208:211], v[60:63]
    ds_read_b128 a[200:203], v220
    v_mfma_f32_16x16x32_bf16 v[60:63], a[252:255], a[212:215], v[60:63]
    ds_read_b64_tr_b16 a[196:197], v218 offset:4096
    v_mfma_f32_16x16x32_bf16 v[116:119], a[248:251], a[216:219], v[116:119]
    ds_read_b64_tr_b16 a[198:199], v218 offset:4608
    v_mfma_f32_16x16x32_bf16 v[116:119], a[252:255], a[220:223], v[116:119]
    ds_read_b128 a[204:207], v221
    v_mfma_f32_16x16x32_bf16 v[124:127], a[248:251], a[224:227], v[124:127]
    ds_read_b128 a[208:211], v220 offset:2048
    v_mfma_f32_16x16x32_bf16 v[124:127], a[252:255], a[228:231], v[124:127]
    ds_read_b128 a[212:215], v221 offset:2048
    v_mfma_f32_16x16x32_bf16 v[180:183], a[248:251], a[232:235], v[180:183]
    ds_read_b128 a[216:219], v220 offset:4096
    v_mfma_f32_16x16x32_bf16 v[180:183], a[252:255], a[236:239], v[180:183]
    ds_read_b128 a[220:223], v221 offset:4096
    v_mfma_f32_16x16x32_bf16 v[188:191], a[248:251], a[240:243], v[188:191]
    ds_read_b128 a[224:227], v220 offset:6144
    v_mfma_f32_16x16x32_bf16 v[188:191], a[252:255], a[244:247], v[188:191]
    s_waitcnt lgkmcnt(7)
    ds_read_b128 a[228:231], v221 offset:6144
    v_mfma_f32_16x16x32_bf16 v[0:3], a[192:195], a[200:203], v[0:3]
    s_waitcnt lgkmcnt(6)
    ds_read_b128 a[232:235], v220 offset:8192
    v_mfma_f32_16x16x32_bf16 v[0:3], a[196:199], a[204:207], v[0:3]
    s_waitcnt lgkmcnt(6)
    ds_read_b128 a[236:239], v221 offset:8192
    v_mfma_f32_16x16x32_bf16 v[8:11], a[192:195], a[208:211], v[8:11]
    s_waitcnt lgkmcnt(6)
    ds_read_b128 a[240:243], v220 offset:10240
    v_mfma_f32_16x16x32_bf16 v[8:11], a[196:199], a[212:215], v[8:11]
    s_waitcnt lgkmcnt(6)
    ds_read_b128 a[244:247], v221 offset:10240
    v_mfma_f32_16x16x32_bf16 v[64:67], a[192:195], a[216:219], v[64:67]
    s_waitcnt lgkmcnt(6)
    ds_read_b64_tr_b16 a[248:249], v218 offset:8
    v_mfma_f32_16x16x32_bf16 v[64:67], a[196:199], a[220:223], v[64:67]
    s_waitcnt lgkmcnt(6)
    ds_read_b64_tr_b16 a[250:251], v218 offset:520
    v_mfma_f32_16x16x32_bf16 v[72:75], a[192:195], a[224:227], v[72:75]
    s_waitcnt lgkmcnt(6)
    ds_read_b64_tr_b16 a[252:253], v218 offset:4104
    v_mfma_f32_16x16x32_bf16 v[72:75], a[196:199], a[228:231], v[72:75]
    s_waitcnt lgkmcnt(6)
    ds_read_b64_tr_b16 a[254:255], v218 offset:4616
    v_mfma_f32_16x16x32_bf16 v[128:131], a[192:195], a[232:235], v[128:131]
    s_waitcnt lgkmcnt(6)
    s_add_u32 m0, s39, 49152
    v_mfma_f32_16x16x32_bf16 v[128:131], a[196:199], a[236:239], v[128:131]
    s_waitcnt lgkmcnt(5)
    buffer_load_dwordx4 v198, s[20:23], s63 offen lds
    v_mfma_f32_16x16x32_bf16 v[136:139], a[192:195], a[240:243], v[136:139]
    s_waitcnt lgkmcnt(4)
    v_mfma_f32_16x16x32_bf16 v[136:139], a[196:199], a[244:247], v[136:139]
    s_waitcnt lgkmcnt(2)
    v_mfma_f32_16x16x32_bf16 v[4:7], a[248:251], a[200:203], v[4:7]
    s_waitcnt lgkmcnt(0)
    ds_read_b64_tr_b16 a[192:193], v219
    v_mfma_f32_16x16x32_bf16 v[4:7], a[252:255], a[204:207], v[4:7]
    buffer_load_dwordx4 v199, s[20:23], s63 offen offset:1024 lds
    v_mfma_f32_16x16x32_bf16 v[12:15], a[248:251], a[208:211], v[12:15]
    ds_read_b64_tr_b16 a[194:195], v219 offset:512
    v_mfma_f32_16x16x32_bf16 v[12:15], a[252:255], a[212:215], v[12:15]
    ds_read_b64_tr_b16 a[196:197], v219 offset:4096
    v_mfma_f32_16x16x32_bf16 v[68:71], a[248:251], a[216:219], v[68:71]
    ds_read_b64_tr_b16 a[198:199], v219 offset:4608
    v_mfma_f32_16x16x32_bf16 v[68:71], a[252:255], a[220:223], v[68:71]
    buffer_load_dwordx4 v200, s[20:23], s63 offen offset:2048 lds
    v_mfma_f32_16x16x32_bf16 v[76:79], a[248:251], a[224:227], v[76:79]
    v_mfma_f32_16x16x32_bf16 v[76:79], a[252:255], a[228:231], v[76:79]
    v_mfma_f32_16x16x32_bf16 v[132:135], a[248:251], a[232:235], v[132:135]
    v_mfma_f32_16x16x32_bf16 v[132:135], a[252:255], a[236:239], v[132:135]
    buffer_load_dwordx4 v201, s[20:23], s63 offen offset:3072 lds
    v_mfma_f32_16x16x32_bf16 v[140:143], a[248:251], a[240:243], v[140:143]
    v_mfma_f32_16x16x32_bf16 v[140:143], a[252:255], a[244:247], v[140:143]
    s_waitcnt lgkmcnt(1)
    v_mfma_f32_16x16x32_bf16 v[16:19], a[192:195], a[200:203], v[16:19]
    s_waitcnt lgkmcnt(0)
    ds_read_b64_tr_b16 a[248:249], v219 offset:8
    v_mfma_f32_16x16x32_bf16 v[16:19], a[196:199], a[204:207], v[16:19]
    v_mfma_f32_16x16x32_bf16 v[24:27], a[192:195], a[208:211], v[24:27]
    s_bfe_u32 s95, s50, 0x40010
    ds_read_b64_tr_b16 a[250:251], v219 offset:520
    v_mfma_f32_16x16x32_bf16 v[24:27], a[196:199], a[212:215], v[24:27]
    s_lshl_b32 s67, s95, 19
    ds_read_b64_tr_b16 a[252:253], v219 offset:4104
    v_mfma_f32_16x16x32_bf16 v[80:83], a[192:195], a[216:219], v[80:83]
    s_add_u32 s67, s67, s37
    ds_read_b64_tr_b16 a[254:255], v219 offset:4616
    v_mfma_f32_16x16x32_bf16 v[80:83], a[196:199], a[220:223], v[80:83]
    s_lshl_b32 s95, s95, 7
    v_mfma_f32_16x16x32_bf16 v[88:91], a[192:195], a[224:227], v[88:91]
    s_add_u32 s95, s95, s38
    v_mfma_f32_16x16x32_bf16 v[88:91], a[196:199], a[228:231], v[88:91]
    s_add_u32 s63, s67, 128
    v_mfma_f32_16x16x32_bf16 v[144:147], a[192:195], a[232:235], v[144:147]
    v_mfma_f32_16x16x32_bf16 v[144:147], a[196:199], a[236:239], v[144:147]
    v_mfma_f32_16x16x32_bf16 v[152:155], a[192:195], a[240:243], v[152:155]
    v_mfma_f32_16x16x32_bf16 v[152:155], a[196:199], a[244:247], v[152:155]
    s_waitcnt lgkmcnt(1)
    s_waitcnt vmcnt(16) lgkmcnt(0)
    s_barrier
    v_mfma_f32_16x16x32_bf16 v[20:23], a[248:251], a[200:203], v[20:23]
    s_add_u32 m0, s39, 0
    ds_read_b64_tr_b16 a[192:193], v218 offset:16384
    v_mfma_f32_16x16x32_bf16 v[20:23], a[252:255], a[204:207], v[20:23]
    buffer_load_dwordx4 v198, s[20:23], s67 offen lds
    v_mfma_f32_16x16x32_bf16 v[28:31], a[248:251], a[208:211], v[28:31]
    ds_read_b64_tr_b16 a[194:195], v218 offset:16896
    v_mfma_f32_16x16x32_bf16 v[28:31], a[252:255], a[212:215], v[28:31]
    ds_read_b64_tr_b16 a[196:197], v218 offset:20480
    v_mfma_f32_16x16x32_bf16 v[84:87], a[248:251], a[216:219], v[84:87]
    ds_read_b64_tr_b16 a[198:199], v218 offset:20992
    v_mfma_f32_16x16x32_bf16 v[84:87], a[252:255], a[220:223], v[84:87]
    buffer_load_dwordx4 v199, s[20:23], s67 offen offset:1024 lds
    v_mfma_f32_16x16x32_bf16 v[92:95], a[248:251], a[224:227], v[92:95]
    v_mfma_f32_16x16x32_bf16 v[92:95], a[252:255], a[228:231], v[92:95]
    v_mfma_f32_16x16x32_bf16 v[148:151], a[248:251], a[232:235], v[148:151]
    v_mfma_f32_16x16x32_bf16 v[148:151], a[252:255], a[236:239], v[148:151]
    buffer_load_dwordx4 v200, s[20:23], s67 offen offset:2048 lds
    v_mfma_f32_16x16x32_bf16 v[156:159], a[248:251], a[240:243], v[156:159]
    v_mfma_f32_16x16x32_bf16 v[156:159], a[252:255], a[244:247], v[156:159]
    s_waitcnt lgkmcnt(1)
    v_mfma_f32_16x16x32_bf16 v[32:35], a[192:195], a[200:203], v[32:35]
    s_waitcnt lgkmcnt(0)
    ds_read_b64_tr_b16 a[248:249], v218 offset:16392
    v_mfma_f32_16x16x32_bf16 v[32:35], a[196:199], a[204:207], v[32:35]
    buffer_load_dwordx4 v201, s[20:23], s67 offen offset:3072 lds
    v_mfma_f32_16x16x32_bf16 v[40:43], a[192:195], a[208:211], v[40:43]
    ds_read_b64_tr_b16 a[250:251], v218 offset:16904
    v_mfma_f32_16x16x32_bf16 v[40:43], a[196:199], a[212:215], v[40:43]
    ds_read_b64_tr_b16 a[252:253], v218 offset:20488
    v_mfma_f32_16x16x32_bf16 v[96:99], a[192:195], a[216:219], v[96:99]
    s_add_u32 m0, s40, 98304
    ds_read_b64_tr_b16 a[254:255], v218 offset:21000
    v_mfma_f32_16x16x32_bf16 v[96:99], a[196:199], a[220:223], v[96:99]
    buffer_load_dwordx4 v202, s[16:19], s95 offen lds
    v_mfma_f32_16x16x32_bf16 v[104:107], a[192:195], a[224:227], v[104:107]
    v_mfma_f32_16x16x32_bf16 v[104:107], a[196:199], a[228:231], v[104:107]
    v_mfma_f32_16x16x32_bf16 v[160:163], a[192:195], a[232:235], v[160:163]
    v_mfma_f32_16x16x32_bf16 v[160:163], a[196:199], a[236:239], v[160:163]
    buffer_load_dwordx4 v203, s[16:19], s95 offen offset:1024 lds
    v_mfma_f32_16x16x32_bf16 v[168:171], a[192:195], a[240:243], v[168:171]
    v_mfma_f32_16x16x32_bf16 v[168:171], a[196:199], a[244:247], v[168:171]
    s_waitcnt lgkmcnt(1)
    v_mfma_f32_16x16x32_bf16 v[36:39], a[248:251], a[200:203], v[36:39]
    s_waitcnt lgkmcnt(0)
    ds_read_b64_tr_b16 a[192:193], v219 offset:16384
    v_mfma_f32_16x16x32_bf16 v[36:39], a[252:255], a[204:207], v[36:39]
    buffer_load_dwordx4 v204, s[16:19], s95 offen offset:2048 lds
    v_mfma_f32_16x16x32_bf16 v[44:47], a[248:251], a[208:211], v[44:47]
    ds_read_b64_tr_b16 a[194:195], v219 offset:16896
    v_mfma_f32_16x16x32_bf16 v[44:47], a[252:255], a[212:215], v[44:47]
    ds_read_b64_tr_b16 a[196:197], v219 offset:20480
    v_mfma_f32_16x16x32_bf16 v[100:103], a[248:251], a[216:219], v[100:103]
    ds_read_b64_tr_b16 a[198:199], v219 offset:20992
    v_mfma_f32_16x16x32_bf16 v[100:103], a[252:255], a[220:223], v[100:103]
    s_add_u32 s44, s95, 40960
    buffer_load_dwordx4 v205, s[16:19], s95 offen offset:3072 lds
    v_mfma_f32_16x16x32_bf16 v[108:111], a[248:251], a[224:227], v[108:111]
    s_add_u32 m0, s40, 102400
    v_mfma_f32_16x16x32_bf16 v[108:111], a[252:255], a[228:231], v[108:111]
    s_add_u32 s54, s62, 0
    buffer_load_dwordx4 v202, s[16:19], s44 offen lds
    v_mfma_f32_16x16x32_bf16 v[164:167], a[248:251], a[232:235], v[164:167]
    s_and_b32 s54, s54, 0x1ffff
    v_mfma_f32_16x16x32_bf16 v[164:167], a[252:255], a[236:239], v[164:167]
    s_add_u32 s54, s54, s36
    buffer_load_dwordx4 v203, s[16:19], s44 offen offset:1024 lds
    v_mfma_f32_16x16x32_bf16 v[172:175], a[248:251], a[240:243], v[172:175]
    s_add_u32 m0, s39, 81920
    v_mfma_f32_16x16x32_bf16 v[172:175], a[252:255], a[244:247], v[172:175]
    s_waitcnt lgkmcnt(1)
    buffer_load_dwordx4 v192, s[8:11], s54 offen nt lds
    v_mfma_f32_16x16x32_bf16 v[48:51], a[192:195], a[200:203], v[48:51]
    s_waitcnt lgkmcnt(0)
    ds_read_b64_tr_b16 a[248:249], v219 offset:16392
    v_mfma_f32_16x16x32_bf16 v[48:51], a[196:199], a[204:207], v[48:51]
    buffer_load_dwordx4 v193, s[8:11], s54 offen offset:1024 nt lds
    v_mfma_f32_16x16x32_bf16 v[56:59], a[192:195], a[208:211], v[56:59]
    ds_read_b64_tr_b16 a[250:251], v219 offset:16904
    v_mfma_f32_16x16x32_bf16 v[56:59], a[196:199], a[212:215], v[56:59]
    ds_read_b64_tr_b16 a[252:253], v219 offset:20488
    v_mfma_f32_16x16x32_bf16 v[112:115], a[192:195], a[216:219], v[112:115]
    ds_read_b64_tr_b16 a[254:255], v219 offset:21000
    v_mfma_f32_16x16x32_bf16 v[112:115], a[196:199], a[220:223], v[112:115]
    buffer_load_dwordx4 v194, s[8:11], s54 offen offset:2048 nt lds
    v_mfma_f32_16x16x32_bf16 v[120:123], a[192:195], a[224:227], v[120:123]
    s_add_u32 s55, s49, 16384
    v_mfma_f32_16x16x32_bf16 v[120:123], a[196:199], a[228:231], v[120:123]
    buffer_store_dwordx4 a[8:11], v223, s[32:35], s55 offen sc1
    v_mfma_f32_16x16x32_bf16 v[176:179], a[192:195], a[232:235], v[176:179]
    v_mfma_f32_16x16x32_bf16 v[176:179], a[196:199], a[236:239], v[176:179]
    s_add_u32 s55, s48, 1314816
    buffer_load_dwordx4 v195, s[8:11], s54 offen offset:3072 nt lds
    v_mfma_f32_16x16x32_bf16 v[184:187], a[192:195], a[240:243], v[184:187]
    buffer_store_dwordx4 a[12:15], v223, s[32:35], s55 offen sc1
    v_mfma_f32_16x16x32_bf16 v[184:187], a[196:199], a[244:247], v[184:187]
    s_waitcnt lgkmcnt(1)
    s_waitcnt vmcnt(22) lgkmcnt(0)
    s_barrier
    v_mfma_f32_16x16x32_bf16 v[52:55], a[248:251], a[200:203], v[52:55]
    ds_read_b64_tr_b16 a[192:193], v218 offset:32768
    v_mfma_f32_16x16x32_bf16 v[52:55], a[252:255], a[204:207], v[52:55]
    ds_read_b64_tr_b16 a[194:195], v218 offset:33280
    v_mfma_f32_16x16x32_bf16 v[60:63], a[248:251], a[208:211], v[60:63]
    ds_read_b128 a[200:203], v220 offset:24576
    v_mfma_f32_16x16x32_bf16 v[60:63], a[252:255], a[212:215], v[60:63]
    ds_read_b64_tr_b16 a[196:197], v218 offset:36864
    v_mfma_f32_16x16x32_bf16 v[116:119], a[248:251], a[216:219], v[116:119]
    ds_read_b64_tr_b16 a[198:199], v218 offset:37376
    v_mfma_f32_16x16x32_bf16 v[116:119], a[252:255], a[220:223], v[116:119]
    ds_read_b128 a[204:207], v221 offset:24576
    v_mfma_f32_16x16x32_bf16 v[124:127], a[248:251], a[224:227], v[124:127]
    ds_read_b128 a[208:211], v220 offset:26624
    v_mfma_f32_16x16x32_bf16 v[124:127], a[252:255], a[228:231], v[124:127]
    ds_read_b128 a[212:215], v221 offset:26624
    v_mfma_f32_16x16x32_bf16 v[180:183], a[248:251], a[232:235], v[180:183]
    ds_read_b128 a[216:219], v220 offset:28672
    v_mfma_f32_16x16x32_bf16 v[180:183], a[252:255], a[236:239], v[180:183]
    ds_read_b128 a[220:223], v221 offset:28672
    v_mfma_f32_16x16x32_bf16 v[188:191], a[248:251], a[240:243], v[188:191]
    ds_read_b128 a[224:227], v220 offset:30720
    v_mfma_f32_16x16x32_bf16 v[188:191], a[252:255], a[244:247], v[188:191]
    s_waitcnt lgkmcnt(7)
    ds_read_b128 a[228:231], v221 offset:30720
    v_mfma_f32_16x16x32_bf16 v[0:3], a[192:195], a[200:203], v[0:3]
    s_waitcnt lgkmcnt(6)
    ds_read_b128 a[232:235], v220 offset:32768
    v_mfma_f32_16x16x32_bf16 v[0:3], a[196:199], a[204:207], v[0:3]
    s_waitcnt lgkmcnt(6)
    ds_read_b128 a[236:239], v221 offset:32768
    v_mfma_f32_16x16x32_bf16 v[8:11], a[192:195], a[208:211], v[8:11]
    s_waitcnt lgkmcnt(6)
    ds_read_b128 a[240:243], v220 offset:34816
    v_mfma_f32_16x16x32_bf16 v[8:11], a[196:199], a[212:215], v[8:11]
    s_waitcnt lgkmcnt(6)
    ds_read_b128 a[244:247], v221 offset:34816
    v_mfma_f32_16x16x32_bf16 v[64:67], a[192:195], a[216:219], v[64:67]
    s_waitcnt lgkmcnt(6)
    ds_read_b64_tr_b16 a[248:249], v218 offset:32776
    v_mfma_f32_16x16x32_bf16 v[64:67], a[196:199], a[220:223], v[64:67]
    s_waitcnt lgkmcnt(6)
    ds_read_b64_tr_b16 a[250:251], v218 offset:33288
    v_mfma_f32_16x16x32_bf16 v[72:75], a[192:195], a[224:227], v[72:75]
    s_waitcnt lgkmcnt(6)
    ds_read_b64_tr_b16 a[252:253], v218 offset:36872
    v_mfma_f32_16x16x32_bf16 v[72:75], a[196:199], a[228:231], v[72:75]
    s_waitcnt lgkmcnt(6)
    ds_read_b64_tr_b16 a[254:255], v218 offset:37384
    v_mfma_f32_16x16x32_bf16 v[128:131], a[192:195], a[232:235], v[128:131]
    s_waitcnt lgkmcnt(6)
    s_add_u32 m0, s39, 16384
    v_mfma_f32_16x16x32_bf16 v[128:131], a[196:199], a[236:239], v[128:131]
    s_waitcnt lgkmcnt(5)
    buffer_load_dwordx4 v198, s[20:23], s63 offen lds
    v_mfma_f32_16x16x32_bf16 v[136:139], a[192:195], a[240:243], v[136:139]
    s_waitcnt lgkmcnt(4)
    v_mfma_f32_16x16x32_bf16 v[136:139], a[196:199], a[244:247], v[136:139]
    s_waitcnt lgkmcnt(2)
    v_mfma_f32_16x16x32_bf16 v[4:7], a[248:251], a[200:203], v[4:7]
    s_waitcnt lgkmcnt(0)
    ds_read_b64_tr_b16 a[192:193], v219 offset:32768
    v_mfma_f32_16x16x32_bf16 v[4:7], a[252:255], a[204:207], v[4:7]
    buffer_load_dwordx4 v199, s[20:23], s63 offen offset:1024 lds
    v_mfma_f32_16x16x32_bf16 v[12:15], a[248:251], a[208:211], v[12:15]
    ds_read_b64_tr_b16 a[194:195], v219 offset:33280
    v_mfma_f32_16x16x32_bf16 v[12:15], a[252:255], a[212:215], v[12:15]
    ds_read_b64_tr_b16 a[196:197], v219 offset:36864
    v_mfma_f32_16x16x32_bf16 v[68:71], a[248:251], a[216:219], v[68:71]
    ds_read_b64_tr_b16 a[198:199], v219 offset:37376
    v_mfma_f32_16x16x32_bf16 v[68:71], a[252:255], a[220:223], v[68:71]
    buffer_load_dwordx4 v200, s[20:23], s63 offen offset:2048 lds
    v_mfma_f32_16x16x32_bf16 v[76:79], a[248:251], a[224:227], v[76:79]
    v_mfma_f32_16x16x32_bf16 v[76:79], a[252:255], a[228:231], v[76:79]
    v_mfma_f32_16x16x32_bf16 v[132:135], a[248:251], a[232:235], v[132:135]
    v_mfma_f32_16x16x32_bf16 v[132:135], a[252:255], a[236:239], v[132:135]
    buffer_load_dwordx4 v201, s[20:23], s63 offen offset:3072 lds
    v_mfma_f32_16x16x32_bf16 v[140:143], a[248:251], a[240:243], v[140:143]
    v_mfma_f32_16x16x32_bf16 v[140:143], a[252:255], a[244:247], v[140:143]
    s_waitcnt lgkmcnt(1)
    v_mfma_f32_16x16x32_bf16 v[16:19], a[192:195], a[200:203], v[16:19]
    s_waitcnt lgkmcnt(0)
    ds_read_b64_tr_b16 a[248:249], v219 offset:32776
    v_mfma_f32_16x16x32_bf16 v[16:19], a[196:199], a[204:207], v[16:19]
    v_mfma_f32_16x16x32_bf16 v[24:27], a[192:195], a[208:211], v[24:27]
    s_bfe_u32 s95, s50, 0x40014
    ds_read_b64_tr_b16 a[250:251], v219 offset:33288
    v_mfma_f32_16x16x32_bf16 v[24:27], a[196:199], a[212:215], v[24:27]
    s_lshl_b32 s67, s95, 19
    ds_read_b64_tr_b16 a[252:253], v219 offset:36872
    v_mfma_f32_16x16x32_bf16 v[80:83], a[192:195], a[216:219], v[80:83]
    s_add_u32 s67, s67, s37
    ds_read_b64_tr_b16 a[254:255], v219 offset:37384
    v_mfma_f32_16x16x32_bf16 v[80:83], a[196:199], a[220:223], v[80:83]
    s_lshl_b32 s95, s95, 7
    v_mfma_f32_16x16x32_bf16 v[88:91], a[192:195], a[224:227], v[88:91]
    s_add_u32 s95, s95, s38
    v_mfma_f32_16x16x32_bf16 v[88:91], a[196:199], a[228:231], v[88:91]
    s_add_u32 s63, s67, 128
    v_mfma_f32_16x16x32_bf16 v[144:147], a[192:195], a[232:235], v[144:147]
    v_mfma_f32_16x16x32_bf16 v[144:147], a[196:199], a[236:239], v[144:147]
    v_mfma_f32_16x16x32_bf16 v[152:155], a[192:195], a[240:243], v[152:155]
    v_mfma_f32_16x16x32_bf16 v[152:155], a[196:199], a[244:247], v[152:155]
    s_waitcnt lgkmcnt(1)
    s_waitcnt vmcnt(20) lgkmcnt(0)
    s_barrier
    v_mfma_f32_16x16x32_bf16 v[20:23], a[248:251], a[200:203], v[20:23]
    s_add_u32 m0, s39, 32768
    ds_read_b64_tr_b16 a[192:193], v218 offset:49152
    v_mfma_f32_16x16x32_bf16 v[20:23], a[252:255], a[204:207], v[20:23]
    buffer_load_dwordx4 v198, s[20:23], s67 offen lds
    v_mfma_f32_16x16x32_bf16 v[28:31], a[248:251], a[208:211], v[28:31]
    ds_read_b64_tr_b16 a[194:195], v218 offset:49664
    v_mfma_f32_16x16x32_bf16 v[28:31], a[252:255], a[212:215], v[28:31]
    ds_read_b64_tr_b16 a[196:197], v218 offset:53248
    v_mfma_f32_16x16x32_bf16 v[84:87], a[248:251], a[216:219], v[84:87]
    ds_read_b64_tr_b16 a[198:199], v218 offset:53760
    v_mfma_f32_16x16x32_bf16 v[84:87], a[252:255], a[220:223], v[84:87]
    buffer_load_dwordx4 v199, s[20:23], s67 offen offset:1024 lds
    v_mfma_f32_16x16x32_bf16 v[92:95], a[248:251], a[224:227], v[92:95]
    v_mfma_f32_16x16x32_bf16 v[92:95], a[252:255], a[228:231], v[92:95]
    v_mfma_f32_16x16x32_bf16 v[148:151], a[248:251], a[232:235], v[148:151]
    v_mfma_f32_16x16x32_bf16 v[148:151], a[252:255], a[236:239], v[148:151]
    buffer_load_dwordx4 v200, s[20:23], s67 offen offset:2048 lds
    v_mfma_f32_16x16x32_bf16 v[156:159], a[248:251], a[240:243], v[156:159]
    v_mfma_f32_16x16x32_bf16 v[156:159], a[252:255], a[244:247], v[156:159]
    s_waitcnt lgkmcnt(1)
    v_mfma_f32_16x16x32_bf16 v[32:35], a[192:195], a[200:203], v[32:35]
    s_waitcnt lgkmcnt(0)
    ds_read_b64_tr_b16 a[248:249], v218 offset:49160
    v_mfma_f32_16x16x32_bf16 v[32:35], a[196:199], a[204:207], v[32:35]
    buffer_load_dwordx4 v201, s[20:23], s67 offen offset:3072 lds
    v_mfma_f32_16x16x32_bf16 v[40:43], a[192:195], a[208:211], v[40:43]
    ds_read_b64_tr_b16 a[250:251], v218 offset:49672
    v_mfma_f32_16x16x32_bf16 v[40:43], a[196:199], a[212:215], v[40:43]
    ds_read_b64_tr_b16 a[252:253], v218 offset:53256
    v_mfma_f32_16x16x32_bf16 v[96:99], a[192:195], a[216:219], v[96:99]
    s_add_u32 m0, s40, 122880
    ds_read_b64_tr_b16 a[254:255], v218 offset:53768
    v_mfma_f32_16x16x32_bf16 v[96:99], a[196:199], a[220:223], v[96:99]
    buffer_load_dwordx4 v202, s[16:19], s95 offen lds
    v_mfma_f32_16x16x32_bf16 v[104:107], a[192:195], a[224:227], v[104:107]
    v_mfma_f32_16x16x32_bf16 v[104:107], a[196:199], a[228:231], v[104:107]
    v_mfma_f32_16x16x32_bf16 v[160:163], a[192:195], a[232:235], v[160:163]
    v_mfma_f32_16x16x32_bf16 v[160:163], a[196:199], a[236:239], v[160:163]
    buffer_load_dwordx4 v203, s[16:19], s95 offen offset:1024 lds
    v_mfma_f32_16x16x32_bf16 v[168:171], a[192:195], a[240:243], v[168:171]
    v_mfma_f32_16x16x32_bf16 v[168:171], a[196:199], a[244:247], v[168:171]
    s_waitcnt lgkmcnt(1)
    v_mfma_f32_16x16x32_bf16 v[36:39], a[248:251], a[200:203], v[36:39]
    s_waitcnt lgkmcnt(0)
    ds_read_b64_tr_b16 a[192:193], v219 offset:49152
    v_mfma_f32_16x16x32_bf16 v[36:39], a[252:255], a[204:207], v[36:39]
    buffer_load_dwordx4 v204, s[16:19], s95 offen offset:2048 lds
    v_mfma_f32_16x16x32_bf16 v[44:47], a[248:251], a[208:211], v[44:47]
    ds_read_b64_tr_b16 a[194:195], v219 offset:49664
    v_mfma_f32_16x16x32_bf16 v[44:47], a[252:255], a[212:215], v[44:47]
    ds_read_b64_tr_b16 a[196:197], v219 offset:53248
    v_mfma_f32_16x16x32_bf16 v[100:103], a[248:251], a[216:219], v[100:103]
    ds_read_b64_tr_b16 a[198:199], v219 offset:53760
    v_mfma_f32_16x16x32_bf16 v[100:103], a[252:255], a[220:223], v[100:103]
    s_add_u32 s43, s95, 40960
    buffer_load_dwordx4 v205, s[16:19], s95 offen offset:3072 lds
    v_mfma_f32_16x16x32_bf16 v[108:111], a[248:251], a[224:227], v[108:111]
    s_add_u32 m0, s40, 126976
    v_mfma_f32_16x16x32_bf16 v[108:111], a[252:255], a[228:231], v[108:111]
    s_add_u32 s54, s62, 0
    buffer_load_dwordx4 v202, s[16:19], s43 offen lds
    v_mfma_f32_16x16x32_bf16 v[164:167], a[248:251], a[232:235], v[164:167]
    s_and_b32 s54, s54, 0x1ffff
    v_mfma_f32_16x16x32_bf16 v[164:167], a[252:255], a[236:239], v[164:167]
    s_add_u32 s54, s54, s36
    buffer_load_dwordx4 v203, s[16:19], s43 offen offset:1024 lds
    v_mfma_f32_16x16x32_bf16 v[172:175], a[248:251], a[240:243], v[172:175]
    s_add_u32 m0, s39, 147456
    v_mfma_f32_16x16x32_bf16 v[172:175], a[252:255], a[244:247], v[172:175]
    s_waitcnt lgkmcnt(1)
    buffer_load_dwordx4 v196, s[12:15], s54 offen nt lds
    v_mfma_f32_16x16x32_bf16 v[48:51], a[192:195], a[200:203], v[48:51]
    s_waitcnt lgkmcnt(0)
    ds_read_b64_tr_b16 a[248:249], v219 offset:49160
    v_mfma_f32_16x16x32_bf16 v[48:51], a[196:199], a[204:207], v[48:51]
    buffer_load_dwordx4 v197, s[12:15], s54 offen offset:1024 nt lds
    v_mfma_f32_16x16x32_bf16 v[56:59], a[192:195], a[208:211], v[56:59]
    ds_read_b64_tr_b16 a[250:251], v219 offset:49672
    v_mfma_f32_16x16x32_bf16 v[56:59], a[196:199], a[212:215], v[56:59]
    ds_read_b64_tr_b16 a[252:253], v219 offset:53256
    v_mfma_f32_16x16x32_bf16 v[112:115], a[192:195], a[216:219], v[112:115]
    ds_read_b64_tr_b16 a[254:255], v219 offset:53768
    v_mfma_f32_16x16x32_bf16 v[112:115], a[196:199], a[220:223], v[112:115]
    buffer_load_dwordx4 v196, s[12:15], s54 offen offset:2048 nt lds
    v_mfma_f32_16x16x32_bf16 v[120:123], a[192:195], a[224:227], v[120:123]
    s_add_u32 s55, s48, 1323008
    v_mfma_f32_16x16x32_bf16 v[120:123], a[196:199], a[228:231], v[120:123]
    buffer_store_dwordx4 a[16:19], v223, s[32:35], s55 offen sc1
    v_mfma_f32_16x16x32_bf16 v[176:179], a[192:195], a[232:235], v[176:179]
    v_mfma_f32_16x16x32_bf16 v[176:179], a[196:199], a[236:239], v[176:179]
    s_add_u32 s55, s48, 2621440
    buffer_load_dwordx4 v197, s[12:15], s54 offen offset:3072 nt lds
    v_mfma_f32_16x16x32_bf16 v[184:187], a[192:195], a[240:243], v[184:187]
    buffer_store_dwordx4 a[20:23], v223, s[32:35], s55 offen sc1
    v_mfma_f32_16x16x32_bf16 v[184:187], a[196:199], a[244:247], v[184:187]
    s_waitcnt lgkmcnt(1)
    s_waitcnt vmcnt(26) lgkmcnt(0)
    s_barrier
    v_mfma_f32_16x16x32_bf16 v[52:55], a[248:251], a[200:203], v[52:55]
    ds_read_b64_tr_b16 a[192:193], v218
    v_mfma_f32_16x16x32_bf16 v[52:55], a[252:255], a[204:207], v[52:55]
    ds_read_b64_tr_b16 a[194:195], v218 offset:512
    v_mfma_f32_16x16x32_bf16 v[60:63], a[248:251], a[208:211], v[60:63]
    ds_read_b128 a[200:203], v220
    v_mfma_f32_16x16x32_bf16 v[60:63], a[252:255], a[212:215], v[60:63]
    ds_read_b64_tr_b16 a[196:197], v218 offset:4096
    v_mfma_f32_16x16x32_bf16 v[116:119], a[248:251], a[216:219], v[116:119]
    ds_read_b64_tr_b16 a[198:199], v218 offset:4608
    v_mfma_f32_16x16x32_bf16 v[116:119], a[252:255], a[220:223], v[116:119]
    ds_read_b128 a[204:207], v221
    v_mfma_f32_16x16x32_bf16 v[124:127], a[248:251], a[224:227], v[124:127]
    ds_read_b128 a[208:211], v220 offset:2048
    v_mfma_f32_16x16x32_bf16 v[124:127], a[252:255], a[228:231], v[124:127]
    ds_read_b128 a[212:215], v221 offset:2048
    v_mfma_f32_16x16x32_bf16 v[180:183], a[248:251], a[232:235], v[180:183]
    ds_read_b128 a[216:219], v220 offset:4096
    v_mfma_f32_16x16x32_bf16 v[180:183], a[252:255], a[236:239], v[180:183]
    ds_read_b128 a[220:223], v221 offset:4096
    v_mfma_f32_16x16x32_bf16 v[188:191], a[248:251], a[240:243], v[188:191]
    ds_read_b128 a[224:227], v220 offset:6144
    v_mfma_f32_16x16x32_bf16 v[188:191], a[252:255], a[244:247], v[188:191]
    s_waitcnt lgkmcnt(7)
    ds_read_b128 a[228:231], v221 offset:6144
    v_mfma_f32_16x16x32_bf16 v[0:3], a[192:195], a[200:203], v[0:3]
    s_waitcnt lgkmcnt(6)
    ds_read_b128 a[232:235], v220 offset:8192
    v_mfma_f32_16x16x32_bf16 v[0:3], a[196:199], a[204:207], v[0:3]
    s_waitcnt lgkmcnt(6)
    ds_read_b128 a[236:239], v221 offset:8192
    v_mfma_f32_16x16x32_bf16 v[8:11], a[192:195], a[208:211], v[8:11]
    s_waitcnt lgkmcnt(6)
    ds_read_b128 a[240:243], v220 offset:10240
    v_mfma_f32_16x16x32_bf16 v[8:11], a[196:199], a[212:215], v[8:11]
    s_waitcnt lgkmcnt(6)
    ds_read_b128 a[244:247], v221 offset:10240
    v_mfma_f32_16x16x32_bf16 v[64:67], a[192:195], a[216:219], v[64:67]
    s_waitcnt lgkmcnt(6)
    ds_read_b64_tr_b16 a[248:249], v218 offset:8
    v_mfma_f32_16x16x32_bf16 v[64:67], a[196:199], a[220:223], v[64:67]
    s_waitcnt lgkmcnt(6)
    ds_read_b64_tr_b16 a[250:251], v218 offset:520
    v_mfma_f32_16x16x32_bf16 v[72:75], a[192:195], a[224:227], v[72:75]
    s_waitcnt lgkmcnt(6)
    ds_read_b64_tr_b16 a[252:253], v218 offset:4104
    v_mfma_f32_16x16x32_bf16 v[72:75], a[196:199], a[228:231], v[72:75]
    s_waitcnt lgkmcnt(6)
    ds_read_b64_tr_b16 a[254:255], v218 offset:4616
    v_mfma_f32_16x16x32_bf16 v[128:131], a[192:195], a[232:235], v[128:131]
    s_waitcnt lgkmcnt(6)
    s_add_u32 m0, s39, 49152
    v_mfma_f32_16x16x32_bf16 v[128:131], a[196:199], a[236:239], v[128:131]
    s_waitcnt lgkmcnt(5)
    buffer_load_dwordx4 v198, s[20:23], s63 offen lds
    v_mfma_f32_16x16x32_bf16 v[136:139], a[192:195], a[240:243], v[136:139]
    s_waitcnt lgkmcnt(4)
    v_mfma_f32_16x16x32_bf16 v[136:139], a[196:199], a[244:247], v[136:139]
    s_waitcnt lgkmcnt(2)
    v_mfma_f32_16x16x32_bf16 v[4:7], a[248:251], a[200:203], v[4:7]
    s_waitcnt lgkmcnt(0)
    ds_read_b64_tr_b16 a[192:193], v219
    v_mfma_f32_16x16x32_bf16 v[4:7], a[252:255], a[204:207], v[4:7]
    buffer_load_dwordx4 v199, s[20:23], s63 offen offset:1024 lds
    v_mfma_f32_16x16x32_bf16 v[12:15], a[248:251], a[208:211], v[12:15]
    ds_read_b64_tr_b16 a[194:195], v219 offset:512
    v_mfma_f32_16x16x32_bf16 v[12:15], a[252:255], a[212:215], v[12:15]
    ds_read_b64_tr_b16 a[196:197], v219 offset:4096
    v_mfma_f32_16x16x32_bf16 v[68:71], a[248:251], a[216:219], v[68:71]
    ds_read_b64_tr_b16 a[198:199], v219 offset:4608
    v_mfma_f32_16x16x32_bf16 v[68:71], a[252:255], a[220:223], v[68:71]
    buffer_load_dwordx4 v200, s[20:23], s63 offen offset:2048 lds
    v_mfma_f32_16x16x32_bf16 v[76:79], a[248:251], a[224:227], v[76:79]
    v_mfma_f32_16x16x32_bf16 v[76:79], a[252:255], a[228:231], v[76:79]
    v_mfma_f32_16x16x32_bf16 v[132:135], a[248:251], a[232:235], v[132:135]
    v_mfma_f32_16x16x32_bf16 v[132:135], a[252:255], a[236:239], v[132:135]
    buffer_load_dwordx4 v201, s[20:23], s63 offen offset:3072 lds
    v_mfma_f32_16x16x32_bf16 v[140:143], a[248:251], a[240:243], v[140:143]
    v_mfma_f32_16x16x32_bf16 v[140:143], a[252:255], a[244:247], v[140:143]
    s_waitcnt lgkmcnt(1)
    v_mfma_f32_16x16x32_bf16 v[16:19], a[192:195], a[200:203], v[16:19]
    s_waitcnt lgkmcnt(0)
    ds_read_b64_tr_b16 a[248:249], v219 offset:8
    v_mfma_f32_16x16x32_bf16 v[16:19], a[196:199], a[204:207], v[16:19]
    v_mfma_f32_16x16x32_bf16 v[24:27], a[192:195], a[208:211], v[24:27]
    s_bfe_u32 s95, s50, 0x40018
    ds_read_b64_tr_b16 a[250:251], v219 offset:520
    v_mfma_f32_16x16x32_bf16 v[24:27], a[196:199], a[212:215], v[24:27]
    s_lshl_b32 s67, s95, 19
    ds_read_b64_tr_b16 a[252:253], v219 offset:4104
    v_mfma_f32_16x16x32_bf16 v[80:83], a[192:195], a[216:219], v[80:83]
    s_add_u32 s67, s67, s37
    ds_read_b64_tr_b16 a[254:255], v219 offset:4616
    v_mfma_f32_16x16x32_bf16 v[80:83], a[196:199], a[220:223], v[80:83]
    s_lshl_b32 s95, s95, 7
    v_mfma_f32_16x16x32_bf16 v[88:91], a[192:195], a[224:227], v[88:91]
    s_add_u32 s95, s95, s38
    v_mfma_f32_16x16x32_bf16 v[88:91], a[196:199], a[228:231], v[88:91]
    s_add_u32 s63, s67, 128
    v_mfma_f32_16x16x32_bf16 v[144:147], a[192:195], a[232:235], v[144:147]
    v_mfma_f32_16x16x32_bf16 v[144:147], a[196:199], a[236:239], v[144:147]
    v_mfma_f32_16x16x32_bf16 v[152:155], a[192:195], a[240:243], v[152:155]
    v_mfma_f32_16x16x32_bf16 v[152:155], a[196:199], a[244:247], v[152:155]
    s_waitcnt lgkmcnt(1)
    s_waitcnt vmcnt(20) lgkmcnt(0)
    s_barrier
    v_mfma_f32_16x16x32_bf16 v[20:23], a[248:251], a[200:203], v[20:23]
    s_add_u32 m0, s39, 0
    ds_read_b64_tr_b16 a[192:193], v218 offset:16384
    v_mfma_f32_16x16x32_bf16 v[20:23], a[252:255], a[204:207], v[20:23]
    buffer_load_dwordx4 v198, s[20:23], s67 offen lds
    v_mfma_f32_16x16x32_bf16 v[28:31], a[248:251], a[208:211], v[28:31]
    ds_read_b64_tr_b16 a[194:195], v218 offset:16896
    v_mfma_f32_16x16x32_bf16 v[28:31], a[252:255], a[212:215], v[28:31]
    ds_read_b64_tr_b16 a[196:197], v218 offset:20480
    v_mfma_f32_16x16x32_bf16 v[84:87], a[248:251], a[216:219], v[84:87]
    ds_read_b64_tr_b16 a[198:199], v218 offset:20992
    v_mfma_f32_16x16x32_bf16 v[84:87], a[252:255], a[220:223], v[84:87]
    buffer_load_dwordx4 v199, s[20:23], s67 offen offset:1024 lds
    v_mfma_f32_16x16x32_bf16 v[92:95], a[248:251], a[224:227], v[92:95]
    v_mfma_f32_16x16x32_bf16 v[92:95], a[252:255], a[228:231], v[92:95]
    v_mfma_f32_16x16x32_bf16 v[148:151], a[248:251], a[232:235], v[148:151]
    v_mfma_f32_16x16x32_bf16 v[148:151], a[252:255], a[236:239], v[148:151]
    buffer_load_dwordx4 v200, s[20:23], s67 offen offset:2048 lds
    v_mfma_f32_16x16x32_bf16 v[156:159], a[248:251], a[240:243], v[156:159]
    v_mfma_f32_16x16x32_bf16 v[156:159], a[252:255], a[244:247], v[156:159]
    s_waitcnt lgkmcnt(1)
    v_mfma_f32_16x16x32_bf16 v[32:35], a[192:195], a[200:203], v[32:35]
    s_waitcnt lgkmcnt(0)
    ds_read_b64_tr_b16 a[248:249], v218 offset:16392
    v_mfma_f32_16x16x32_bf16 v[32:35], a[196:199], a[204:207], v[32:35]
    buffer_load_dwordx4 v201, s[20:23], s67 offen offset:3072 lds
    v_mfma_f32_16x16x32_bf16 v[40:43], a[192:195], a[208:211], v[40:43]
    ds_read_b64_tr_b16 a[250:251], v218 offset:16904
    v_mfma_f32_16x16x32_bf16 v[40:43], a[196:199], a[212:215], v[40:43]
    ds_read_b64_tr_b16 a[252:253], v218 offset:20488
    v_mfma_f32_16x16x32_bf16 v[96:99], a[192:195], a[216:219], v[96:99]
    s_add_u32 m0, s40, 98304
    ds_read_b64_tr_b16 a[254:255], v218 offset:21000
    v_mfma_f32_16x16x32_bf16 v[96:99], a[196:199], a[220:223], v[96:99]
    buffer_load_dwordx4 v202, s[16:19], s95 offen lds
    v_mfma_f32_16x16x32_bf16 v[104:107], a[192:195], a[224:227], v[104:107]
    v_mfma_f32_16x16x32_bf16 v[104:107], a[196:199], a[228:231], v[104:107]
    v_mfma_f32_16x16x32_bf16 v[160:163], a[192:195], a[232:235], v[160:163]
    v_mfma_f32_16x16x32_bf16 v[160:163], a[196:199], a[236:239], v[160:163]
    buffer_load_dwordx4 v203, s[16:19], s95 offen offset:1024 lds
    v_mfma_f32_16x16x32_bf16 v[168:171], a[192:195], a[240:243], v[168:171]
    v_mfma_f32_16x16x32_bf16 v[168:171], a[196:199], a[244:247], v[168:171]
    s_waitcnt lgkmcnt(1)
    v_mfma_f32_16x16x32_bf16 v[36:39], a[248:251], a[200:203], v[36:39]
    s_waitcnt lgkmcnt(0)
    ds_read_b64_tr_b16 a[192:193], v219 offset:16384
    v_mfma_f32_16x16x32_bf16 v[36:39], a[252:255], a[204:207], v[36:39]
    buffer_load_dwordx4 v204, s[16:19], s95 offen offset:2048 lds
    v_mfma_f32_16x16x32_bf16 v[44:47], a[248:251], a[208:211], v[44:47]
    ds_read_b64_tr_b16 a[194:195], v219 offset:16896
    v_mfma_f32_16x16x32_bf16 v[44:47], a[252:255], a[212:215], v[44:47]
    ds_read_b64_tr_b16 a[196:197], v219 offset:20480
    v_mfma_f32_16x16x32_bf16 v[100:103], a[248:251], a[216:219], v[100:103]
    ds_read_b64_tr_b16 a[198:199], v219 offset:20992
    v_mfma_f32_16x16x32_bf16 v[100:103], a[252:255], a[220:223], v[100:103]
    s_add_u32 s44, s95, 40960
    buffer_load_dwordx4 v205, s[16:19], s95 offen offset:3072 lds
    v_mfma_f32_16x16x32_bf16 v[108:111], a[248:251], a[224:227], v[108:111]
    s_add_u32 m0, s40, 102400
    v_mfma_f32_16x16x32_bf16 v[108:111], a[252:255], a[228:231], v[108:111]
    s_add_u32 s54, s62, 8192
    buffer_load_dwordx4 v202, s[16:19], s44 offen lds
    v_mfma_f32_16x16x32_bf16 v[164:167], a[248:251], a[232:235], v[164:167]
    s_and_b32 s54, s54, 0x1ffff
    v_mfma_f32_16x16x32_bf16 v[164:167], a[252:255], a[236:239], v[164:167]
    s_add_u32 s54, s54, s36
    buffer_load_dwordx4 v203, s[16:19], s44 offen offset:1024 lds
    v_mfma_f32_16x16x32_bf16 v[172:175], a[248:251], a[240:243], v[172:175]
    s_add_u32 m0, s39, 65536
    v_mfma_f32_16x16x32_bf16 v[172:175], a[252:255], a[244:247], v[172:175]
    s_waitcnt lgkmcnt(1)
    buffer_load_dwordx4 v192, s[8:11], s54 offen nt lds
    v_mfma_f32_16x16x32_bf16 v[48:51], a[192:195], a[200:203], v[48:51]
    s_waitcnt lgkmcnt(0)
    ds_read_b64_tr_b16 a[248:249], v219 offset:16392
    v_mfma_f32_16x16x32_bf16 v[48:51], a[196:199], a[204:207], v[48:51]
    buffer_load_dwordx4 v193, s[8:11], s54 offen offset:1024 nt lds
    v_mfma_f32_16x16x32_bf16 v[56:59], a[192:195], a[208:211], v[56:59]
    ds_read_b64_tr_b16 a[250:251], v219 offset:16904
    v_mfma_f32_16x16x32_bf16 v[56:59], a[196:199], a[212:215], v[56:59]
    ds_read_b64_tr_b16 a[252:253], v219 offset:20488
    v_mfma_f32_16x16x32_bf16 v[112:115], a[192:195], a[216:219], v[112:115]
    ds_read_b64_tr_b16 a[254:255], v219 offset:21000
    v_mfma_f32_16x16x32_bf16 v[112:115], a[196:199], a[220:223], v[112:115]
    buffer_load_dwordx4 v194, s[8:11], s54 offen offset:2048 nt lds
    v_mfma_f32_16x16x32_bf16 v[120:123], a[192:195], a[224:227], v[120:123]
    s_add_u32 s55, s48, 2629632
    v_mfma_f32_16x16x32_bf16 v[120:123], a[196:199], a[228:231], v[120:123]
    buffer_store_dwordx4 a[24:27], v223, s[32:35], s55 offen sc1
    v_mfma_f32_16x16x32_bf16 v[176:179], a[192:195], a[232:235], v[176:179]
    v_mfma_f32_16x16x32_bf16 v[176:179], a[196:199], a[236:239], v[176:179]
    s_add_u32 s55, s49, 2637824
    buffer_load_dwordx4 v195, s[8:11], s54 offen offset:3072 nt lds
    v_mfma_f32_16x16x32_bf16 v[184:187], a[192:195], a[240:243], v[184:187]
    buffer_store_dwordx4 a[28:31], v223, s[32:35], s55 offen sc1
    v_mfma_f32_16x16x32_bf16 v[184:187], a[196:199], a[244:247], v[184:187]
    s_waitcnt lgkmcnt(1)
    s_waitcnt vmcnt(26) lgkmcnt(0)
    s_barrier
    v_mfma_f32_16x16x32_bf16 v[52:55], a[248:251], a[200:203], v[52:55]
    ds_read_b64_tr_b16 a[192:193], v218 offset:32768
    v_mfma_f32_16x16x32_bf16 v[52:55], a[252:255], a[204:207], v[52:55]
    ds_read_b64_tr_b16 a[194:195], v218 offset:33280
    v_mfma_f32_16x16x32_bf16 v[60:63], a[248:251], a[208:211], v[60:63]
    ds_read_b128 a[200:203], v220 offset:24576
    v_mfma_f32_16x16x32_bf16 v[60:63], a[252:255], a[212:215], v[60:63]
    ds_read_b64_tr_b16 a[196:197], v218 offset:36864
    v_mfma_f32_16x16x32_bf16 v[116:119], a[248:251], a[216:219], v[116:119]
    ds_read_b64_tr_b16 a[198:199], v218 offset:37376
    v_mfma_f32_16x16x32_bf16 v[116:119], a[252:255], a[220:223], v[116:119]
    ds_read_b128 a[204:207], v221 offset:24576
    v_mfma_f32_16x16x32_bf16 v[124:127], a[248:251], a[224:227], v[124:127]
    ds_read_b128 a[208:211], v220 offset:26624
    v_mfma_f32_16x16x32_bf16 v[124:127], a[252:255], a[228:231], v[124:127]
    ds_read_b128 a[212:215], v221 offset:26624
    v_mfma_f32_16x16x32_bf16 v[180:183], a[248:251], a[232:235], v[180:183]
    ds_read_b128 a[216:219], v220 offset:28672
    v_mfma_f32_16x16x32_bf16 v[180:183], a[252:255], a[236:239], v[180:183]
    ds_read_b128 a[220:223], v221 offset:28672
    v_mfma_f32_16x16x32_bf16 v[188:191], a[248:251], a[240:243], v[188:191]
    ds_read_b128 a[224:227], v220 offset:30720
    v_mfma_f32_16x16x32_bf16 v[188:191], a[252:255], a[244:247], v[188:191]
    s_waitcnt lgkmcnt(7)
    ds_read_b128 a[228:231], v221 offset:30720
    v_mfma_f32_16x16x32_bf16 v[0:3], a[192:195], a[200:203], v[0:3]
    s_waitcnt lgkmcnt(6)
    ds_read_b128 a[232:235], v220 offset:32768
    v_mfma_f32_16x16x32_bf16 v[0:3], a[196:199], a[204:207], v[0:3]
    s_waitcnt lgkmcnt(6)
    ds_read_b128 a[236:239], v221 offset:32768
    v_mfma_f32_16x16x32_bf16 v[8:11], a[192:195], a[208:211], v[8:11]
    s_waitcnt lgkmcnt(6)
    ds_read_b128 a[240:243], v220 offset:34816
    v_mfma_f32_16x16x32_bf16 v[8:11], a[196:199], a[212:215], v[8:11]
    s_waitcnt lgkmcnt(6)
    ds_read_b128 a[244:247], v221 offset:34816
    v_mfma_f32_16x16x32_bf16 v[64:67], a[192:195], a[216:219], v[64:67]
    s_waitcnt lgkmcnt(6)
    ds_read_b64_tr_b16 a[248:249], v218 offset:32776
    v_mfma_f32_16x16x32_bf16 v[64:67], a[196:199], a[220:223], v[64:67]
    s_waitcnt lgkmcnt(6)
    ds_read_b64_tr_b16 a[250:251], v218 offset:33288
    v_mfma_f32_16x16x32_bf16 v[72:75], a[192:195], a[224:227], v[72:75]
    s_waitcnt lgkmcnt(6)
    ds_read_b64_tr_b16 a[252:253], v218 offset:36872
    v_mfma_f32_16x16x32_bf16 v[72:75], a[196:199], a[228:231], v[72:75]
    s_waitcnt lgkmcnt(6)
    ds_read_b64_tr_b16 a[254:255], v218 offset:37384
    v_mfma_f32_16x16x32_bf16 v[128:131], a[192:195], a[232:235], v[128:131]
    s_waitcnt lgkmcnt(6)
    s_add_u32 m0, s39, 16384
    v_mfma_f32_16x16x32_bf16 v[128:131], a[196:199], a[236:239], v[128:131]
    s_waitcnt lgkmcnt(5)
    buffer_load_dwordx4 v198, s[20:23], s63 offen lds
    v_mfma_f32_16x16x32_bf16 v[136:139], a[192:195], a[240:243], v[136:139]
    s_waitcnt lgkmcnt(4)
    v_mfma_f32_16x16x32_bf16 v[136:139], a[196:199], a[244:247], v[136:139]
    s_waitcnt lgkmcnt(2)
    v_mfma_f32_16x16x32_bf16 v[4:7], a[248:251], a[200:203], v[4:7]
    s_waitcnt lgkmcnt(0)
    ds_read_b64_tr_b16 a[192:193], v219 offset:32768
    v_mfma_f32_16x16x32_bf16 v[4:7], a[252:255], a[204:207], v[4:7]
    buffer_load_dwordx4 v199, s[20:23], s63 offen offset:1024 lds
    v_mfma_f32_16x16x32_bf16 v[12:15], a[248:251], a[208:211], v[12:15]
    ds_read_b64_tr_b16 a[194:195], v219 offset:33280
    v_mfma_f32_16x16x32_bf16 v[12:15], a[252:255], a[212:215], v[12:15]
    ds_read_b64_tr_b16 a[196:197], v219 offset:36864
    v_mfma_f32_16x16x32_bf16 v[68:71], a[248:251], a[216:219], v[68:71]
    ds_read_b64_tr_b16 a[198:199], v219 offset:37376
    v_mfma_f32_16x16x32_bf16 v[68:71], a[252:255], a[220:223], v[68:71]
    buffer_load_dwordx4 v200, s[20:23], s63 offen offset:2048 lds
    v_mfma_f32_16x16x32_bf16 v[76:79], a[248:251], a[224:227], v[76:79]
    v_mfma_f32_16x16x32_bf16 v[76:79], a[252:255], a[228:231], v[76:79]
    v_mfma_f32_16x16x32_bf16 v[132:135], a[248:251], a[232:235], v[132:135]
    v_mfma_f32_16x16x32_bf16 v[132:135], a[252:255], a[236:239], v[132:135]
    buffer_load_dwordx4 v201, s[20:23], s63 offen offset:3072 lds
    v_mfma_f32_16x16x32_bf16 v[140:143], a[248:251], a[240:243], v[140:143]
    v_mfma_f32_16x16x32_bf16 v[140:143], a[252:255], a[244:247], v[140:143]
    s_waitcnt lgkmcnt(1)
    v_mfma_f32_16x16x32_bf16 v[16:19], a[192:195], a[200:203], v[16:19]
    s_waitcnt lgkmcnt(0)
    ds_read_b64_tr_b16 a[248:249], v219 offset:32776
    v_mfma_f32_16x16x32_bf16 v[16:19], a[196:199], a[204:207], v[16:19]
    v_mfma_f32_16x16x32_bf16 v[24:27], a[192:195], a[208:211], v[24:27]
    s_bfe_u32 s95, s50, 0x4001c
    ds_read_b64_tr_b16 a[250:251], v219 offset:33288
    v_mfma_f32_16x16x32_bf16 v[24:27], a[196:199], a[212:215], v[24:27]
    s_lshl_b32 s67, s95, 19
    ds_read_b64_tr_b16 a[252:253], v219 offset:36872
    v_mfma_f32_16x16x32_bf16 v[80:83], a[192:195], a[216:219], v[80:83]
    s_add_u32 s67, s67, s37
    ds_read_b64_tr_b16 a[254:255], v219 offset:37384
    v_mfma_f32_16x16x32_bf16 v[80:83], a[196:199], a[220:223], v[80:83]
    s_lshl_b32 s95, s95, 7
    v_mfma_f32_16x16x32_bf16 v[88:91], a[192:195], a[224:227], v[88:91]
    s_add_u32 s95, s95, s38
    v_mfma_f32_16x16x32_bf16 v[88:91], a[196:199], a[228:231], v[88:91]
    s_add_u32 s63, s67, 128
    v_mfma_f32_16x16x32_bf16 v[144:147], a[192:195], a[232:235], v[144:147]
    v_mfma_f32_16x16x32_bf16 v[144:147], a[196:199], a[236:239], v[144:147]
    v_mfma_f32_16x16x32_bf16 v[152:155], a[192:195], a[240:243], v[152:155]
    v_mfma_f32_16x16x32_bf16 v[152:155], a[196:199], a[244:247], v[152:155]
    s_waitcnt lgkmcnt(1)
    s_waitcnt vmcnt(20) lgkmcnt(0)
    s_barrier
    v_mfma_f32_16x16x32_bf16 v[20:23], a[248:251], a[200:203], v[20:23]
    s_add_u32 m0, s39, 32768
    ds_read_b64_tr_b16 a[192:193], v218 offset:49152
    v_mfma_f32_16x16x32_bf16 v[20:23], a[252:255], a[204:207], v[20:23]
    buffer_load_dwordx4 v198, s[20:23], s67 offen lds
    v_mfma_f32_16x16x32_bf16 v[28:31], a[248:251], a[208:211], v[28:31]
    ds_read_b64_tr_b16 a[194:195], v218 offset:49664
    v_mfma_f32_16x16x32_bf16 v[28:31], a[252:255], a[212:215], v[28:31]
    ds_read_b64_tr_b16 a[196:197], v218 offset:53248
    v_mfma_f32_16x16x32_bf16 v[84:87], a[248:251], a[216:219], v[84:87]
    ds_read_b64_tr_b16 a[198:199], v218 offset:53760
    v_mfma_f32_16x16x32_bf16 v[84:87], a[252:255], a[220:223], v[84:87]
    buffer_load_dwordx4 v199, s[20:23], s67 offen offset:1024 lds
    v_mfma_f32_16x16x32_bf16 v[92:95], a[248:251], a[224:227], v[92:95]
    v_mfma_f32_16x16x32_bf16 v[92:95], a[252:255], a[228:231], v[92:95]
    v_mfma_f32_16x16x32_bf16 v[148:151], a[248:251], a[232:235], v[148:151]
    v_mfma_f32_16x16x32_bf16 v[148:151], a[252:255], a[236:239], v[148:151]
    buffer_load_dwordx4 v200, s[20:23], s67 offen offset:2048 lds
    v_mfma_f32_16x16x32_bf16 v[156:159], a[248:251], a[240:243], v[156:159]
    v_mfma_f32_16x16x32_bf16 v[156:159], a[252:255], a[244:247], v[156:159]
    s_waitcnt lgkmcnt(1)
    v_mfma_f32_16x16x32_bf16 v[32:35], a[192:195], a[200:203], v[32:35]
    s_waitcnt lgkmcnt(0)
    ds_read_b64_tr_b16 a[248:249], v218 offset:49160
    v_mfma_f32_16x16x32_bf16 v[32:35], a[196:199], a[204:207], v[32:35]
    buffer_load_dwordx4 v201, s[20:23], s67 offen offset:3072 lds
    v_mfma_f32_16x16x32_bf16 v[40:43], a[192:195], a[208:211], v[40:43]
    ds_read_b64_tr_b16 a[250:251], v218 offset:49672
    v_mfma_f32_16x16x32_bf16 v[40:43], a[196:199], a[212:215], v[40:43]
    ds_read_b64_tr_b16 a[252:253], v218 offset:53256
    v_mfma_f32_16x16x32_bf16 v[96:99], a[192:195], a[216:219], v[96:99]
    s_add_u32 m0, s40, 122880
    ds_read_b64_tr_b16 a[254:255], v218 offset:53768
    v_mfma_f32_16x16x32_bf16 v[96:99], a[196:199], a[220:223], v[96:99]
    buffer_load_dwordx4 v202, s[16:19], s95 offen lds
    v_mfma_f32_16x16x32_bf16 v[104:107], a[192:195], a[224:227], v[104:107]
    v_mfma_f32_16x16x32_bf16 v[104:107], a[196:199], a[228:231], v[104:107]
    v_mfma_f32_16x16x32_bf16 v[160:163], a[192:195], a[232:235], v[160:163]
    v_mfma_f32_16x16x32_bf16 v[160:163], a[196:199], a[236:239], v[160:163]
    buffer_load_dwordx4 v203, s[16:19], s95 offen offset:1024 lds
    v_mfma_f32_16x16x32_bf16 v[168:171], a[192:195], a[240:243], v[168:171]
    v_mfma_f32_16x16x32_bf16 v[168:171], a[196:199], a[244:247], v[168:171]
    s_waitcnt lgkmcnt(1)
    v_mfma_f32_16x16x32_bf16 v[36:39], a[248:251], a[200:203], v[36:39]
    s_waitcnt lgkmcnt(0)
    ds_read_b64_tr_b16 a[192:193], v219 offset:49152
    v_mfma_f32_16x16x32_bf16 v[36:39], a[252:255], a[204:207], v[36:39]
    buffer_load_dwordx4 v204, s[16:19], s95 offen offset:2048 lds
    v_mfma_f32_16x16x32_bf16 v[44:47], a[248:251], a[208:211], v[44:47]
    ds_read_b64_tr_b16 a[194:195], v219 offset:49664
    v_mfma_f32_16x16x32_bf16 v[44:47], a[252:255], a[212:215], v[44:47]
    ds_read_b64_tr_b16 a[196:197], v219 offset:53248
    v_mfma_f32_16x16x32_bf16 v[100:103], a[248:251], a[216:219], v[100:103]
    ds_read_b64_tr_b16 a[198:199], v219 offset:53760
    v_mfma_f32_16x16x32_bf16 v[100:103], a[252:255], a[220:223], v[100:103]
    buffer_load_dwordx4 v205, s[16:19], s95 offen offset:3072 lds
    v_mfma_f32_16x16x32_bf16 v[108:111], a[248:251], a[224:227], v[108:111]
    v_mfma_f32_16x16x32_bf16 v[108:111], a[252:255], a[228:231], v[108:111]
    s_add_u32 s43, s95, 40960
    v_mfma_f32_16x16x32_bf16 v[164:167], a[248:251], a[232:235], v[164:167]
    s_add_u32 m0, s40, 126976
    v_mfma_f32_16x16x32_bf16 v[164:167], a[252:255], a[236:239], v[164:167]
    buffer_load_dwordx4 v202, s[16:19], s43 offen lds
    v_mfma_f32_16x16x32_bf16 v[172:175], a[248:251], a[240:243], v[172:175]
    v_mfma_f32_16x16x32_bf16 v[172:175], a[252:255], a[244:247], v[172:175]
    s_waitcnt lgkmcnt(1)
    v_mfma_f32_16x16x32_bf16 v[48:51], a[192:195], a[200:203], v[48:51]
    s_waitcnt lgkmcnt(0)
    ds_read_b64_tr_b16 a[248:249], v219 offset:49160
    v_mfma_f32_16x16x32_bf16 v[48:51], a[196:199], a[204:207], v[48:51]
    buffer_load_dwordx4 v203, s[16:19], s43 offen offset:1024 lds
    v_mfma_f32_16x16x32_bf16 v[56:59], a[192:195], a[208:211], v[56:59]
    ds_read_b64_tr_b16 a[250:251], v219 offset:49672
    v_mfma_f32_16x16x32_bf16 v[56:59], a[196:199], a[212:215], v[56:59]
    ds_read_b64_tr_b16 a[252:253], v219 offset:53256
    v_mfma_f32_16x16x32_bf16 v[112:115], a[192:195], a[216:219], v[112:115]
    s_add_u32 s55, s48, 3936256
    ds_read_b64_tr_b16 a[254:255], v219 offset:53768
    v_mfma_f32_16x16x32_bf16 v[112:115], a[196:199], a[220:223], v[112:115]
    buffer_store_dwordx4 a[32:35], v223, s[32:35], s55 offen sc1
    v_mfma_f32_16x16x32_bf16 v[120:123], a[192:195], a[224:227], v[120:123]
    v_mfma_f32_16x16x32_bf16 v[120:123], a[196:199], a[228:231], v[120:123]
    v_mfma_f32_16x16x32_bf16 v[176:179], a[192:195], a[232:235], v[176:179]
    s_add_u32 s55, s48, 3944448
    v_mfma_f32_16x16x32_bf16 v[176:179], a[196:199], a[236:239], v[176:179]
    buffer_store_dwordx4 a[36:39], v223, s[32:35], s55 offen sc1
    v_mfma_f32_16x16x32_bf16 v[184:187], a[192:195], a[240:243], v[184:187]
    v_mfma_f32_16x16x32_bf16 v[184:187], a[196:199], a[244:247], v[184:187]
    s_waitcnt lgkmcnt(1)
    s_waitcnt vmcnt(22) lgkmcnt(0)
    s_barrier
    v_mfma_f32_16x16x32_bf16 v[52:55], a[248:251], a[200:203], v[52:55]
    ds_read_b64_tr_b16 a[192:193], v218
    v_mfma_f32_16x16x32_bf16 v[52:55], a[252:255], a[204:207], v[52:55]
    ds_read_b64_tr_b16 a[194:195], v218 offset:512
    v_mfma_f32_16x16x32_bf16 v[60:63], a[248:251], a[208:211], v[60:63]
    ds_read_b128 a[200:203], v220
    v_mfma_f32_16x16x32_bf16 v[60:63], a[252:255], a[212:215], v[60:63]
    ds_read_b64_tr_b16 a[196:197], v218 offset:4096
    v_mfma_f32_16x16x32_bf16 v[116:119], a[248:251], a[216:219], v[116:119]
    ds_read_b64_tr_b16 a[198:199], v218 offset:4608
    v_mfma_f32_16x16x32_bf16 v[116:119], a[252:255], a[220:223], v[116:119]
    ds_read_b128 a[204:207], v221
    v_mfma_f32_16x16x32_bf16 v[124:127], a[248:251], a[224:227], v[124:127]
    ds_read_b128 a[208:211], v220 offset:2048
    v_mfma_f32_16x16x32_bf16 v[124:127], a[252:255], a[228:231], v[124:127]
    ds_read_b128 a[212:215], v221 offset:2048
    v_mfma_f32_16x16x32_bf16 v[180:183], a[248:251], a[232:235], v[180:183]
    ds_read_b128 a[216:219], v220 offset:4096
    v_mfma_f32_16x16x32_bf16 v[180:183], a[252:255], a[236:239], v[180:183]
    ds_read_b128 a[220:223], v221 offset:4096
    v_mfma_f32_16x16x32_bf16 v[188:191], a[248:251], a[240:243], v[188:191]
    ds_read_b128 a[224:227], v220 offset:6144
    v_mfma_f32_16x16x32_bf16 v[188:191], a[252:255], a[244:247], v[188:191]
    s_waitcnt lgkmcnt(7)
    ds_read_b128 a[228:231], v221 offset:6144
    v_mfma_f32_16x16x32_bf16 v[0:3], a[192:195], a[200:203], v[0:3]
    s_waitcnt lgkmcnt(6)
    ds_read_b128 a[232:235], v220 offset:8192
    v_mfma_f32_16x16x32_bf16 v[0:3], a[196:199], a[204:207], v[0:3]
    s_waitcnt lgkmcnt(6)
    ds_read_b128 a[236:239], v221 offset:8192
    v_mfma_f32_16x16x32_bf16 v[8:11], a[192:195], a[208:211], v[8:11]
    s_waitcnt lgkmcnt(6)
    ds_read_b128 a[240:243], v220 offset:10240
    v_mfma_f32_16x16x32_bf16 v[8:11], a[196:199], a[212:215], v[8:11]
    s_waitcnt lgkmcnt(6)
    ds_read_b128 a[244:247], v221 offset:10240
    v_mfma_f32_16x16x32_bf16 v[64:67], a[192:195], a[216:219], v[64:67]
    s_waitcnt lgkmcnt(6)
    ds_read_b64_tr_b16 a[248:249], v218 offset:8
    v_mfma_f32_16x16x32_bf16 v[64:67], a[196:199], a[220:223], v[64:67]
    s_waitcnt lgkmcnt(6)
    ds_read_b64_tr_b16 a[250:251], v218 offset:520
    v_mfma_f32_16x16x32_bf16 v[72:75], a[192:195], a[224:227], v[72:75]
    s_waitcnt lgkmcnt(6)
    ds_read_b64_tr_b16 a[252:253], v218 offset:4104
    v_mfma_f32_16x16x32_bf16 v[72:75], a[196:199], a[228:231], v[72:75]
    s_waitcnt lgkmcnt(6)
    ds_read_b64_tr_b16 a[254:255], v218 offset:4616
    v_mfma_f32_16x16x32_bf16 v[128:131], a[192:195], a[232:235], v[128:131]
    s_waitcnt lgkmcnt(6)
    s_add_u32 m0, s39, 49152
    v_mfma_f32_16x16x32_bf16 v[128:131], a[196:199], a[236:239], v[128:131]
    s_waitcnt lgkmcnt(5)
    buffer_load_dwordx4 v198, s[20:23], s63 offen lds
    v_mfma_f32_16x16x32_bf16 v[136:139], a[192:195], a[240:243], v[136:139]
    s_waitcnt lgkmcnt(4)
    v_mfma_f32_16x16x32_bf16 v[136:139], a[196:199], a[244:247], v[136:139]
    s_waitcnt lgkmcnt(2)
    v_mfma_f32_16x16x32_bf16 v[4:7], a[248:251], a[200:203], v[4:7]
    s_waitcnt lgkmcnt(0)
    ds_read_b64_tr_b16 a[192:193], v219
    v_mfma_f32_16x16x32_bf16 v[4:7], a[252:255], a[204:207], v[4:7]
    buffer_load_dwordx4 v199, s[20:23], s63 offen offset:1024 lds
    v_mfma_f32_16x16x32_bf16 v[12:15], a[248:251], a[208:211], v[12:15]
    ds_read_b64_tr_b16 a[194:195], v219 offset:512
    v_mfma_f32_16x16x32_bf16 v[12:15], a[252:255], a[212:215], v[12:15]
    ds_read_b64_tr_b16 a[196:197], v219 offset:4096
    v_mfma_f32_16x16x32_bf16 v[68:71], a[248:251], a[216:219], v[68:71]
    ds_read_b64_tr_b16 a[198:199], v219 offset:4608
    v_mfma_f32_16x16x32_bf16 v[68:71], a[252:255], a[220:223], v[68:71]
    buffer_load_dwordx4 v200, s[20:23], s63 offen offset:2048 lds
    v_mfma_f32_16x16x32_bf16 v[76:79], a[248:251], a[224:227], v[76:79]
    v_mfma_f32_16x16x32_bf16 v[76:79], a[252:255], a[228:231], v[76:79]
    v_mfma_f32_16x16x32_bf16 v[132:135], a[248:251], a[232:235], v[132:135]
    v_mfma_f32_16x16x32_bf16 v[132:135], a[252:255], a[236:239], v[132:135]
    buffer_load_dwordx4 v201, s[20:23], s63 offen offset:3072 lds
    v_mfma_f32_16x16x32_bf16 v[140:143], a[248:251], a[240:243], v[140:143]
    v_mfma_f32_16x16x32_bf16 v[140:143], a[252:255], a[244:247], v[140:143]
    s_waitcnt lgkmcnt(1)
    v_mfma_f32_16x16x32_bf16 v[16:19], a[192:195], a[200:203], v[16:19]
    s_waitcnt lgkmcnt(0)
    ds_read_b64_tr_b16 a[248:249], v219 offset:8
    v_mfma_f32_16x16x32_bf16 v[16:19], a[196:199], a[204:207], v[16:19]
    v_mfma_f32_16x16x32_bf16 v[24:27], a[192:195], a[208:211], v[24:27]
    ds_read_b64_tr_b16 a[250:251], v219 offset:520
    v_mfma_f32_16x16x32_bf16 v[24:27], a[196:199], a[212:215], v[24:27]
    ds_read_b64_tr_b16 a[252:253], v219 offset:4104
    v_mfma_f32_16x16x32_bf16 v[80:83], a[192:195], a[216:219], v[80:83]
    ds_read_b64_tr_b16 a[254:255], v219 offset:4616
    v_mfma_f32_16x16x32_bf16 v[80:83], a[196:199], a[220:223], v[80:83]
    v_mfma_f32_16x16x32_bf16 v[88:91], a[192:195], a[224:227], v[88:91]
    v_mfma_f32_16x16x32_bf16 v[88:91], a[196:199], a[228:231], v[88:91]
    v_mfma_f32_16x16x32_bf16 v[144:147], a[192:195], a[232:235], v[144:147]
    v_mfma_f32_16x16x32_bf16 v[144:147], a[196:199], a[236:239], v[144:147]
    v_mfma_f32_16x16x32_bf16 v[152:155], a[192:195], a[240:243], v[152:155]
    v_mfma_f32_16x16x32_bf16 v[152:155], a[196:199], a[244:247], v[152:155]
    s_waitcnt lgkmcnt(1)
    s_waitcnt vmcnt(16) lgkmcnt(0)
    s_barrier
    s_add_u32 s43, s62, 16384
    s_and_b32 s43, s43, 0x1ffff
    s_add_u32 s43, s43, s36
    v_mfma_f32_16x16x32_bf16 v[20:23], a[248:251], a[200:203], v[20:23]
    s_add_u32 m0, s39, 0
    ds_read_b64_tr_b16 a[192:193], v218 offset:16384
    v_mfma_f32_16x16x32_bf16 v[20:23], a[252:255], a[204:207], v[20:23]
    buffer_load_dwordx4 v192, s[8:11], s43 offen nt lds
    v_mfma_f32_16x16x32_bf16 v[28:31], a[248:251], a[208:211], v[28:31]
    ds_read_b64_tr_b16 a[194:195], v218 offset:16896
    v_mfma_f32_16x16x32_bf16 v[28:31], a[252:255], a[212:215], v[28:31]
    ds_read_b64_tr_b16 a[196:197], v218 offset:20480
    v_mfma_f32_16x16x32_bf16 v[84:87], a[248:251], a[216:219], v[84:87]
    ds_read_b64_tr_b16 a[198:199], v218 offset:20992
    v_mfma_f32_16x16x32_bf16 v[84:87], a[252:255], a[220:223], v[84:87]
    v_mfma_f32_16x16x32_bf16 v[92:95], a[248:251], a[224:227], v[92:95]
    v_mfma_f32_16x16x32_bf16 v[92:95], a[252:255], a[228:231], v[92:95]
    v_mfma_f32_16x16x32_bf16 v[148:151], a[248:251], a[232:235], v[148:151]
    v_mfma_f32_16x16x32_bf16 v[148:151], a[252:255], a[236:239], v[148:151]
    buffer_load_dwordx4 v193, s[8:11], s43 offen offset:1024 nt lds
    v_mfma_f32_16x16x32_bf16 v[156:159], a[248:251], a[240:243], v[156:159]
    v_mfma_f32_16x16x32_bf16 v[156:159], a[252:255], a[244:247], v[156:159]
    s_waitcnt lgkmcnt(1)
    v_mfma_f32_16x16x32_bf16 v[32:35], a[192:195], a[200:203], v[32:35]
    s_waitcnt lgkmcnt(0)
    ds_read_b64_tr_b16 a[248:249], v218 offset:16392
    v_mfma_f32_16x16x32_bf16 v[32:35], a[196:199], a[204:207], v[32:35]
    buffer_load_dwordx4 v194, s[8:11], s43 offen offset:2048 nt lds
    v_mfma_f32_16x16x32_bf16 v[40:43], a[192:195], a[208:211], v[40:43]
    ds_read_b64_tr_b16 a[250:251], v218 offset:16904
    v_mfma_f32_16x16x32_bf16 v[40:43], a[196:199], a[212:215], v[40:43]
    ds_read_b64_tr_b16 a[252:253], v218 offset:20488
    v_mfma_f32_16x16x32_bf16 v[96:99], a[192:195], a[216:219], v[96:99]
    ds_read_b64_tr_b16 a[254:255], v218 offset:21000
    v_mfma_f32_16x16x32_bf16 v[96:99], a[196:199], a[220:223], v[96:99]
    v_mfma_f32_16x16x32_bf16 v[104:107], a[192:195], a[224:227], v[104:107]
    v_mfma_f32_16x16x32_bf16 v[104:107], a[196:199], a[228:231], v[104:107]
    v_mfma_f32_16x16x32_bf16 v[160:163], a[192:195], a[232:235], v[160:163]
    v_mfma_f32_16x16x32_bf16 v[160:163], a[196:199], a[236:239], v[160:163]
    s_add_u32 s44, s62, 8192
    buffer_load_dwordx4 v195, s[8:11], s43 offen offset:3072 nt lds
    v_mfma_f32_16x16x32_bf16 v[168:171], a[192:195], a[240:243], v[168:171]
    s_and_b32 s44, s44, 0x1ffff
    v_mfma_f32_16x16x32_bf16 v[168:171], a[196:199], a[244:247], v[168:171]
    s_waitcnt lgkmcnt(1)
    s_add_u32 s44, s44, s36
    v_mfma_f32_16x16x32_bf16 v[36:39], a[248:251], a[200:203], v[36:39]
    s_waitcnt lgkmcnt(0)
    s_add_u32 m0, s39, 98304
    ds_read_b64_tr_b16 a[192:193], v219 offset:16384
    v_mfma_f32_16x16x32_bf16 v[36:39], a[252:255], a[204:207], v[36:39]
    buffer_load_dwordx4 v196, s[12:15], s44 offen nt lds
    v_mfma_f32_16x16x32_bf16 v[44:47], a[248:251], a[208:211], v[44:47]
    ds_read_b64_tr_b16 a[194:195], v219 offset:16896
    v_mfma_f32_16x16x32_bf16 v[44:47], a[252:255], a[212:215], v[44:47]
    ds_read_b64_tr_b16 a[196:197], v219 offset:20480
    v_mfma_f32_16x16x32_bf16 v[100:103], a[248:251], a[216:219], v[100:103]
    ds_read_b64_tr_b16 a[198:199], v219 offset:20992
    v_mfma_f32_16x16x32_bf16 v[100:103], a[252:255], a[220:223], v[100:103]
    v_mfma_f32_16x16x32_bf16 v[108:111], a[248:251], a[224:227], v[108:111]
    v_mfma_f32_16x16x32_bf16 v[108:111], a[252:255], a[228:231], v[108:111]
    v_mfma_f32_16x16x32_bf16 v[164:167], a[248:251], a[232:235], v[164:167]
    v_mfma_f32_16x16x32_bf16 v[164:167], a[252:255], a[236:239], v[164:167]
    buffer_load_dwordx4 v197, s[12:15], s44 offen offset:1024 nt lds
    v_mfma_f32_16x16x32_bf16 v[172:175], a[248:251], a[240:243], v[172:175]
    v_mfma_f32_16x16x32_bf16 v[172:175], a[252:255], a[244:247], v[172:175]
    s_waitcnt lgkmcnt(1)
    v_mfma_f32_16x16x32_bf16 v[48:51], a[192:195], a[200:203], v[48:51]
    s_waitcnt lgkmcnt(0)
    ds_read_b64_tr_b16 a[248:249], v219 offset:16392
    v_mfma_f32_16x16x32_bf16 v[48:51], a[196:199], a[204:207], v[48:51]
    buffer_load_dwordx4 v196, s[12:15], s44 offen offset:2048 nt lds
    v_mfma_f32_16x16x32_bf16 v[56:59], a[192:195], a[208:211], v[56:59]
    ds_read_b64_tr_b16 a[250:251], v219 offset:16904
    v_mfma_f32_16x16x32_bf16 v[56:59], a[196:199], a[212:215], v[56:59]
    ds_read_b64_tr_b16 a[252:253], v219 offset:20488
    v_mfma_f32_16x16x32_bf16 v[112:115], a[192:195], a[216:219], v[112:115]
    ds_read_b64_tr_b16 a[254:255], v219 offset:21000
    v_mfma_f32_16x16x32_bf16 v[112:115], a[196:199], a[220:223], v[112:115]
    v_mfma_f32_16x16x32_bf16 v[120:123], a[192:195], a[224:227], v[120:123]
    v_mfma_f32_16x16x32_bf16 v[120:123], a[196:199], a[228:231], v[120:123]
    v_mfma_f32_16x16x32_bf16 v[176:179], a[192:195], a[232:235], v[176:179]
    v_mfma_f32_16x16x32_bf16 v[176:179], a[196:199], a[236:239], v[176:179]
    buffer_load_dwordx4 v197, s[12:15], s44 offen offset:3072 nt lds
    v_mfma_f32_16x16x32_bf16 v[184:187], a[192:195], a[240:243], v[184:187]
    v_mfma_f32_16x16x32_bf16 v[184:187], a[196:199], a[244:247], v[184:187]
    s_waitcnt lgkmcnt(1)
    s_waitcnt vmcnt(14) lgkmcnt(0)
    s_barrier
    v_mfma_f32_16x16x32_bf16 v[52:55], a[248:251], a[200:203], v[52:55]
    ds_read_b64_tr_b16 a[192:193], v218 offset:32768
    v_mfma_f32_16x16x32_bf16 v[52:55], a[252:255], a[204:207], v[52:55]
    ds_read_b64_tr_b16 a[194:195], v218 offset:33280
    v_mfma_f32_16x16x32_bf16 v[60:63], a[248:251], a[208:211], v[60:63]
    ds_read_b128 a[200:203], v220 offset:24576
    v_mfma_f32_16x16x32_bf16 v[60:63], a[252:255], a[212:215], v[60:63]
    ds_read_b64_tr_b16 a[196:197], v218 offset:36864
    v_mfma_f32_16x16x32_bf16 v[116:119], a[248:251], a[216:219], v[116:119]
    ds_read_b64_tr_b16 a[198:199], v218 offset:37376
    v_mfma_f32_16x16x32_bf16 v[116:119], a[252:255], a[220:223], v[116:119]
    ds_read_b128 a[204:207], v221 offset:24576
    v_mfma_f32_16x16x32_bf16 v[124:127], a[248:251], a[224:227], v[124:127]
    ds_read_b128 a[208:211], v220 offset:26624
    v_mfma_f32_16x16x32_bf16 v[124:127], a[252:255], a[228:231], v[124:127]
    ds_read_b128 a[212:215], v221 offset:26624
    v_mfma_f32_16x16x32_bf16 v[180:183], a[248:251], a[232:235], v[180:183]
    ds_read_b128 a[216:219], v220 offset:28672
    v_mfma_f32_16x16x32_bf16 v[180:183], a[252:255], a[236:239], v[180:183]
    ds_read_b128 a[220:223], v221 offset:28672
    v_mfma_f32_16x16x32_bf16 v[188:191], a[248:251], a[240:243], v[188:191]
    ds_read_b128 a[224:227], v220 offset:30720
    v_mfma_f32_16x16x32_bf16 v[188:191], a[252:255], a[244:247], v[188:191]
    s_waitcnt lgkmcnt(7)
    ds_read_b128 a[228:231], v221 offset:30720
    v_mfma_f32_16x16x32_bf16 v[0:3], a[192:195], a[200:203], v[0:3]
    s_waitcnt lgkmcnt(6)
    ds_read_b128 a[232:235], v220 offset:32768
    v_mfma_f32_16x16x32_bf16 v[0:3], a[196:199], a[204:207], v[0:3]
    s_waitcnt lgkmcnt(6)
    ds_read_b128 a[236:239], v221 offset:32768
    v_mfma_f32_16x16x32_bf16 v[8:11], a[192:195], a[208:211], v[8:11]
    s_waitcnt lgkmcnt(6)
    s_add_u32 s37, s37, 512
    ds_read_b128 a[240:243], v220 offset:34816
    v_mfma_f32_16x16x32_bf16 v[8:11], a[196:199], a[212:215], v[8:11]
    s_waitcnt lgkmcnt(6)
    s_add_u32 s63, s37, 524416
    ds_read_b128 a[244:247], v221 offset:34816
    v_mfma_f32_16x16x32_bf16 v[64:67], a[192:195], a[216:219], v[64:67]
    s_waitcnt lgkmcnt(6)
    s_add_u32 s84, s37, 0
    ds_read_b64_tr_b16 a[248:249], v218 offset:32776
    v_mfma_f32_16x16x32_bf16 v[64:67], a[196:199], a[220:223], v[64:67]
    s_waitcnt lgkmcnt(6)
    s_add_u32 s85, s37, 128
    ds_read_b64_tr_b16 a[250:251], v218 offset:33288
    v_mfma_f32_16x16x32_bf16 v[72:75], a[192:195], a[224:227], v[72:75]
    s_waitcnt lgkmcnt(6)
    s_add_u32 s86, s38, 0
    ds_read_b64_tr_b16 a[252:253], v218 offset:36872
    v_mfma_f32_16x16x32_bf16 v[72:75], a[196:199], a[228:231], v[72:75]
    s_waitcnt lgkmcnt(6)
    s_add_u32 s87, s38, 40960
    ds_read_b64_tr_b16 a[254:255], v218 offset:37384
    v_mfma_f32_16x16x32_bf16 v[128:131], a[192:195], a[232:235], v[128:131]
    s_waitcnt lgkmcnt(6)
    s_add_u32 s98, s38, 128
    v_mfma_f32_16x16x32_bf16 v[128:131], a[196:199], a[236:239], v[128:131]
    s_waitcnt lgkmcnt(5)
    s_add_u32 s99, s38, 41088
    v_mfma_f32_16x16x32_bf16 v[136:139], a[192:195], a[240:243], v[136:139]
    s_waitcnt lgkmcnt(4)
    s_add_u32 s100, s37, 524288
    v_mfma_f32_16x16x32_bf16 v[136:139], a[196:199], a[244:247], v[136:139]
    s_waitcnt lgkmcnt(2)
    s_add_u32 s68, s3, s4
    v_mfma_f32_16x16x32_bf16 v[4:7], a[248:251], a[200:203], v[4:7]
    s_waitcnt lgkmcnt(0)
    s_and_b32 s68, s68, 3
    ds_read_b64_tr_b16 a[192:193], v219 offset:32768
    v_mfma_f32_16x16x32_bf16 v[4:7], a[252:255], a[204:207], v[4:7]
    s_mov_b32 s50, 0x97685342
    v_mfma_f32_16x16x32_bf16 v[12:15], a[248:251], a[208:211], v[12:15]
    ds_read_b64_tr_b16 a[194:195], v219 offset:33280
    s_cmp_eq_u32 s68, 1
    s_cselect_b32 s50, 0x87964352, s50
    v_mfma_f32_16x16x32_bf16 v[12:15], a[252:255], a[212:215], v[12:15]
    ds_read_b64_tr_b16 a[196:197], v219 offset:36864
    s_cmp_eq_u32 s68, 2
    s_cselect_b32 s50, 0x98754623, s50
    v_mfma_f32_16x16x32_bf16 v[68:71], a[248:251], a[216:219], v[68:71]
    ds_read_b64_tr_b16 a[198:199], v219 offset:37376
    s_cmp_eq_u32 s68, 3
    s_cselect_b32 s50, 0x98657423, s50
    v_mfma_f32_16x16x32_bf16 v[68:71], a[252:255], a[220:223], v[68:71]
    v_cvt_pk_bf16_f32 v0, v0, v1
    v_cvt_pk_bf16_f32 v1, v2, v3
    v_mfma_f32_16x16x32_bf16 v[76:79], a[248:251], a[224:227], v[76:79]
    v_cvt_pk_bf16_f32 v2, v4, v5
    v_cvt_pk_bf16_f32 v3, v6, v7
    v_mfma_f32_16x16x32_bf16 v[76:79], a[252:255], a[228:231], v[76:79]
    v_cvt_pk_bf16_f32 v4, v8, v9
    v_cvt_pk_bf16_f32 v5, v10, v11
    v_mfma_f32_16x16x32_bf16 v[132:135], a[248:251], a[232:235], v[132:135]
    v_cvt_pk_bf16_f32 v6, v12, v13
    v_cvt_pk_bf16_f32 v7, v14, v15
    v_mfma_f32_16x16x32_bf16 v[132:135], a[252:255], a[236:239], v[132:135]
    v_cvt_pk_bf16_f32 v64, v64, v65
    v_cvt_pk_bf16_f32 v65, v66, v67
    v_mfma_f32_16x16x32_bf16 v[140:143], a[248:251], a[240:243], v[140:143]
    v_cvt_pk_bf16_f32 v66, v68, v69
    v_cvt_pk_bf16_f32 v67, v70, v71
    v_mfma_f32_16x16x32_bf16 v[140:143], a[252:255], a[244:247], v[140:143]
    s_waitcnt lgkmcnt(1)
    v_cvt_pk_bf16_f32 v68, v72, v73
    v_cvt_pk_bf16_f32 v69, v74, v75
    v_mfma_f32_16x16x32_bf16 v[16:19], a[192:195], a[200:203], v[16:19]
    s_waitcnt lgkmcnt(0)
    ds_read_b64_tr_b16 a[248:249], v219 offset:32776
    v_cvt_pk_bf16_f32 v70, v76, v77
    v_mfma_f32_16x16x32_bf16 v[16:19], a[196:199], a[204:207], v[16:19]
    v_cvt_pk_bf16_f32 v71, v78, v79
    v_cvt_pk_bf16_f32 v128, v128, v129
    v_mfma_f32_16x16x32_bf16 v[24:27], a[192:195], a[208:211], v[24:27]
    ds_read_b64_tr_b16 a[250:251], v219 offset:33288
    v_cvt_pk_bf16_f32 v129, v130, v131
    v_mfma_f32_16x16x32_bf16 v[24:27], a[196:199], a[212:215], v[24:27]
    ds_read_b64_tr_b16 a[252:253], v219 offset:36872
    v_cvt_pk_bf16_f32 v130, v132, v133
    v_mfma_f32_16x16x32_bf16 v[80:83], a[192:195], a[216:219], v[80:83]
    ds_read_b64_tr_b16 a[254:255], v219 offset:37384
    v_cvt_pk_bf16_f32 v131, v134, v135
    v_mfma_f32_16x16x32_bf16 v[80:83], a[196:199], a[220:223], v[80:83]
    v_cvt_pk_bf16_f32 v132, v136, v137
    v_cvt_pk_bf16_f32 v133, v138, v139
    v_mfma_f32_16x16x32_bf16 v[88:91], a[192:195], a[224:227], v[88:91]
    v_cvt_pk_bf16_f32 v134, v140, v141
    v_cvt_pk_bf16_f32 v135, v142, v143
    v_mfma_f32_16x16x32_bf16 v[88:91], a[196:199], a[228:231], v[88:91]
    v_mfma_f32_16x16x32_bf16 v[144:147], a[192:195], a[232:235], v[144:147]
    v_mfma_f32_16x16x32_bf16 v[144:147], a[196:199], a[236:239], v[144:147]
    v_mfma_f32_16x16x32_bf16 v[152:155], a[192:195], a[240:243], v[152:155]
    v_mfma_f32_16x16x32_bf16 v[152:155], a[196:199], a[244:247], v[152:155]
    s_waitcnt lgkmcnt(1)
    s_waitcnt vmcnt(8) lgkmcnt(0)
    s_barrier
    s_add_u32 s43, s62, 16384
    s_and_b32 s43, s43, 0x1ffff
    s_add_u32 s43, s43, s36
    v_mfma_f32_16x16x32_bf16 v[20:23], a[248:251], a[200:203], v[20:23]
    s_add_u32 m0, s39, 114688
    ds_read_b64_tr_b16 a[192:193], v218 offset:49152
    v_mfma_f32_16x16x32_bf16 v[20:23], a[252:255], a[204:207], v[20:23]
    buffer_load_dwordx4 v196, s[12:15], s43 offen nt lds
    v_mfma_f32_16x16x32_bf16 v[28:31], a[248:251], a[208:211], v[28:31]
    ds_read_b64_tr_b16 a[194:195], v218 offset:49664
    v_mfma_f32_16x16x32_bf16 v[28:31], a[252:255], a[212:215], v[28:31]
    ds_read_b64_tr_b16 a[196:197], v218 offset:53248
    v_cvt_pk_bf16_f32 v8, v16, v17
    v_mfma_f32_16x16x32_bf16 v[84:87], a[248:251], a[216:219], v[84:87]
    ds_read_b64_tr_b16 a[198:199], v218 offset:53760
    v_cvt_pk_bf16_f32 v9, v18, v19
    v_mfma_f32_16x16x32_bf16 v[84:87], a[252:255], a[220:223], v[84:87]
    v_cvt_pk_bf16_f32 v10, v20, v21
    v_cvt_pk_bf16_f32 v11, v22, v23
    v_mfma_f32_16x16x32_bf16 v[92:95], a[248:251], a[224:227], v[92:95]
    v_cvt_pk_bf16_f32 v12, v24, v25
    v_cvt_pk_bf16_f32 v13, v26, v27
    v_mfma_f32_16x16x32_bf16 v[92:95], a[252:255], a[228:231], v[92:95]
    v_cvt_pk_bf16_f32 v14, v28, v29
    v_cvt_pk_bf16_f32 v15, v30, v31
    v_mfma_f32_16x16x32_bf16 v[148:151], a[248:251], a[232:235], v[148:151]
    v_cvt_pk_bf16_f32 v72, v80, v81
    v_cvt_pk_bf16_f32 v73, v82, v83
    v_mfma_f32_16x16x32_bf16 v[148:151], a[252:255], a[236:239], v[148:151]
    v_cvt_pk_bf16_f32 v74, v84, v85
    v_cvt_pk_bf16_f32 v75, v86, v87
    v_mfma_f32_16x16x32_bf16 v[156:159], a[248:251], a[240:243], v[156:159]
    v_cvt_pk_bf16_f32 v76, v88, v89
    v_cvt_pk_bf16_f32 v77, v90, v91
    v_mfma_f32_16x16x32_bf16 v[156:159], a[252:255], a[244:247], v[156:159]
    s_waitcnt lgkmcnt(1)
    v_cvt_pk_bf16_f32 v78, v92, v93
    v_cvt_pk_bf16_f32 v79, v94, v95
    v_mfma_f32_16x16x32_bf16 v[32:35], a[192:195], a[200:203], v[32:35]
    s_waitcnt lgkmcnt(0)
    ds_read_b64_tr_b16 a[248:249], v218 offset:49160
    v_cvt_pk_bf16_f32 v136, v144, v145
    v_mfma_f32_16x16x32_bf16 v[32:35], a[196:199], a[204:207], v[32:35]
    v_cvt_pk_bf16_f32 v137, v146, v147
    v_cvt_pk_bf16_f32 v138, v148, v149
    v_mfma_f32_16x16x32_bf16 v[40:43], a[192:195], a[208:211], v[40:43]
    ds_read_b64_tr_b16 a[250:251], v218 offset:49672
    v_cvt_pk_bf16_f32 v139, v150, v151
    v_mfma_f32_16x16x32_bf16 v[40:43], a[196:199], a[212:215], v[40:43]
    ds_read_b64_tr_b16 a[252:253], v218 offset:53256
    v_cvt_pk_bf16_f32 v140, v152, v153
    v_mfma_f32_16x16x32_bf16 v[96:99], a[192:195], a[216:219], v[96:99]
    ds_read_b64_tr_b16 a[254:255], v218 offset:53768
    v_cvt_pk_bf16_f32 v141, v154, v155
    v_mfma_f32_16x16x32_bf16 v[96:99], a[196:199], a[220:223], v[96:99]
    buffer_load_dwordx4 v197, s[12:15], s43 offen offset:1024 nt lds
    v_mfma_f32_16x16x32_bf16 v[104:107], a[192:195], a[224:227], v[104:107]
    v_cvt_pk_bf16_f32 v142, v156, v157
    v_cvt_pk_bf16_f32 v143, v158, v159
    v_mfma_f32_16x16x32_bf16 v[104:107], a[196:199], a[228:231], v[104:107]
    v_mfma_f32_16x16x32_bf16 v[160:163], a[192:195], a[232:235], v[160:163]
    v_mfma_f32_16x16x32_bf16 v[160:163], a[196:199], a[236:239], v[160:163]
    v_mfma_f32_16x16x32_bf16 v[168:171], a[192:195], a[240:243], v[168:171]
    v_mfma_f32_16x16x32_bf16 v[168:171], a[196:199], a[244:247], v[168:171]
    s_waitcnt lgkmcnt(1)
    v_mfma_f32_16x16x32_bf16 v[36:39], a[248:251], a[200:203], v[36:39]
    s_waitcnt lgkmcnt(0)
    ds_read_b64_tr_b16 a[192:193], v219 offset:49152
    v_mfma_f32_16x16x32_bf16 v[36:39], a[252:255], a[204:207], v[36:39]
    v_mfma_f32_16x16x32_bf16 v[44:47], a[248:251], a[208:211], v[44:47]
    ds_read_b64_tr_b16 a[194:195], v219 offset:49664
    v_mfma_f32_16x16x32_bf16 v[44:47], a[252:255], a[212:215], v[44:47]
    ds_read_b64_tr_b16 a[196:197], v219 offset:53248
    v_cvt_pk_bf16_f32 v16, v32, v33
    v_mfma_f32_16x16x32_bf16 v[100:103], a[248:251], a[216:219], v[100:103]
    ds_read_b64_tr_b16 a[198:199], v219 offset:53760
    v_cvt_pk_bf16_f32 v17, v34, v35
    v_mfma_f32_16x16x32_bf16 v[100:103], a[252:255], a[220:223], v[100:103]
    v_cvt_pk_bf16_f32 v18, v36, v37
    v_cvt_pk_bf16_f32 v19, v38, v39
    v_mfma_f32_16x16x32_bf16 v[108:111], a[248:251], a[224:227], v[108:111]
    v_cvt_pk_bf16_f32 v20, v40, v41
    v_cvt_pk_bf16_f32 v21, v42, v43
    v_mfma_f32_16x16x32_bf16 v[108:111], a[252:255], a[228:231], v[108:111]
    buffer_load_dwordx4 v196, s[12:15], s43 offen offset:2048 nt lds
    v_mfma_f32_16x16x32_bf16 v[164:167], a[248:251], a[232:235], v[164:167]
    v_cvt_pk_bf16_f32 v22, v44, v45
    v_cvt_pk_bf16_f32 v23, v46, v47
    v_mfma_f32_16x16x32_bf16 v[164:167], a[252:255], a[236:239], v[164:167]
    v_cvt_pk_bf16_f32 v80, v96, v97
    v_cvt_pk_bf16_f32 v81, v98, v99
    v_mfma_f32_16x16x32_bf16 v[172:175], a[248:251], a[240:243], v[172:175]
    v_cvt_pk_bf16_f32 v82, v100, v101
    v_cvt_pk_bf16_f32 v83, v102, v103
    v_mfma_f32_16x16x32_bf16 v[172:175], a[252:255], a[244:247], v[172:175]
    s_waitcnt lgkmcnt(1)
    v_cvt_pk_bf16_f32 v84, v104, v105
    v_cvt_pk_bf16_f32 v85, v106, v107
    v_mfma_f32_16x16x32_bf16 v[48:51], a[192:195], a[200:203], v[48:51]
    s_waitcnt lgkmcnt(0)
    ds_read_b64_tr_b16 a[248:249], v219 offset:49160
    v_cvt_pk_bf16_f32 v86, v108, v109
    v_mfma_f32_16x16x32_bf16 v[48:51], a[196:199], a[204:207], v[48:51]
    v_cvt_pk_bf16_f32 v87, v110, v111
    v_cvt_pk_bf16_f32 v144, v160, v161
    v_mfma_f32_16x16x32_bf16 v[56:59], a[192:195], a[208:211], v[56:59]
    ds_read_b64_tr_b16 a[250:251], v219 offset:49672
    v_cvt_pk_bf16_f32 v145, v162, v163
    v_mfma_f32_16x16x32_bf16 v[56:59], a[196:199], a[212:215], v[56:59]
    ds_read_b64_tr_b16 a[252:253], v219 offset:53256
    v_cvt_pk_bf16_f32 v146, v164, v165
    v_mfma_f32_16x16x32_bf16 v[112:115], a[192:195], a[216:219], v[112:115]
    ds_read_b64_tr_b16 a[254:255], v219 offset:53768
    v_cvt_pk_bf16_f32 v147, v166, v167
    v_mfma_f32_16x16x32_bf16 v[112:115], a[196:199], a[220:223], v[112:115]
    v_cvt_pk_bf16_f32 v148, v168, v169
    v_cvt_pk_bf16_f32 v149, v170, v171
    v_mfma_f32_16x16x32_bf16 v[120:123], a[192:195], a[224:227], v[120:123]
    v_cvt_pk_bf16_f32 v150, v172, v173
    v_cvt_pk_bf16_f32 v151, v174, v175
    v_mfma_f32_16x16x32_bf16 v[120:123], a[196:199], a[228:231], v[120:123]
    v_mfma_f32_16x16x32_bf16 v[176:179], a[192:195], a[232:235], v[176:179]
    v_add_u32 v206, 0xc000, v206
    v_add_u32 v207, 0xc000, v207
    v_mfma_f32_16x16x32_bf16 v[176:179], a[196:199], a[236:239], v[176:179]
    buffer_load_dwordx4 v197, s[12:15], s43 offen offset:3072 nt lds
    v_mfma_f32_16x16x32_bf16 v[184:187], a[192:195], a[240:243], v[184:187]
    v_add_u32 v208, 0xc000, v208
    v_add_u32 v209, 0xc000, v209
    v_mfma_f32_16x16x32_bf16 v[184:187], a[196:199], a[244:247], v[184:187]
    s_waitcnt lgkmcnt(1)
    s_waitcnt lgkmcnt(0)
    s_barrier
    v_mfma_f32_16x16x32_bf16 v[52:55], a[248:251], a[200:203], v[52:55]
    ds_read_b128 a[192:195], v206 offset:16384
    v_mfma_f32_16x16x32_bf16 v[52:55], a[252:255], a[204:207], v[52:55]
    ds_read_b128 a[196:199], v207 offset:16384
    v_mfma_f32_16x16x32_bf16 v[60:63], a[248:251], a[208:211], v[60:63]
    ds_read_b128 a[200:203], v208 offset:16384
    v_mfma_f32_16x16x32_bf16 v[60:63], a[252:255], a[212:215], v[60:63]
    ds_read_b128 a[204:207], v209 offset:16384
    v_cvt_pk_bf16_f32 v24, v48, v49
    v_mfma_f32_16x16x32_bf16 v[116:119], a[248:251], a[216:219], v[116:119]
    ds_read_b128 a[208:211], v206 offset:20480
    v_cvt_pk_bf16_f32 v25, v50, v51
    v_mfma_f32_16x16x32_bf16 v[116:119], a[252:255], a[220:223], v[116:119]
    ds_read_b128 a[212:215], v207 offset:20480
    v_cvt_pk_bf16_f32 v26, v52, v53
    v_mfma_f32_16x16x32_bf16 v[124:127], a[248:251], a[224:227], v[124:127]
    ds_read_b128 a[216:219], v208 offset:20480
    v_cvt_pk_bf16_f32 v27, v54, v55
    v_mfma_f32_16x16x32_bf16 v[124:127], a[252:255], a[228:231], v[124:127]
    ds_read_b128 a[220:223], v209 offset:20480
    v_cvt_pk_bf16_f32 v28, v56, v57
    v_mfma_f32_16x16x32_bf16 v[180:183], a[248:251], a[232:235], v[180:183]
    v_cvt_pk_bf16_f32 v29, v58, v59
    v_cvt_pk_bf16_f32 v30, v60, v61
    v_mfma_f32_16x16x32_bf16 v[180:183], a[252:255], a[236:239], v[180:183]
    v_cvt_pk_bf16_f32 v31, v62, v63
    v_mfma_f32_16x16x32_bf16 v[188:191], a[248:251], a[240:243], v[188:191]
    v_mfma_f32_16x16x32_bf16 v[188:191], a[252:255], a[244:247], v[188:191]
.p2align 3
L_att:
    s_waitcnt lgkmcnt(3)
    v_mfma_f32_16x16x32_bf16 v[32:35], a[192:195], v[0:3], 0
    v_cvt_pk_bf16_f32 v88, v112, v113
    v_cvt_pk_bf16_f32 v89, v114, v115
    v_mfma_f32_16x16x32_bf16 v[32:35], a[196:199], v[8:11], v[32:35]
    v_cvt_pk_bf16_f32 v90, v116, v117
    v_cvt_pk_bf16_f32 v91, v118, v119
    v_mfma_f32_16x16x32_bf16 v[32:35], a[200:203], v[16:19], v[32:35]
    v_cvt_pk_bf16_f32 v92, v120, v121
    v_cvt_pk_bf16_f32 v93, v122, v123
    v_mfma_f32_16x16x32_bf16 v[32:35], a[204:207], v[24:27], v[32:35]
    v_cvt_pk_bf16_f32 v94, v124, v125
    v_cvt_pk_bf16_f32 v95, v126, v127
    v_mfma_f32_16x16x32_bf16 v[36:39], a[208:211], v[0:3], 0
    s_waitcnt lgkmcnt(0)
    v_cvt_pk_bf16_f32 v152, v176, v177
    v_cvt_pk_bf16_f32 v153, v178, v179
    v_mfma_f32_16x16x32_bf16 v[36:39], a[212:215], v[8:11], v[36:39]
    v_cvt_pk_bf16_f32 v154, v180, v181
    v_cvt_pk_bf16_f32 v155, v182, v183
    v_mfma_f32_16x16x32_bf16 v[36:39], a[216:219], v[16:19], v[36:39]
    v_cvt_pk_bf16_f32 v156, v184, v185
    v_cvt_pk_bf16_f32 v157, v186, v187
    v_mfma_f32_16x16x32_bf16 v[36:39], a[220:223], v[24:27], v[36:39]
    v_cvt_pk_bf16_f32 v158, v188, v189
    v_cvt_pk_bf16_f32 v159, v190, v191
    v_mfma_f32_16x16x32_bf16 v[40:43], a[192:195], v[4:7], 0
    v_mfma_f32_16x16x32_bf16 v[40:43], a[196:199], v[12:15], v[40:43]
    v_max3_f32 v56, v32, v33, v34
    v_max3_f32 v58, v35, v36, v37
    v_mfma_f32_16x16x32_bf16 v[40:43], a[200:203], v[20:23], v[40:43]
    v_max3_f32 v56, v56, v38, v39
    v_max_f32 v56, v56, v58
    v_mov_b32 v58, v56
    v_mfma_f32_16x16x32_bf16 v[40:43], a[204:207], v[28:31], v[40:43]
    s_nop 0
    v_permlane32_swap_b32 v58, v56
    v_max_f32 v56, v56, v58
    v_mfma_f32_16x16x32_bf16 v[44:47], a[208:211], v[4:7], 0
    v_mov_b32 v58, v56
    s_nop 1
    v_permlane16_swap_b32 v58, v56
    v_mfma_f32_16x16x32_bf16 v[44:47], a[212:215], v[12:15], v[44:47]
    v_max_f32 v56, v56, v58
    v_mul_f32 v58, s7, v56
    v_fma_f32 v32, v32, s45, v58
    v_mfma_f32_16x16x32_bf16 v[44:47], a[216:219], v[20:23], v[44:47]
    s_add_u32 s44, s62, 24576
    v_exp_f32 v32, v32
    v_mfma_f32_16x16x32_bf16 v[44:47], a[220:223], v[28:31], v[44:47]
    s_barrier
    s_and_b32 s44, s44, 0x1ffff
    v_mfma_f32_16x16x32_bf16 v[96:99], a[192:195], v[64:67], 0
    s_add_u32 s44, s44, s36
    v_fma_f32 v33, v33, s45, v58
    v_fma_f32 v34, v34, s45, v58
    v_mfma_f32_16x16x32_bf16 v[96:99], a[196:199], v[72:75], v[96:99]
    s_add_u32 m0, s39, 16384
    ds_read_b64_tr_b16 a[224:225], v210 offset:49152
    v_fma_f32 v35, v35, s45, v58
    v_mfma_f32_16x16x32_bf16 v[96:99], a[200:203], v[80:83], v[96:99]
    buffer_load_dwordx4 v192, s[8:11], s44 offen nt lds
    buffer_load_dwordx4 v193, s[8:11], s44 offen offset:1024 nt lds
    v_mfma_f32_16x16x32_bf16 v[96:99], a[204:207], v[88:91], v[96:99]
    ds_read_b64_tr_b16 a[226:227], v210 offset:53248
    v_fma_f32 v36, v36, s45, v58
    v_mfma_f32_16x16x32_bf16 v[100:103], a[208:211], v[64:67], 0
    buffer_load_dwordx4 v194, s[8:11], s44 offen offset:2048 nt lds
    v_mfma_f32_16x16x32_bf16 v[100:103], a[212:215], v[72:75], v[100:103]
    ds_read_b64_tr_b16 a[228:229], v211 offset:49152
    v_fma_f32 v37, v37, s45, v58
    v_mfma_f32_16x16x32_bf16 v[100:103], a[216:219], v[80:83], v[100:103]
    buffer_load_dwordx4 v195, s[8:11], s44 offen offset:3072 nt lds
    v_mfma_f32_16x16x32_bf16 v[100:103], a[220:223], v[88:91], v[100:103]
    ds_read_b64_tr_b16 a[230:231], v211 offset:53248
    v_exp_f32 v33, v33
    v_mfma_f32_16x16x32_bf16 v[104:107], a[192:195], v[68:71], 0
    v_exp_f32 v34, v34
    v_mfma_f32_16x16x32_bf16 v[104:107], a[196:199], v[76:79], v[104:107]
    ds_read_b64_tr_b16 a[232:233], v212 offset:49152
    v_exp_f32 v35, v35
    v_mfma_f32_16x16x32_bf16 v[104:107], a[200:203], v[84:87], v[104:107]
    v_exp_f32 v36, v36
    v_mfma_f32_16x16x32_bf16 v[104:107], a[204:207], v[92:95], v[104:107]
    ds_read_b64_tr_b16 a[234:235], v212 offset:53248
    v_cvt_pk_bf16_f32 v32, v32, v33
    v_mfma_f32_16x16x32_bf16 v[108:111], a[208:211], v[68:71], 0
    v_exp_f32 v37, v37
    v_cvt_pk_bf16_f32 v33, v34, v35
    v_mfma_f32_16x16x32_bf16 v[108:111], a[212:215], v[76:79], v[108:111]
    ds_read_b64_tr_b16 a[236:237], v213 offset:49152
    v_cvt_pk_bf16_f32 v34, v36, v37
    v_mfma_f32_16x16x32_bf16 v[108:111], a[216:219], v[84:87], v[108:111]
    v_fma_f32 v38, v38, s45, v58
    v_exp_f32 v38, v38
    v_mfma_f32_16x16x32_bf16 v[108:111], a[220:223], v[92:95], v[108:111]
    ds_read_b64_tr_b16 a[238:239], v213 offset:53248
    v_fma_f32 v39, v39, s45, v58
    v_mfma_f32_16x16x32_bf16 v[160:163], a[192:195], v[128:131], 0
    v_exp_f32 v39, v39
    v_mfma_f32_16x16x32_bf16 v[160:163], a[196:199], v[136:139], v[160:163]
    ds_read_b64_tr_b16 a[240:241], v214 offset:49152
    v_cvt_pk_bf16_f32 v35, v38, v39
    v_max3_f32 v57, v40, v41, v42
    v_mfma_f32_16x16x32_bf16 v[160:163], a[200:203], v[144:147], v[160:163]
    v_max3_f32 v59, v43, v44, v45
    v_max3_f32 v57, v57, v46, v47
    v_mfma_f32_16x16x32_bf16 v[160:163], a[204:207], v[152:155], v[160:163]
    ds_read_b64_tr_b16 a[242:243], v214 offset:53248
    v_max_f32 v57, v57, v59
    v_mov_b32 v59, v57
    v_mfma_f32_16x16x32_bf16 v[164:167], a[208:211], v[128:131], 0
    s_nop 0
    v_permlane32_swap_b32 v59, v57
    v_max_f32 v57, v57, v59
    v_mfma_f32_16x16x32_bf16 v[164:167], a[212:215], v[136:139], v[164:167]
    ds_read_b64_tr_b16 a[244:245], v215 offset:49152
    v_mov_b32 v59, v57
    v_mfma_f32_16x16x32_bf16 v[164:167], a[216:219], v[144:147], v[164:167]
    v_permlane16_swap_b32 v59, v57
    v_max_f32 v57, v57, v59
    v_mul_f32 v59, s7, v57
    v_mfma_f32_16x16x32_bf16 v[164:167], a[220:223], v[152:155], v[164:167]
    ds_read_b64_tr_b16 a[246:247], v215 offset:53248
    v_fma_f32 v40, v40, s45, v59
    v_mfma_f32_16x16x32_bf16 v[168:171], a[192:195], v[132:135], 0
    ds_read_b128 a[192:195], v206
    v_exp_f32 v40, v40
    v_mfma_f32_16x16x32_bf16 v[168:171], a[196:199], v[140:143], v[168:171]
    ds_read_b64_tr_b16 a[248:249], v216 offset:49152
    v_fma_f32 v41, v41, s45, v59
    v_mfma_f32_16x16x32_bf16 v[168:171], a[200:203], v[148:151], v[168:171]
    ds_read_b128 a[196:199], v207
    v_fma_f32 v42, v42, s45, v59
    v_mfma_f32_16x16x32_bf16 v[168:171], a[204:207], v[156:159], v[168:171]
    ds_read_b64_tr_b16 a[250:251], v216 offset:53248
    v_exp_f32 v41, v41
    v_mfma_f32_16x16x32_bf16 v[172:175], a[208:211], v[132:135], 0
    ds_read_b128 a[200:203], v208
    v_cvt_pk_bf16_f32 v40, v40, v41
    v_mfma_f32_16x16x32_bf16 v[172:175], a[212:215], v[140:143], v[172:175]
    ds_read_b64_tr_b16 a[252:253], v217 offset:49152
    v_exp_f32 v42, v42
    v_mfma_f32_16x16x32_bf16 v[172:175], a[216:219], v[148:151], v[172:175]
    ds_read_b128 a[204:207], v209
    v_fma_f32 v43, v43, s45, v59
    v_mfma_f32_16x16x32_bf16 v[172:175], a[220:223], v[156:159], v[172:175]
    s_waitcnt lgkmcnt(7)
    ds_read_b64_tr_b16 a[254:255], v217 offset:53248
    v_exp_f32 v43, v43
    s_nop 0
    v_cvt_pk_bf16_f32 v41, v42, v43
    v_fma_f32 v44, v44, s45, v59
    v_exp_f32 v44, v44
    v_fma_f32 v45, v45, s45, v59
    v_exp_f32 v45, v45
    s_nop 0
    v_cvt_pk_bf16_f32 v42, v44, v45
    v_fma_f32 v46, v46, s45, v59
    v_exp_f32 v46, v46
    v_fma_f32 v47, v47, s45, v59
    v_exp_f32 v47, v47
    s_nop 0
    v_cvt_pk_bf16_f32 v43, v46, v47
    v_mfma_f32_16x16x32_bf16 a[0:3], a[224:227], v[32:35], 0
    v_max3_f32 v120, v96, v97, v98
    v_max3_f32 v122, v99, v100, v101
    v_max3_f32 v120, v120, v102, v103
    v_mfma_f32_16x16x32_bf16 a[32:35], a[224:227], v[40:43], 0
    ds_read_b128 a[208:211], v206 offset:4096
    v_max_f32 v120, v120, v122
    v_mfma_f32_16x16x32_bf16 a[4:7], a[228:231], v[32:35], 0
    v_mov_b32 v122, v120
    s_nop 1
    v_permlane32_swap_b32 v122, v120
    v_max_f32 v120, v120, v122
    v_mfma_f32_16x16x32_bf16 a[36:39], a[228:231], v[40:43], 0
    ds_read_b128 a[212:215], v207 offset:4096
    v_mov_b32 v122, v120
    v_mfma_f32_16x16x32_bf16 a[8:11], a[232:235], v[32:35], 0
    v_permlane16_swap_b32 v122, v120
    v_max_f32 v120, v120, v122
    v_mfma_f32_16x16x32_bf16 a[40:43], a[232:235], v[40:43], 0
    ds_read_b128 a[216:219], v208 offset:4096
    v_mul_f32 v122, s7, v120
    v_fma_f32 v96, v96, s45, v122
    v_mfma_f32_16x16x32_bf16 a[12:15], a[236:239], v[32:35], 0
    v_exp_f32 v96, v96
    v_mfma_f32_16x16x32_bf16 a[44:47], a[236:239], v[40:43], 0
    ds_read_b128 a[220:223], v209 offset:4096
    v_fma_f32 v97, v97, s45, v122
    v_fma_f32 v98, v98, s45, v122
    v_mfma_f32_16x16x32_bf16 a[16:19], a[240:243], v[32:35], 0
    v_exp_f32 v97, v97
    v_mfma_f32_16x16x32_bf16 a[48:51], a[240:243], v[40:43], 0
    v_exp_f32 v98, v98
    v_mfma_f32_16x16x32_bf16 a[20:23], a[244:247], v[32:35], 0
    v_cvt_pk_bf16_f32 v96, v96, v97
    v_fma_f32 v99, v99, s45, v122
    v_fma_f32 v100, v100, s45, v122
    v_mfma_f32_16x16x32_bf16 a[52:55], a[244:247], v[40:43], 0
    s_waitcnt lgkmcnt(2)
    v_exp_f32 v99, v99
    v_mfma_f32_16x16x32_bf16 a[24:27], a[248:251], v[32:35], 0
    v_exp_f32 v100, v100
    v_cvt_pk_bf16_f32 v97, v98, v99
    v_mfma_f32_16x16x32_bf16 a[56:59], a[248:251], v[40:43], 0
    v_fma_f32 v101, v101, s45, v122
    v_fma_f32 v102, v102, s45, v122
    v_mfma_f32_16x16x32_bf16 a[28:31], a[252:255], v[32:35], 0
    v_exp_f32 v101, v101
    v_mfma_f32_16x16x32_bf16 a[60:63], a[252:255], v[40:43], 0
    v_exp_f32 v102, v102
    v_cvt_pk_bf16_f32 v98, v100, v101
    v_mfma_f32_16x16x32_bf16 v[48:51], v[224:227], v[32:35], 0
    v_fma_f32 v103, v103, s45, v122
    v_max3_f32 v121, v104, v105, v106
    v_mfma_f32_16x16x32_bf16 v[52:55], v[224:227], v[40:43], 0
    v_exp_f32 v103, v103
    v_max3_f32 v123, v107, v108, v109
    v_mfma_f32_16x16x32_bf16 v[32:35], a[192:195], v[0:3], 0
    s_add_u32 s43, s62, 24576
    v_cvt_pk_bf16_f32 v99, v102, v103
    v_max3_f32 v121, v121, v110, v111
    v_mfma_f32_16x16x32_bf16 v[32:35], a[196:199], v[8:11], v[32:35]
    s_and_b32 s43, s43, 0x1ffff
    v_max_f32 v121, v121, v123
    v_mov_b32 v123, v121
    v_mfma_f32_16x16x32_bf16 v[32:35], a[200:203], v[16:19], v[32:35]
    s_add_u32 s43, s43, s36
    v_permlane32_swap_b32 v123, v121
    v_max_f32 v121, v121, v123
    v_mov_b32 v123, v121
    v_mfma_f32_16x16x32_bf16 v[32:35], a[204:207], v[24:27], v[32:35]
    s_add_u32 m0, s39, 131072
    v_permlane16_swap_b32 v123, v121
    v_max_f32 v121, v121, v123
    v_mfma_f32_16x16x32_bf16 v[36:39], a[208:211], v[0:3], 0
    buffer_load_dwordx4 v196, s[12:15], s43 offen nt lds
    v_mfma_f32_16x16x32_bf16 v[36:39], a[212:215], v[8:11], v[36:39]
    s_waitcnt lgkmcnt(0)
    v_mul_f32 v123, s7, v121
    v_fma_f32 v104, v104, s45, v123
    v_mfma_f32_16x16x32_bf16 v[36:39], a[216:219], v[16:19], v[36:39]
    buffer_load_dwordx4 v197, s[12:15], s43 offen offset:1024 nt lds
    v_mfma_f32_16x16x32_bf16 v[36:39], a[220:223], v[24:27], v[36:39]
    v_exp_f32 v104, v104
    v_fma_f32 v105, v105, s45, v123
    v_mfma_f32_16x16x32_bf16 v[40:43], a[192:195], v[4:7], 0
    buffer_load_dwordx4 v196, s[12:15], s43 offen offset:2048 nt lds
    v_mfma_f32_16x16x32_bf16 v[40:43], a[196:199], v[12:15], v[40:43]
    v_add_u32 v206, 0xffff0000, v206
    v_add_u32 v207, 0xffff0000, v207
    v_mfma_f32_16x16x32_bf16 v[40:43], a[200:203], v[20:23], v[40:43]
    buffer_load_dwordx4 v197, s[12:15], s43 offen offset:3072 nt lds
    v_mfma_f32_16x16x32_bf16 v[40:43], a[204:207], v[28:31], v[40:43]
    v_exp_f32 v105, v105
    v_mfma_f32_16x16x32_bf16 v[44:47], a[208:211], v[4:7], 0
    v_add_u32 v208, 0xffff0000, v208
    v_add_u32 v209, 0xffff0000, v209
    v_mfma_f32_16x16x32_bf16 v[44:47], a[212:215], v[12:15], v[44:47]
    v_cvt_pk_bf16_f32 v104, v104, v105
    v_fma_f32 v106, v106, s45, v123
    v_mfma_f32_16x16x32_bf16 v[44:47], a[216:219], v[20:23], v[44:47]
    v_exp_f32 v106, v106
    v_fma_f32 v107, v107, s45, v123
    v_mfma_f32_16x16x32_bf16 v[44:47], a[220:223], v[28:31], v[44:47]
    v_exp_f32 v107, v107
    s_nop 0
    v_cvt_pk_bf16_f32 v105, v106, v107
    v_fma_f32 v108, v108, s45, v123
    v_exp_f32 v108, v108
    v_fma_f32 v109, v109, s45, v123
    v_exp_f32 v109, v109
    s_nop 0
    v_cvt_pk_bf16_f32 v106, v108, v109
    v_fma_f32 v110, v110, s45, v123
    v_exp_f32 v110, v110
    v_fma_f32 v111, v111, s45, v123
    v_exp_f32 v111, v111
    s_nop 0
    v_cvt_pk_bf16_f32 v107, v110, v111
    v_mfma_f32_16x16x32_bf16 a[64:67], a[224:227], v[96:99], 0
    v_max3_f32 v184, v160, v161, v162
    v_max3_f32 v186, v163, v164, v165
    v_mfma_f32_16x16x32_bf16 a[96:99], a[224:227], v[104:107], 0
    v_max3_f32 v184, v184, v166, v167
    v_max_f32 v184, v184, v186
    v_mov_b32 v186, v184
    v_mfma_f32_16x16x32_bf16 a[68:71], a[228:231], v[96:99], 0
    s_nop 0
    v_permlane32_swap_b32 v186, v184
    v_max_f32 v184, v184, v186
    v_mfma_f32_16x16x32_bf16 a[100:103], a[228:231], v[104:107], 0
    v_mov_b32 v186, v184
    s_nop 1
    v_permlane16_swap_b32 v186, v184
    v_max_f32 v184, v184, v186
    v_mfma_f32_16x16x32_bf16 a[72:75], a[232:235], v[96:99], 0
    v_mul_f32 v186, s7, v184
    v_fma_f32 v160, v160, s45, v186
    v_mfma_f32_16x16x32_bf16 a[104:107], a[232:235], v[104:107], 0
    v_exp_f32 v160, v160
    v_mfma_f32_16x16x32_bf16 a[76:79], a[236:239], v[96:99], 0
    v_fma_f32 v161, v161, s45, v186
    v_exp_f32 v161, v161
    v_mfma_f32_16x16x32_bf16 a[108:111], a[236:239], v[104:107], 0
    v_cvt_pk_bf16_f32 v160, v160, v161
    v_fma_f32 v162, v162, s45, v186
    v_mfma_f32_16x16x32_bf16 a[80:83], a[240:243], v[96:99], 0
    v_exp_f32 v162, v162
    v_fma_f32 v163, v163, s45, v186
    v_mfma_f32_16x16x32_bf16 a[112:115], a[240:243], v[104:107], 0
    v_exp_f32 v163, v163
    v_mfma_f32_16x16x32_bf16 a[84:87], a[244:247], v[96:99], 0
    v_cvt_pk_bf16_f32 v161, v162, v163
    v_fma_f32 v164, v164, s45, v186
    v_mfma_f32_16x16x32_bf16 a[116:119], a[244:247], v[104:107], 0
    v_exp_f32 v164, v164
    v_fma_f32 v165, v165, s45, v186
    v_mfma_f32_16x16x32_bf16 a[88:91], a[248:251], v[96:99], 0
    v_exp_f32 v165, v165
    v_mfma_f32_16x16x32_bf16 a[120:123], a[248:251], v[104:107], 0
    v_cvt_pk_bf16_f32 v162, v164, v165
    v_fma_f32 v166, v166, s45, v186
    v_fma_f32 v167, v167, s45, v186
    v_mfma_f32_16x16x32_bf16 a[92:95], a[252:255], v[96:99], 0
    v_exp_f32 v166, v166
    v_mfma_f32_16x16x32_bf16 a[124:127], a[252:255], v[104:107], 0
    v_exp_f32 v167, v167
    v_mfma_f32_16x16x32_bf16 v[112:115], v[224:227], v[96:99], 0
    v_cvt_pk_bf16_f32 v163, v166, v167
    v_max3_f32 v185, v168, v169, v170
    v_max3_f32 v187, v171, v172, v173
    v_mfma_f32_16x16x32_bf16 v[116:119], v[224:227], v[104:107], 0
    v_max3_f32 v185, v185, v174, v175
    v_max_f32 v185, v185, v187
    v_mfma_f32_16x16x32_bf16 v[96:99], a[192:195], v[64:67], 0
    v_mov_b32 v187, v185
    s_nop 1
    v_permlane32_swap_b32 v187, v185
    v_max_f32 v185, v185, v187
    v_mfma_f32_16x16x32_bf16 v[96:99], a[196:199], v[72:75], v[96:99]
    v_mov_b32 v187, v185
    s_nop 1
    v_permlane16_swap_b32 v187, v185
    v_mfma_f32_16x16x32_bf16 v[96:99], a[200:203], v[80:83], v[96:99]
    v_max_f32 v185, v185, v187
    v_mul_f32 v187, s7, v185
    v_mfma_f32_16x16x32_bf16 v[96:99], a[204:207], v[88:91], v[96:99]
    v_fma_f32 v168, v168, s45, v187
    v_exp_f32 v168, v168
    v_mfma_f32_16x16x32_bf16 v[100:103], a[208:211], v[64:67], 0
    v_fma_f32 v169, v169, s45, v187
    v_fma_f32 v170, v170, s45, v187
    v_mfma_f32_16x16x32_bf16 v[100:103], a[212:215], v[72:75], v[100:103]
    v_exp_f32 v169, v169
    v_fma_f32 v171, v171, s45, v187
    v_mfma_f32_16x16x32_bf16 v[100:103], a[216:219], v[80:83], v[100:103]
    v_exp_f32 v170, v170
    v_mfma_f32_16x16x32_bf16 v[100:103], a[220:223], v[88:91], v[100:103]
    v_exp_f32 v171, v171
    v_mfma_f32_16x16x32_bf16 v[104:107], a[192:195], v[68:71], 0
    v_cvt_pk_bf16_f32 v168, v168, v169
    v_cvt_pk_bf16_f32 v169, v170, v171
    v_fma_f32 v172, v172, s45, v187
    v_mfma_f32_16x16x32_bf16 v[104:107], a[196:199], v[76:79], v[104:107]
    v_exp_f32 v172, v172
    v_mfma_f32_16x16x32_bf16 v[104:107], a[200:203], v[84:87], v[104:107]
    v_fma_f32 v173, v173, s45, v187
    v_exp_f32 v173, v173
    v_mfma_f32_16x16x32_bf16 v[104:107], a[204:207], v[92:95], v[104:107]
    v_cvt_pk_bf16_f32 v170, v172, v173
    v_fma_f32 v174, v174, s45, v187
    v_mfma_f32_16x16x32_bf16 v[108:111], a[208:211], v[68:71], 0
    v_exp_f32 v174, v174
    v_mfma_f32_16x16x32_bf16 v[108:111], a[212:215], v[76:79], v[108:111]
    v_fma_f32 v175, v175, s45, v187
    v_exp_f32 v175, v175
    v_mfma_f32_16x16x32_bf16 v[108:111], a[216:219], v[84:87], v[108:111]
    v_cvt_pk_bf16_f32 v171, v174, v175
    v_fma_f32 v32, v32, s45, v58
    v_mfma_f32_16x16x32_bf16 v[108:111], a[220:223], v[92:95], v[108:111]
    s_waitcnt vmcnt(12)
    s_barrier
    v_mfma_f32_16x16x32_bf16 a[128:131], a[224:227], v[160:163], 0
    v_exp_f32 v32, v32
    v_mfma_f32_16x16x32_bf16 a[160:163], a[224:227], v[168:171], 0
    ds_read_b64_tr_b16 a[224:225], v210
    v_fma_f32 v33, v33, s45, v58
    v_mfma_f32_16x16x32_bf16 a[132:135], a[228:231], v[160:163], 0
    v_exp_f32 v33, v33
    v_fma_f32 v34, v34, s45, v58
    v_mfma_f32_16x16x32_bf16 a[164:167], a[228:231], v[168:171], 0
    ds_read_b64_tr_b16 a[226:227], v210 offset:4096
    v_cvt_pk_bf16_f32 v32, v32, v33
    v_mfma_f32_16x16x32_bf16 a[136:139], a[232:235], v[160:163], 0
    s_add_u32 s44, s62, 32768
    v_exp_f32 v34, v34
    v_fma_f32 v35, v35, s45, v58
    v_mfma_f32_16x16x32_bf16 a[168:171], a[232:235], v[168:171], 0
    s_and_b32 s44, s44, 0x1ffff
    ds_read_b64_tr_b16 a[228:229], v211
    v_fma_f32 v36, v36, s45, v58
    v_mfma_f32_16x16x32_bf16 a[140:143], a[236:239], v[160:163], 0
    s_add_u32 s44, s44, s36
    v_exp_f32 v35, v35
    v_mfma_f32_16x16x32_bf16 a[172:175], a[236:239], v[168:171], 0
    s_add_u32 m0, s39, 147456
    ds_read_b64_tr_b16 a[230:231], v211 offset:4096
    v_exp_f32 v36, v36
    v_mfma_f32_16x16x32_bf16 a[144:147], a[240:243], v[160:163], 0
    buffer_load_dwordx4 v192, s[8:11], s44 offen nt lds
    v_mfma_f32_16x16x32_bf16 a[176:179], a[240:243], v[168:171], 0
    ds_read_b64_tr_b16 a[232:233], v212
    v_cvt_pk_bf16_f32 v33, v34, v35
    v_fma_f32 v37, v37, s45, v58
    v_mfma_f32_16x16x32_bf16 a[148:151], a[244:247], v[160:163], 0
    buffer_load_dwordx4 v193, s[8:11], s44 offen offset:1024 nt lds
    v_mfma_f32_16x16x32_bf16 a[180:183], a[244:247], v[168:171], 0
    ds_read_b64_tr_b16 a[234:235], v212 offset:4096
    v_fma_f32 v38, v38, s45, v58
    v_mfma_f32_16x16x32_bf16 a[152:155], a[248:251], v[160:163], 0
    buffer_load_dwordx4 v194, s[8:11], s44 offen offset:2048 nt lds
    v_mfma_f32_16x16x32_bf16 a[184:187], a[248:251], v[168:171], 0
    ds_read_b64_tr_b16 a[236:237], v213
    v_fma_f32 v39, v39, s45, v58
    v_mfma_f32_16x16x32_bf16 a[156:159], a[252:255], v[160:163], 0
    buffer_load_dwordx4 v195, s[8:11], s44 offen offset:3072 nt lds
    v_mfma_f32_16x16x32_bf16 a[188:191], a[252:255], v[168:171], 0
    ds_read_b64_tr_b16 a[238:239], v213 offset:4096
    v_fma_f32 v40, v40, s45, v59
    v_mfma_f32_16x16x32_bf16 v[176:179], v[224:227], v[160:163], 0
    v_exp_f32 v37, v37
    v_mfma_f32_16x16x32_bf16 v[180:183], v[224:227], v[168:171], 0
    ds_read_b64_tr_b16 a[240:241], v214
    v_exp_f32 v38, v38
    v_mfma_f32_16x16x32_bf16 v[160:163], a[192:195], v[128:131], 0
    v_exp_f32 v39, v39
    v_mfma_f32_16x16x32_bf16 v[160:163], a[196:199], v[136:139], v[160:163]
    ds_read_b64_tr_b16 a[242:243], v214 offset:4096
    v_exp_f32 v40, v40
    v_mfma_f32_16x16x32_bf16 v[160:163], a[200:203], v[144:147], v[160:163]
    v_cvt_pk_bf16_f32 v34, v36, v37
    v_cvt_pk_bf16_f32 v35, v38, v39
    v_mfma_f32_16x16x32_bf16 v[160:163], a[204:207], v[152:155], v[160:163]
    ds_read_b64_tr_b16 a[244:245], v215
    v_fma_f32 v41, v41, s45, v59
    v_mfma_f32_16x16x32_bf16 v[164:167], a[208:211], v[128:131], 0
    v_exp_f32 v41, v41
    v_fma_f32 v42, v42, s45, v59
    v_mfma_f32_16x16x32_bf16 v[164:167], a[212:215], v[136:139], v[164:167]
    ds_read_b64_tr_b16 a[246:247], v215 offset:4096
    v_cvt_pk_bf16_f32 v40, v40, v41
    v_mfma_f32_16x16x32_bf16 v[164:167], a[216:219], v[144:147], v[164:167]
    v_exp_f32 v42, v42
    v_fma_f32 v43, v43, s45, v59
    v_mfma_f32_16x16x32_bf16 v[164:167], a[220:223], v[152:155], v[164:167]
    ds_read_b64_tr_b16 a[248:249], v216
    v_fma_f32 v44, v44, s45, v59
    v_mfma_f32_16x16x32_bf16 v[168:171], a[192:195], v[132:135], 0
    ds_read_b128 a[192:195], v206
    v_fma_f32 v45, v45, s45, v59
    v_mfma_f32_16x16x32_bf16 v[168:171], a[196:199], v[140:143], v[168:171]
    ds_read_b64_tr_b16 a[250:251], v216 offset:4096
    v_exp_f32 v43, v43
    v_mfma_f32_16x16x32_bf16 v[168:171], a[200:203], v[148:151], v[168:171]
    ds_read_b128 a[196:199], v207
    v_cvt_pk_bf16_f32 v41, v42, v43
    v_mfma_f32_16x16x32_bf16 v[168:171], a[204:207], v[156:159], v[168:171]
    ds_read_b64_tr_b16 a[252:253], v217
    v_exp_f32 v44, v44
    v_mfma_f32_16x16x32_bf16 v[172:175], a[208:211], v[132:135], 0
    ds_read_b128 a[200:203], v208
    v_fma_f32 v46, v46, s45, v59
    v_mfma_f32_16x16x32_bf16 v[172:175], a[212:215], v[140:143], v[172:175]
    ds_read_b64_tr_b16 a[254:255], v217 offset:4096
    v_fma_f32 v47, v47, s45, v59
    v_mfma_f32_16x16x32_bf16 v[172:175], a[216:219], v[148:151], v[172:175]
    ds_read_b128 a[204:207], v209
    v_exp_f32 v45, v45
    v_mfma_f32_16x16x32_bf16 v[172:175], a[220:223], v[156:159], v[172:175]
    s_waitcnt lgkmcnt(7)
    v_cvt_pk_bf16_f32 v42, v44, v45
    v_exp_f32 v46, v46
    v_exp_f32 v47, v47
    s_nop 0
    v_cvt_pk_bf16_f32 v43, v46, v47
    v_mfma_f32_16x16x32_bf16 a[0:3], a[224:227], v[32:35], a[0:3]
    v_fma_f32 v96, v96, s45, v122
    v_exp_f32 v96, v96
    v_mfma_f32_16x16x32_bf16 a[32:35], a[224:227], v[40:43], a[32:35]
    ds_read_b128 a[208:211], v206 offset:4096
    v_fma_f32 v97, v97, s45, v122
    v_mfma_f32_16x16x32_bf16 a[4:7], a[228:231], v[32:35], a[4:7]
    v_exp_f32 v97, v97
    v_mfma_f32_16x16x32_bf16 a[36:39], a[228:231], v[40:43], a[36:39]
    ds_read_b128 a[212:215], v207 offset:4096
    v_cvt_pk_bf16_f32 v96, v96, v97
    v_fma_f32 v98, v98, s45, v122
    v_mfma_f32_16x16x32_bf16 a[8:11], a[232:235], v[32:35], a[8:11]
    v_exp_f32 v98, v98
    v_mfma_f32_16x16x32_bf16 a[40:43], a[232:235], v[40:43], a[40:43]
    ds_read_b128 a[216:219], v208 offset:4096
    v_fma_f32 v99, v99, s45, v122
    v_fma_f32 v100, v100, s45, v122
    v_mfma_f32_16x16x32_bf16 a[12:15], a[236:239], v[32:35], a[12:15]
    v_exp_f32 v99, v99
    v_mfma_f32_16x16x32_bf16 a[44:47], a[236:239], v[40:43], a[44:47]
    ds_read_b128 a[220:223], v209 offset:4096
    v_cvt_pk_bf16_f32 v97, v98, v99
    v_mfma_f32_16x16x32_bf16 a[16:19], a[240:243], v[32:35], a[16:19]
    v_exp_f32 v100, v100
    v_fma_f32 v101, v101, s45, v122
    v_mfma_f32_16x16x32_bf16 a[48:51], a[240:243], v[40:43], a[48:51]
    v_exp_f32 v101, v101
    v_mfma_f32_16x16x32_bf16 a[20:23], a[244:247], v[32:35], a[20:23]
    v_cvt_pk_bf16_f32 v98, v100, v101
    v_fma_f32 v102, v102, s45, v122
    v_fma_f32 v103, v103, s45, v122
    v_mfma_f32_16x16x32_bf16 a[52:55], a[244:247], v[40:43], a[52:55]
    s_waitcnt lgkmcnt(2)
    v_exp_f32 v102, v102
    v_mfma_f32_16x16x32_bf16 a[24:27], a[248:251], v[32:35], a[24:27]
    v_exp_f32 v103, v103
    v_mfma_f32_16x16x32_bf16 a[56:59], a[248:251], v[40:43], a[56:59]
    v_cvt_pk_bf16_f32 v99, v102, v103
    v_fma_f32 v104, v104, s45, v123
    v_fma_f32 v105, v105, s45, v123
    v_mfma_f32_16x16x32_bf16 a[28:31], a[252:255], v[32:35], a[28:31]
    v_exp_f32 v104, v104
    v_mfma_f32_16x16x32_bf16 a[60:63], a[252:255], v[40:43], a[60:63]
    v_exp_f32 v105, v105
    v_fma_f32 v106, v106, s45, v123
    v_mfma_f32_16x16x32_bf16 v[48:51], v[224:227], v[32:35], v[48:51]
    v_exp_f32 v106, v106
    v_mfma_f32_16x16x32_bf16 v[52:55], v[224:227], v[40:43], v[52:55]
    v_cvt_pk_bf16_f32 v104, v104, v105
    v_fma_f32 v107, v107, s45, v123
    v_mfma_f32_16x16x32_bf16 v[32:35], a[192:195], v[0:3], 0
    v_exp_f32 v107, v107
    v_mfma_f32_16x16x32_bf16 v[32:35], a[196:199], v[8:11], v[32:35]
    v_cvt_pk_bf16_f32 v105, v106, v107
    v_fma_f32 v108, v108, s45, v123
    v_mfma_f32_16x16x32_bf16 v[32:35], a[200:203], v[16:19], v[32:35]
    v_exp_f32 v108, v108
    v_mfma_f32_16x16x32_bf16 v[32:35], a[204:207], v[24:27], v[32:35]
    v_fma_f32 v109, v109, s45, v123
    v_fma_f32 v110, v110, s45, v123
    v_mfma_f32_16x16x32_bf16 v[36:39], a[208:211], v[0:3], 0
    v_exp_f32 v109, v109
    v_mfma_f32_16x16x32_bf16 v[36:39], a[212:215], v[8:11], v[36:39]
    s_waitcnt lgkmcnt(0)
    v_exp_f32 v110, v110
    v_mfma_f32_16x16x32_bf16 v[36:39], a[216:219], v[16:19], v[36:39]
    s_add_u32 s43, s62, 32768
    v_cvt_pk_bf16_f32 v106, v108, v109
    v_fma_f32 v111, v111, s45, v123
    v_fma_f32 v160, v160, s45, v186
    v_mfma_f32_16x16x32_bf16 v[36:39], a[220:223], v[24:27], v[36:39]
    s_and_b32 s43, s43, 0x1ffff
    v_exp_f32 v111, v111
    v_mfma_f32_16x16x32_bf16 v[40:43], a[192:195], v[4:7], 0
    s_add_u32 s43, s43, s36
    v_exp_f32 v160, v160
    v_mfma_f32_16x16x32_bf16 v[40:43], a[196:199], v[12:15], v[40:43]
    s_add_u32 m0, s39, 49152
    v_cvt_pk_bf16_f32 v107, v110, v111
    v_fma_f32 v161, v161, s45, v186
    v_mfma_f32_16x16x32_bf16 v[40:43], a[200:203], v[20:23], v[40:43]
    buffer_load_dwordx4 v196, s[12:15], s43 offen nt lds
    v_mfma_f32_16x16x32_bf16 v[40:43], a[204:207], v[28:31], v[40:43]
    v_exp_f32 v161, v161
    v_mfma_f32_16x16x32_bf16 v[44:47], a[208:211], v[4:7], 0
    buffer_load_dwordx4 v197, s[12:15], s43 offen offset:1024 nt lds
    v_mfma_f32_16x16x32_bf16 v[44:47], a[212:215], v[12:15], v[44:47]
    v_cvt_pk_bf16_f32 v160, v160, v161
    v_fma_f32 v162, v162, s45, v186
    v_mfma_f32_16x16x32_bf16 v[44:47], a[216:219], v[20:23], v[44:47]
    buffer_load_dwordx4 v196, s[12:15], s43 offen offset:2048 nt lds
    v_mfma_f32_16x16x32_bf16 v[44:47], a[220:223], v[28:31], v[44:47]
    v_exp_f32 v162, v162
    v_mfma_f32_16x16x32_bf16 a[64:67], a[224:227], v[96:99], a[64:67]
    buffer_load_dwordx4 v197, s[12:15], s43 offen offset:3072 nt lds
    v_mfma_f32_16x16x32_bf16 a[96:99], a[224:227], v[104:107], a[96:99]
    v_fma_f32 v163, v163, s45, v186
    v_fma_f32 v164, v164, s45, v186
    v_mfma_f32_16x16x32_bf16 a[68:71], a[228:231], v[96:99], a[68:71]
    v_exp_f32 v163, v163
    v_mfma_f32_16x16x32_bf16 a[100:103], a[228:231], v[104:107], a[100:103]
    v_exp_f32 v164, v164
    v_cvt_pk_bf16_f32 v161, v162, v163
    v_mfma_f32_16x16x32_bf16 a[72:75], a[232:235], v[96:99], a[72:75]
    v_fma_f32 v165, v165, s45, v186
    v_fma_f32 v166, v166, s45, v186
    v_mfma_f32_16x16x32_bf16 a[104:107], a[232:235], v[104:107], a[104:107]
    v_exp_f32 v165, v165
    v_mfma_f32_16x16x32_bf16 a[76:79], a[236:239], v[96:99], a[76:79]
    v_exp_f32 v166, v166
    v_mfma_f32_16x16x32_bf16 a[108:111], a[236:239], v[104:107], a[108:111]
    v_cvt_pk_bf16_f32 v162, v164, v165
    v_fma_f32 v167, v167, s45, v186
    v_mfma_f32_16x16x32_bf16 a[80:83], a[240:243], v[96:99], a[80:83]
    v_exp_f32 v167, v167
    v_mfma_f32_16x16x32_bf16 a[112:115], a[240:243], v[104:107], a[112:115]
    v_cvt_pk_bf16_f32 v163, v166, v167
    v_fma_f32 v168, v168, s45, v187
    v_mfma_f32_16x16x32_bf16 a[84:87], a[244:247], v[96:99], a[84:87]
    v_exp_f32 v168, v168
    v_fma_f32 v169, v169, s45, v187
    v_mfma_f32_16x16x32_bf16 a[116:119], a[244:247], v[104:107], a[116:119]
    v_exp_f32 v169, v169
    v_mfma_f32_16x16x32_bf16 a[88:91], a[248:251], v[96:99], a[88:91]
    v_cvt_pk_bf16_f32 v168, v168, v169
    v_fma_f32 v170, v170, s45, v187
    v_mfma_f32_16x16x32_bf16 a[120:123], a[248:251], v[104:107], a[120:123]
    v_exp_f32 v170, v170
    v_mfma_f32_16x16x32_bf16 a[92:95], a[252:255], v[96:99], a[92:95]
    v_fma_f32 v171, v171, s45, v187
    v_fma_f32 v172, v172, s45, v187
    v_mfma_f32_16x16x32_bf16 a[124:127], a[252:255], v[104:107], a[124:127]
    v_exp_f32 v171, v171
    v_mfma_f32_16x16x32_bf16 v[112:115], v[224:227], v[96:99], v[112:115]
    v_exp_f32 v172, v172
    v_cvt_pk_bf16_f32 v169, v170, v171
    v_mfma_f32_16x16x32_bf16 v[116:119], v[224:227], v[104:107], v[116:119]
    v_fma_f32 v173, v173, s45, v187
    v_fma_f32 v174, v174, s45, v187
    v_mfma_f32_16x16x32_bf16 v[96:99], a[192:195], v[64:67], 0
    v_exp_f32 v173, v173
    v_mfma_f32_16x16x32_bf16 v[96:99], a[196:199], v[72:75], v[96:99]
    v_exp_f32 v174, v174
    v_mfma_f32_16x16x32_bf16 v[96:99], a[200:203], v[80:83], v[96:99]
    v_cvt_pk_bf16_f32 v170, v172, v173
    v_fma_f32 v175, v175, s45, v187
    v_mfma_f32_16x16x32_bf16 v[96:99], a[204:207], v[88:91], v[96:99]
    v_exp_f32 v175, v175
    v_mfma_f32_16x16x32_bf16 v[100:103], a[208:211], v[64:67], 0
    v_cvt_pk_bf16_f32 v171, v174, v175
    v_fma_f32 v32, v32, s45, v58
    v_mfma_f32_16x16x32_bf16 v[100:103], a[212:215], v[72:75], v[100:103]
    v_exp_f32 v32, v32
    v_fma_f32 v33, v33, s45, v58
    v_mfma_f32_16x16x32_bf16 v[100:103], a[216:219], v[80:83], v[100:103]
    v_exp_f32 v33, v33
    v_mfma_f32_16x16x32_bf16 v[100:103], a[220:223], v[88:91], v[100:103]
    v_cvt_pk_bf16_f32 v32, v32, v33
    v_fma_f32 v34, v34, s45, v58
    v_mfma_f32_16x16x32_bf16 v[104:107], a[192:195], v[68:71], 0
    v_exp_f32 v34, v34
    v_mfma_f32_16x16x32_bf16 v[104:107], a[196:199], v[76:79], v[104:107]
    v_fma_f32 v35, v35, s45, v58
    v_fma_f32 v36, v36, s45, v58
    v_mfma_f32_16x16x32_bf16 v[104:107], a[200:203], v[84:87], v[104:107]
    v_exp_f32 v35, v35
    v_mfma_f32_16x16x32_bf16 v[104:107], a[204:207], v[92:95], v[104:107]
    v_exp_f32 v36, v36
    v_mfma_f32_16x16x32_bf16 v[108:111], a[208:211], v[68:71], 0
    v_cvt_pk_bf16_f32 v33, v34, v35
    v_fma_f32 v37, v37, s45, v58
    v_fma_f32 v38, v38, s45, v58
    v_mfma_f32_16x16x32_bf16 v[108:111], a[212:215], v[76:79], v[108:111]
    v_exp_f32 v37, v37
    v_mfma_f32_16x16x32_bf16 v[108:111], a[216:219], v[84:87], v[108:111]
    v_exp_f32 v38, v38
    v_mfma_f32_16x16x32_bf16 v[108:111], a[220:223], v[92:95], v[108:111]
    s_waitcnt vmcnt(12)
    s_barrier
    v_mfma_f32_16x16x32_bf16 a[128:131], a[224:227], v[160:163], a[128:131]
    s_cmp_eq_u32 s42, 0
    s_cselect_b32 s54, s66, s65
    s_cselect_b32 s55, 0x10000, 1
    v_mfma_f32_16x16x32_bf16 a[160:163], a[224:227], v[168:171], a[160:163]
    ds_read_b64_tr_b16 a[224:225], v210 offset:16384
    v_cvt_pk_bf16_f32 v34, v36, v37
    v_mfma_f32_16x16x32_bf16 a[132:135], a[228:231], v[160:163], a[132:135]
    v_mov_b32 v228, s55
    v_fma_f32 v39, v39, s45, v58
    v_fma_f32 v40, v40, s45, v59
    v_mfma_f32_16x16x32_bf16 a[164:167], a[228:231], v[168:171], a[164:167]
    ds_read_b64_tr_b16 a[226:227], v210 offset:20480
    v_fma_f32 v41, v41, s45, v59
    v_mfma_f32_16x16x32_bf16 a[136:139], a[232:235], v[160:163], a[136:139]
    v_exp_f32 v39, v39
    v_mfma_f32_16x16x32_bf16 a[168:171], a[232:235], v[168:171], a[168:171]
    ds_read_b64_tr_b16 a[228:229], v211 offset:16384
    buffer_atomic_add v228, v250, s[80:83], s54 offen sc1
    v_mfma_f32_16x16x32_bf16 a[140:143], a[236:239], v[160:163], a[140:143]
    v_exp_f32 v40, v40
    v_mfma_f32_16x16x32_bf16 a[172:175], a[236:239], v[168:171], a[172:175]
    ds_read_b64_tr_b16 a[230:231], v211 offset:20480
    v_cvt_pk_bf16_f32 v35, v38, v39
    v_mfma_f32_16x16x32_bf16 a[144:147], a[240:243], v[160:163], a[144:147]
    v_exp_f32 v41, v41
    v_mfma_f32_16x16x32_bf16 a[176:179], a[240:243], v[168:171], a[176:179]
    ds_read_b64_tr_b16 a[232:233], v212 offset:16384
    v_cvt_pk_bf16_f32 v40, v40, v41
    v_fma_f32 v42, v42, s45, v59
    v_mfma_f32_16x16x32_bf16 a[148:151], a[244:247], v[160:163], a[148:151]
    v_exp_f32 v42, v42
    v_mfma_f32_16x16x32_bf16 a[180:183], a[244:247], v[168:171], a[180:183]
    ds_read_b64_tr_b16 a[234:235], v212 offset:20480
    v_fma_f32 v43, v43, s45, v59
    v_mfma_f32_16x16x32_bf16 a[152:155], a[248:251], v[160:163], a[152:155]
    s_add_u32 s44, s62, 40960
    v_exp_f32 v43, v43
    v_mfma_f32_16x16x32_bf16 a[184:187], a[248:251], v[168:171], a[184:187]
    s_and_b32 s44, s44, 0x1ffff
    ds_read_b64_tr_b16 a[236:237], v213 offset:16384
    v_cvt_pk_bf16_f32 v41, v42, v43
    v_mfma_f32_16x16x32_bf16 a[156:159], a[252:255], v[160:163], a[156:159]
    s_add_u32 s44, s44, s36
    v_fma_f32 v44, v44, s45, v59
    v_fma_f32 v45, v45, s45, v59
    v_mfma_f32_16x16x32_bf16 a[188:191], a[252:255], v[168:171], a[188:191]
    s_add_u32 m0, s39, 81920
    ds_read_b64_tr_b16 a[238:239], v213 offset:20480
    v_fma_f32 v46, v46, s45, v59
    v_mfma_f32_16x16x32_bf16 v[176:179], v[224:227], v[160:163], v[176:179]
    buffer_load_dwordx4 v192, s[8:11], s44 offen nt lds
    v_mfma_f32_16x16x32_bf16 v[180:183], v[224:227], v[168:171], v[180:183]
    ds_read_b64_tr_b16 a[240:241], v214 offset:16384
    v_fma_f32 v47, v47, s45, v59
    v_mfma_f32_16x16x32_bf16 v[160:163], a[192:195], v[128:131], 0
    buffer_load_dwordx4 v193, s[8:11], s44 offen offset:1024 nt lds
    v_mfma_f32_16x16x32_bf16 v[160:163], a[196:199], v[136:139], v[160:163]
    ds_read_b64_tr_b16 a[242:243], v214 offset:20480
    v_fma_f32 v96, v96, s45, v122
    v_mfma_f32_16x16x32_bf16 v[160:163], a[200:203], v[144:147], v[160:163]
    buffer_load_dwordx4 v194, s[8:11], s44 offen offset:2048 nt lds
    v_mfma_f32_16x16x32_bf16 v[160:163], a[204:207], v[152:155], v[160:163]
    ds_read_b64_tr_b16 a[244:245], v215 offset:16384
    v_fma_f32 v97, v97, s45, v122
    v_mfma_f32_16x16x32_bf16 v[164:167], a[208:211], v[128:131], 0
    buffer_load_dwordx4 v195, s[8:11], s44 offen offset:3072 nt lds
    v_mfma_f32_16x16x32_bf16 v[164:167], a[212:215], v[136:139], v[164:167]
    ds_read_b64_tr_b16 a[246:247], v215 offset:20480
    v_fma_f32 v98, v98, s45, v122
    v_mfma_f32_16x16x32_bf16 v[164:167], a[216:219], v[144:147], v[164:167]
    v_exp_f32 v44, v44
    v_mfma_f32_16x16x32_bf16 v[164:167], a[220:223], v[152:155], v[164:167]
    ds_read_b64_tr_b16 a[248:249], v216 offset:16384
    v_fma_f32 v99, v99, s45, v122
    v_mfma_f32_16x16x32_bf16 v[168:171], a[192:195], v[132:135], 0
    ds_read_b128 a[192:195], v206 offset:16384
    v_fma_f32 v100, v100, s45, v122
    v_mfma_f32_16x16x32_bf16 v[168:171], a[196:199], v[140:143], v[168:171]
    ds_read_b64_tr_b16 a[250:251], v216 offset:20480
    v_fma_f32 v101, v101, s45, v122
    v_mfma_f32_16x16x32_bf16 v[168:171], a[200:203], v[148:151], v[168:171]
    ds_read_b128 a[196:199], v207 offset:16384
    v_fma_f32 v102, v102, s45, v122
    v_mfma_f32_16x16x32_bf16 v[168:171], a[204:207], v[156:159], v[168:171]
    ds_read_b64_tr_b16 a[252:253], v217 offset:16384
    v_exp_f32 v45, v45
    v_mfma_f32_16x16x32_bf16 v[172:175], a[208:211], v[132:135], 0
    ds_read_b128 a[200:203], v208 offset:16384
    v_cvt_pk_bf16_f32 v42, v44, v45
    v_mfma_f32_16x16x32_bf16 v[172:175], a[212:215], v[140:143], v[172:175]
    ds_read_b64_tr_b16 a[254:255], v217 offset:20480
    v_fma_f32 v103, v103, s45, v122
    v_mfma_f32_16x16x32_bf16 v[172:175], a[216:219], v[148:151], v[172:175]
    ds_read_b128 a[204:207], v209 offset:16384
    v_fma_f32 v104, v104, s45, v123
    v_mfma_f32_16x16x32_bf16 v[172:175], a[220:223], v[156:159], v[172:175]
    s_waitcnt lgkmcnt(7)
    v_exp_f32 v46, v46
    v_exp_f32 v47, v47
    s_nop 0
    v_cvt_pk_bf16_f32 v43, v46, v47
    v_mfma_f32_16x16x32_bf16 a[0:3], a[224:227], v[32:35], a[0:3]
    v_exp_f32 v96, v96
    v_mfma_f32_16x16x32_bf16 a[32:35], a[224:227], v[40:43], a[32:35]
    ds_read_b128 a[208:211], v206 offset:20480
    v_fma_f32 v105, v105, s45, v123
    v_mfma_f32_16x16x32_bf16 a[4:7], a[228:231], v[32:35], a[4:7]
    v_exp_f32 v97, v97
    v_fma_f32 v106, v106, s45, v123
    v_mfma_f32_16x16x32_bf16 a[36:39], a[228:231], v[40:43], a[36:39]
    ds_read_b128 a[212:215], v207 offset:20480
    v_cvt_pk_bf16_f32 v96, v96, v97
    v_mfma_f32_16x16x32_bf16 a[8:11], a[232:235], v[32:35], a[8:11]
    v_exp_f32 v98, v98
    v_mfma_f32_16x16x32_bf16 a[40:43], a[232:235], v[40:43], a[40:43]
    ds_read_b128 a[216:219], v208 offset:20480
    v_fma_f32 v107, v107, s45, v123
    v_mfma_f32_16x16x32_bf16 a[12:15], a[236:239], v[32:35], a[12:15]
    v_exp_f32 v99, v99
    v_mfma_f32_16x16x32_bf16 a[44:47], a[236:239], v[40:43], a[44:47]
    ds_read_b128 a[220:223], v209 offset:20480
    v_cvt_pk_bf16_f32 v97, v98, v99
    v_mfma_f32_16x16x32_bf16 a[16:19], a[240:243], v[32:35], a[16:19]
    v_exp_f32 v100, v100
    v_fma_f32 v108, v108, s45, v123
    v_mfma_f32_16x16x32_bf16 a[48:51], a[240:243], v[40:43], a[48:51]
    v_exp_f32 v101, v101
    v_mfma_f32_16x16x32_bf16 a[20:23], a[244:247], v[32:35], a[20:23]
    v_exp_f32 v102, v102
    v_mfma_f32_16x16x32_bf16 a[52:55], a[244:247], v[40:43], a[52:55]
    s_waitcnt lgkmcnt(2)
    v_exp_f32 v103, v103
    v_mfma_f32_16x16x32_bf16 a[24:27], a[248:251], v[32:35], a[24:27]
    v_exp_f32 v104, v104
    v_mfma_f32_16x16x32_bf16 a[56:59], a[248:251], v[40:43], a[56:59]
    v_exp_f32 v105, v105
    v_mfma_f32_16x16x32_bf16 a[28:31], a[252:255], v[32:35], a[28:31]
    v_exp_f32 v106, v106
    v_mfma_f32_16x16x32_bf16 a[60:63], a[252:255], v[40:43], a[60:63]
    v_exp_f32 v107, v107
    v_cvt_pk_bf16_f32 v98, v100, v101
    v_mfma_f32_16x16x32_bf16 v[48:51], v[224:227], v[32:35], v[48:51]
    v_exp_f32 v108, v108
    v_mfma_f32_16x16x32_bf16 v[52:55], v[224:227], v[40:43], v[52:55]
    v_cvt_pk_bf16_f32 v99, v102, v103
    v_cvt_pk_bf16_f32 v104, v104, v105
    v_mfma_f32_16x16x32_bf16 v[32:35], a[192:195], v[0:3], 0
    v_cvt_pk_bf16_f32 v105, v106, v107
    v_fma_f32 v109, v109, s45, v123
    v_mfma_f32_16x16x32_bf16 v[32:35], a[196:199], v[8:11], v[32:35]
    v_exp_f32 v109, v109
    v_mfma_f32_16x16x32_bf16 v[32:35], a[200:203], v[16:19], v[32:35]
    v_cvt_pk_bf16_f32 v106, v108, v109
    v_fma_f32 v110, v110, s45, v123
    v_mfma_f32_16x16x32_bf16 v[32:35], a[204:207], v[24:27], v[32:35]
    v_exp_f32 v110, v110
    v_mfma_f32_16x16x32_bf16 v[36:39], a[208:211], v[0:3], 0
    v_fma_f32 v111, v111, s45, v123
    v_exp_f32 v111, v111
    v_mfma_f32_16x16x32_bf16 v[36:39], a[212:215], v[8:11], v[36:39]
    s_waitcnt lgkmcnt(0)
    v_cvt_pk_bf16_f32 v107, v110, v111
    v_fma_f32 v160, v160, s45, v186
    v_mfma_f32_16x16x32_bf16 v[36:39], a[216:219], v[16:19], v[36:39]
    v_exp_f32 v160, v160
    v_mfma_f32_16x16x32_bf16 v[36:39], a[220:223], v[24:27], v[36:39]
    v_fma_f32 v161, v161, s45, v186
    v_fma_f32 v162, v162, s45, v186
    v_mfma_f32_16x16x32_bf16 v[40:43], a[192:195], v[4:7], 0
    v_exp_f32 v161, v161
    v_mfma_f32_16x16x32_bf16 v[40:43], a[196:199], v[12:15], v[40:43]
    v_add_u32 v206, 0x24000, v206
    v_add_u32 v207, 0x24000, v207
    v_mfma_f32_16x16x32_bf16 v[40:43], a[200:203], v[20:23], v[40:43]
    v_exp_f32 v162, v162
    v_cvt_pk_bf16_f32 v160, v160, v161
    v_mfma_f32_16x16x32_bf16 v[40:43], a[204:207], v[28:31], v[40:43]
    v_fma_f32 v163, v163, s45, v186
    v_fma_f32 v164, v164, s45, v186
    v_mfma_f32_16x16x32_bf16 v[44:47], a[208:211], v[4:7], 0
    v_add_u32 v208, 0x24000, v208
    v_add_u32 v209, 0x24000, v209
    v_mfma_f32_16x16x32_bf16 v[44:47], a[212:215], v[12:15], v[44:47]
    s_add_u32 s43, s62, 40960
    v_exp_f32 v163, v163
    v_mfma_f32_16x16x32_bf16 v[44:47], a[216:219], v[20:23], v[44:47]
    s_and_b32 s43, s43, 0x1ffff
    v_exp_f32 v164, v164
    v_mfma_f32_16x16x32_bf16 v[44:47], a[220:223], v[28:31], v[44:47]
    s_add_u32 s43, s43, s36
    v_cvt_pk_bf16_f32 v161, v162, v163
    v_fma_f32 v165, v165, s45, v186
    v_mfma_f32_16x16x32_bf16 a[64:67], a[224:227], v[96:99], a[64:67]
    s_add_u32 m0, s39, 65536
    v_exp_f32 v165, v165
    v_mfma_f32_16x16x32_bf16 a[96:99], a[224:227], v[104:107], a[96:99]
    buffer_load_dwordx4 v196, s[12:15], s43 offen nt lds
    v_mfma_f32_16x16x32_bf16 a[68:71], a[228:231], v[96:99], a[68:71]
    v_cvt_pk_bf16_f32 v162, v164, v165
    v_fma_f32 v166, v166, s45, v186
    v_mfma_f32_16x16x32_bf16 a[100:103], a[228:231], v[104:107], a[100:103]
    buffer_load_dwordx4 v197, s[12:15], s43 offen offset:1024 nt lds
    v_mfma_f32_16x16x32_bf16 a[72:75], a[232:235], v[96:99], a[72:75]
    v_exp_f32 v166, v166
    v_mfma_f32_16x16x32_bf16 a[104:107], a[232:235], v[104:107], a[104:107]
    buffer_load_dwordx4 v196, s[12:15], s43 offen offset:2048 nt lds
    v_mfma_f32_16x16x32_bf16 a[76:79], a[236:239], v[96:99], a[76:79]
    v_fma_f32 v167, v167, s45, v186
    v_fma_f32 v168, v168, s45, v187
    v_mfma_f32_16x16x32_bf16 a[108:111], a[236:239], v[104:107], a[108:111]
    buffer_load_dwordx4 v197, s[12:15], s43 offen offset:3072 nt lds
    v_mfma_f32_16x16x32_bf16 a[80:83], a[240:243], v[96:99], a[80:83]
    v_exp_f32 v167, v167
    v_fma_f32 v169, v169, s45, v187
    v_mfma_f32_16x16x32_bf16 a[112:115], a[240:243], v[104:107], a[112:115]
    v_exp_f32 v168, v168
    v_mfma_f32_16x16x32_bf16 a[84:87], a[244:247], v[96:99], a[84:87]
    v_exp_f32 v169, v169
    v_mfma_f32_16x16x32_bf16 a[116:119], a[244:247], v[104:107], a[116:119]
    v_cvt_pk_bf16_f32 v163, v166, v167
    v_cvt_pk_bf16_f32 v168, v168, v169
    v_mfma_f32_16x16x32_bf16 a[88:91], a[248:251], v[96:99], a[88:91]
    v_fma_f32 v170, v170, s45, v187
    v_fma_f32 v171, v171, s45, v187
    v_mfma_f32_16x16x32_bf16 a[120:123], a[248:251], v[104:107], a[120:123]
    v_exp_f32 v170, v170
    v_mfma_f32_16x16x32_bf16 a[92:95], a[252:255], v[96:99], a[92:95]
    v_exp_f32 v171, v171
    v_fma_f32 v172, v172, s45, v187
    v_mfma_f32_16x16x32_bf16 a[124:127], a[252:255], v[104:107], a[124:127]
    v_exp_f32 v172, v172
    v_mfma_f32_16x16x32_bf16 v[112:115], v[224:227], v[96:99], v[112:115]
    v_cvt_pk_bf16_f32 v169, v170, v171
    v_fma_f32 v173, v173, s45, v187
    v_mfma_f32_16x16x32_bf16 v[116:119], v[224:227], v[104:107], v[116:119]
    v_exp_f32 v173, v173
    v_mfma_f32_16x16x32_bf16 v[96:99], a[192:195], v[64:67], 0
    v_cvt_pk_bf16_f32 v170, v172, v173
    v_fma_f32 v174, v174, s45, v187
    v_mfma_f32_16x16x32_bf16 v[96:99], a[196:199], v[72:75], v[96:99]
    v_exp_f32 v174, v174
    v_mfma_f32_16x16x32_bf16 v[96:99], a[200:203], v[80:83], v[96:99]
    v_fma_f32 v175, v175, s45, v187
    v_fma_f32 v32, v32, s45, v58
    v_mfma_f32_16x16x32_bf16 v[96:99], a[204:207], v[88:91], v[96:99]
    v_exp_f32 v175, v175
    v_fma_f32 v33, v33, s45, v58
    v_mfma_f32_16x16x32_bf16 v[100:103], a[208:211], v[64:67], 0
    v_exp_f32 v32, v32
    v_mfma_f32_16x16x32_bf16 v[100:103], a[212:215], v[72:75], v[100:103]
    v_exp_f32 v33, v33
    v_mfma_f32_16x16x32_bf16 v[100:103], a[216:219], v[80:83], v[100:103]
    v_cvt_pk_bf16_f32 v171, v174, v175
    v_cvt_pk_bf16_f32 v32, v32, v33
    v_mfma_f32_16x16x32_bf16 v[100:103], a[220:223], v[88:91], v[100:103]
    v_fma_f32 v34, v34, s45, v58
    v_fma_f32 v35, v35, s45, v58
    v_mfma_f32_16x16x32_bf16 v[104:107], a[192:195], v[68:71], 0
    v_exp_f32 v34, v34
    v_mfma_f32_16x16x32_bf16 v[104:107], a[196:199], v[76:79], v[104:107]
    v_exp_f32 v35, v35
    v_mfma_f32_16x16x32_bf16 v[104:107], a[200:203], v[84:87], v[104:107]
    v_cvt_pk_bf16_f32 v33, v34, v35
    v_fma_f32 v36, v36, s45, v58
    v_fma_f32 v37, v37, s45, v58
    v_mfma_f32_16x16x32_bf16 v[104:107], a[204:207], v[92:95], v[104:107]
    v_exp_f32 v36, v36
    v_mfma_f32_16x16x32_bf16 v[108:111], a[208:211], v[68:71], 0
    v_exp_f32 v37, v37
    v_mfma_f32_16x16x32_bf16 v[108:111], a[212:215], v[76:79], v[108:111]
    v_cvt_pk_bf16_f32 v34, v36, v37
    v_fma_f32 v38, v38, s45, v58
    v_mfma_f32_16x16x32_bf16 v[108:111], a[216:219], v[84:87], v[108:111]
    v_exp_f32 v38, v38
    v_mfma_f32_16x16x32_bf16 v[108:111], a[220:223], v[92:95], v[108:111]
    s_waitcnt vmcnt(13)
    s_barrier
    v_mfma_f32_16x16x32_bf16 a[128:131], a[224:227], v[160:163], a[128:131]
    v_fma_f32 v39, v39, s45, v58
    v_exp_f32 v39, v39
    v_mfma_f32_16x16x32_bf16 a[160:163], a[224:227], v[168:171], a[160:163]
    ds_read_b64_tr_b16 a[224:225], v210 offset:32768
    v_cvt_pk_bf16_f32 v35, v38, v39
    v_mfma_f32_16x16x32_bf16 a[132:135], a[228:231], v[160:163], a[132:135]
    v_fma_f32 v40, v40, s45, v59
    v_fma_f32 v41, v41, s45, v59
    v_mfma_f32_16x16x32_bf16 a[164:167], a[228:231], v[168:171], a[164:167]
    ds_read_b64_tr_b16 a[226:227], v210 offset:36864
    v_fma_f32 v42, v42, s45, v59
    v_mfma_f32_16x16x32_bf16 a[136:139], a[232:235], v[160:163], a[136:139]
    v_exp_f32 v40, v40
    v_mfma_f32_16x16x32_bf16 a[168:171], a[232:235], v[168:171], a[168:171]
    ds_read_b64_tr_b16 a[228:229], v211 offset:32768
    v_fma_f32 v43, v43, s45, v59
    v_mfma_f32_16x16x32_bf16 a[140:143], a[236:239], v[160:163], a[140:143]
    v_exp_f32 v41, v41
    v_mfma_f32_16x16x32_bf16 a[172:175], a[236:239], v[168:171], a[172:175]
    ds_read_b64_tr_b16 a[230:231], v211 offset:36864
    v_exp_f32 v42, v42
    v_mfma_f32_16x16x32_bf16 a[144:147], a[240:243], v[160:163], a[144:147]
    v_exp_f32 v43, v43
    v_mfma_f32_16x16x32_bf16 a[176:179], a[240:243], v[168:171], a[176:179]
    ds_read_b64_tr_b16 a[232:233], v212 offset:32768
    v_cvt_pk_bf16_f32 v40, v40, v41
    v_mfma_f32_16x16x32_bf16 a[148:151], a[244:247], v[160:163], a[148:151]
    v_cvt_pk_bf16_f32 v41, v42, v43
    v_fma_f32 v44, v44, s45, v59
    v_mfma_f32_16x16x32_bf16 a[180:183], a[244:247], v[168:171], a[180:183]
    ds_read_b64_tr_b16 a[234:235], v212 offset:36864
    v_fma_f32 v45, v45, s45, v59
    v_mfma_f32_16x16x32_bf16 a[152:155], a[248:251], v[160:163], a[152:155]
    v_exp_f32 v44, v44
    v_mfma_f32_16x16x32_bf16 a[184:187], a[248:251], v[168:171], a[184:187]
    ds_read_b64_tr_b16 a[236:237], v213 offset:32768
    v_fma_f32 v46, v46, s45, v59
    v_mfma_f32_16x16x32_bf16 a[156:159], a[252:255], v[160:163], a[156:159]
    v_exp_f32 v45, v45
    v_fma_f32 v47, v47, s45, v59
    v_mfma_f32_16x16x32_bf16 a[188:191], a[252:255], v[168:171], a[188:191]
    ds_read_b64_tr_b16 a[238:239], v213 offset:36864
    v_cvt_pk_bf16_f32 v42, v44, v45
    v_mfma_f32_16x16x32_bf16 v[176:179], v[224:227], v[160:163], v[176:179]
    v_exp_f32 v46, v46
    v_mfma_f32_16x16x32_bf16 v[180:183], v[224:227], v[168:171], v[180:183]
    ds_read_b64_tr_b16 a[240:241], v214 offset:32768
    v_fma_f32 v96, v96, s45, v122
    v_mfma_f32_16x16x32_bf16 v[160:163], a[192:195], v[128:131], 0
    s_add_u32 s44, s62, 49152
    v_exp_f32 v47, v47
    v_mfma_f32_16x16x32_bf16 v[160:163], a[196:199], v[136:139], v[160:163]
    s_and_b32 s44, s44, 0x1ffff
    ds_read_b64_tr_b16 a[242:243], v214 offset:36864
    v_cvt_pk_bf16_f32 v43, v46, v47
    v_mfma_f32_16x16x32_bf16 v[160:163], a[200:203], v[144:147], v[160:163]
    s_add_u32 s44, s44, s36
    v_exp_f32 v96, v96
    v_fma_f32 v97, v97, s45, v122
    v_mfma_f32_16x16x32_bf16 v[160:163], a[204:207], v[152:155], v[160:163]
    s_add_u32 m0, s39, 0
    ds_read_b64_tr_b16 a[244:245], v215 offset:32768
    v_fma_f32 v98, v98, s45, v122
    v_mfma_f32_16x16x32_bf16 v[164:167], a[208:211], v[128:131], 0
    buffer_load_dwordx4 v192, s[8:11], s44 offen nt lds
    v_mfma_f32_16x16x32_bf16 v[164:167], a[212:215], v[136:139], v[164:167]
    ds_read_b64_tr_b16 a[246:247], v215 offset:36864
    v_fma_f32 v99, v99, s45, v122
    v_mfma_f32_16x16x32_bf16 v[164:167], a[216:219], v[144:147], v[164:167]
    buffer_load_dwordx4 v193, s[8:11], s44 offen offset:1024 nt lds
    v_mfma_f32_16x16x32_bf16 v[164:167], a[220:223], v[152:155], v[164:167]
    ds_read_b64_tr_b16 a[248:249], v216 offset:32768
    v_fma_f32 v100, v100, s45, v122
    v_mfma_f32_16x16x32_bf16 v[168:171], a[192:195], v[132:135], 0
    ds_read_b128 a[192:195], v206
    v_fma_f32 v101, v101, s45, v122
    v_mfma_f32_16x16x32_bf16 v[168:171], a[196:199], v[140:143], v[168:171]
    ds_read_b64_tr_b16 a[250:251], v216 offset:36864
    v_exp_f32 v97, v97
    v_mfma_f32_16x16x32_bf16 v[168:171], a[200:203], v[148:151], v[168:171]
    ds_read_b128 a[196:199], v207
    v_cvt_pk_bf16_f32 v96, v96, v97
    v_mfma_f32_16x16x32_bf16 v[168:171], a[204:207], v[156:159], v[168:171]
    ds_read_b64_tr_b16 a[252:253], v217 offset:32768
    v_fma_f32 v102, v102, s45, v122
    v_mfma_f32_16x16x32_bf16 v[172:175], a[208:211], v[132:135], 0
    ds_read_b128 a[200:203], v208
    v_fma_f32 v103, v103, s45, v122
    v_mfma_f32_16x16x32_bf16 v[172:175], a[212:215], v[140:143], v[172:175]
    ds_read_b64_tr_b16 a[254:255], v217 offset:36864
    v_fma_f32 v104, v104, s45, v123
    v_mfma_f32_16x16x32_bf16 v[172:175], a[216:219], v[148:151], v[172:175]
    ds_read_b128 a[204:207], v209
    v_fma_f32 v105, v105, s45, v123
    v_mfma_f32_16x16x32_bf16 v[172:175], a[220:223], v[156:159], v[172:175]
    s_waitcnt lgkmcnt(7)
    buffer_load_dwordx4 v194, s[8:11], s44 offen offset:2048 nt lds
    buffer_load_dwordx4 v195, s[8:11], s44 offen offset:3072 nt lds
    v_mfma_f32_16x16x32_bf16 a[0:3], a[224:227], v[32:35], a[0:3]
    v_exp_f32 v98, v98
    v_fma_f32 v106, v106, s45, v123
    v_mfma_f32_16x16x32_bf16 a[32:35], a[224:227], v[40:43], a[32:35]
    ds_read_b128 a[208:211], v206 offset:4096
    v_fma_f32 v107, v107, s45, v123
    v_mfma_f32_16x16x32_bf16 a[4:7], a[228:231], v[32:35], a[4:7]
    v_exp_f32 v99, v99
    v_mfma_f32_16x16x32_bf16 a[36:39], a[228:231], v[40:43], a[36:39]
    ds_read_b128 a[212:215], v207 offset:4096
    v_cvt_pk_bf16_f32 v97, v98, v99
    v_mfma_f32_16x16x32_bf16 a[8:11], a[232:235], v[32:35], a[8:11]
    v_exp_f32 v100, v100
    v_mfma_f32_16x16x32_bf16 a[40:43], a[232:235], v[40:43], a[40:43]
    ds_read_b128 a[216:219], v208 offset:4096
    v_fma_f32 v108, v108, s45, v123
    v_mfma_f32_16x16x32_bf16 a[12:15], a[236:239], v[32:35], a[12:15]
    v_exp_f32 v101, v101
    v_fma_f32 v109, v109, s45, v123
    v_mfma_f32_16x16x32_bf16 a[44:47], a[236:239], v[40:43], a[44:47]
    ds_read_b128 a[220:223], v209 offset:4096
    v_cvt_pk_bf16_f32 v98, v100, v101
    v_mfma_f32_16x16x32_bf16 a[16:19], a[240:243], v[32:35], a[16:19]
    v_exp_f32 v102, v102
    v_mfma_f32_16x16x32_bf16 a[48:51], a[240:243], v[40:43], a[48:51]
    v_exp_f32 v103, v103
    v_mfma_f32_16x16x32_bf16 a[20:23], a[244:247], v[32:35], a[20:23]
    v_exp_f32 v104, v104
    v_mfma_f32_16x16x32_bf16 a[52:55], a[244:247], v[40:43], a[52:55]
    s_waitcnt lgkmcnt(2)
    v_exp_f32 v105, v105
    v_mfma_f32_16x16x32_bf16 a[24:27], a[248:251], v[32:35], a[24:27]
    v_exp_f32 v106, v106
    v_mfma_f32_16x16x32_bf16 a[56:59], a[248:251], v[40:43], a[56:59]
    v_exp_f32 v107, v107
    v_cvt_pk_bf16_f32 v99, v102, v103
    v_mfma_f32_16x16x32_bf16 a[28:31], a[252:255], v[32:35], a[28:31]
    v_exp_f32 v108, v108
    v_mfma_f32_16x16x32_bf16 a[60:63], a[252:255], v[40:43], a[60:63]
    v_exp_f32 v109, v109
    v_mfma_f32_16x16x32_bf16 v[48:51], v[224:227], v[32:35], v[48:51]
    v_cvt_pk_bf16_f32 v104, v104, v105
    v_cvt_pk_bf16_f32 v105, v106, v107
    v_mfma_f32_16x16x32_bf16 v[52:55], v[224:227], v[40:43], v[52:55]
    v_cvt_pk_bf16_f32 v106, v108, v109
    v_fma_f32 v110, v110, s45, v123
    v_mfma_f32_16x16x32_bf16 v[32:35], a[192:195], v[0:3], 0
    v_exp_f32 v110, v110
    v_mfma_f32_16x16x32_bf16 v[32:35], a[196:199], v[8:11], v[32:35]
    v_fma_f32 v111, v111, s45, v123
    v_fma_f32 v160, v160, s45, v186
    v_mfma_f32_16x16x32_bf16 v[32:35], a[200:203], v[16:19], v[32:35]
    v_exp_f32 v111, v111
    v_fma_f32 v161, v161, s45, v186
    v_mfma_f32_16x16x32_bf16 v[32:35], a[204:207], v[24:27], v[32:35]
    v_exp_f32 v160, v160
    v_mfma_f32_16x16x32_bf16 v[36:39], a[208:211], v[0:3], 0
    v_exp_f32 v161, v161
    v_mfma_f32_16x16x32_bf16 v[36:39], a[212:215], v[8:11], v[36:39]
    s_waitcnt lgkmcnt(0)
    v_cvt_pk_bf16_f32 v107, v110, v111
    v_cvt_pk_bf16_f32 v160, v160, v161
    v_mfma_f32_16x16x32_bf16 v[36:39], a[216:219], v[16:19], v[36:39]
    v_fma_f32 v162, v162, s45, v186
    v_fma_f32 v163, v163, s45, v186
    v_mfma_f32_16x16x32_bf16 v[36:39], a[220:223], v[24:27], v[36:39]
    v_exp_f32 v162, v162
    v_mfma_f32_16x16x32_bf16 v[40:43], a[192:195], v[4:7], 0
    v_exp_f32 v163, v163
    v_fma_f32 v164, v164, s45, v186
    v_mfma_f32_16x16x32_bf16 v[40:43], a[196:199], v[12:15], v[40:43]
    v_add_u32 v206, 0xffff0000, v206
    v_add_u32 v207, 0xffff0000, v207
    v_mfma_f32_16x16x32_bf16 v[40:43], a[200:203], v[20:23], v[40:43]
    v_exp_f32 v164, v164
    v_mfma_f32_16x16x32_bf16 v[40:43], a[204:207], v[28:31], v[40:43]
    v_cvt_pk_bf16_f32 v161, v162, v163
    v_fma_f32 v165, v165, s45, v186
    v_mfma_f32_16x16x32_bf16 v[44:47], a[208:211], v[4:7], 0
    v_add_u32 v208, 0xffff0000, v208
    v_add_u32 v209, 0xffff0000, v209
    v_mfma_f32_16x16x32_bf16 v[44:47], a[212:215], v[12:15], v[44:47]
    v_exp_f32 v165, v165
    v_mfma_f32_16x16x32_bf16 v[44:47], a[216:219], v[20:23], v[44:47]
    v_cvt_pk_bf16_f32 v162, v164, v165
    v_fma_f32 v166, v166, s45, v186
    v_mfma_f32_16x16x32_bf16 v[44:47], a[220:223], v[28:31], v[44:47]
    v_exp_f32 v166, v166
    v_fma_f32 v167, v167, s45, v186
    v_mfma_f32_16x16x32_bf16 a[64:67], a[224:227], v[96:99], a[64:67]
    v_exp_f32 v167, v167
    v_mfma_f32_16x16x32_bf16 a[96:99], a[224:227], v[104:107], a[96:99]
    v_cvt_pk_bf16_f32 v163, v166, v167
    v_fma_f32 v168, v168, s45, v187
    v_mfma_f32_16x16x32_bf16 a[68:71], a[228:231], v[96:99], a[68:71]
    v_exp_f32 v168, v168
    v_mfma_f32_16x16x32_bf16 a[100:103], a[228:231], v[104:107], a[100:103]
    v_fma_f32 v169, v169, s45, v187
    v_fma_f32 v170, v170, s45, v187
    v_mfma_f32_16x16x32_bf16 a[72:75], a[232:235], v[96:99], a[72:75]
    s_add_u32 s43, s62, 49152
    v_exp_f32 v169, v169
    v_mfma_f32_16x16x32_bf16 a[104:107], a[232:235], v[104:107], a[104:107]
    s_and_b32 s43, s43, 0x1ffff
    v_exp_f32 v170, v170
    v_mfma_f32_16x16x32_bf16 a[76:79], a[236:239], v[96:99], a[76:79]
    s_add_u32 s43, s43, s36
    v_cvt_pk_bf16_f32 v168, v168, v169
    v_fma_f32 v171, v171, s45, v187
    v_fma_f32 v172, v172, s45, v187
    v_mfma_f32_16x16x32_bf16 a[108:111], a[236:239], v[104:107], a[108:111]
    s_add_u32 m0, s39, 16384
    v_exp_f32 v171, v171
    v_mfma_f32_16x16x32_bf16 a[80:83], a[240:243], v[96:99], a[80:83]
    buffer_load_dwordx4 v196, s[12:15], s43 offen nt lds
    v_mfma_f32_16x16x32_bf16 a[112:115], a[240:243], v[104:107], a[112:115]
    v_exp_f32 v172, v172
    v_mfma_f32_16x16x32_bf16 a[84:87], a[244:247], v[96:99], a[84:87]
    buffer_load_dwordx4 v197, s[12:15], s43 offen offset:1024 nt lds
    v_mfma_f32_16x16x32_bf16 a[116:119], a[244:247], v[104:107], a[116:119]
    v_cvt_pk_bf16_f32 v169, v170, v171
    v_fma_f32 v173, v173, s45, v187
    v_mfma_f32_16x16x32_bf16 a[88:91], a[248:251], v[96:99], a[88:91]
    buffer_load_dwordx4 v196, s[12:15], s43 offen offset:2048 nt lds
    v_mfma_f32_16x16x32_bf16 a[120:123], a[248:251], v[104:107], a[120:123]
    v_exp_f32 v173, v173
    v_mfma_f32_16x16x32_bf16 a[92:95], a[252:255], v[96:99], a[92:95]
    buffer_load_dwordx4 v197, s[12:15], s43 offen offset:3072 nt lds
    v_mfma_f32_16x16x32_bf16 a[124:127], a[252:255], v[104:107], a[124:127]
    v_cvt_pk_bf16_f32 v170, v172, v173
    v_fma_f32 v174, v174, s45, v187
    v_mfma_f32_16x16x32_bf16 v[112:115], v[224:227], v[96:99], v[112:115]
    v_exp_f32 v174, v174
    v_mfma_f32_16x16x32_bf16 v[116:119], v[224:227], v[104:107], v[116:119]
    v_fma_f32 v175, v175, s45, v187
    v_fma_f32 v32, v32, s45, v58
    v_mfma_f32_16x16x32_bf16 v[96:99], a[192:195], v[64:67], 0
    v_exp_f32 v175, v175
    v_mfma_f32_16x16x32_bf16 v[96:99], a[196:199], v[72:75], v[96:99]
    v_exp_f32 v32, v32
    v_cvt_pk_bf16_f32 v171, v174, v175
    v_mfma_f32_16x16x32_bf16 v[96:99], a[200:203], v[80:83], v[96:99]
    v_add_u32 v210, 0xfffec000, v210
    v_add_u32 v211, 0xfffec000, v211
    v_mfma_f32_16x16x32_bf16 v[96:99], a[204:207], v[88:91], v[96:99]
    v_fma_f32 v33, v33, s45, v58
    v_fma_f32 v34, v34, s45, v58
    v_mfma_f32_16x16x32_bf16 v[100:103], a[208:211], v[64:67], 0
    v_exp_f32 v33, v33
    v_mfma_f32_16x16x32_bf16 v[100:103], a[212:215], v[72:75], v[100:103]
    v_add_u32 v212, 0xfffec000, v212
    v_add_u32 v213, 0xfffec000, v213
    v_mfma_f32_16x16x32_bf16 v[100:103], a[216:219], v[80:83], v[100:103]
    v_exp_f32 v34, v34
    v_mfma_f32_16x16x32_bf16 v[100:103], a[220:223], v[88:91], v[100:103]
    v_cvt_pk_bf16_f32 v32, v32, v33
    v_fma_f32 v35, v35, s45, v58
    v_mfma_f32_16x16x32_bf16 v[104:107], a[192:195], v[68:71], 0
    v_add_u32 v214, 0xfffec000, v214
    v_add_u32 v215, 0xfffec000, v215
    v_mfma_f32_16x16x32_bf16 v[104:107], a[196:199], v[76:79], v[104:107]
    v_exp_f32 v35, v35
    v_mfma_f32_16x16x32_bf16 v[104:107], a[200:203], v[84:87], v[104:107]
    v_cvt_pk_bf16_f32 v33, v34, v35
    v_fma_f32 v36, v36, s45, v58
    v_mfma_f32_16x16x32_bf16 v[104:107], a[204:207], v[92:95], v[104:107]
    v_add_u32 v216, 0xfffec000, v216
    v_add_u32 v217, 0xfffec000, v217
    v_mfma_f32_16x16x32_bf16 v[108:111], a[208:211], v[68:71], 0
    v_exp_f32 v36, v36
    v_mfma_f32_16x16x32_bf16 v[108:111], a[212:215], v[76:79], v[108:111]
    v_fma_f32 v37, v37, s45, v58
    v_fma_f32 v38, v38, s45, v58
    v_mfma_f32_16x16x32_bf16 v[108:111], a[216:219], v[84:87], v[108:111]
    v_exp_f32 v37, v37
    v_fma_f32 v39, v39, s45, v58
    v_mfma_f32_16x16x32_bf16 v[108:111], a[220:223], v[92:95], v[108:111]
    s_waitcnt vmcnt(12)
    s_barrier
    v_mfma_f32_16x16x32_bf16 a[128:131], a[224:227], v[160:163], a[128:131]
    v_exp_f32 v38, v38
    v_mfma_f32_16x16x32_bf16 a[160:163], a[224:227], v[168:171], a[160:163]
    ds_read_b64_tr_b16 a[224:225], v210 offset:32768
    v_cvt_pk_bf16_f32 v34, v36, v37
    v_mfma_f32_16x16x32_bf16 a[132:135], a[228:231], v[160:163], a[132:135]
    v_exp_f32 v39, v39
    v_mfma_f32_16x16x32_bf16 a[164:167], a[228:231], v[168:171], a[164:167]
    ds_read_b64_tr_b16 a[226:227], v210 offset:36864
    v_cvt_pk_bf16_f32 v35, v38, v39
    v_mfma_f32_16x16x32_bf16 a[136:139], a[232:235], v[160:163], a[136:139]
    v_fma_f32 v40, v40, s45, v59
    v_fma_f32 v41, v41, s45, v59
    v_mfma_f32_16x16x32_bf16 a[168:171], a[232:235], v[168:171], a[168:171]
    ds_read_b64_tr_b16 a[228:229], v211 offset:32768
    v_exp_f32 v40, v40
    v_mfma_f32_16x16x32_bf16 a[140:143], a[236:239], v[160:163], a[140:143]
    v_exp_f32 v41, v41
    v_mfma_f32_16x16x32_bf16 a[172:175], a[236:239], v[168:171], a[172:175]
    ds_read_b64_tr_b16 a[230:231], v211 offset:36864
    v_cvt_pk_bf16_f32 v40, v40, v41
    v_mfma_f32_16x16x32_bf16 a[144:147], a[240:243], v[160:163], a[144:147]
    v_fma_f32 v42, v42, s45, v59
    v_fma_f32 v43, v43, s45, v59
    v_mfma_f32_16x16x32_bf16 a[176:179], a[240:243], v[168:171], a[176:179]
    ds_read_b64_tr_b16 a[232:233], v212 offset:32768
    v_fma_f32 v44, v44, s45, v59
    v_mfma_f32_16x16x32_bf16 a[148:151], a[244:247], v[160:163], a[148:151]
    v_exp_f32 v42, v42
    v_mfma_f32_16x16x32_bf16 a[180:183], a[244:247], v[168:171], a[180:183]
    ds_read_b64_tr_b16 a[234:235], v212 offset:36864
    v_fma_f32 v45, v45, s45, v59
    v_mfma_f32_16x16x32_bf16 a[152:155], a[248:251], v[160:163], a[152:155]
    v_exp_f32 v43, v43
    v_fma_f32 v46, v46, s45, v59
    v_mfma_f32_16x16x32_bf16 a[184:187], a[248:251], v[168:171], a[184:187]
    ds_read_b64_tr_b16 a[236:237], v213 offset:32768
    v_cvt_pk_bf16_f32 v41, v42, v43
    v_mfma_f32_16x16x32_bf16 a[156:159], a[252:255], v[160:163], a[156:159]
    v_exp_f32 v44, v44
    v_mfma_f32_16x16x32_bf16 a[188:191], a[252:255], v[168:171], a[188:191]
    ds_read_b64_tr_b16 a[238:239], v213 offset:36864
    v_fma_f32 v47, v47, s45, v59
    v_mfma_f32_16x16x32_bf16 v[176:179], v[224:227], v[160:163], v[176:179]
    v_exp_f32 v45, v45
    v_mfma_f32_16x16x32_bf16 v[180:183], v[224:227], v[168:171], v[180:183]
    ds_read_b64_tr_b16 a[240:241], v214 offset:32768
    v_cvt_pk_bf16_f32 v42, v44, v45
    v_mfma_f32_16x16x32_bf16 v[160:163], a[192:195], v[128:131], 0
    v_exp_f32 v46, v46
    v_fma_f32 v96, v96, s45, v122
    v_mfma_f32_16x16x32_bf16 v[160:163], a[196:199], v[136:139], v[160:163]
    ds_read_b64_tr_b16 a[242:243], v214 offset:36864
    v_fma_f32 v97, v97, s45, v122
    v_mfma_f32_16x16x32_bf16 v[160:163], a[200:203], v[144:147], v[160:163]
    v_exp_f32 v47, v47
    v_mfma_f32_16x16x32_bf16 v[160:163], a[204:207], v[152:155], v[160:163]
    ds_read_b64_tr_b16 a[244:245], v215 offset:32768
    v_cvt_pk_bf16_f32 v43, v46, v47
    v_mfma_f32_16x16x32_bf16 v[164:167], a[208:211], v[128:131], 0
    v_exp_f32 v96, v96
    v_mfma_f32_16x16x32_bf16 v[164:167], a[212:215], v[136:139], v[164:167]
    ds_read_b64_tr_b16 a[246:247], v215 offset:36864
    v_fma_f32 v98, v98, s45, v122
    v_mfma_f32_16x16x32_bf16 v[164:167], a[216:219], v[144:147], v[164:167]
    v_exp_f32 v97, v97
    v_mfma_f32_16x16x32_bf16 v[164:167], a[220:223], v[152:155], v[164:167]
    ds_read_b64_tr_b16 a[248:249], v216 offset:32768
    v_exp_f32 v98, v98
    v_mfma_f32_16x16x32_bf16 v[168:171], a[192:195], v[132:135], 0
    ds_read_b128 a[192:195], v206
    v_cvt_pk_bf16_f32 v96, v96, v97
    v_mfma_f32_16x16x32_bf16 v[168:171], a[196:199], v[140:143], v[168:171]
    ds_read_b64_tr_b16 a[250:251], v216 offset:36864
    v_fma_f32 v99, v99, s45, v122
    v_mfma_f32_16x16x32_bf16 v[168:171], a[200:203], v[148:151], v[168:171]
    ds_read_b128 a[196:199], v207
    v_fma_f32 v100, v100, s45, v122
    v_mfma_f32_16x16x32_bf16 v[168:171], a[204:207], v[156:159], v[168:171]
    s_add_u32 s44, s62, 57344
    ds_read_b64_tr_b16 a[252:253], v217 offset:32768
    v_fma_f32 v101, v101, s45, v122
    v_mfma_f32_16x16x32_bf16 v[172:175], a[208:211], v[132:135], 0
    s_and_b32 s44, s44, 0x1ffff
    ds_read_b128 a[200:203], v208
    v_fma_f32 v102, v102, s45, v122
    v_mfma_f32_16x16x32_bf16 v[172:175], a[212:215], v[140:143], v[172:175]
    s_add_u32 s44, s44, s36
    ds_read_b64_tr_b16 a[254:255], v217 offset:36864
    v_fma_f32 v103, v103, s45, v122
    v_mfma_f32_16x16x32_bf16 v[172:175], a[216:219], v[148:151], v[172:175]
    s_add_u32 m0, s39, 32768
    ds_read_b128 a[204:207], v209
    v_exp_f32 v99, v99
    v_mfma_f32_16x16x32_bf16 v[172:175], a[220:223], v[156:159], v[172:175]
    s_waitcnt lgkmcnt(6)
    buffer_load_dwordx4 v192, s[8:11], s44 offen nt lds
    buffer_load_dwordx4 v193, s[8:11], s44 offen offset:1024 nt lds
    buffer_load_dwordx4 v194, s[8:11], s44 offen offset:2048 nt lds
    v_mfma_f32_16x16x32_bf16 a[0:3], a[224:227], v[32:35], a[0:3]
    buffer_load_dwordx4 v195, s[8:11], s44 offen offset:3072 nt lds
    v_mfma_f32_16x16x32_bf16 a[32:35], a[224:227], v[40:43], a[32:35]
    ds_read_b128 a[208:211], v206 offset:4096
    v_cvt_pk_bf16_f32 v97, v98, v99
    v_mfma_f32_16x16x32_bf16 a[4:7], a[228:231], v[32:35], a[4:7]
    v_exp_f32 v100, v100
    v_mfma_f32_16x16x32_bf16 a[36:39], a[228:231], v[40:43], a[36:39]
    ds_read_b128 a[212:215], v207 offset:4096
    v_fma_f32 v104, v104, s45, v123
    v_mfma_f32_16x16x32_bf16 a[8:11], a[232:235], v[32:35], a[8:11]
    v_exp_f32 v101, v101
    v_fma_f32 v105, v105, s45, v123
    v_mfma_f32_16x16x32_bf16 a[40:43], a[232:235], v[40:43], a[40:43]
    ds_read_b128 a[216:219], v208 offset:4096
    v_cvt_pk_bf16_f32 v98, v100, v101
    v_mfma_f32_16x16x32_bf16 a[12:15], a[236:239], v[32:35], a[12:15]
    v_exp_f32 v102, v102
    v_mfma_f32_16x16x32_bf16 a[44:47], a[236:239], v[40:43], a[44:47]
    ds_read_b128 a[220:223], v209 offset:4096
    v_fma_f32 v106, v106, s45, v123
    v_mfma_f32_16x16x32_bf16 a[16:19], a[240:243], v[32:35], a[16:19]
    v_exp_f32 v103, v103
    v_mfma_f32_16x16x32_bf16 a[48:51], a[240:243], v[40:43], a[48:51]
    v_exp_f32 v104, v104
    v_mfma_f32_16x16x32_bf16 a[20:23], a[244:247], v[32:35], a[20:23]
    v_exp_f32 v105, v105
    v_mfma_f32_16x16x32_bf16 a[52:55], a[244:247], v[40:43], a[52:55]
    s_waitcnt lgkmcnt(2)
    v_exp_f32 v106, v106
    v_cvt_pk_bf16_f32 v99, v102, v103
    v_mfma_f32_16x16x32_bf16 a[24:27], a[248:251], v[32:35], a[24:27]
    v_cvt_pk_bf16_f32 v104, v104, v105
    v_fma_f32 v107, v107, s45, v123
    v_mfma_f32_16x16x32_bf16 a[56:59], a[248:251], v[40:43], a[56:59]
    v_exp_f32 v107, v107
    v_mfma_f32_16x16x32_bf16 a[28:31], a[252:255], v[32:35], a[28:31]
    v_cvt_pk_bf16_f32 v105, v106, v107
    v_fma_f32 v108, v108, s45, v123
    v_mfma_f32_16x16x32_bf16 a[60:63], a[252:255], v[40:43], a[60:63]
    v_exp_f32 v108, v108
    v_mfma_f32_16x16x32_bf16 v[48:51], v[224:227], v[32:35], v[48:51]
    v_fma_f32 v109, v109, s45, v123
    v_fma_f32 v110, v110, s45, v123
    v_mfma_f32_16x16x32_bf16 v[52:55], v[224:227], v[40:43], v[52:55]
    v_exp_f32 v109, v109
    v_mfma_f32_16x16x32_bf16 v[32:35], a[192:195], v[0:3], 0
    v_exp_f32 v110, v110
    v_cvt_pk_bf16_f32 v106, v108, v109
    v_mfma_f32_16x16x32_bf16 v[32:35], a[196:199], v[8:11], v[32:35]
    v_fma_f32 v111, v111, s45, v123
    v_fma_f32 v160, v160, s45, v186
    v_mfma_f32_16x16x32_bf16 v[32:35], a[200:203], v[16:19], v[32:35]
    v_exp_f32 v111, v111
    v_mfma_f32_16x16x32_bf16 v[32:35], a[204:207], v[24:27], v[32:35]
    v_exp_f32 v160, v160
    v_mfma_f32_16x16x32_bf16 v[36:39], a[208:211], v[0:3], 0
    v_cvt_pk_bf16_f32 v107, v110, v111
    v_fma_f32 v161, v161, s45, v186
    v_mfma_f32_16x16x32_bf16 v[36:39], a[212:215], v[8:11], v[36:39]
    s_waitcnt lgkmcnt(0)
    v_exp_f32 v161, v161
    v_mfma_f32_16x16x32_bf16 v[36:39], a[216:219], v[16:19], v[36:39]
    v_cvt_pk_bf16_f32 v160, v160, v161
    v_fma_f32 v162, v162, s45, v186
    v_fma_f32 v163, v163, s45, v186
    v_mfma_f32_16x16x32_bf16 v[36:39], a[220:223], v[24:27], v[36:39]
    v_exp_f32 v162, v162
    v_mfma_f32_16x16x32_bf16 v[40:43], a[192:195], v[4:7], 0
    v_exp_f32 v163, v163
    v_mfma_f32_16x16x32_bf16 v[40:43], a[196:199], v[12:15], v[40:43]
    v_add_u32 v206, 0xfffec000, v206
    v_add_u32 v207, 0xfffec000, v207
    v_mfma_f32_16x16x32_bf16 v[40:43], a[200:203], v[20:23], v[40:43]
    v_cvt_pk_bf16_f32 v161, v162, v163
    v_fma_f32 v164, v164, s45, v186
    v_mfma_f32_16x16x32_bf16 v[40:43], a[204:207], v[28:31], v[40:43]
    v_exp_f32 v164, v164
    v_mfma_f32_16x16x32_bf16 v[44:47], a[208:211], v[4:7], 0
    v_add_u32 v208, 0xfffec000, v208
    v_add_u32 v209, 0xfffec000, v209
    v_mfma_f32_16x16x32_bf16 v[44:47], a[212:215], v[12:15], v[44:47]
    v_fma_f32 v165, v165, s45, v186
    v_exp_f32 v165, v165
    v_mfma_f32_16x16x32_bf16 v[44:47], a[216:219], v[20:23], v[44:47]
    v_cvt_pk_bf16_f32 v162, v164, v165
    v_fma_f32 v166, v166, s45, v186
    v_mfma_f32_16x16x32_bf16 v[44:47], a[220:223], v[28:31], v[44:47]
    v_exp_f32 v166, v166
    v_mfma_f32_16x16x32_bf16 a[64:67], a[224:227], v[96:99], a[64:67]
    v_fma_f32 v167, v167, s45, v186
    v_fma_f32 v168, v168, s45, v187
    v_mfma_f32_16x16x32_bf16 a[96:99], a[224:227], v[104:107], a[96:99]
    v_exp_f32 v167, v167
    v_mfma_f32_16x16x32_bf16 a[68:71], a[228:231], v[96:99], a[68:71]
    v_exp_f32 v168, v168
    v_mfma_f32_16x16x32_bf16 a[100:103], a[228:231], v[104:107], a[100:103]
    v_cvt_pk_bf16_f32 v163, v166, v167
    v_fma_f32 v169, v169, s45, v187
    v_mfma_f32_16x16x32_bf16 a[72:75], a[232:235], v[96:99], a[72:75]
    v_exp_f32 v169, v169
    v_fma_f32 v170, v170, s45, v187
    v_mfma_f32_16x16x32_bf16 a[104:107], a[232:235], v[104:107], a[104:107]
    v_exp_f32 v170, v170
    v_mfma_f32_16x16x32_bf16 a[76:79], a[236:239], v[96:99], a[76:79]
    v_cvt_pk_bf16_f32 v168, v168, v169
    v_fma_f32 v171, v171, s45, v187
    v_mfma_f32_16x16x32_bf16 a[108:111], a[236:239], v[104:107], a[108:111]
    v_exp_f32 v171, v171
    v_mfma_f32_16x16x32_bf16 a[80:83], a[240:243], v[96:99], a[80:83]
    v_cvt_pk_bf16_f32 v169, v170, v171
    v_fma_f32 v172, v172, s45, v187
    v_mfma_f32_16x16x32_bf16 a[112:115], a[240:243], v[104:107], a[112:115]
    v_exp_f32 v172, v172
    v_mfma_f32_16x16x32_bf16 a[84:87], a[244:247], v[96:99], a[84:87]
    v_fma_f32 v173, v173, s45, v187
    v_exp_f32 v173, v173
    v_mfma_f32_16x16x32_bf16 a[116:119], a[244:247], v[104:107], a[116:119]
    s_add_u32 s43, s62, 57344
    v_cvt_pk_bf16_f32 v170, v172, v173
    v_fma_f32 v174, v174, s45, v187
    v_mfma_f32_16x16x32_bf16 a[88:91], a[248:251], v[96:99], a[88:91]
    s_and_b32 s43, s43, 0x1ffff
    v_exp_f32 v174, v174
    v_mfma_f32_16x16x32_bf16 a[120:123], a[248:251], v[104:107], a[120:123]
    s_add_u32 s43, s43, s36
    v_fma_f32 v175, v175, s45, v187
    v_fma_f32 v32, v32, s45, v58
    v_mfma_f32_16x16x32_bf16 a[92:95], a[252:255], v[96:99], a[92:95]
    s_add_u32 m0, s39, 147456
    v_exp_f32 v175, v175
    v_mfma_f32_16x16x32_bf16 a[124:127], a[252:255], v[104:107], a[124:127]
    buffer_load_dwordx4 v196, s[12:15], s43 offen nt lds
    v_mfma_f32_16x16x32_bf16 v[112:115], v[224:227], v[96:99], v[112:115]
    v_exp_f32 v32, v32
    v_mfma_f32_16x16x32_bf16 v[116:119], v[224:227], v[104:107], v[116:119]
    buffer_load_dwordx4 v197, s[12:15], s43 offen offset:1024 nt lds
    v_mfma_f32_16x16x32_bf16 v[96:99], a[192:195], v[64:67], 0
    v_cvt_pk_bf16_f32 v171, v174, v175
    v_fma_f32 v33, v33, s45, v58
    v_mfma_f32_16x16x32_bf16 v[96:99], a[196:199], v[72:75], v[96:99]
    buffer_load_dwordx4 v196, s[12:15], s43 offen offset:2048 nt lds
    v_mfma_f32_16x16x32_bf16 v[96:99], a[200:203], v[80:83], v[96:99]
    v_exp_f32 v33, v33
    v_mfma_f32_16x16x32_bf16 v[96:99], a[204:207], v[88:91], v[96:99]
    buffer_load_dwordx4 v197, s[12:15], s43 offen offset:3072 nt lds
    v_mfma_f32_16x16x32_bf16 v[100:103], a[208:211], v[64:67], 0
    v_cvt_pk_bf16_f32 v32, v32, v33
    v_fma_f32 v34, v34, s45, v58
    v_mfma_f32_16x16x32_bf16 v[100:103], a[212:215], v[72:75], v[100:103]
    v_exp_f32 v34, v34
    v_mfma_f32_16x16x32_bf16 v[100:103], a[216:219], v[80:83], v[100:103]
    v_fma_f32 v35, v35, s45, v58
    v_exp_f32 v35, v35
    v_mfma_f32_16x16x32_bf16 v[100:103], a[220:223], v[88:91], v[100:103]
    v_cvt_pk_bf16_f32 v33, v34, v35
    v_fma_f32 v36, v36, s45, v58
    v_mfma_f32_16x16x32_bf16 v[104:107], a[192:195], v[68:71], 0
    v_exp_f32 v36, v36
    v_mfma_f32_16x16x32_bf16 v[104:107], a[196:199], v[76:79], v[104:107]
    v_fma_f32 v37, v37, s45, v58
    v_fma_f32 v38, v38, s45, v58
    v_mfma_f32_16x16x32_bf16 v[104:107], a[200:203], v[84:87], v[104:107]
    v_exp_f32 v37, v37
    v_mfma_f32_16x16x32_bf16 v[104:107], a[204:207], v[92:95], v[104:107]
    v_exp_f32 v38, v38
    v_mfma_f32_16x16x32_bf16 v[108:111], a[208:211], v[68:71], 0
    v_cvt_pk_bf16_f32 v34, v36, v37
    v_fma_f32 v39, v39, s45, v58
    v_fma_f32 v40, v40, s45, v59
    v_mfma_f32_16x16x32_bf16 v[108:111], a[212:215], v[76:79], v[108:111]
    v_exp_f32 v39, v39
    v_mfma_f32_16x16x32_bf16 v[108:111], a[216:219], v[84:87], v[108:111]
    v_exp_f32 v40, v40
    v_mfma_f32_16x16x32_bf16 v[108:111], a[220:223], v[92:95], v[108:111]
    s_waitcnt vmcnt(12)
    s_barrier
    v_mfma_f32_16x16x32_bf16 a[128:131], a[224:227], v[160:163], a[128:131]
    v_cvt_pk_bf16_f32 v35, v38, v39
    v_fma_f32 v41, v41, s45, v59
    v_mfma_f32_16x16x32_bf16 a[160:163], a[224:227], v[168:171], a[160:163]
    ds_read_b64_tr_b16 a[224:225], v210 offset:49152
    v_fma_f32 v42, v42, s45, v59
    v_mfma_f32_16x16x32_bf16 a[132:135], a[228:231], v[160:163], a[132:135]
    v_exp_f32 v41, v41
    v_mfma_f32_16x16x32_bf16 a[164:167], a[228:231], v[168:171], a[164:167]
    ds_read_b64_tr_b16 a[226:227], v210 offset:53248
    v_exp_f32 v42, v42
    v_mfma_f32_16x16x32_bf16 a[136:139], a[232:235], v[160:163], a[136:139]
    v_cvt_pk_bf16_f32 v40, v40, v41
    v_fma_f32 v43, v43, s45, v59
    v_mfma_f32_16x16x32_bf16 a[168:171], a[232:235], v[168:171], a[168:171]
    ds_read_b64_tr_b16 a[228:229], v211 offset:49152
    v_fma_f32 v44, v44, s45, v59
    v_mfma_f32_16x16x32_bf16 a[140:143], a[236:239], v[160:163], a[140:143]
    v_exp_f32 v43, v43
    v_mfma_f32_16x16x32_bf16 a[172:175], a[236:239], v[168:171], a[172:175]
    ds_read_b64_tr_b16 a[230:231], v211 offset:53248
    v_cvt_pk_bf16_f32 v41, v42, v43
    v_mfma_f32_16x16x32_bf16 a[144:147], a[240:243], v[160:163], a[144:147]
    v_exp_f32 v44, v44
    v_mfma_f32_16x16x32_bf16 a[176:179], a[240:243], v[168:171], a[176:179]
    ds_read_b64_tr_b16 a[232:233], v212 offset:49152
    v_fma_f32 v45, v45, s45, v59
    v_mfma_f32_16x16x32_bf16 a[148:151], a[244:247], v[160:163], a[148:151]
    v_exp_f32 v45, v45
    v_fma_f32 v46, v46, s45, v59
    v_mfma_f32_16x16x32_bf16 a[180:183], a[244:247], v[168:171], a[180:183]
    ds_read_b64_tr_b16 a[234:235], v212 offset:53248
    v_cvt_pk_bf16_f32 v42, v44, v45
    v_mfma_f32_16x16x32_bf16 a[152:155], a[248:251], v[160:163], a[152:155]
    v_exp_f32 v46, v46
    v_mfma_f32_16x16x32_bf16 a[184:187], a[248:251], v[168:171], a[184:187]
    ds_read_b64_tr_b16 a[236:237], v213 offset:49152
    v_fma_f32 v47, v47, s45, v59
    v_mfma_f32_16x16x32_bf16 a[156:159], a[252:255], v[160:163], a[156:159]
    v_exp_f32 v47, v47
    v_mfma_f32_16x16x32_bf16 a[188:191], a[252:255], v[168:171], a[188:191]
    ds_read_b64_tr_b16 a[238:239], v213 offset:53248
    v_cvt_pk_bf16_f32 v43, v46, v47
    v_mfma_f32_16x16x32_bf16 v[176:179], v[224:227], v[160:163], v[176:179]
    v_fma_f32 v96, v96, s45, v122
    v_exp_f32 v96, v96
    v_mfma_f32_16x16x32_bf16 v[180:183], v[224:227], v[168:171], v[180:183]
    ds_read_b64_tr_b16 a[240:241], v214 offset:49152
    v_fma_f32 v97, v97, s45, v122
    v_mfma_f32_16x16x32_bf16 v[160:163], a[192:195], v[128:131], 0
    v_exp_f32 v97, v97
    v_mfma_f32_16x16x32_bf16 v[160:163], a[196:199], v[136:139], v[160:163]
    ds_read_b64_tr_b16 a[242:243], v214 offset:53248
    v_cvt_pk_bf16_f32 v96, v96, v97
    v_mfma_f32_16x16x32_bf16 v[160:163], a[200:203], v[144:147], v[160:163]
    v_fma_f32 v98, v98, s45, v122
    v_fma_f32 v99, v99, s45, v122
    v_mfma_f32_16x16x32_bf16 v[160:163], a[204:207], v[152:155], v[160:163]
    ds_read_b64_tr_b16 a[244:245], v215 offset:49152
    v_fma_f32 v100, v100, s45, v122
    v_mfma_f32_16x16x32_bf16 v[164:167], a[208:211], v[128:131], 0
    v_exp_f32 v98, v98
    v_mfma_f32_16x16x32_bf16 v[164:167], a[212:215], v[136:139], v[164:167]
    ds_read_b64_tr_b16 a[246:247], v215 offset:53248
    v_exp_f32 v99, v99
    v_mfma_f32_16x16x32_bf16 v[164:167], a[216:219], v[144:147], v[164:167]
    v_exp_f32 v100, v100
    v_mfma_f32_16x16x32_bf16 v[164:167], a[220:223], v[152:155], v[164:167]
    ds_read_b64_tr_b16 a[248:249], v216 offset:49152
    v_cvt_pk_bf16_f32 v97, v98, v99
    v_mfma_f32_16x16x32_bf16 v[168:171], a[192:195], v[132:135], 0
    ds_read_b128 a[192:195], v206
    v_fma_f32 v101, v101, s45, v122
    v_mfma_f32_16x16x32_bf16 v[168:171], a[196:199], v[140:143], v[168:171]
    ds_read_b64_tr_b16 a[250:251], v216 offset:53248
    v_fma_f32 v102, v102, s45, v122
    v_mfma_f32_16x16x32_bf16 v[168:171], a[200:203], v[148:151], v[168:171]
    ds_read_b128 a[196:199], v207
    v_fma_f32 v103, v103, s45, v122
    v_mfma_f32_16x16x32_bf16 v[168:171], a[204:207], v[156:159], v[168:171]
    ds_read_b64_tr_b16 a[252:253], v217 offset:49152
    v_fma_f32 v104, v104, s45, v123
    v_mfma_f32_16x16x32_bf16 v[172:175], a[208:211], v[132:135], 0
    ds_read_b128 a[200:203], v208
    v_exp_f32 v101, v101
    v_mfma_f32_16x16x32_bf16 v[172:175], a[212:215], v[140:143], v[172:175]
    ds_read_b64_tr_b16 a[254:255], v217 offset:53248
    v_cvt_pk_bf16_f32 v98, v100, v101
    v_mfma_f32_16x16x32_bf16 v[172:175], a[216:219], v[148:151], v[172:175]
    s_add_u32 s44, s62, 65536
    ds_read_b128 a[204:207], v209
    v_fma_f32 v105, v105, s45, v123
    v_mfma_f32_16x16x32_bf16 v[172:175], a[220:223], v[156:159], v[172:175]
    s_waitcnt lgkmcnt(7)
    s_and_b32 s44, s44, 0x1ffff
    v_fma_f32 v106, v106, s45, v123
    v_mfma_f32_16x16x32_bf16 a[0:3], a[224:227], v[32:35], a[0:3]
    s_add_u32 s44, s44, s36
    v_exp_f32 v102, v102
    v_mfma_f32_16x16x32_bf16 a[32:35], a[224:227], v[40:43], a[32:35]
    s_add_u32 m0, s39, 49152
    ds_read_b128 a[208:211], v206 offset:4096
    v_fma_f32 v107, v107, s45, v123
    v_mfma_f32_16x16x32_bf16 a[4:7], a[228:231], v[32:35], a[4:7]
    buffer_load_dwordx4 v192, s[8:11], s44 offen nt lds
    v_mfma_f32_16x16x32_bf16 a[36:39], a[228:231], v[40:43], a[36:39]
    ds_read_b128 a[212:215], v207 offset:4096
    v_fma_f32 v108, v108, s45, v123
    v_mfma_f32_16x16x32_bf16 a[8:11], a[232:235], v[32:35], a[8:11]
    buffer_load_dwordx4 v193, s[8:11], s44 offen offset:1024 nt lds
    v_mfma_f32_16x16x32_bf16 a[40:43], a[232:235], v[40:43], a[40:43]
    ds_read_b128 a[216:219], v208 offset:4096
    v_fma_f32 v109, v109, s45, v123
    v_mfma_f32_16x16x32_bf16 a[12:15], a[236:239], v[32:35], a[12:15]
    buffer_load_dwordx4 v194, s[8:11], s44 offen offset:2048 nt lds
    v_mfma_f32_16x16x32_bf16 a[44:47], a[236:239], v[40:43], a[44:47]
    ds_read_b128 a[220:223], v209 offset:4096
    v_fma_f32 v110, v110, s45, v123
    v_mfma_f32_16x16x32_bf16 a[16:19], a[240:243], v[32:35], a[16:19]
    buffer_load_dwordx4 v195, s[8:11], s44 offen offset:3072 nt lds
    v_mfma_f32_16x16x32_bf16 a[48:51], a[240:243], v[40:43], a[48:51]
    v_exp_f32 v103, v103
    v_fma_f32 v111, v111, s45, v123
    v_mfma_f32_16x16x32_bf16 a[20:23], a[244:247], v[32:35], a[20:23]
    v_exp_f32 v104, v104
    v_mfma_f32_16x16x32_bf16 a[52:55], a[244:247], v[40:43], a[52:55]
    s_waitcnt lgkmcnt(2)
    v_exp_f32 v105, v105
    v_mfma_f32_16x16x32_bf16 a[24:27], a[248:251], v[32:35], a[24:27]
    v_exp_f32 v106, v106
    v_mfma_f32_16x16x32_bf16 a[56:59], a[248:251], v[40:43], a[56:59]
    v_exp_f32 v107, v107
    v_mfma_f32_16x16x32_bf16 a[28:31], a[252:255], v[32:35], a[28:31]
    v_exp_f32 v108, v108
    v_mfma_f32_16x16x32_bf16 a[60:63], a[252:255], v[40:43], a[60:63]
    v_exp_f32 v109, v109
    v_mfma_f32_16x16x32_bf16 v[48:51], v[224:227], v[32:35], v[48:51]
    v_exp_f32 v110, v110
    v_cvt_pk_bf16_f32 v99, v102, v103
    v_mfma_f32_16x16x32_bf16 v[52:55], v[224:227], v[40:43], v[52:55]
    v_exp_f32 v111, v111
    v_mfma_f32_16x16x32_bf16 v[32:35], a[192:195], v[0:3], 0
    v_cvt_pk_bf16_f32 v104, v104, v105
    v_cvt_pk_bf16_f32 v105, v106, v107
    v_mfma_f32_16x16x32_bf16 v[32:35], a[196:199], v[8:11], v[32:35]
    v_cvt_pk_bf16_f32 v106, v108, v109
    v_cvt_pk_bf16_f32 v107, v110, v111
    v_mfma_f32_16x16x32_bf16 v[32:35], a[200:203], v[16:19], v[32:35]
    v_fma_f32 v160, v160, s45, v186
    v_fma_f32 v161, v161, s45, v186
    v_mfma_f32_16x16x32_bf16 v[32:35], a[204:207], v[24:27], v[32:35]
    v_exp_f32 v160, v160
    v_mfma_f32_16x16x32_bf16 v[36:39], a[208:211], v[0:3], 0
    v_exp_f32 v161, v161
    v_fma_f32 v162, v162, s45, v186
    v_mfma_f32_16x16x32_bf16 v[36:39], a[212:215], v[8:11], v[36:39]
    s_waitcnt lgkmcnt(0)
    v_exp_f32 v162, v162
    v_mfma_f32_16x16x32_bf16 v[36:39], a[216:219], v[16:19], v[36:39]
    v_cvt_pk_bf16_f32 v160, v160, v161
    v_fma_f32 v163, v163, s45, v186
    v_mfma_f32_16x16x32_bf16 v[36:39], a[220:223], v[24:27], v[36:39]
    v_exp_f32 v163, v163
    v_mfma_f32_16x16x32_bf16 v[40:43], a[192:195], v[4:7], 0
    v_cvt_pk_bf16_f32 v161, v162, v163
    v_fma_f32 v164, v164, s45, v186
    v_mfma_f32_16x16x32_bf16 v[40:43], a[196:199], v[12:15], v[40:43]
    v_exp_f32 v164, v164
    v_mfma_f32_16x16x32_bf16 v[40:43], a[200:203], v[20:23], v[40:43]
    v_fma_f32 v165, v165, s45, v186
    v_fma_f32 v166, v166, s45, v186
    v_mfma_f32_16x16x32_bf16 v[40:43], a[204:207], v[28:31], v[40:43]
    v_exp_f32 v165, v165
    v_fma_f32 v167, v167, s45, v186
    v_mfma_f32_16x16x32_bf16 v[44:47], a[208:211], v[4:7], 0
    v_exp_f32 v166, v166
    v_mfma_f32_16x16x32_bf16 v[44:47], a[212:215], v[12:15], v[44:47]
    v_exp_f32 v167, v167
    v_mfma_f32_16x16x32_bf16 v[44:47], a[216:219], v[20:23], v[44:47]
    v_cvt_pk_bf16_f32 v162, v164, v165
    v_cvt_pk_bf16_f32 v163, v166, v167
    v_mfma_f32_16x16x32_bf16 v[44:47], a[220:223], v[28:31], v[44:47]
    v_fma_f32 v168, v168, s45, v187
    v_fma_f32 v169, v169, s45, v187
    v_mfma_f32_16x16x32_bf16 a[64:67], a[224:227], v[96:99], a[64:67]
    v_exp_f32 v168, v168
    v_mfma_f32_16x16x32_bf16 a[96:99], a[224:227], v[104:107], a[96:99]
    v_exp_f32 v169, v169
    v_mfma_f32_16x16x32_bf16 a[68:71], a[228:231], v[96:99], a[68:71]
    v_cvt_pk_bf16_f32 v168, v168, v169
    v_fma_f32 v170, v170, s45, v187
    v_fma_f32 v171, v171, s45, v187
    v_mfma_f32_16x16x32_bf16 a[100:103], a[228:231], v[104:107], a[100:103]
    v_exp_f32 v170, v170
    v_mfma_f32_16x16x32_bf16 a[72:75], a[232:235], v[96:99], a[72:75]
    v_exp_f32 v171, v171
    v_mfma_f32_16x16x32_bf16 a[104:107], a[232:235], v[104:107], a[104:107]
    v_cvt_pk_bf16_f32 v169, v170, v171
    v_fma_f32 v172, v172, s45, v187
    v_mfma_f32_16x16x32_bf16 a[76:79], a[236:239], v[96:99], a[76:79]
    v_exp_f32 v172, v172
    v_mfma_f32_16x16x32_bf16 a[108:111], a[236:239], v[104:107], a[108:111]
    v_fma_f32 v173, v173, s45, v187
    v_fma_f32 v174, v174, s45, v187
    v_mfma_f32_16x16x32_bf16 a[80:83], a[240:243], v[96:99], a[80:83]
    v_exp_f32 v173, v173
    v_fma_f32 v175, v175, s45, v187
    v_mfma_f32_16x16x32_bf16 a[112:115], a[240:243], v[104:107], a[112:115]
    v_exp_f32 v174, v174
    v_mfma_f32_16x16x32_bf16 a[84:87], a[244:247], v[96:99], a[84:87]
    v_exp_f32 v175, v175
    v_mfma_f32_16x16x32_bf16 a[116:119], a[244:247], v[104:107], a[116:119]
    v_cvt_pk_bf16_f32 v170, v172, v173
    v_cvt_pk_bf16_f32 v171, v174, v175
    v_mfma_f32_16x16x32_bf16 a[88:91], a[248:251], v[96:99], a[88:91]
    v_fma_f32 v32, v32, s45, v58
    v_fma_f32 v33, v33, s45, v58
    v_mfma_f32_16x16x32_bf16 a[120:123], a[248:251], v[104:107], a[120:123]
    v_exp_f32 v32, v32
    v_mfma_f32_16x16x32_bf16 a[92:95], a[252:255], v[96:99], a[92:95]
    v_exp_f32 v33, v33
    v_mfma_f32_16x16x32_bf16 a[124:127], a[252:255], v[104:107], a[124:127]
    v_cvt_pk_bf16_f32 v32, v32, v33
    v_fma_f32 v34, v34, s45, v58
    v_fma_f32 v35, v35, s45, v58
    v_mfma_f32_16x16x32_bf16 v[112:115], v[224:227], v[96:99], v[112:115]
    v_exp_f32 v34, v34
    v_mfma_f32_16x16x32_bf16 v[116:119], v[224:227], v[104:107], v[116:119]
    v_exp_f32 v35, v35
    v_mfma_f32_16x16x32_bf16 v[96:99], a[192:195], v[64:67], 0
    s_add_u32 s43, s62, 65536
    v_cvt_pk_bf16_f32 v33, v34, v35
    v_fma_f32 v36, v36, s45, v58
    v_mfma_f32_16x16x32_bf16 v[96:99], a[196:199], v[72:75], v[96:99]
    s_and_b32 s43, s43, 0x1ffff
    v_exp_f32 v36, v36
    v_mfma_f32_16x16x32_bf16 v[96:99], a[200:203], v[80:83], v[96:99]
    s_add_u32 s43, s43, s36
    v_fma_f32 v37, v37, s45, v58
    v_fma_f32 v38, v38, s45, v58
    v_mfma_f32_16x16x32_bf16 v[96:99], a[204:207], v[88:91], v[96:99]
    s_add_u32 m0, s39, 114688
    v_exp_f32 v37, v37
    v_mfma_f32_16x16x32_bf16 v[100:103], a[208:211], v[64:67], 0
    buffer_load_dwordx4 v196, s[12:15], s43 offen nt lds
    v_mfma_f32_16x16x32_bf16 v[100:103], a[212:215], v[72:75], v[100:103]
    v_exp_f32 v38, v38
    v_mfma_f32_16x16x32_bf16 v[100:103], a[216:219], v[80:83], v[100:103]
    buffer_load_dwordx4 v197, s[12:15], s43 offen offset:1024 nt lds
    v_mfma_f32_16x16x32_bf16 v[100:103], a[220:223], v[88:91], v[100:103]
    v_cvt_pk_bf16_f32 v34, v36, v37
    v_fma_f32 v39, v39, s45, v58
    v_mfma_f32_16x16x32_bf16 v[104:107], a[192:195], v[68:71], 0
    buffer_load_dwordx4 v196, s[12:15], s43 offen offset:2048 nt lds
    v_mfma_f32_16x16x32_bf16 v[104:107], a[196:199], v[76:79], v[104:107]
    v_exp_f32 v39, v39
    v_mfma_f32_16x16x32_bf16 v[104:107], a[200:203], v[84:87], v[104:107]
    buffer_load_dwordx4 v197, s[12:15], s43 offen offset:3072 nt lds
    v_mfma_f32_16x16x32_bf16 v[104:107], a[204:207], v[92:95], v[104:107]
    v_cvt_pk_bf16_f32 v35, v38, v39
    v_fma_f32 v40, v40, s45, v59
    v_mfma_f32_16x16x32_bf16 v[108:111], a[208:211], v[68:71], 0
    v_exp_f32 v40, v40
    v_mfma_f32_16x16x32_bf16 v[108:111], a[212:215], v[76:79], v[108:111]
    v_fma_f32 v41, v41, s45, v59
    v_fma_f32 v42, v42, s45, v59
    v_mfma_f32_16x16x32_bf16 v[108:111], a[216:219], v[84:87], v[108:111]
    v_exp_f32 v41, v41
    v_mfma_f32_16x16x32_bf16 v[108:111], a[220:223], v[92:95], v[108:111]
    s_waitcnt vmcnt(12)
    s_barrier
    v_mfma_f32_16x16x32_bf16 a[128:131], a[224:227], v[160:163], a[128:131]
    v_exp_f32 v42, v42
    v_mfma_f32_16x16x32_bf16 a[160:163], a[224:227], v[168:171], a[160:163]
    ds_read_b64_tr_b16 a[224:225], v210
    v_cvt_pk_bf16_f32 v40, v40, v41
    v_fma_f32 v43, v43, s45, v59
    v_mfma_f32_16x16x32_bf16 a[132:135], a[228:231], v[160:163], a[132:135]
    v_exp_f32 v43, v43
    v_mfma_f32_16x16x32_bf16 a[164:167], a[228:231], v[168:171], a[164:167]
    ds_read_b64_tr_b16 a[226:227], v210 offset:4096
    v_cvt_pk_bf16_f32 v41, v42, v43
    v_mfma_f32_16x16x32_bf16 a[136:139], a[232:235], v[160:163], a[136:139]
    v_fma_f32 v44, v44, s45, v59
    v_fma_f32 v45, v45, s45, v59
    v_mfma_f32_16x16x32_bf16 a[168:171], a[232:235], v[168:171], a[168:171]
    ds_read_b64_tr_b16 a[228:229], v211
    v_fma_f32 v46, v46, s45, v59
    v_mfma_f32_16x16x32_bf16 a[140:143], a[236:239], v[160:163], a[140:143]
    v_exp_f32 v44, v44
    v_mfma_f32_16x16x32_bf16 a[172:175], a[236:239], v[168:171], a[172:175]
    ds_read_b64_tr_b16 a[230:231], v211 offset:4096
    v_fma_f32 v47, v47, s45, v59
    v_mfma_f32_16x16x32_bf16 a[144:147], a[240:243], v[160:163], a[144:147]
    v_exp_f32 v45, v45
    v_fma_f32 v96, v96, s45, v122
    v_mfma_f32_16x16x32_bf16 a[176:179], a[240:243], v[168:171], a[176:179]
    ds_read_b64_tr_b16 a[232:233], v212
    v_cvt_pk_bf16_f32 v42, v44, v45
    v_mfma_f32_16x16x32_bf16 a[148:151], a[244:247], v[160:163], a[148:151]
    v_exp_f32 v46, v46
    v_mfma_f32_16x16x32_bf16 a[180:183], a[244:247], v[168:171], a[180:183]
    ds_read_b64_tr_b16 a[234:235], v212 offset:4096
    v_fma_f32 v97, v97, s45, v122
    v_mfma_f32_16x16x32_bf16 a[152:155], a[248:251], v[160:163], a[152:155]
    v_exp_f32 v47, v47
    v_mfma_f32_16x16x32_bf16 a[184:187], a[248:251], v[168:171], a[184:187]
    ds_read_b64_tr_b16 a[236:237], v213
    v_cvt_pk_bf16_f32 v43, v46, v47
    v_mfma_f32_16x16x32_bf16 a[156:159], a[252:255], v[160:163], a[156:159]
    v_exp_f32 v96, v96
    v_fma_f32 v98, v98, s45, v122
    v_mfma_f32_16x16x32_bf16 a[188:191], a[252:255], v[168:171], a[188:191]
    ds_read_b64_tr_b16 a[238:239], v213 offset:4096
    v_fma_f32 v99, v99, s45, v122
    v_mfma_f32_16x16x32_bf16 v[176:179], v[224:227], v[160:163], v[176:179]
    v_exp_f32 v97, v97
    v_mfma_f32_16x16x32_bf16 v[180:183], v[224:227], v[168:171], v[180:183]
    ds_read_b64_tr_b16 a[240:241], v214
    v_cvt_pk_bf16_f32 v96, v96, v97
    v_mfma_f32_16x16x32_bf16 v[160:163], a[192:195], v[128:131], 0
    v_exp_f32 v98, v98
    v_mfma_f32_16x16x32_bf16 v[160:163], a[196:199], v[136:139], v[160:163]
    ds_read_b64_tr_b16 a[242:243], v214 offset:4096
    v_fma_f32 v100, v100, s45, v122
    v_mfma_f32_16x16x32_bf16 v[160:163], a[200:203], v[144:147], v[160:163]
    v_exp_f32 v99, v99
    v_mfma_f32_16x16x32_bf16 v[160:163], a[204:207], v[152:155], v[160:163]
    ds_read_b64_tr_b16 a[244:245], v215
    v_exp_f32 v100, v100
    v_mfma_f32_16x16x32_bf16 v[164:167], a[208:211], v[128:131], 0
    v_cvt_pk_bf16_f32 v97, v98, v99
    v_fma_f32 v101, v101, s45, v122
    v_mfma_f32_16x16x32_bf16 v[164:167], a[212:215], v[136:139], v[164:167]
    ds_read_b64_tr_b16 a[246:247], v215 offset:4096
    v_fma_f32 v102, v102, s45, v122
    v_mfma_f32_16x16x32_bf16 v[164:167], a[216:219], v[144:147], v[164:167]
    v_exp_f32 v101, v101
    v_mfma_f32_16x16x32_bf16 v[164:167], a[220:223], v[152:155], v[164:167]
    ds_read_b64_tr_b16 a[248:249], v216
    v_cvt_pk_bf16_f32 v98, v100, v101
    v_mfma_f32_16x16x32_bf16 v[168:171], a[192:195], v[132:135], 0
    ds_read_b128 a[192:195], v206 offset:32768
    v_fma_f32 v103, v103, s45, v122
    v_mfma_f32_16x16x32_bf16 v[168:171], a[196:199], v[140:143], v[168:171]
    ds_read_b64_tr_b16 a[250:251], v216 offset:4096
    v_fma_f32 v104, v104, s45, v123
    v_mfma_f32_16x16x32_bf16 v[168:171], a[200:203], v[148:151], v[168:171]
    ds_read_b128 a[196:199], v207 offset:32768
    v_exp_f32 v102, v102
    v_mfma_f32_16x16x32_bf16 v[168:171], a[204:207], v[156:159], v[168:171]
    ds_read_b64_tr_b16 a[252:253], v217
    v_fma_f32 v105, v105, s45, v123
    v_mfma_f32_16x16x32_bf16 v[172:175], a[208:211], v[132:135], 0
    ds_read_b128 a[200:203], v208 offset:32768
    v_fma_f32 v106, v106, s45, v123
    v_mfma_f32_16x16x32_bf16 v[172:175], a[212:215], v[140:143], v[172:175]
    ds_read_b64_tr_b16 a[254:255], v217 offset:4096
    v_fma_f32 v107, v107, s45, v123
    v_mfma_f32_16x16x32_bf16 v[172:175], a[216:219], v[148:151], v[172:175]
    ds_read_b128 a[204:207], v209 offset:32768
    v_fma_f32 v108, v108, s45, v123
    v_mfma_f32_16x16x32_bf16 v[172:175], a[220:223], v[156:159], v[172:175]
    s_waitcnt lgkmcnt(7)
    v_exp_f32 v103, v103
    v_mfma_f32_16x16x32_bf16 a[0:3], a[224:227], v[32:35], a[0:3]
    v_exp_f32 v104, v104
    v_cvt_pk_bf16_f32 v99, v102, v103
    v_mfma_f32_16x16x32_bf16 a[32:35], a[224:227], v[40:43], a[32:35]
    ds_read_b128 a[208:211], v206 offset:36864
    v_fma_f32 v109, v109, s45, v123
    v_mfma_f32_16x16x32_bf16 a[4:7], a[228:231], v[32:35], a[4:7]
    v_exp_f32 v105, v105
    v_mfma_f32_16x16x32_bf16 a[36:39], a[228:231], v[40:43], a[36:39]
    ds_read_b128 a[212:215], v207 offset:36864
    v_cvt_pk_bf16_f32 v104, v104, v105
    v_mfma_f32_16x16x32_bf16 a[8:11], a[232:235], v[32:35], a[8:11]
    s_add_u32 s44, s62, 73728
    v_exp_f32 v106, v106
    v_mfma_f32_16x16x32_bf16 a[40:43], a[232:235], v[40:43], a[40:43]
    s_and_b32 s44, s44, 0x1ffff
    ds_read_b128 a[216:219], v208 offset:36864
    v_fma_f32 v110, v110, s45, v123
    v_mfma_f32_16x16x32_bf16 a[12:15], a[236:239], v[32:35], a[12:15]
    s_add_u32 s44, s44, s36
    v_exp_f32 v107, v107
    v_mfma_f32_16x16x32_bf16 a[44:47], a[236:239], v[40:43], a[44:47]
    s_add_u32 m0, s39, 0
    ds_read_b128 a[220:223], v209 offset:36864
    v_exp_f32 v108, v108
    v_mfma_f32_16x16x32_bf16 a[16:19], a[240:243], v[32:35], a[16:19]
    buffer_load_dwordx4 v192, s[8:11], s44 offen nt lds
    v_mfma_f32_16x16x32_bf16 a[48:51], a[240:243], v[40:43], a[48:51]
    v_exp_f32 v109, v109
    v_mfma_f32_16x16x32_bf16 a[20:23], a[244:247], v[32:35], a[20:23]
    buffer_load_dwordx4 v193, s[8:11], s44 offen offset:1024 nt lds
    v_mfma_f32_16x16x32_bf16 a[52:55], a[244:247], v[40:43], a[52:55]
    s_waitcnt lgkmcnt(2)
    v_exp_f32 v110, v110
    v_mfma_f32_16x16x32_bf16 a[24:27], a[248:251], v[32:35], a[24:27]
    buffer_load_dwordx4 v194, s[8:11], s44 offen offset:2048 nt lds
    v_mfma_f32_16x16x32_bf16 a[56:59], a[248:251], v[40:43], a[56:59]
    v_cvt_pk_bf16_f32 v105, v106, v107
    v_cvt_pk_bf16_f32 v106, v108, v109
    v_mfma_f32_16x16x32_bf16 a[28:31], a[252:255], v[32:35], a[28:31]
    buffer_load_dwordx4 v195, s[8:11], s44 offen offset:3072 nt lds
    v_mfma_f32_16x16x32_bf16 a[60:63], a[252:255], v[40:43], a[60:63]
    v_fma_f32 v111, v111, s45, v123
    v_fma_f32 v160, v160, s45, v186
    v_mfma_f32_16x16x32_bf16 v[48:51], v[224:227], v[32:35], v[48:51]
    v_exp_f32 v111, v111
    v_mfma_f32_16x16x32_bf16 v[52:55], v[224:227], v[40:43], v[52:55]
    v_exp_f32 v160, v160
    v_mfma_f32_16x16x32_bf16 v[32:35], a[192:195], v[0:3], 0
    v_cvt_pk_bf16_f32 v107, v110, v111
    v_fma_f32 v161, v161, s45, v186
    v_mfma_f32_16x16x32_bf16 v[32:35], a[196:199], v[8:11], v[32:35]
    v_exp_f32 v161, v161
    v_mfma_f32_16x16x32_bf16 v[32:35], a[200:203], v[16:19], v[32:35]
    v_cvt_pk_bf16_f32 v160, v160, v161
    v_fma_f32 v162, v162, s45, v186
    v_fma_f32 v163, v163, s45, v186
    v_mfma_f32_16x16x32_bf16 v[32:35], a[204:207], v[24:27], v[32:35]
    v_exp_f32 v162, v162
    v_mfma_f32_16x16x32_bf16 v[36:39], a[208:211], v[0:3], 0
    v_exp_f32 v163, v163
    v_mfma_f32_16x16x32_bf16 v[36:39], a[212:215], v[8:11], v[36:39]
    s_waitcnt lgkmcnt(0)
    v_cvt_pk_bf16_f32 v161, v162, v163
    v_fma_f32 v164, v164, s45, v186
    v_mfma_f32_16x16x32_bf16 v[36:39], a[216:219], v[16:19], v[36:39]
    v_exp_f32 v164, v164
    v_mfma_f32_16x16x32_bf16 v[36:39], a[220:223], v[24:27], v[36:39]
    v_fma_f32 v165, v165, s45, v186
    v_fma_f32 v166, v166, s45, v186
    v_mfma_f32_16x16x32_bf16 v[40:43], a[192:195], v[4:7], 0
    v_exp_f32 v165, v165
    v_mfma_f32_16x16x32_bf16 v[40:43], a[196:199], v[12:15], v[40:43]
    v_exp_f32 v166, v166
    v_cvt_pk_bf16_f32 v162, v164, v165
    v_mfma_f32_16x16x32_bf16 v[40:43], a[200:203], v[20:23], v[40:43]
    v_fma_f32 v167, v167, s45, v186
    v_fma_f32 v168, v168, s45, v187
    v_mfma_f32_16x16x32_bf16 v[40:43], a[204:207], v[28:31], v[40:43]
    v_exp_f32 v167, v167
    v_mfma_f32_16x16x32_bf16 v[44:47], a[208:211], v[4:7], 0
    v_exp_f32 v168, v168
    v_mfma_f32_16x16x32_bf16 v[44:47], a[212:215], v[12:15], v[44:47]
    v_cvt_pk_bf16_f32 v163, v166, v167
    v_fma_f32 v169, v169, s45, v187
    v_mfma_f32_16x16x32_bf16 v[44:47], a[216:219], v[20:23], v[44:47]
    v_exp_f32 v169, v169
    v_mfma_f32_16x16x32_bf16 v[44:47], a[220:223], v[28:31], v[44:47]
    v_cvt_pk_bf16_f32 v168, v168, v169
    v_fma_f32 v170, v170, s45, v187
    v_mfma_f32_16x16x32_bf16 a[64:67], a[224:227], v[96:99], a[64:67]
    v_exp_f32 v170, v170
    v_fma_f32 v171, v171, s45, v187
    v_mfma_f32_16x16x32_bf16 a[96:99], a[224:227], v[104:107], a[96:99]
    v_exp_f32 v171, v171
    v_mfma_f32_16x16x32_bf16 a[68:71], a[228:231], v[96:99], a[68:71]
    v_cvt_pk_bf16_f32 v169, v170, v171
    v_fma_f32 v172, v172, s45, v187
    v_mfma_f32_16x16x32_bf16 a[100:103], a[228:231], v[104:107], a[100:103]
    v_exp_f32 v172, v172
    v_mfma_f32_16x16x32_bf16 a[72:75], a[232:235], v[96:99], a[72:75]
    v_fma_f32 v173, v173, s45, v187
    v_fma_f32 v174, v174, s45, v187
    v_mfma_f32_16x16x32_bf16 a[104:107], a[232:235], v[104:107], a[104:107]
    v_exp_f32 v173, v173
    v_mfma_f32_16x16x32_bf16 a[76:79], a[236:239], v[96:99], a[76:79]
    v_exp_f32 v174, v174
    v_cvt_pk_bf16_f32 v170, v172, v173
    v_mfma_f32_16x16x32_bf16 a[108:111], a[236:239], v[104:107], a[108:111]
    v_fma_f32 v175, v175, s45, v187
    v_fma_f32 v32, v32, s45, v58
    v_mfma_f32_16x16x32_bf16 a[80:83], a[240:243], v[96:99], a[80:83]
    v_exp_f32 v175, v175
    v_mfma_f32_16x16x32_bf16 a[112:115], a[240:243], v[104:107], a[112:115]
    v_exp_f32 v32, v32
    v_mfma_f32_16x16x32_bf16 a[84:87], a[244:247], v[96:99], a[84:87]
    v_cvt_pk_bf16_f32 v171, v174, v175
    v_fma_f32 v33, v33, s45, v58
    v_mfma_f32_16x16x32_bf16 a[116:119], a[244:247], v[104:107], a[116:119]
    v_exp_f32 v33, v33
    v_mfma_f32_16x16x32_bf16 a[88:91], a[248:251], v[96:99], a[88:91]
    v_cvt_pk_bf16_f32 v32, v32, v33
    v_fma_f32 v34, v34, s45, v58
    v_mfma_f32_16x16x32_bf16 a[120:123], a[248:251], v[104:107], a[120:123]
    v_exp_f32 v34, v34
    v_fma_f32 v35, v35, s45, v58
    v_mfma_f32_16x16x32_bf16 a[92:95], a[252:255], v[96:99], a[92:95]
    v_exp_f32 v35, v35
    v_mfma_f32_16x16x32_bf16 a[124:127], a[252:255], v[104:107], a[124:127]
    v_cvt_pk_bf16_f32 v33, v34, v35
    v_fma_f32 v36, v36, s45, v58
    v_mfma_f32_16x16x32_bf16 v[112:115], v[224:227], v[96:99], v[112:115]
    v_exp_f32 v36, v36
    v_mfma_f32_16x16x32_bf16 v[116:119], v[224:227], v[104:107], v[116:119]
    v_fma_f32 v37, v37, s45, v58
    v_fma_f32 v38, v38, s45, v58
    v_mfma_f32_16x16x32_bf16 v[96:99], a[192:195], v[64:67], 0
    v_exp_f32 v37, v37
    v_mfma_f32_16x16x32_bf16 v[96:99], a[196:199], v[72:75], v[96:99]
    v_exp_f32 v38, v38
    v_mfma_f32_16x16x32_bf16 v[96:99], a[200:203], v[80:83], v[96:99]
    v_add_u32 v210, 0x14000, v210
    v_add_u32 v211, 0x14000, v211
    v_mfma_f32_16x16x32_bf16 v[96:99], a[204:207], v[88:91], v[96:99]
    v_cvt_pk_bf16_f32 v34, v36, v37
    v_fma_f32 v39, v39, s45, v58
    v_mfma_f32_16x16x32_bf16 v[100:103], a[208:211], v[64:67], 0
    v_exp_f32 v39, v39
    v_mfma_f32_16x16x32_bf16 v[100:103], a[212:215], v[72:75], v[100:103]
    v_add_u32 v212, 0x14000, v212
    v_add_u32 v213, 0x14000, v213
    v_mfma_f32_16x16x32_bf16 v[100:103], a[216:219], v[80:83], v[100:103]
    s_add_u32 s43, s62, 73728
    v_cvt_pk_bf16_f32 v35, v38, v39
    v_fma_f32 v40, v40, s45, v59
    v_mfma_f32_16x16x32_bf16 v[100:103], a[220:223], v[88:91], v[100:103]
    s_and_b32 s43, s43, 0x1ffff
    v_exp_f32 v40, v40
    v_mfma_f32_16x16x32_bf16 v[104:107], a[192:195], v[68:71], 0
    s_add_u32 s43, s43, s36
    v_add_u32 v214, 0x14000, v214
    v_add_u32 v215, 0x14000, v215
    v_mfma_f32_16x16x32_bf16 v[104:107], a[196:199], v[76:79], v[104:107]
    s_add_u32 m0, s39, 98304
    v_fma_f32 v41, v41, s45, v59
    v_fma_f32 v42, v42, s45, v59
    v_mfma_f32_16x16x32_bf16 v[104:107], a[200:203], v[84:87], v[104:107]
    buffer_load_dwordx4 v196, s[12:15], s43 offen nt lds
    v_mfma_f32_16x16x32_bf16 v[104:107], a[204:207], v[92:95], v[104:107]
    v_add_u32 v216, 0x14000, v216
    v_add_u32 v217, 0x14000, v217
    v_mfma_f32_16x16x32_bf16 v[108:111], a[208:211], v[68:71], 0
    buffer_load_dwordx4 v197, s[12:15], s43 offen offset:1024 nt lds
    v_mfma_f32_16x16x32_bf16 v[108:111], a[212:215], v[76:79], v[108:111]
    v_exp_f32 v41, v41
    v_mfma_f32_16x16x32_bf16 v[108:111], a[216:219], v[84:87], v[108:111]
    buffer_load_dwordx4 v196, s[12:15], s43 offen offset:2048 nt lds
    v_mfma_f32_16x16x32_bf16 v[108:111], a[220:223], v[92:95], v[108:111]
    s_waitcnt vmcnt(11)
    s_barrier
    v_mfma_f32_16x16x32_bf16 a[128:131], a[224:227], v[160:163], a[128:131]
    v_exp_f32 v42, v42
    v_mfma_f32_16x16x32_bf16 a[160:163], a[224:227], v[168:171], a[160:163]
    ds_read_b64_tr_b16 a[224:225], v210 offset:49152
    v_cvt_pk_bf16_f32 v40, v40, v41
    v_mfma_f32_16x16x32_bf16 a[132:135], a[228:231], v[160:163], a[132:135]
    buffer_load_dwordx4 v197, s[12:15], s43 offen offset:3072 nt lds
    v_mfma_f32_16x16x32_bf16 a[164:167], a[228:231], v[168:171], a[164:167]
    ds_read_b64_tr_b16 a[226:227], v210 offset:53248
    v_fma_f32 v43, v43, s45, v59
    v_mfma_f32_16x16x32_bf16 a[136:139], a[232:235], v[160:163], a[136:139]
    v_exp_f32 v43, v43
    v_mfma_f32_16x16x32_bf16 a[168:171], a[232:235], v[168:171], a[168:171]
    ds_read_b64_tr_b16 a[228:229], v211 offset:49152
    v_cvt_pk_bf16_f32 v41, v42, v43
    v_mfma_f32_16x16x32_bf16 a[140:143], a[236:239], v[160:163], a[140:143]
    v_fma_f32 v44, v44, s45, v59
    v_exp_f32 v44, v44
    v_mfma_f32_16x16x32_bf16 a[172:175], a[236:239], v[168:171], a[172:175]
    ds_read_b64_tr_b16 a[230:231], v211 offset:53248
    v_fma_f32 v45, v45, s45, v59
    v_mfma_f32_16x16x32_bf16 a[144:147], a[240:243], v[160:163], a[144:147]
    v_exp_f32 v45, v45
    v_mfma_f32_16x16x32_bf16 a[176:179], a[240:243], v[168:171], a[176:179]
    ds_read_b64_tr_b16 a[232:233], v212 offset:49152
    v_cvt_pk_bf16_f32 v42, v44, v45
    v_mfma_f32_16x16x32_bf16 a[148:151], a[244:247], v[160:163], a[148:151]
    v_fma_f32 v46, v46, s45, v59
    v_fma_f32 v47, v47, s45, v59
    v_mfma_f32_16x16x32_bf16 a[180:183], a[244:247], v[168:171], a[180:183]
    ds_read_b64_tr_b16 a[234:235], v212 offset:53248
    v_fma_f32 v96, v96, s45, v122
    v_mfma_f32_16x16x32_bf16 a[152:155], a[248:251], v[160:163], a[152:155]
    v_exp_f32 v46, v46
    v_fma_f32 v97, v97, s45, v122
    v_mfma_f32_16x16x32_bf16 a[184:187], a[248:251], v[168:171], a[184:187]
    ds_read_b64_tr_b16 a[236:237], v213 offset:49152
    v_fma_f32 v98, v98, s45, v122
    v_mfma_f32_16x16x32_bf16 a[156:159], a[252:255], v[160:163], a[156:159]
    v_exp_f32 v47, v47
    v_mfma_f32_16x16x32_bf16 a[188:191], a[252:255], v[168:171], a[188:191]
    ds_read_b64_tr_b16 a[238:239], v213 offset:53248
    v_cvt_pk_bf16_f32 v43, v46, v47
    v_mfma_f32_16x16x32_bf16 v[176:179], v[224:227], v[160:163], v[176:179]
    v_exp_f32 v96, v96
    v_mfma_f32_16x16x32_bf16 v[180:183], v[224:227], v[168:171], v[180:183]
    ds_read_b64_tr_b16 a[240:241], v214 offset:49152
    v_fma_f32 v99, v99, s45, v122
    v_mfma_f32_16x16x32_bf16 v[160:163], a[192:195], v[128:131], 0
    v_exp_f32 v97, v97
    v_mfma_f32_16x16x32_bf16 v[160:163], a[196:199], v[136:139], v[160:163]
    ds_read_b64_tr_b16 a[242:243], v214 offset:53248
    v_exp_f32 v98, v98
    v_mfma_f32_16x16x32_bf16 v[160:163], a[200:203], v[144:147], v[160:163]
    v_exp_f32 v99, v99
    v_mfma_f32_16x16x32_bf16 v[160:163], a[204:207], v[152:155], v[160:163]
    ds_read_b64_tr_b16 a[244:245], v215 offset:49152
    v_cvt_pk_bf16_f32 v96, v96, v97
    v_mfma_f32_16x16x32_bf16 v[164:167], a[208:211], v[128:131], 0
    v_cvt_pk_bf16_f32 v97, v98, v99
    v_fma_f32 v100, v100, s45, v122
    v_mfma_f32_16x16x32_bf16 v[164:167], a[212:215], v[136:139], v[164:167]
    ds_read_b64_tr_b16 a[246:247], v215 offset:53248
    v_fma_f32 v101, v101, s45, v122
    v_mfma_f32_16x16x32_bf16 v[164:167], a[216:219], v[144:147], v[164:167]
    v_exp_f32 v100, v100
    v_mfma_f32_16x16x32_bf16 v[164:167], a[220:223], v[152:155], v[164:167]
    ds_read_b64_tr_b16 a[248:249], v216 offset:49152
    v_fma_f32 v102, v102, s45, v122
    v_mfma_f32_16x16x32_bf16 v[168:171], a[192:195], v[132:135], 0
    ds_read_b128 a[192:195], v206 offset:49152
    v_exp_f32 v101, v101
    v_mfma_f32_16x16x32_bf16 v[168:171], a[196:199], v[140:143], v[168:171]
    ds_read_b64_tr_b16 a[250:251], v216 offset:53248
    v_cvt_pk_bf16_f32 v98, v100, v101
    v_mfma_f32_16x16x32_bf16 v[168:171], a[200:203], v[148:151], v[168:171]
    ds_read_b128 a[196:199], v207 offset:49152
    v_fma_f32 v103, v103, s45, v122
    v_mfma_f32_16x16x32_bf16 v[168:171], a[204:207], v[156:159], v[168:171]
    ds_read_b64_tr_b16 a[252:253], v217 offset:49152
    v_fma_f32 v104, v104, s45, v123
    v_mfma_f32_16x16x32_bf16 v[172:175], a[208:211], v[132:135], 0
    ds_read_b128 a[200:203], v208 offset:49152
    v_fma_f32 v105, v105, s45, v123
    v_mfma_f32_16x16x32_bf16 v[172:175], a[212:215], v[140:143], v[172:175]
    ds_read_b64_tr_b16 a[254:255], v217 offset:53248
    v_fma_f32 v106, v106, s45, v123
    v_mfma_f32_16x16x32_bf16 v[172:175], a[216:219], v[148:151], v[172:175]
    ds_read_b128 a[204:207], v209 offset:49152
    v_exp_f32 v102, v102
    v_mfma_f32_16x16x32_bf16 v[172:175], a[220:223], v[156:159], v[172:175]
    s_waitcnt lgkmcnt(7)
    v_exp_f32 v103, v103
    v_mfma_f32_16x16x32_bf16 a[0:3], a[224:227], v[32:35], a[0:3]
    v_exp_f32 v104, v104
    v_mfma_f32_16x16x32_bf16 a[32:35], a[224:227], v[40:43], a[32:35]
    ds_read_b128 a[208:211], v206 offset:53248
    v_cvt_pk_bf16_f32 v99, v102, v103
    v_mfma_f32_16x16x32_bf16 a[4:7], a[228:231], v[32:35], a[4:7]
    v_exp_f32 v105, v105
    v_mfma_f32_16x16x32_bf16 a[36:39], a[228:231], v[40:43], a[36:39]
    ds_read_b128 a[212:215], v207 offset:53248
    v_cvt_pk_bf16_f32 v104, v104, v105
    v_mfma_f32_16x16x32_bf16 a[8:11], a[232:235], v[32:35], a[8:11]
    v_exp_f32 v106, v106
    v_mfma_f32_16x16x32_bf16 a[40:43], a[232:235], v[40:43], a[40:43]
    ds_read_b128 a[216:219], v208 offset:53248
    v_fma_f32 v107, v107, s45, v123
    v_fma_f32 v108, v108, s45, v123
    v_mfma_f32_16x16x32_bf16 a[12:15], a[236:239], v[32:35], a[12:15]
    v_exp_f32 v107, v107
    v_mfma_f32_16x16x32_bf16 a[44:47], a[236:239], v[40:43], a[44:47]
    ds_read_b128 a[220:223], v209 offset:53248
    v_cvt_pk_bf16_f32 v105, v106, v107
    v_mfma_f32_16x16x32_bf16 a[16:19], a[240:243], v[32:35], a[16:19]
    v_exp_f32 v108, v108
    v_mfma_f32_16x16x32_bf16 a[48:51], a[240:243], v[40:43], a[48:51]
    v_fma_f32 v109, v109, s45, v123
    v_fma_f32 v110, v110, s45, v123
    v_mfma_f32_16x16x32_bf16 a[20:23], a[244:247], v[32:35], a[20:23]
    v_exp_f32 v109, v109
    v_mfma_f32_16x16x32_bf16 a[52:55], a[244:247], v[40:43], a[52:55]
    s_waitcnt lgkmcnt(2)
    s_add_u32 s44, s62, 81920
    v_cvt_pk_bf16_f32 v106, v108, v109
    v_mfma_f32_16x16x32_bf16 a[24:27], a[248:251], v[32:35], a[24:27]
    s_and_b32 s44, s44, 0x1ffff
    v_exp_f32 v110, v110
    v_fma_f32 v111, v111, s45, v123
    v_mfma_f32_16x16x32_bf16 a[56:59], a[248:251], v[40:43], a[56:59]
    s_add_u32 s44, s44, s36
    v_exp_f32 v111, v111
    v_mfma_f32_16x16x32_bf16 a[28:31], a[252:255], v[32:35], a[28:31]
    s_add_u32 m0, s39, 16384
    v_cvt_pk_bf16_f32 v107, v110, v111
    v_fma_f32 v160, v160, s45, v186
    v_mfma_f32_16x16x32_bf16 a[60:63], a[252:255], v[40:43], a[60:63]
    buffer_load_dwordx4 v192, s[8:11], s44 offen nt lds
    v_mfma_f32_16x16x32_bf16 v[48:51], v[224:227], v[32:35], v[48:51]
    v_exp_f32 v160, v160
    v_mfma_f32_16x16x32_bf16 v[52:55], v[224:227], v[40:43], v[52:55]
    buffer_load_dwordx4 v193, s[8:11], s44 offen offset:1024 nt lds
    v_mfma_f32_16x16x32_bf16 v[32:35], a[192:195], v[0:3], 0
    v_fma_f32 v161, v161, s45, v186
    v_exp_f32 v161, v161
    v_mfma_f32_16x16x32_bf16 v[32:35], a[196:199], v[8:11], v[32:35]
    buffer_load_dwordx4 v194, s[8:11], s44 offen offset:2048 nt lds
    v_mfma_f32_16x16x32_bf16 v[32:35], a[200:203], v[16:19], v[32:35]
    v_cvt_pk_bf16_f32 v160, v160, v161
    v_fma_f32 v162, v162, s45, v186
    v_mfma_f32_16x16x32_bf16 v[32:35], a[204:207], v[24:27], v[32:35]
    buffer_load_dwordx4 v195, s[8:11], s44 offen offset:3072 nt lds
    v_mfma_f32_16x16x32_bf16 v[36:39], a[208:211], v[0:3], 0
    v_exp_f32 v162, v162
    v_mfma_f32_16x16x32_bf16 v[36:39], a[212:215], v[8:11], v[36:39]
    s_waitcnt lgkmcnt(0)
    v_fma_f32 v163, v163, s45, v186
    v_fma_f32 v164, v164, s45, v186
    v_mfma_f32_16x16x32_bf16 v[36:39], a[216:219], v[16:19], v[36:39]
    v_exp_f32 v163, v163
    v_mfma_f32_16x16x32_bf16 v[36:39], a[220:223], v[24:27], v[36:39]
    v_exp_f32 v164, v164
    v_cvt_pk_bf16_f32 v161, v162, v163
    v_mfma_f32_16x16x32_bf16 v[40:43], a[192:195], v[4:7], 0
    v_fma_f32 v165, v165, s45, v186
    v_fma_f32 v166, v166, s45, v186
    v_mfma_f32_16x16x32_bf16 v[40:43], a[196:199], v[12:15], v[40:43]
    v_exp_f32 v165, v165
    v_mfma_f32_16x16x32_bf16 v[40:43], a[200:203], v[20:23], v[40:43]
    v_exp_f32 v166, v166
    v_mfma_f32_16x16x32_bf16 v[40:43], a[204:207], v[28:31], v[40:43]
    v_cvt_pk_bf16_f32 v162, v164, v165
    v_fma_f32 v167, v167, s45, v186
    v_mfma_f32_16x16x32_bf16 v[44:47], a[208:211], v[4:7], 0
    v_exp_f32 v167, v167
    v_mfma_f32_16x16x32_bf16 v[44:47], a[212:215], v[12:15], v[44:47]
    v_cvt_pk_bf16_f32 v163, v166, v167
    v_fma_f32 v168, v168, s45, v187
    v_mfma_f32_16x16x32_bf16 v[44:47], a[216:219], v[20:23], v[44:47]
    v_exp_f32 v168, v168
    v_fma_f32 v169, v169, s45, v187
    v_mfma_f32_16x16x32_bf16 v[44:47], a[220:223], v[28:31], v[44:47]
    v_exp_f32 v169, v169
    v_mfma_f32_16x16x32_bf16 a[64:67], a[224:227], v[96:99], a[64:67]
    v_cvt_pk_bf16_f32 v168, v168, v169
    v_fma_f32 v170, v170, s45, v187
    v_mfma_f32_16x16x32_bf16 a[96:99], a[224:227], v[104:107], a[96:99]
    v_exp_f32 v170, v170
    v_mfma_f32_16x16x32_bf16 a[68:71], a[228:231], v[96:99], a[68:71]
    v_fma_f32 v171, v171, s45, v187
    v_fma_f32 v172, v172, s45, v187
    v_mfma_f32_16x16x32_bf16 a[100:103], a[228:231], v[104:107], a[100:103]
    v_exp_f32 v171, v171
    v_mfma_f32_16x16x32_bf16 a[72:75], a[232:235], v[96:99], a[72:75]
    v_exp_f32 v172, v172
    v_cvt_pk_bf16_f32 v169, v170, v171
    v_mfma_f32_16x16x32_bf16 a[104:107], a[232:235], v[104:107], a[104:107]
    v_fma_f32 v173, v173, s45, v187
    v_fma_f32 v174, v174, s45, v187
    v_mfma_f32_16x16x32_bf16 a[76:79], a[236:239], v[96:99], a[76:79]
    v_exp_f32 v173, v173
    v_mfma_f32_16x16x32_bf16 a[108:111], a[236:239], v[104:107], a[108:111]
    v_exp_f32 v174, v174
    v_mfma_f32_16x16x32_bf16 a[80:83], a[240:243], v[96:99], a[80:83]
    v_cvt_pk_bf16_f32 v170, v172, v173
    v_fma_f32 v175, v175, s45, v187
    v_mfma_f32_16x16x32_bf16 a[112:115], a[240:243], v[104:107], a[112:115]
    v_exp_f32 v175, v175
    v_mfma_f32_16x16x32_bf16 a[84:87], a[244:247], v[96:99], a[84:87]
    v_cvt_pk_bf16_f32 v171, v174, v175
    v_fma_f32 v32, v32, s45, v58
    v_mfma_f32_16x16x32_bf16 a[116:119], a[244:247], v[104:107], a[116:119]
    v_exp_f32 v32, v32
    v_fma_f32 v33, v33, s45, v58
    v_mfma_f32_16x16x32_bf16 a[88:91], a[248:251], v[96:99], a[88:91]
    v_exp_f32 v33, v33
    v_mfma_f32_16x16x32_bf16 a[120:123], a[248:251], v[104:107], a[120:123]
    v_cvt_pk_bf16_f32 v32, v32, v33
    v_fma_f32 v34, v34, s45, v58
    v_mfma_f32_16x16x32_bf16 a[92:95], a[252:255], v[96:99], a[92:95]
    v_exp_f32 v34, v34
    v_mfma_f32_16x16x32_bf16 a[124:127], a[252:255], v[104:107], a[124:127]
    v_fma_f32 v35, v35, s45, v58
    v_fma_f32 v36, v36, s45, v58
    v_mfma_f32_16x16x32_bf16 v[112:115], v[224:227], v[96:99], v[112:115]
    v_exp_f32 v35, v35
    v_mfma_f32_16x16x32_bf16 v[116:119], v[224:227], v[104:107], v[116:119]
    v_exp_f32 v36, v36
    v_mfma_f32_16x16x32_bf16 v[96:99], a[192:195], v[64:67], 0
    v_cvt_pk_bf16_f32 v33, v34, v35
    v_fma_f32 v37, v37, s45, v58
    v_fma_f32 v38, v38, s45, v58
    v_mfma_f32_16x16x32_bf16 v[96:99], a[196:199], v[72:75], v[96:99]
    v_exp_f32 v37, v37
    v_mfma_f32_16x16x32_bf16 v[96:99], a[200:203], v[80:83], v[96:99]
    v_exp_f32 v38, v38
    v_mfma_f32_16x16x32_bf16 v[96:99], a[204:207], v[88:91], v[96:99]
    v_cvt_pk_bf16_f32 v34, v36, v37
    v_fma_f32 v39, v39, s45, v58
    v_mfma_f32_16x16x32_bf16 v[100:103], a[208:211], v[64:67], 0
    v_exp_f32 v39, v39
    v_mfma_f32_16x16x32_bf16 v[100:103], a[212:215], v[72:75], v[100:103]
    v_cvt_pk_bf16_f32 v35, v38, v39
    v_fma_f32 v40, v40, s45, v59
    v_mfma_f32_16x16x32_bf16 v[100:103], a[216:219], v[80:83], v[100:103]
    v_exp_f32 v40, v40
    v_fma_f32 v41, v41, s45, v59
    v_mfma_f32_16x16x32_bf16 v[100:103], a[220:223], v[88:91], v[100:103]
    v_exp_f32 v41, v41
    v_mfma_f32_16x16x32_bf16 v[104:107], a[192:195], v[68:71], 0
    v_cvt_pk_bf16_f32 v40, v40, v41
    v_fma_f32 v42, v42, s45, v59
    v_mfma_f32_16x16x32_bf16 v[104:107], a[196:199], v[76:79], v[104:107]
    v_exp_f32 v42, v42
    v_mfma_f32_16x16x32_bf16 v[104:107], a[200:203], v[84:87], v[104:107]
    v_fma_f32 v43, v43, s45, v59
    v_fma_f32 v44, v44, s45, v59
    v_mfma_f32_16x16x32_bf16 v[104:107], a[204:207], v[92:95], v[104:107]
    v_exp_f32 v43, v43
    v_mfma_f32_16x16x32_bf16 v[108:111], a[208:211], v[68:71], 0
    v_exp_f32 v44, v44
    v_mfma_f32_16x16x32_bf16 v[108:111], a[212:215], v[76:79], v[108:111]
    v_cvt_pk_bf16_f32 v41, v42, v43
    v_fma_f32 v45, v45, s45, v59
    v_fma_f32 v46, v46, s45, v59
    v_mfma_f32_16x16x32_bf16 v[108:111], a[216:219], v[84:87], v[108:111]
    s_add_u32 s43, s62, 81920
    v_exp_f32 v45, v45
    v_mfma_f32_16x16x32_bf16 v[108:111], a[220:223], v[92:95], v[108:111]
    s_waitcnt vmcnt(8)
    s_barrier
    s_and_b32 s43, s43, 0x1ffff
    v_mfma_f32_16x16x32_bf16 a[128:131], a[224:227], v[160:163], a[128:131]
    s_add_u32 s43, s43, s36
    v_exp_f32 v46, v46
    v_mfma_f32_16x16x32_bf16 a[160:163], a[224:227], v[168:171], a[160:163]
    s_add_u32 m0, s39, 32768
    ds_read_b64_tr_b16 a[224:225], v210 offset:16384
    v_cvt_pk_bf16_f32 v42, v44, v45
    v_mfma_f32_16x16x32_bf16 a[132:135], a[228:231], v[160:163], a[132:135]
    buffer_load_dwordx4 v196, s[12:15], s43 offen nt lds
    v_mfma_f32_16x16x32_bf16 a[164:167], a[228:231], v[168:171], a[164:167]
    ds_read_b64_tr_b16 a[226:227], v210 offset:20480
    v_fma_f32 v47, v47, s45, v59
    v_mfma_f32_16x16x32_bf16 a[136:139], a[232:235], v[160:163], a[136:139]
    buffer_load_dwordx4 v197, s[12:15], s43 offen offset:1024 nt lds
    v_mfma_f32_16x16x32_bf16 a[168:171], a[232:235], v[168:171], a[168:171]
    ds_read_b64_tr_b16 a[228:229], v211 offset:16384
    v_fma_f32 v96, v96, s45, v122
    v_mfma_f32_16x16x32_bf16 a[140:143], a[236:239], v[160:163], a[140:143]
    buffer_load_dwordx4 v196, s[12:15], s43 offen offset:2048 nt lds
    v_mfma_f32_16x16x32_bf16 a[172:175], a[236:239], v[168:171], a[172:175]
    ds_read_b64_tr_b16 a[230:231], v211 offset:20480
    v_fma_f32 v97, v97, s45, v122
    v_mfma_f32_16x16x32_bf16 a[144:147], a[240:243], v[160:163], a[144:147]
    buffer_load_dwordx4 v197, s[12:15], s43 offen offset:3072 nt lds
    v_mfma_f32_16x16x32_bf16 a[176:179], a[240:243], v[168:171], a[176:179]
    ds_read_b64_tr_b16 a[232:233], v212 offset:16384
    v_fma_f32 v98, v98, s45, v122
    v_mfma_f32_16x16x32_bf16 a[148:151], a[244:247], v[160:163], a[148:151]
    v_exp_f32 v47, v47
    v_fma_f32 v99, v99, s45, v122
    v_mfma_f32_16x16x32_bf16 a[180:183], a[244:247], v[168:171], a[180:183]
    ds_read_b64_tr_b16 a[234:235], v212 offset:20480
    v_cvt_pk_bf16_f32 v43, v46, v47
    v_mfma_f32_16x16x32_bf16 a[152:155], a[248:251], v[160:163], a[152:155]
    v_exp_f32 v96, v96
    v_mfma_f32_16x16x32_bf16 a[184:187], a[248:251], v[168:171], a[184:187]
    ds_read_b64_tr_b16 a[236:237], v213 offset:16384
    v_fma_f32 v100, v100, s45, v122
    v_mfma_f32_16x16x32_bf16 a[156:159], a[252:255], v[160:163], a[156:159]
    v_exp_f32 v97, v97
    v_mfma_f32_16x16x32_bf16 a[188:191], a[252:255], v[168:171], a[188:191]
    ds_read_b64_tr_b16 a[238:239], v213 offset:20480
    v_cvt_pk_bf16_f32 v96, v96, v97
    v_mfma_f32_16x16x32_bf16 v[176:179], v[224:227], v[160:163], v[176:179]
    v_exp_f32 v98, v98
    v_mfma_f32_16x16x32_bf16 v[180:183], v[224:227], v[168:171], v[180:183]
    ds_read_b64_tr_b16 a[240:241], v214 offset:16384
    v_exp_f32 v99, v99
    v_mfma_f32_16x16x32_bf16 v[160:163], a[192:195], v[128:131], 0
    v_exp_f32 v100, v100
    v_mfma_f32_16x16x32_bf16 v[160:163], a[196:199], v[136:139], v[160:163]
    ds_read_b64_tr_b16 a[242:243], v214 offset:20480
    v_cvt_pk_bf16_f32 v97, v98, v99
    v_mfma_f32_16x16x32_bf16 v[160:163], a[200:203], v[144:147], v[160:163]
    v_fma_f32 v101, v101, s45, v122
    v_fma_f32 v102, v102, s45, v122
    v_mfma_f32_16x16x32_bf16 v[160:163], a[204:207], v[152:155], v[160:163]
    ds_read_b64_tr_b16 a[244:245], v215 offset:16384
    v_fma_f32 v103, v103, s45, v122
    v_mfma_f32_16x16x32_bf16 v[164:167], a[208:211], v[128:131], 0
    v_exp_f32 v101, v101
    v_mfma_f32_16x16x32_bf16 v[164:167], a[212:215], v[136:139], v[164:167]
    ds_read_b64_tr_b16 a[246:247], v215 offset:20480
    v_cvt_pk_bf16_f32 v98, v100, v101
    v_mfma_f32_16x16x32_bf16 v[164:167], a[216:219], v[144:147], v[164:167]
    v_exp_f32 v102, v102
    v_fma_f32 v104, v104, s45, v123
    v_mfma_f32_16x16x32_bf16 v[164:167], a[220:223], v[152:155], v[164:167]
    ds_read_b64_tr_b16 a[248:249], v216 offset:16384
    v_fma_f32 v105, v105, s45, v123
    v_mfma_f32_16x16x32_bf16 v[168:171], a[192:195], v[132:135], 0
    ds_read_b128 a[192:195], v206
    v_fma_f32 v106, v106, s45, v123
    v_mfma_f32_16x16x32_bf16 v[168:171], a[196:199], v[140:143], v[168:171]
    ds_read_b64_tr_b16 a[250:251], v216 offset:20480
    v_fma_f32 v107, v107, s45, v123
    v_mfma_f32_16x16x32_bf16 v[168:171], a[200:203], v[148:151], v[168:171]
    ds_read_b128 a[196:199], v207
    v_fma_f32 v108, v108, s45, v123
    v_mfma_f32_16x16x32_bf16 v[168:171], a[204:207], v[156:159], v[168:171]
    ds_read_b64_tr_b16 a[252:253], v217 offset:16384
    v_fma_f32 v109, v109, s45, v123
    v_mfma_f32_16x16x32_bf16 v[172:175], a[208:211], v[132:135], 0
    ds_read_b128 a[200:203], v208
    v_exp_f32 v103, v103
    v_mfma_f32_16x16x32_bf16 v[172:175], a[212:215], v[140:143], v[172:175]
    ds_read_b64_tr_b16 a[254:255], v217 offset:20480
    v_cvt_pk_bf16_f32 v99, v102, v103
    v_mfma_f32_16x16x32_bf16 v[172:175], a[216:219], v[148:151], v[172:175]
    ds_read_b128 a[204:207], v209
    v_fma_f32 v110, v110, s45, v123
    v_mfma_f32_16x16x32_bf16 v[172:175], a[220:223], v[156:159], v[172:175]
    s_waitcnt lgkmcnt(7)
    v_exp_f32 v104, v104
    v_mfma_f32_16x16x32_bf16 a[0:3], a[224:227], v[32:35], a[0:3]
    v_exp_f32 v105, v105
    v_mfma_f32_16x16x32_bf16 a[32:35], a[224:227], v[40:43], a[32:35]
    ds_read_b128 a[208:211], v206 offset:4096
    v_cvt_pk_bf16_f32 v104, v104, v105
    v_mfma_f32_16x16x32_bf16 a[4:7], a[228:231], v[32:35], a[4:7]
    v_exp_f32 v106, v106
    v_mfma_f32_16x16x32_bf16 a[36:39], a[228:231], v[40:43], a[36:39]
    ds_read_b128 a[212:215], v207 offset:4096
    v_exp_f32 v107, v107
    v_mfma_f32_16x16x32_bf16 a[8:11], a[232:235], v[32:35], a[8:11]
    v_exp_f32 v108, v108
    v_mfma_f32_16x16x32_bf16 a[40:43], a[232:235], v[40:43], a[40:43]
    ds_read_b128 a[216:219], v208 offset:4096
    v_cvt_pk_bf16_f32 v105, v106, v107
    v_mfma_f32_16x16x32_bf16 a[12:15], a[236:239], v[32:35], a[12:15]
    v_exp_f32 v109, v109
    v_mfma_f32_16x16x32_bf16 a[44:47], a[236:239], v[40:43], a[44:47]
    ds_read_b128 a[220:223], v209 offset:4096
    v_cvt_pk_bf16_f32 v106, v108, v109
    v_mfma_f32_16x16x32_bf16 a[16:19], a[240:243], v[32:35], a[16:19]
    v_exp_f32 v110, v110
    v_mfma_f32_16x16x32_bf16 a[48:51], a[240:243], v[40:43], a[48:51]
    v_fma_f32 v111, v111, s45, v123
    v_fma_f32 v160, v160, s45, v186
    v_mfma_f32_16x16x32_bf16 a[20:23], a[244:247], v[32:35], a[20:23]
    v_exp_f32 v111, v111
    v_fma_f32 v161, v161, s45, v186
    v_mfma_f32_16x16x32_bf16 a[52:55], a[244:247], v[40:43], a[52:55]
    s_waitcnt lgkmcnt(2)
    v_exp_f32 v160, v160
    v_mfma_f32_16x16x32_bf16 a[24:27], a[248:251], v[32:35], a[24:27]
    v_exp_f32 v161, v161
    v_mfma_f32_16x16x32_bf16 a[56:59], a[248:251], v[40:43], a[56:59]
    v_cvt_pk_bf16_f32 v107, v110, v111
    v_cvt_pk_bf16_f32 v160, v160, v161
    v_mfma_f32_16x16x32_bf16 a[28:31], a[252:255], v[32:35], a[28:31]
    v_fma_f32 v162, v162, s45, v186
    v_fma_f32 v163, v163, s45, v186
    v_mfma_f32_16x16x32_bf16 a[60:63], a[252:255], v[40:43], a[60:63]
    v_exp_f32 v162, v162
    v_mfma_f32_16x16x32_bf16 v[48:51], v[224:227], v[32:35], v[48:51]
    v_exp_f32 v163, v163
    v_fma_f32 v164, v164, s45, v186
    v_mfma_f32_16x16x32_bf16 v[52:55], v[224:227], v[40:43], v[52:55]
    v_exp_f32 v164, v164
    v_mfma_f32_16x16x32_bf16 v[32:35], a[192:195], v[0:3], 0
    s_add_u32 s44, s62, 90112
    v_cvt_pk_bf16_f32 v161, v162, v163
    v_fma_f32 v165, v165, s45, v186
    v_mfma_f32_16x16x32_bf16 v[32:35], a[196:199], v[8:11], v[32:35]
    s_and_b32 s44, s44, 0x1ffff
    v_exp_f32 v165, v165
    v_mfma_f32_16x16x32_bf16 v[32:35], a[200:203], v[16:19], v[32:35]
    s_add_u32 s44, s44, s36
    v_cvt_pk_bf16_f32 v162, v164, v165
    v_fma_f32 v166, v166, s45, v186
    v_mfma_f32_16x16x32_bf16 v[32:35], a[204:207], v[24:27], v[32:35]
    s_add_u32 m0, s39, 131072
    v_exp_f32 v166, v166
    v_mfma_f32_16x16x32_bf16 v[36:39], a[208:211], v[0:3], 0
    buffer_load_dwordx4 v192, s[8:11], s44 offen nt lds
    v_mfma_f32_16x16x32_bf16 v[36:39], a[212:215], v[8:11], v[36:39]
    s_waitcnt lgkmcnt(0)
    v_fma_f32 v167, v167, s45, v186
    v_exp_f32 v167, v167
    v_mfma_f32_16x16x32_bf16 v[36:39], a[216:219], v[16:19], v[36:39]
    buffer_load_dwordx4 v193, s[8:11], s44 offen offset:1024 nt lds
    v_mfma_f32_16x16x32_bf16 v[36:39], a[220:223], v[24:27], v[36:39]
    v_cvt_pk_bf16_f32 v163, v166, v167
    v_fma_f32 v168, v168, s45, v187
    v_mfma_f32_16x16x32_bf16 v[40:43], a[192:195], v[4:7], 0
    buffer_load_dwordx4 v194, s[8:11], s44 offen offset:2048 nt lds
    v_mfma_f32_16x16x32_bf16 v[40:43], a[196:199], v[12:15], v[40:43]
    v_exp_f32 v168, v168
    v_mfma_f32_16x16x32_bf16 v[40:43], a[200:203], v[20:23], v[40:43]
    buffer_load_dwordx4 v195, s[8:11], s44 offen offset:3072 nt lds
    v_mfma_f32_16x16x32_bf16 v[40:43], a[204:207], v[28:31], v[40:43]
    v_fma_f32 v169, v169, s45, v187
    v_fma_f32 v170, v170, s45, v187
    v_mfma_f32_16x16x32_bf16 v[44:47], a[208:211], v[4:7], 0
    v_exp_f32 v169, v169
    v_fma_f32 v171, v171, s45, v187
    v_mfma_f32_16x16x32_bf16 v[44:47], a[212:215], v[12:15], v[44:47]
    v_exp_f32 v170, v170
    v_mfma_f32_16x16x32_bf16 v[44:47], a[216:219], v[20:23], v[44:47]
    v_exp_f32 v171, v171
    v_mfma_f32_16x16x32_bf16 v[44:47], a[220:223], v[28:31], v[44:47]
    v_cvt_pk_bf16_f32 v168, v168, v169
    v_cvt_pk_bf16_f32 v169, v170, v171
    v_mfma_f32_16x16x32_bf16 a[64:67], a[224:227], v[96:99], a[64:67]
    v_fma_f32 v172, v172, s45, v187
    v_fma_f32 v173, v173, s45, v187
    v_mfma_f32_16x16x32_bf16 a[96:99], a[224:227], v[104:107], a[96:99]
    v_exp_f32 v172, v172
    v_mfma_f32_16x16x32_bf16 a[68:71], a[228:231], v[96:99], a[68:71]
    v_exp_f32 v173, v173
    v_fma_f32 v174, v174, s45, v187
    v_mfma_f32_16x16x32_bf16 a[100:103], a[228:231], v[104:107], a[100:103]
    v_exp_f32 v174, v174
    v_mfma_f32_16x16x32_bf16 a[72:75], a[232:235], v[96:99], a[72:75]
    v_cvt_pk_bf16_f32 v170, v172, v173
    v_fma_f32 v175, v175, s45, v187
    v_mfma_f32_16x16x32_bf16 a[104:107], a[232:235], v[104:107], a[104:107]
    v_exp_f32 v175, v175
    v_mfma_f32_16x16x32_bf16 a[76:79], a[236:239], v[96:99], a[76:79]
    v_cvt_pk_bf16_f32 v171, v174, v175
    v_fma_f32 v32, v32, s45, v58
    v_mfma_f32_16x16x32_bf16 a[108:111], a[236:239], v[104:107], a[108:111]
    v_exp_f32 v32, v32
    v_mfma_f32_16x16x32_bf16 a[80:83], a[240:243], v[96:99], a[80:83]
    v_fma_f32 v33, v33, s45, v58
    v_fma_f32 v34, v34, s45, v58
    v_mfma_f32_16x16x32_bf16 a[112:115], a[240:243], v[104:107], a[112:115]
    v_exp_f32 v33, v33
    v_fma_f32 v35, v35, s45, v58
    v_mfma_f32_16x16x32_bf16 a[84:87], a[244:247], v[96:99], a[84:87]
    v_exp_f32 v34, v34
    v_mfma_f32_16x16x32_bf16 a[116:119], a[244:247], v[104:107], a[116:119]
    v_exp_f32 v35, v35
    v_mfma_f32_16x16x32_bf16 a[88:91], a[248:251], v[96:99], a[88:91]
    v_cvt_pk_bf16_f32 v32, v32, v33
    v_cvt_pk_bf16_f32 v33, v34, v35
    v_mfma_f32_16x16x32_bf16 a[120:123], a[248:251], v[104:107], a[120:123]
    v_fma_f32 v36, v36, s45, v58
    v_fma_f32 v37, v37, s45, v58
    v_mfma_f32_16x16x32_bf16 a[92:95], a[252:255], v[96:99], a[92:95]
    v_exp_f32 v36, v36
    v_mfma_f32_16x16x32_bf16 a[124:127], a[252:255], v[104:107], a[124:127]
    v_exp_f32 v37, v37
    v_mfma_f32_16x16x32_bf16 v[112:115], v[224:227], v[96:99], v[112:115]
    v_cvt_pk_bf16_f32 v34, v36, v37
    v_fma_f32 v38, v38, s45, v58
    v_fma_f32 v39, v39, s45, v58
    v_mfma_f32_16x16x32_bf16 v[116:119], v[224:227], v[104:107], v[116:119]
    v_exp_f32 v38, v38
    v_mfma_f32_16x16x32_bf16 v[96:99], a[192:195], v[64:67], 0
    v_exp_f32 v39, v39
    v_mfma_f32_16x16x32_bf16 v[96:99], a[196:199], v[72:75], v[96:99]
    v_cvt_pk_bf16_f32 v35, v38, v39
    v_fma_f32 v40, v40, s45, v59
    v_mfma_f32_16x16x32_bf16 v[96:99], a[200:203], v[80:83], v[96:99]
    v_exp_f32 v40, v40
    v_mfma_f32_16x16x32_bf16 v[96:99], a[204:207], v[88:91], v[96:99]
    v_fma_f32 v41, v41, s45, v59
    v_fma_f32 v42, v42, s45, v59
    v_mfma_f32_16x16x32_bf16 v[100:103], a[208:211], v[64:67], 0
    v_exp_f32 v41, v41
    v_fma_f32 v43, v43, s45, v59
    v_mfma_f32_16x16x32_bf16 v[100:103], a[212:215], v[72:75], v[100:103]
    v_exp_f32 v42, v42
    v_mfma_f32_16x16x32_bf16 v[100:103], a[216:219], v[80:83], v[100:103]
    v_exp_f32 v43, v43
    v_mfma_f32_16x16x32_bf16 v[100:103], a[220:223], v[88:91], v[100:103]
    v_cvt_pk_bf16_f32 v40, v40, v41
    v_cvt_pk_bf16_f32 v41, v42, v43
    v_mfma_f32_16x16x32_bf16 v[104:107], a[192:195], v[68:71], 0
    v_fma_f32 v44, v44, s45, v59
    v_fma_f32 v45, v45, s45, v59
    v_mfma_f32_16x16x32_bf16 v[104:107], a[196:199], v[76:79], v[104:107]
    v_exp_f32 v44, v44
    v_mfma_f32_16x16x32_bf16 v[104:107], a[200:203], v[84:87], v[104:107]
    v_exp_f32 v45, v45
    v_mfma_f32_16x16x32_bf16 v[104:107], a[204:207], v[92:95], v[104:107]
    v_cvt_pk_bf16_f32 v42, v44, v45
    v_fma_f32 v46, v46, s45, v59
    v_fma_f32 v47, v47, s45, v59
    v_mfma_f32_16x16x32_bf16 v[108:111], a[208:211], v[68:71], 0
    v_exp_f32 v46, v46
    v_mfma_f32_16x16x32_bf16 v[108:111], a[212:215], v[76:79], v[108:111]
    v_exp_f32 v47, v47
    v_mfma_f32_16x16x32_bf16 v[108:111], a[216:219], v[84:87], v[108:111]
    v_cvt_pk_bf16_f32 v43, v46, v47
    v_fma_f32 v96, v96, s45, v122
    v_mfma_f32_16x16x32_bf16 v[108:111], a[220:223], v[92:95], v[108:111]
    s_waitcnt vmcnt(8)
    s_barrier
    v_mfma_f32_16x16x32_bf16 a[128:131], a[224:227], v[160:163], a[128:131]
    v_exp_f32 v96, v96
    v_mfma_f32_16x16x32_bf16 a[160:163], a[224:227], v[168:171], a[160:163]
    ds_read_b64_tr_b16 a[224:225], v210
    v_fma_f32 v97, v97, s45, v122
    v_mfma_f32_16x16x32_bf16 a[132:135], a[228:231], v[160:163], a[132:135]
    v_exp_f32 v97, v97
    v_fma_f32 v98, v98, s45, v122
    v_mfma_f32_16x16x32_bf16 a[164:167], a[228:231], v[168:171], a[164:167]
    ds_read_b64_tr_b16 a[226:227], v210 offset:4096
    v_cvt_pk_bf16_f32 v96, v96, v97
    v_mfma_f32_16x16x32_bf16 a[136:139], a[232:235], v[160:163], a[136:139]
    s_add_u32 s43, s62, 90112
    v_exp_f32 v98, v98
    v_mfma_f32_16x16x32_bf16 a[168:171], a[232:235], v[168:171], a[168:171]
    s_and_b32 s43, s43, 0x1ffff
    ds_read_b64_tr_b16 a[228:229], v211
    v_fma_f32 v99, v99, s45, v122
    v_mfma_f32_16x16x32_bf16 a[140:143], a[236:239], v[160:163], a[140:143]
    s_add_u32 s43, s43, s36
    v_exp_f32 v99, v99
    v_mfma_f32_16x16x32_bf16 a[172:175], a[236:239], v[168:171], a[172:175]
    s_add_u32 m0, s39, 81920
    ds_read_b64_tr_b16 a[230:231], v211 offset:4096
    v_cvt_pk_bf16_f32 v97, v98, v99
    v_mfma_f32_16x16x32_bf16 a[144:147], a[240:243], v[160:163], a[144:147]
    buffer_load_dwordx4 v196, s[12:15], s43 offen nt lds
    v_mfma_f32_16x16x32_bf16 a[176:179], a[240:243], v[168:171], a[176:179]
    ds_read_b64_tr_b16 a[232:233], v212
    v_fma_f32 v100, v100, s45, v122
    v_mfma_f32_16x16x32_bf16 a[148:151], a[244:247], v[160:163], a[148:151]
    buffer_load_dwordx4 v197, s[12:15], s43 offen offset:1024 nt lds
    v_mfma_f32_16x16x32_bf16 a[180:183], a[244:247], v[168:171], a[180:183]
    ds_read_b64_tr_b16 a[234:235], v212 offset:4096
    v_fma_f32 v101, v101, s45, v122
    v_mfma_f32_16x16x32_bf16 a[152:155], a[248:251], v[160:163], a[152:155]
    buffer_load_dwordx4 v196, s[12:15], s43 offen offset:2048 nt lds
    v_mfma_f32_16x16x32_bf16 a[184:187], a[248:251], v[168:171], a[184:187]
    ds_read_b64_tr_b16 a[236:237], v213
    v_fma_f32 v102, v102, s45, v122
    v_mfma_f32_16x16x32_bf16 a[156:159], a[252:255], v[160:163], a[156:159]
    buffer_load_dwordx4 v197, s[12:15], s43 offen offset:3072 nt lds
    v_mfma_f32_16x16x32_bf16 a[188:191], a[252:255], v[168:171], a[188:191]
    ds_read_b64_tr_b16 a[238:239], v213 offset:4096
    v_exp_f32 v100, v100
    v_mfma_f32_16x16x32_bf16 v[176:179], v[224:227], v[160:163], v[176:179]
    v_exp_f32 v101, v101
    v_mfma_f32_16x16x32_bf16 v[180:183], v[224:227], v[168:171], v[180:183]
    ds_read_b64_tr_b16 a[240:241], v214
    v_cvt_pk_bf16_f32 v98, v100, v101
    v_mfma_f32_16x16x32_bf16 v[160:163], a[192:195], v[128:131], 0
    v_exp_f32 v102, v102
    v_mfma_f32_16x16x32_bf16 v[160:163], a[196:199], v[136:139], v[160:163]
    ds_read_b64_tr_b16 a[242:243], v214 offset:4096
    v_fma_f32 v103, v103, s45, v122
    v_mfma_f32_16x16x32_bf16 v[160:163], a[200:203], v[144:147], v[160:163]
    v_exp_f32 v103, v103
    v_mfma_f32_16x16x32_bf16 v[160:163], a[204:207], v[152:155], v[160:163]
    ds_read_b64_tr_b16 a[244:245], v215
    v_cvt_pk_bf16_f32 v99, v102, v103
    v_mfma_f32_16x16x32_bf16 v[164:167], a[208:211], v[128:131], 0
    v_fma_f32 v104, v104, s45, v123
    v_exp_f32 v104, v104
    v_mfma_f32_16x16x32_bf16 v[164:167], a[212:215], v[136:139], v[164:167]
    ds_read_b64_tr_b16 a[246:247], v215 offset:4096
    v_fma_f32 v105, v105, s45, v123
    v_mfma_f32_16x16x32_bf16 v[164:167], a[216:219], v[144:147], v[164:167]
    v_exp_f32 v105, v105
    v_mfma_f32_16x16x32_bf16 v[164:167], a[220:223], v[152:155], v[164:167]
    ds_read_b64_tr_b16 a[248:249], v216
    v_cvt_pk_bf16_f32 v104, v104, v105
    v_mfma_f32_16x16x32_bf16 v[168:171], a[192:195], v[132:135], 0
    ds_read_b128 a[192:195], v206 offset:16384
    v_fma_f32 v106, v106, s45, v123
    v_mfma_f32_16x16x32_bf16 v[168:171], a[196:199], v[140:143], v[168:171]
    ds_read_b64_tr_b16 a[250:251], v216 offset:4096
    v_fma_f32 v107, v107, s45, v123
    v_mfma_f32_16x16x32_bf16 v[168:171], a[200:203], v[148:151], v[168:171]
    ds_read_b128 a[196:199], v207 offset:16384
    v_exp_f32 v106, v106
    v_mfma_f32_16x16x32_bf16 v[168:171], a[204:207], v[156:159], v[168:171]
    ds_read_b64_tr_b16 a[252:253], v217
    v_fma_f32 v108, v108, s45, v123
    v_mfma_f32_16x16x32_bf16 v[172:175], a[208:211], v[132:135], 0
    ds_read_b128 a[200:203], v208 offset:16384
    v_fma_f32 v109, v109, s45, v123
    v_mfma_f32_16x16x32_bf16 v[172:175], a[212:215], v[140:143], v[172:175]
    ds_read_b64_tr_b16 a[254:255], v217 offset:4096
    v_fma_f32 v110, v110, s45, v123
    v_mfma_f32_16x16x32_bf16 v[172:175], a[216:219], v[148:151], v[172:175]
    ds_read_b128 a[204:207], v209 offset:16384
    v_fma_f32 v111, v111, s45, v123
    v_mfma_f32_16x16x32_bf16 v[172:175], a[220:223], v[156:159], v[172:175]
    s_waitcnt lgkmcnt(7)
    v_exp_f32 v107, v107
    v_mfma_f32_16x16x32_bf16 a[0:3], a[224:227], v[32:35], a[0:3]
    v_exp_f32 v108, v108
    v_mfma_f32_16x16x32_bf16 a[32:35], a[224:227], v[40:43], a[32:35]
    ds_read_b128 a[208:211], v206 offset:20480
    v_exp_f32 v109, v109
    v_mfma_f32_16x16x32_bf16 a[4:7], a[228:231], v[32:35], a[4:7]
    v_exp_f32 v110, v110
    v_mfma_f32_16x16x32_bf16 a[36:39], a[228:231], v[40:43], a[36:39]
    ds_read_b128 a[212:215], v207 offset:20480
    v_cvt_pk_bf16_f32 v105, v106, v107
    v_mfma_f32_16x16x32_bf16 a[8:11], a[232:235], v[32:35], a[8:11]
    v_exp_f32 v111, v111
    v_mfma_f32_16x16x32_bf16 a[40:43], a[232:235], v[40:43], a[40:43]
    ds_read_b128 a[216:219], v208 offset:20480
    v_cvt_pk_bf16_f32 v106, v108, v109
    v_mfma_f32_16x16x32_bf16 a[12:15], a[236:239], v[32:35], a[12:15]
    v_cvt_pk_bf16_f32 v107, v110, v111
    v_fma_f32 v160, v160, s45, v186
    v_mfma_f32_16x16x32_bf16 a[44:47], a[236:239], v[40:43], a[44:47]
    ds_read_b128 a[220:223], v209 offset:20480
    v_fma_f32 v161, v161, s45, v186
    v_mfma_f32_16x16x32_bf16 a[16:19], a[240:243], v[32:35], a[16:19]
    v_exp_f32 v160, v160
    v_fma_f32 v162, v162, s45, v186
    v_mfma_f32_16x16x32_bf16 a[48:51], a[240:243], v[40:43], a[48:51]
    v_exp_f32 v161, v161
    v_mfma_f32_16x16x32_bf16 a[20:23], a[244:247], v[32:35], a[20:23]
    v_exp_f32 v162, v162
    v_mfma_f32_16x16x32_bf16 a[52:55], a[244:247], v[40:43], a[52:55]
    s_waitcnt lgkmcnt(2)
    v_cvt_pk_bf16_f32 v160, v160, v161
    v_fma_f32 v163, v163, s45, v186
    v_mfma_f32_16x16x32_bf16 a[24:27], a[248:251], v[32:35], a[24:27]
    v_exp_f32 v163, v163
    v_mfma_f32_16x16x32_bf16 a[56:59], a[248:251], v[40:43], a[56:59]
    v_cvt_pk_bf16_f32 v161, v162, v163
    v_fma_f32 v164, v164, s45, v186
    v_mfma_f32_16x16x32_bf16 a[28:31], a[252:255], v[32:35], a[28:31]
    v_exp_f32 v164, v164
    v_fma_f32 v165, v165, s45, v186
    v_mfma_f32_16x16x32_bf16 a[60:63], a[252:255], v[40:43], a[60:63]
    v_exp_f32 v165, v165
    v_mfma_f32_16x16x32_bf16 v[48:51], v[224:227], v[32:35], v[48:51]
    v_cvt_pk_bf16_f32 v162, v164, v165
    v_fma_f32 v166, v166, s45, v186
    v_mfma_f32_16x16x32_bf16 v[52:55], v[224:227], v[40:43], v[52:55]
    v_exp_f32 v166, v166
    v_mfma_f32_16x16x32_bf16 v[32:35], a[192:195], v[0:3], 0
    v_fma_f32 v167, v167, s45, v186
    v_fma_f32 v168, v168, s45, v187
    v_mfma_f32_16x16x32_bf16 v[32:35], a[196:199], v[8:11], v[32:35]
    v_exp_f32 v167, v167
    v_mfma_f32_16x16x32_bf16 v[32:35], a[200:203], v[16:19], v[32:35]
    v_exp_f32 v168, v168
    v_mfma_f32_16x16x32_bf16 v[32:35], a[204:207], v[24:27], v[32:35]
    v_cvt_pk_bf16_f32 v163, v166, v167
    v_fma_f32 v169, v169, s45, v187
    v_fma_f32 v170, v170, s45, v187
    v_mfma_f32_16x16x32_bf16 v[36:39], a[208:211], v[0:3], 0
    v_exp_f32 v169, v169
    v_mfma_f32_16x16x32_bf16 v[36:39], a[212:215], v[8:11], v[36:39]
    s_waitcnt lgkmcnt(0)
    v_exp_f32 v170, v170
    v_mfma_f32_16x16x32_bf16 v[36:39], a[216:219], v[16:19], v[36:39]
    s_add_u32 s44, s62, 98304
    v_cvt_pk_bf16_f32 v168, v168, v169
    v_fma_f32 v171, v171, s45, v187
    v_mfma_f32_16x16x32_bf16 v[36:39], a[220:223], v[24:27], v[36:39]
    s_and_b32 s44, s44, 0x1ffff
    v_exp_f32 v171, v171
    v_mfma_f32_16x16x32_bf16 v[40:43], a[192:195], v[4:7], 0
    s_add_u32 s44, s44, s36
    v_cvt_pk_bf16_f32 v169, v170, v171
    v_fma_f32 v172, v172, s45, v187
    v_mfma_f32_16x16x32_bf16 v[40:43], a[196:199], v[12:15], v[40:43]
    s_add_u32 m0, s39, 114688
    v_add_u32 v206, 0x18000, v206
    v_add_u32 v207, 0x18000, v207
    v_mfma_f32_16x16x32_bf16 v[40:43], a[200:203], v[20:23], v[40:43]
    buffer_load_dwordx4 v192, s[8:11], s44 offen nt lds
    v_mfma_f32_16x16x32_bf16 v[40:43], a[204:207], v[28:31], v[40:43]
    v_exp_f32 v172, v172
    v_mfma_f32_16x16x32_bf16 v[44:47], a[208:211], v[4:7], 0
    v_add_u32 v208, 0x18000, v208
    v_add_u32 v209, 0x18000, v209
    v_mfma_f32_16x16x32_bf16 v[44:47], a[212:215], v[12:15], v[44:47]
    buffer_load_dwordx4 v193, s[8:11], s44 offen offset:1024 nt lds
    v_mfma_f32_16x16x32_bf16 v[44:47], a[216:219], v[20:23], v[44:47]
    buffer_load_dwordx4 v194, s[8:11], s44 offen offset:2048 nt lds
    v_mfma_f32_16x16x32_bf16 v[44:47], a[220:223], v[28:31], v[44:47]
    v_fma_f32 v173, v173, s45, v187
    v_fma_f32 v174, v174, s45, v187
    v_mfma_f32_16x16x32_bf16 a[64:67], a[224:227], v[96:99], a[64:67]
    buffer_load_dwordx4 v195, s[8:11], s44 offen offset:3072 nt lds
    v_mfma_f32_16x16x32_bf16 a[96:99], a[224:227], v[104:107], a[96:99]
    v_exp_f32 v173, v173
    v_mfma_f32_16x16x32_bf16 a[68:71], a[228:231], v[96:99], a[68:71]
    v_exp_f32 v174, v174
    v_mfma_f32_16x16x32_bf16 a[100:103], a[228:231], v[104:107], a[100:103]
    v_cvt_pk_bf16_f32 v170, v172, v173
    v_fma_f32 v175, v175, s45, v187
    v_mfma_f32_16x16x32_bf16 a[72:75], a[232:235], v[96:99], a[72:75]
    v_exp_f32 v175, v175
    v_mfma_f32_16x16x32_bf16 a[104:107], a[232:235], v[104:107], a[104:107]
    v_cvt_pk_bf16_f32 v171, v174, v175
    v_fma_f32 v32, v32, s45, v58
    v_mfma_f32_16x16x32_bf16 a[76:79], a[236:239], v[96:99], a[76:79]
    v_exp_f32 v32, v32
    v_mfma_f32_16x16x32_bf16 a[108:111], a[236:239], v[104:107], a[108:111]
    v_fma_f32 v33, v33, s45, v58
    v_exp_f32 v33, v33
    v_mfma_f32_16x16x32_bf16 a[80:83], a[240:243], v[96:99], a[80:83]
    v_cvt_pk_bf16_f32 v32, v32, v33
    v_fma_f32 v34, v34, s45, v58
    v_mfma_f32_16x16x32_bf16 a[112:115], a[240:243], v[104:107], a[112:115]
    v_exp_f32 v34, v34
    v_mfma_f32_16x16x32_bf16 a[84:87], a[244:247], v[96:99], a[84:87]
    v_fma_f32 v35, v35, s45, v58
    v_fma_f32 v36, v36, s45, v58
    v_mfma_f32_16x16x32_bf16 a[116:119], a[244:247], v[104:107], a[116:119]
    v_exp_f32 v35, v35
    v_mfma_f32_16x16x32_bf16 a[88:91], a[248:251], v[96:99], a[88:91]
    v_exp_f32 v36, v36
    v_mfma_f32_16x16x32_bf16 a[120:123], a[248:251], v[104:107], a[120:123]
    v_cvt_pk_bf16_f32 v33, v34, v35
    v_fma_f32 v37, v37, s45, v58
    v_mfma_f32_16x16x32_bf16 a[92:95], a[252:255], v[96:99], a[92:95]
    v_exp_f32 v37, v37
    v_fma_f32 v38, v38, s45, v58
    v_mfma_f32_16x16x32_bf16 a[124:127], a[252:255], v[104:107], a[124:127]
    v_exp_f32 v38, v38
    v_mfma_f32_16x16x32_bf16 v[112:115], v[224:227], v[96:99], v[112:115]
    v_cvt_pk_bf16_f32 v34, v36, v37
    v_fma_f32 v39, v39, s45, v58
    v_mfma_f32_16x16x32_bf16 v[116:119], v[224:227], v[104:107], v[116:119]
    v_exp_f32 v39, v39
    v_mfma_f32_16x16x32_bf16 v[96:99], a[192:195], v[64:67], 0
    v_cvt_pk_bf16_f32 v35, v38, v39
    v_fma_f32 v40, v40, s45, v59
    v_mfma_f32_16x16x32_bf16 v[96:99], a[196:199], v[72:75], v[96:99]
    v_exp_f32 v40, v40
    v_mfma_f32_16x16x32_bf16 v[96:99], a[200:203], v[80:83], v[96:99]
    v_add_u32 v210, 0xffff0000, v210
    v_add_u32 v211, 0xffff0000, v211
    v_mfma_f32_16x16x32_bf16 v[96:99], a[204:207], v[88:91], v[96:99]
    v_fma_f32 v41, v41, s45, v59
    v_fma_f32 v42, v42, s45, v59
    v_mfma_f32_16x16x32_bf16 v[100:103], a[208:211], v[64:67], 0
    v_exp_f32 v41, v41
    v_mfma_f32_16x16x32_bf16 v[100:103], a[212:215], v[72:75], v[100:103]
    v_add_u32 v212, 0xffff0000, v212
    v_add_u32 v213, 0xffff0000, v213
    v_mfma_f32_16x16x32_bf16 v[100:103], a[216:219], v[80:83], v[100:103]
    v_exp_f32 v42, v42
    v_mfma_f32_16x16x32_bf16 v[100:103], a[220:223], v[88:91], v[100:103]
    v_cvt_pk_bf16_f32 v40, v40, v41
    v_fma_f32 v43, v43, s45, v59
    v_mfma_f32_16x16x32_bf16 v[104:107], a[192:195], v[68:71], 0
    v_add_u32 v214, 0xffff0000, v214
    v_add_u32 v215, 0xffff0000, v215
    v_mfma_f32_16x16x32_bf16 v[104:107], a[196:199], v[76:79], v[104:107]
    v_exp_f32 v43, v43
    v_fma_f32 v44, v44, s45, v59
    v_mfma_f32_16x16x32_bf16 v[104:107], a[200:203], v[84:87], v[104:107]
    v_exp_f32 v44, v44
    v_mfma_f32_16x16x32_bf16 v[104:107], a[204:207], v[92:95], v[104:107]
    v_add_u32 v216, 0xffff0000, v216
    v_add_u32 v217, 0xffff0000, v217
    v_mfma_f32_16x16x32_bf16 v[108:111], a[208:211], v[68:71], 0
    v_cvt_pk_bf16_f32 v41, v42, v43
    v_fma_f32 v45, v45, s45, v59
    v_mfma_f32_16x16x32_bf16 v[108:111], a[212:215], v[76:79], v[108:111]
    v_exp_f32 v45, v45
    v_mfma_f32_16x16x32_bf16 v[108:111], a[216:219], v[84:87], v[108:111]
    v_cvt_pk_bf16_f32 v42, v44, v45
    v_fma_f32 v46, v46, s45, v59
    v_mfma_f32_16x16x32_bf16 v[108:111], a[220:223], v[92:95], v[108:111]
    s_waitcnt vmcnt(8)
    s_barrier
    v_mfma_f32_16x16x32_bf16 a[128:131], a[224:227], v[160:163], a[128:131]
    v_exp_f32 v46, v46
    v_fma_f32 v47, v47, s45, v59
    v_mfma_f32_16x16x32_bf16 a[160:163], a[224:227], v[168:171], a[160:163]
    ds_read_b64_tr_b16 a[224:225], v210
    v_fma_f32 v96, v96, s45, v122
    v_mfma_f32_16x16x32_bf16 a[132:135], a[228:231], v[160:163], a[132:135]
    v_exp_f32 v47, v47
    v_mfma_f32_16x16x32_bf16 a[164:167], a[228:231], v[168:171], a[164:167]
    ds_read_b64_tr_b16 a[226:227], v210 offset:4096
    v_cvt_pk_bf16_f32 v43, v46, v47
    v_mfma_f32_16x16x32_bf16 a[136:139], a[232:235], v[160:163], a[136:139]
    v_exp_f32 v96, v96
    v_mfma_f32_16x16x32_bf16 a[168:171], a[232:235], v[168:171], a[168:171]
    ds_read_b64_tr_b16 a[228:229], v211
    v_fma_f32 v97, v97, s45, v122
    v_mfma_f32_16x16x32_bf16 a[140:143], a[236:239], v[160:163], a[140:143]
    v_exp_f32 v97, v97
    v_fma_f32 v98, v98, s45, v122
    v_mfma_f32_16x16x32_bf16 a[172:175], a[236:239], v[168:171], a[172:175]
    ds_read_b64_tr_b16 a[230:231], v211 offset:4096
    v_cvt_pk_bf16_f32 v96, v96, v97
    v_mfma_f32_16x16x32_bf16 a[144:147], a[240:243], v[160:163], a[144:147]
    v_exp_f32 v98, v98
    v_mfma_f32_16x16x32_bf16 a[176:179], a[240:243], v[168:171], a[176:179]
    ds_read_b64_tr_b16 a[232:233], v212
    v_fma_f32 v99, v99, s45, v122
    v_mfma_f32_16x16x32_bf16 a[148:151], a[244:247], v[160:163], a[148:151]
    v_exp_f32 v99, v99
    v_mfma_f32_16x16x32_bf16 a[180:183], a[244:247], v[168:171], a[180:183]
    ds_read_b64_tr_b16 a[234:235], v212 offset:4096
    v_cvt_pk_bf16_f32 v97, v98, v99
    v_mfma_f32_16x16x32_bf16 a[152:155], a[248:251], v[160:163], a[152:155]
    s_add_u32 s43, s62, 98304
    v_fma_f32 v100, v100, s45, v122
    v_fma_f32 v101, v101, s45, v122
    v_mfma_f32_16x16x32_bf16 a[184:187], a[248:251], v[168:171], a[184:187]
    s_and_b32 s43, s43, 0x1ffff
    ds_read_b64_tr_b16 a[236:237], v213
    v_exp_f32 v100, v100
    v_mfma_f32_16x16x32_bf16 a[156:159], a[252:255], v[160:163], a[156:159]
    s_add_u32 s43, s43, s36
    v_exp_f32 v101, v101
    v_mfma_f32_16x16x32_bf16 a[188:191], a[252:255], v[168:171], a[188:191]
    s_add_u32 m0, s39, 49152
    ds_read_b64_tr_b16 a[238:239], v213 offset:4096
    v_cvt_pk_bf16_f32 v98, v100, v101
    v_mfma_f32_16x16x32_bf16 v[176:179], v[224:227], v[160:163], v[176:179]
    buffer_load_dwordx4 v196, s[12:15], s43 offen nt lds
    v_mfma_f32_16x16x32_bf16 v[180:183], v[224:227], v[168:171], v[180:183]
    ds_read_b64_tr_b16 a[240:241], v214
    v_fma_f32 v102, v102, s45, v122
    v_mfma_f32_16x16x32_bf16 v[160:163], a[192:195], v[128:131], 0
    buffer_load_dwordx4 v197, s[12:15], s43 offen offset:1024 nt lds
    v_mfma_f32_16x16x32_bf16 v[160:163], a[196:199], v[136:139], v[160:163]
    ds_read_b64_tr_b16 a[242:243], v214 offset:4096
    v_fma_f32 v103, v103, s45, v122
    v_mfma_f32_16x16x32_bf16 v[160:163], a[200:203], v[144:147], v[160:163]
    buffer_load_dwordx4 v196, s[12:15], s43 offen offset:2048 nt lds
    v_mfma_f32_16x16x32_bf16 v[160:163], a[204:207], v[152:155], v[160:163]
    ds_read_b64_tr_b16 a[244:245], v215
    v_fma_f32 v104, v104, s45, v123
    v_mfma_f32_16x16x32_bf16 v[164:167], a[208:211], v[128:131], 0
    buffer_load_dwordx4 v197, s[12:15], s43 offen offset:3072 nt lds
    v_mfma_f32_16x16x32_bf16 v[164:167], a[212:215], v[136:139], v[164:167]
    ds_read_b64_tr_b16 a[246:247], v215 offset:4096
    v_fma_f32 v105, v105, s45, v123
    v_mfma_f32_16x16x32_bf16 v[164:167], a[216:219], v[144:147], v[164:167]
    v_exp_f32 v102, v102
    v_mfma_f32_16x16x32_bf16 v[164:167], a[220:223], v[152:155], v[164:167]
    ds_read_b64_tr_b16 a[248:249], v216
    v_fma_f32 v106, v106, s45, v123
    v_mfma_f32_16x16x32_bf16 v[168:171], a[192:195], v[132:135], 0
    ds_read_b128 a[192:195], v206 offset:32768
    v_exp_f32 v103, v103
    v_mfma_f32_16x16x32_bf16 v[168:171], a[196:199], v[140:143], v[168:171]
    ds_read_b64_tr_b16 a[250:251], v216 offset:4096
    v_cvt_pk_bf16_f32 v99, v102, v103
    v_mfma_f32_16x16x32_bf16 v[168:171], a[200:203], v[148:151], v[168:171]
    ds_read_b128 a[196:199], v207 offset:32768
    v_fma_f32 v107, v107, s45, v123
    v_mfma_f32_16x16x32_bf16 v[168:171], a[204:207], v[156:159], v[168:171]
    ds_read_b64_tr_b16 a[252:253], v217
    v_fma_f32 v108, v108, s45, v123
    v_mfma_f32_16x16x32_bf16 v[172:175], a[208:211], v[132:135], 0
    ds_read_b128 a[200:203], v208 offset:32768
    v_fma_f32 v109, v109, s45, v123
    v_mfma_f32_16x16x32_bf16 v[172:175], a[212:215], v[140:143], v[172:175]
    ds_read_b64_tr_b16 a[254:255], v217 offset:4096
    v_fma_f32 v110, v110, s45, v123
    v_mfma_f32_16x16x32_bf16 v[172:175], a[216:219], v[148:151], v[172:175]
    ds_read_b128 a[204:207], v209 offset:32768
    v_fma_f32 v111, v111, s45, v123
    v_mfma_f32_16x16x32_bf16 v[172:175], a[220:223], v[156:159], v[172:175]
    s_waitcnt lgkmcnt(7)
    v_exp_f32 v104, v104
    v_fma_f32 v160, v160, s45, v186
    v_mfma_f32_16x16x32_bf16 a[0:3], a[224:227], v[32:35], a[0:3]
    v_exp_f32 v105, v105
    v_mfma_f32_16x16x32_bf16 a[32:35], a[224:227], v[40:43], a[32:35]
    ds_read_b128 a[208:211], v206 offset:36864
    v_cvt_pk_bf16_f32 v104, v104, v105
    v_mfma_f32_16x16x32_bf16 a[4:7], a[228:231], v[32:35], a[4:7]
    v_exp_f32 v106, v106
    v_mfma_f32_16x16x32_bf16 a[36:39], a[228:231], v[40:43], a[36:39]
    ds_read_b128 a[212:215], v207 offset:36864
    v_fma_f32 v161, v161, s45, v186
    v_mfma_f32_16x16x32_bf16 a[8:11], a[232:235], v[32:35], a[8:11]
    v_exp_f32 v107, v107
    v_mfma_f32_16x16x32_bf16 a[40:43], a[232:235], v[40:43], a[40:43]
    ds_read_b128 a[216:219], v208 offset:36864
    v_cvt_pk_bf16_f32 v105, v106, v107
    v_mfma_f32_16x16x32_bf16 a[12:15], a[236:239], v[32:35], a[12:15]
    v_exp_f32 v108, v108
    v_fma_f32 v162, v162, s45, v186
    v_mfma_f32_16x16x32_bf16 a[44:47], a[236:239], v[40:43], a[44:47]
    ds_read_b128 a[220:223], v209 offset:36864
    v_fma_f32 v163, v163, s45, v186
    v_mfma_f32_16x16x32_bf16 a[16:19], a[240:243], v[32:35], a[16:19]
    v_exp_f32 v109, v109
    v_mfma_f32_16x16x32_bf16 a[48:51], a[240:243], v[40:43], a[48:51]
    v_exp_f32 v110, v110
    v_mfma_f32_16x16x32_bf16 a[20:23], a[244:247], v[32:35], a[20:23]
    v_exp_f32 v111, v111
    v_mfma_f32_16x16x32_bf16 a[52:55], a[244:247], v[40:43], a[52:55]
    s_waitcnt lgkmcnt(2)
    v_exp_f32 v160, v160
    v_mfma_f32_16x16x32_bf16 a[24:27], a[248:251], v[32:35], a[24:27]
    v_exp_f32 v161, v161
    v_cvt_pk_bf16_f32 v106, v108, v109
    v_mfma_f32_16x16x32_bf16 a[56:59], a[248:251], v[40:43], a[56:59]
    v_exp_f32 v162, v162
    v_mfma_f32_16x16x32_bf16 a[28:31], a[252:255], v[32:35], a[28:31]
    v_exp_f32 v163, v163
    v_mfma_f32_16x16x32_bf16 a[60:63], a[252:255], v[40:43], a[60:63]
    v_cvt_pk_bf16_f32 v107, v110, v111
    v_cvt_pk_bf16_f32 v160, v160, v161
    v_mfma_f32_16x16x32_bf16 v[48:51], v[224:227], v[32:35], v[48:51]
    v_cvt_pk_bf16_f32 v161, v162, v163
    v_fma_f32 v164, v164, s45, v186
    v_mfma_f32_16x16x32_bf16 v[52:55], v[224:227], v[40:43], v[52:55]
    v_exp_f32 v164, v164
    v_mfma_f32_16x16x32_bf16 v[32:35], a[192:195], v[0:3], 0
    v_fma_f32 v165, v165, s45, v186
    v_fma_f32 v166, v166, s45, v186
    v_mfma_f32_16x16x32_bf16 v[32:35], a[196:199], v[8:11], v[32:35]
    v_exp_f32 v165, v165
    v_fma_f32 v167, v167, s45, v186
    v_mfma_f32_16x16x32_bf16 v[32:35], a[200:203], v[16:19], v[32:35]
    v_exp_f32 v166, v166
    v_mfma_f32_16x16x32_bf16 v[32:35], a[204:207], v[24:27], v[32:35]
    v_exp_f32 v167, v167
    v_mfma_f32_16x16x32_bf16 v[36:39], a[208:211], v[0:3], 0
    v_cvt_pk_bf16_f32 v162, v164, v165
    v_cvt_pk_bf16_f32 v163, v166, v167
    v_mfma_f32_16x16x32_bf16 v[36:39], a[212:215], v[8:11], v[36:39]
    s_waitcnt lgkmcnt(0)
    v_fma_f32 v168, v168, s45, v187
    v_fma_f32 v169, v169, s45, v187
    v_mfma_f32_16x16x32_bf16 v[36:39], a[216:219], v[16:19], v[36:39]
    v_exp_f32 v168, v168
    v_mfma_f32_16x16x32_bf16 v[36:39], a[220:223], v[24:27], v[36:39]
    v_exp_f32 v169, v169
    v_mfma_f32_16x16x32_bf16 v[40:43], a[192:195], v[4:7], 0
    v_cvt_pk_bf16_f32 v168, v168, v169
    v_fma_f32 v170, v170, s45, v187
    v_fma_f32 v171, v171, s45, v187
    v_mfma_f32_16x16x32_bf16 v[40:43], a[196:199], v[12:15], v[40:43]
    v_exp_f32 v170, v170
    v_mfma_f32_16x16x32_bf16 v[40:43], a[200:203], v[20:23], v[40:43]
    v_exp_f32 v171, v171
    v_mfma_f32_16x16x32_bf16 v[40:43], a[204:207], v[28:31], v[40:43]
    v_cvt_pk_bf16_f32 v169, v170, v171
    v_fma_f32 v172, v172, s45, v187
    v_mfma_f32_16x16x32_bf16 v[44:47], a[208:211], v[4:7], 0
    v_exp_f32 v172, v172
    v_mfma_f32_16x16x32_bf16 v[44:47], a[212:215], v[12:15], v[44:47]
    s_add_u32 s44, s62, 106496
    v_fma_f32 v173, v173, s45, v187
    v_fma_f32 v174, v174, s45, v187
    v_mfma_f32_16x16x32_bf16 v[44:47], a[216:219], v[20:23], v[44:47]
    s_and_b32 s44, s44, 0x1ffff
    v_exp_f32 v173, v173
    v_fma_f32 v175, v175, s45, v187
    v_mfma_f32_16x16x32_bf16 v[44:47], a[220:223], v[28:31], v[44:47]
    s_add_u32 s44, s44, s36
    v_exp_f32 v174, v174
    v_mfma_f32_16x16x32_bf16 a[64:67], a[224:227], v[96:99], a[64:67]
    s_add_u32 m0, s39, 98304
    v_exp_f32 v175, v175
    v_mfma_f32_16x16x32_bf16 a[96:99], a[224:227], v[104:107], a[96:99]
    buffer_load_dwordx4 v192, s[8:11], s44 offen nt lds
    v_mfma_f32_16x16x32_bf16 a[68:71], a[228:231], v[96:99], a[68:71]
    v_cvt_pk_bf16_f32 v170, v172, v173
    v_cvt_pk_bf16_f32 v171, v174, v175
    v_mfma_f32_16x16x32_bf16 a[100:103], a[228:231], v[104:107], a[100:103]
    buffer_load_dwordx4 v193, s[8:11], s44 offen offset:1024 nt lds
    v_mfma_f32_16x16x32_bf16 a[72:75], a[232:235], v[96:99], a[72:75]
    v_fma_f32 v32, v32, s45, v58
    v_fma_f32 v33, v33, s45, v58
    v_mfma_f32_16x16x32_bf16 a[104:107], a[232:235], v[104:107], a[104:107]
    buffer_load_dwordx4 v194, s[8:11], s44 offen offset:2048 nt lds
    v_mfma_f32_16x16x32_bf16 a[76:79], a[236:239], v[96:99], a[76:79]
    v_exp_f32 v32, v32
    v_mfma_f32_16x16x32_bf16 a[108:111], a[236:239], v[104:107], a[108:111]
    buffer_load_dwordx4 v195, s[8:11], s44 offen offset:3072 nt lds
    v_mfma_f32_16x16x32_bf16 a[80:83], a[240:243], v[96:99], a[80:83]
    v_exp_f32 v33, v33
    v_mfma_f32_16x16x32_bf16 a[112:115], a[240:243], v[104:107], a[112:115]
    v_cvt_pk_bf16_f32 v32, v32, v33
    v_fma_f32 v34, v34, s45, v58
    v_mfma_f32_16x16x32_bf16 a[84:87], a[244:247], v[96:99], a[84:87]
    v_exp_f32 v34, v34
    v_mfma_f32_16x16x32_bf16 a[116:119], a[244:247], v[104:107], a[116:119]
    v_fma_f32 v35, v35, s45, v58
    v_fma_f32 v36, v36, s45, v58
    v_mfma_f32_16x16x32_bf16 a[88:91], a[248:251], v[96:99], a[88:91]
    v_exp_f32 v35, v35
    v_fma_f32 v37, v37, s45, v58
    v_mfma_f32_16x16x32_bf16 a[120:123], a[248:251], v[104:107], a[120:123]
    v_exp_f32 v36, v36
    v_mfma_f32_16x16x32_bf16 a[92:95], a[252:255], v[96:99], a[92:95]
    v_exp_f32 v37, v37
    v_mfma_f32_16x16x32_bf16 a[124:127], a[252:255], v[104:107], a[124:127]
    v_cvt_pk_bf16_f32 v33, v34, v35
    v_cvt_pk_bf16_f32 v34, v36, v37
    v_mfma_f32_16x16x32_bf16 v[112:115], v[224:227], v[96:99], v[112:115]
    v_fma_f32 v38, v38, s45, v58
    v_fma_f32 v39, v39, s45, v58
    v_mfma_f32_16x16x32_bf16 v[116:119], v[224:227], v[104:107], v[116:119]
    v_exp_f32 v38, v38
    v_mfma_f32_16x16x32_bf16 v[96:99], a[192:195], v[64:67], 0
    v_exp_f32 v39, v39
    v_fma_f32 v40, v40, s45, v59
    v_mfma_f32_16x16x32_bf16 v[96:99], a[196:199], v[72:75], v[96:99]
    v_exp_f32 v40, v40
    v_mfma_f32_16x16x32_bf16 v[96:99], a[200:203], v[80:83], v[96:99]
    v_cvt_pk_bf16_f32 v35, v38, v39
    v_fma_f32 v41, v41, s45, v59
    v_mfma_f32_16x16x32_bf16 v[96:99], a[204:207], v[88:91], v[96:99]
    v_exp_f32 v41, v41
    v_mfma_f32_16x16x32_bf16 v[100:103], a[208:211], v[64:67], 0
    v_cvt_pk_bf16_f32 v40, v40, v41
    v_fma_f32 v42, v42, s45, v59
    v_mfma_f32_16x16x32_bf16 v[100:103], a[212:215], v[72:75], v[100:103]
    v_exp_f32 v42, v42
    v_mfma_f32_16x16x32_bf16 v[100:103], a[216:219], v[80:83], v[100:103]
    v_fma_f32 v43, v43, s45, v59
    v_fma_f32 v44, v44, s45, v59
    v_mfma_f32_16x16x32_bf16 v[100:103], a[220:223], v[88:91], v[100:103]
    v_exp_f32 v43, v43
    v_fma_f32 v45, v45, s45, v59
    v_mfma_f32_16x16x32_bf16 v[104:107], a[192:195], v[68:71], 0
    v_exp_f32 v44, v44
    v_mfma_f32_16x16x32_bf16 v[104:107], a[196:199], v[76:79], v[104:107]
    v_exp_f32 v45, v45
    v_mfma_f32_16x16x32_bf16 v[104:107], a[200:203], v[84:87], v[104:107]
    v_cvt_pk_bf16_f32 v41, v42, v43
    v_cvt_pk_bf16_f32 v42, v44, v45
    v_mfma_f32_16x16x32_bf16 v[104:107], a[204:207], v[92:95], v[104:107]
    v_fma_f32 v46, v46, s45, v59
    v_fma_f32 v47, v47, s45, v59
    v_mfma_f32_16x16x32_bf16 v[108:111], a[208:211], v[68:71], 0
    v_exp_f32 v46, v46
    v_mfma_f32_16x16x32_bf16 v[108:111], a[212:215], v[76:79], v[108:111]
    v_exp_f32 v47, v47
    v_mfma_f32_16x16x32_bf16 v[108:111], a[216:219], v[84:87], v[108:111]
    v_cvt_pk_bf16_f32 v43, v46, v47
    v_fma_f32 v96, v96, s45, v122
    v_fma_f32 v97, v97, s45, v122
    v_mfma_f32_16x16x32_bf16 v[108:111], a[220:223], v[92:95], v[108:111]
    s_waitcnt vmcnt(8)
    s_barrier
    v_mfma_f32_16x16x32_bf16 a[128:131], a[224:227], v[160:163], a[128:131]
    v_exp_f32 v96, v96
    v_mfma_f32_16x16x32_bf16 a[160:163], a[224:227], v[168:171], a[160:163]
    ds_read_b64_tr_b16 a[224:225], v210 offset:49152
    v_fma_f32 v98, v98, s45, v122
    v_mfma_f32_16x16x32_bf16 a[132:135], a[228:231], v[160:163], a[132:135]
    v_exp_f32 v97, v97
    v_mfma_f32_16x16x32_bf16 a[164:167], a[228:231], v[168:171], a[164:167]
    ds_read_b64_tr_b16 a[226:227], v210 offset:53248
    v_cvt_pk_bf16_f32 v96, v96, v97
    v_mfma_f32_16x16x32_bf16 a[136:139], a[232:235], v[160:163], a[136:139]
    v_exp_f32 v98, v98
    v_fma_f32 v99, v99, s45, v122
    v_mfma_f32_16x16x32_bf16 a[168:171], a[232:235], v[168:171], a[168:171]
    ds_read_b64_tr_b16 a[228:229], v211 offset:49152
    v_fma_f32 v100, v100, s45, v122
    v_mfma_f32_16x16x32_bf16 a[140:143], a[236:239], v[160:163], a[140:143]
    v_exp_f32 v99, v99
    v_mfma_f32_16x16x32_bf16 a[172:175], a[236:239], v[168:171], a[172:175]
    ds_read_b64_tr_b16 a[230:231], v211 offset:53248
    v_cvt_pk_bf16_f32 v97, v98, v99
    v_mfma_f32_16x16x32_bf16 a[144:147], a[240:243], v[160:163], a[144:147]
    v_exp_f32 v100, v100
    v_mfma_f32_16x16x32_bf16 a[176:179], a[240:243], v[168:171], a[176:179]
    ds_read_b64_tr_b16 a[232:233], v212 offset:49152
    v_fma_f32 v101, v101, s45, v122
    v_mfma_f32_16x16x32_bf16 a[148:151], a[244:247], v[160:163], a[148:151]
    v_exp_f32 v101, v101
    v_mfma_f32_16x16x32_bf16 a[180:183], a[244:247], v[168:171], a[180:183]
    ds_read_b64_tr_b16 a[234:235], v212 offset:53248
    v_cvt_pk_bf16_f32 v98, v100, v101
    v_fma_f32 v102, v102, s45, v122
    v_mfma_f32_16x16x32_bf16 a[152:155], a[248:251], v[160:163], a[152:155]
    v_exp_f32 v102, v102
    v_mfma_f32_16x16x32_bf16 a[184:187], a[248:251], v[168:171], a[184:187]
    ds_read_b64_tr_b16 a[236:237], v213 offset:49152
    v_fma_f32 v103, v103, s45, v122
    v_mfma_f32_16x16x32_bf16 a[156:159], a[252:255], v[160:163], a[156:159]
    v_exp_f32 v103, v103
    v_mfma_f32_16x16x32_bf16 a[188:191], a[252:255], v[168:171], a[188:191]
    ds_read_b64_tr_b16 a[238:239], v213 offset:53248
    v_cvt_pk_bf16_f32 v99, v102, v103
    v_mfma_f32_16x16x32_bf16 v[176:179], v[224:227], v[160:163], v[176:179]
    v_fma_f32 v104, v104, s45, v123
    v_fma_f32 v105, v105, s45, v123
    v_mfma_f32_16x16x32_bf16 v[180:183], v[224:227], v[168:171], v[180:183]
    ds_read_b64_tr_b16 a[240:241], v214 offset:49152
    v_fma_f32 v106, v106, s45, v123
    v_mfma_f32_16x16x32_bf16 v[160:163], a[192:195], v[128:131], 0
    s_add_u32 s43, s62, 106496
    v_exp_f32 v104, v104
    v_fma_f32 v107, v107, s45, v123
    v_mfma_f32_16x16x32_bf16 v[160:163], a[196:199], v[136:139], v[160:163]
    s_and_b32 s43, s43, 0x1ffff
    ds_read_b64_tr_b16 a[242:243], v214 offset:53248
    v_fma_f32 v108, v108, s45, v123
    v_mfma_f32_16x16x32_bf16 v[160:163], a[200:203], v[144:147], v[160:163]
    s_add_u32 s43, s43, s36
    v_exp_f32 v105, v105
    v_mfma_f32_16x16x32_bf16 v[160:163], a[204:207], v[152:155], v[160:163]
    s_add_u32 m0, s39, 65536
    ds_read_b64_tr_b16 a[244:245], v215 offset:49152
    v_cvt_pk_bf16_f32 v104, v104, v105
    v_mfma_f32_16x16x32_bf16 v[164:167], a[208:211], v[128:131], 0
    buffer_load_dwordx4 v196, s[12:15], s43 offen nt lds
    v_mfma_f32_16x16x32_bf16 v[164:167], a[212:215], v[136:139], v[164:167]
    ds_read_b64_tr_b16 a[246:247], v215 offset:53248
    v_fma_f32 v109, v109, s45, v123
    v_mfma_f32_16x16x32_bf16 v[164:167], a[216:219], v[144:147], v[164:167]
    buffer_load_dwordx4 v197, s[12:15], s43 offen offset:1024 nt lds
    v_mfma_f32_16x16x32_bf16 v[164:167], a[220:223], v[152:155], v[164:167]
    ds_read_b64_tr_b16 a[248:249], v216 offset:49152
    v_fma_f32 v110, v110, s45, v123
    v_mfma_f32_16x16x32_bf16 v[168:171], a[192:195], v[132:135], 0
    ds_read_b128 a[192:195], v206 offset:16384
    v_fma_f32 v111, v111, s45, v123
    v_mfma_f32_16x16x32_bf16 v[168:171], a[196:199], v[140:143], v[168:171]
    ds_read_b64_tr_b16 a[250:251], v216 offset:53248
    v_fma_f32 v160, v160, s45, v186
    v_mfma_f32_16x16x32_bf16 v[168:171], a[200:203], v[148:151], v[168:171]
    ds_read_b128 a[196:199], v207 offset:16384
    v_fma_f32 v161, v161, s45, v186
    v_mfma_f32_16x16x32_bf16 v[168:171], a[204:207], v[156:159], v[168:171]
    ds_read_b64_tr_b16 a[252:253], v217 offset:49152
    v_fma_f32 v162, v162, s45, v186
    v_mfma_f32_16x16x32_bf16 v[172:175], a[208:211], v[132:135], 0
    ds_read_b128 a[200:203], v208 offset:16384
    v_fma_f32 v163, v163, s45, v186
    v_mfma_f32_16x16x32_bf16 v[172:175], a[212:215], v[140:143], v[172:175]
    ds_read_b64_tr_b16 a[254:255], v217 offset:53248
    v_exp_f32 v106, v106
    v_mfma_f32_16x16x32_bf16 v[172:175], a[216:219], v[148:151], v[172:175]
    ds_read_b128 a[204:207], v209 offset:16384
    v_fma_f32 v164, v164, s45, v186
    v_mfma_f32_16x16x32_bf16 v[172:175], a[220:223], v[156:159], v[172:175]
    s_waitcnt lgkmcnt(7)
    buffer_load_dwordx4 v196, s[12:15], s43 offen offset:2048 nt lds
    buffer_load_dwordx4 v197, s[12:15], s43 offen offset:3072 nt lds
    v_mfma_f32_16x16x32_bf16 a[0:3], a[224:227], v[32:35], a[0:3]
    v_exp_f32 v107, v107
    v_mfma_f32_16x16x32_bf16 a[32:35], a[224:227], v[40:43], a[32:35]
    ds_read_b128 a[208:211], v206 offset:20480
    v_cvt_pk_bf16_f32 v105, v106, v107
    v_mfma_f32_16x16x32_bf16 a[4:7], a[228:231], v[32:35], a[4:7]
    v_exp_f32 v108, v108
    v_mfma_f32_16x16x32_bf16 a[36:39], a[228:231], v[40:43], a[36:39]
    ds_read_b128 a[212:215], v207 offset:20480
    v_fma_f32 v165, v165, s45, v186
    v_mfma_f32_16x16x32_bf16 a[8:11], a[232:235], v[32:35], a[8:11]
    v_exp_f32 v109, v109
    v_fma_f32 v166, v166, s45, v186
    v_mfma_f32_16x16x32_bf16 a[40:43], a[232:235], v[40:43], a[40:43]
    ds_read_b128 a[216:219], v208 offset:20480
    v_cvt_pk_bf16_f32 v106, v108, v109
    v_mfma_f32_16x16x32_bf16 a[12:15], a[236:239], v[32:35], a[12:15]
    v_exp_f32 v110, v110
    v_mfma_f32_16x16x32_bf16 a[44:47], a[236:239], v[40:43], a[44:47]
    ds_read_b128 a[220:223], v209 offset:20480
    v_fma_f32 v167, v167, s45, v186
    v_mfma_f32_16x16x32_bf16 a[16:19], a[240:243], v[32:35], a[16:19]
    v_exp_f32 v111, v111
    v_mfma_f32_16x16x32_bf16 a[48:51], a[240:243], v[40:43], a[48:51]
    v_exp_f32 v160, v160
    v_mfma_f32_16x16x32_bf16 a[20:23], a[244:247], v[32:35], a[20:23]
    s_mul_i32 s55, s42, L_tail2-L_tail1
    v_exp_f32 v161, v161
    v_cvt_pk_bf16_f32 v107, v110, v111
    v_mfma_f32_16x16x32_bf16 a[52:55], a[244:247], v[40:43], a[52:55]
    s_waitcnt lgkmcnt(2)
    s_add_u32 s55, s55, L_tail1-L_pc
    v_cvt_pk_bf16_f32 v160, v160, v161
    v_mfma_f32_16x16x32_bf16 a[24:27], a[248:251], v[32:35], a[24:27]
    s_add_u32 s55, s55, s64
    v_exp_f32 v162, v162
    v_mfma_f32_16x16x32_bf16 a[56:59], a[248:251], v[40:43], a[56:59]
    s_min_u32 s55, s55, L_endcode-L_pc-256
    v_exp_f32 v163, v163
    v_mfma_f32_16x16x32_bf16 a[28:31], a[252:255], v[32:35], a[28:31]
    v_and_b32 v230, 16, v223
    v_lshlrev_b32 v230, 3, v230
    v_mfma_f32_16x16x32_bf16 a[60:63], a[252:255], v[40:43], a[60:63]
    v_add_u32 v230, s55, v230
    v_mov_b32 v231, s97
    v_mfma_f32_16x16x32_bf16 v[48:51], v[224:227], v[32:35], v[48:51]
    v_add_co_u32 v230, vcc, s96, v230
    v_cvt_pk_bf16_f32 v161, v162, v163
    v_mfma_f32_16x16x32_bf16 v[52:55], v[224:227], v[40:43], v[52:55]
    v_addc_co_u32 v231, vcc, 0, v231, vcc
    v_exp_f32 v164, v164
    v_mfma_f32_16x16x32_bf16 v[32:35], a[192:195], v[0:3], 0
    v_exp_f32 v165, v165
    v_mfma_f32_16x16x32_bf16 v[32:35], a[196:199], v[8:11], v[32:35]
    s_cmp_eq_u32 s42, 1
    s_cselect_b32 s54, s66, 0x1000
    v_cvt_pk_bf16_f32 v162, v164, v165
    v_mfma_f32_16x16x32_bf16 v[32:35], a[200:203], v[16:19], v[32:35]
    global_load_dword v232, v[230:231], off
    v_mfma_f32_16x16x32_bf16 v[32:35], a[204:207], v[24:27], v[32:35]
    buffer_load_dword v255, off, s[80:83], s54 sc1
    v_mfma_f32_16x16x32_bf16 v[36:39], a[208:211], v[0:3], 0
    v_exp_f32 v166, v166
    v_mfma_f32_16x16x32_bf16 v[36:39], a[212:215], v[8:11], v[36:39]
    s_waitcnt lgkmcnt(0)
    v_exp_f32 v167, v167
    v_mfma_f32_16x16x32_bf16 v[36:39], a[216:219], v[16:19], v[36:39]
    v_cvt_pk_bf16_f32 v163, v166, v167
    v_fma_f32 v168, v168, s45, v187
    v_fma_f32 v169, v169, s45, v187
    v_mfma_f32_16x16x32_bf16 v[36:39], a[220:223], v[24:27], v[36:39]
    v_exp_f32 v168, v168
    v_mfma_f32_16x16x32_bf16 v[40:43], a[192:195], v[4:7], 0
    v_exp_f32 v169, v169
    v_mfma_f32_16x16x32_bf16 v[40:43], a[196:199], v[12:15], v[40:43]
    v_cvt_pk_bf16_f32 v168, v168, v169
    v_fma_f32 v170, v170, s45, v187
    v_mfma_f32_16x16x32_bf16 v[40:43], a[200:203], v[20:23], v[40:43]
    v_exp_f32 v170, v170
    v_mfma_f32_16x16x32_bf16 v[40:43], a[204:207], v[28:31], v[40:43]
    v_fma_f32 v171, v171, s45, v187
    v_fma_f32 v172, v172, s45, v187
    v_mfma_f32_16x16x32_bf16 v[44:47], a[208:211], v[4:7], 0
    v_exp_f32 v171, v171
    v_fma_f32 v173, v173, s45, v187
    v_mfma_f32_16x16x32_bf16 v[44:47], a[212:215], v[12:15], v[44:47]
    v_exp_f32 v172, v172
    v_mfma_f32_16x16x32_bf16 v[44:47], a[216:219], v[20:23], v[44:47]
    v_exp_f32 v173, v173
    v_mfma_f32_16x16x32_bf16 v[44:47], a[220:223], v[28:31], v[44:47]
    v_cvt_pk_bf16_f32 v169, v170, v171
    v_cvt_pk_bf16_f32 v170, v172, v173
    v_mfma_f32_16x16x32_bf16 a[64:67], a[224:227], v[96:99], a[64:67]
    v_fma_f32 v174, v174, s45, v187
    v_fma_f32 v175, v175, s45, v187
    v_mfma_f32_16x16x32_bf16 a[96:99], a[224:227], v[104:107], a[96:99]
    v_exp_f32 v174, v174
    v_mfma_f32_16x16x32_bf16 a[68:71], a[228:231], v[96:99], a[68:71]
    v_exp_f32 v175, v175
    v_mfma_f32_16x16x32_bf16 a[100:103], a[228:231], v[104:107], a[100:103]
    v_cvt_pk_bf16_f32 v171, v174, v175
    v_fma_f32 v32, v32, s45, v58
    v_fma_f32 v33, v33, s45, v58
    v_mfma_f32_16x16x32_bf16 a[72:75], a[232:235], v[96:99], a[72:75]
    s_add_u32 s44, s62, 114688
    v_exp_f32 v32, v32
    v_mfma_f32_16x16x32_bf16 a[104:107], a[232:235], v[104:107], a[104:107]
    s_and_b32 s44, s44, 0x1ffff
    v_exp_f32 v33, v33
    v_mfma_f32_16x16x32_bf16 a[76:79], a[236:239], v[96:99], a[76:79]
    s_add_u32 s44, s44, s36
    v_cvt_pk_bf16_f32 v32, v32, v33
    v_fma_f32 v34, v34, s45, v58
    v_mfma_f32_16x16x32_bf16 a[108:111], a[236:239], v[104:107], a[108:111]
    s_add_u32 m0, s39, 131072
    v_exp_f32 v34, v34
    v_mfma_f32_16x16x32_bf16 a[80:83], a[240:243], v[96:99], a[80:83]
    buffer_load_dwordx4 v192, s[8:11], s44 offen nt lds
    v_mfma_f32_16x16x32_bf16 a[112:115], a[240:243], v[104:107], a[112:115]
    v_fma_f32 v35, v35, s45, v58
    v_fma_f32 v36, v36, s45, v58
    v_mfma_f32_16x16x32_bf16 a[84:87], a[244:247], v[96:99], a[84:87]
    buffer_load_dwordx4 v193, s[8:11], s44 offen offset:1024 nt lds
    v_mfma_f32_16x16x32_bf16 a[116:119], a[244:247], v[104:107], a[116:119]
    v_exp_f32 v35, v35
    v_mfma_f32_16x16x32_bf16 a[88:91], a[248:251], v[96:99], a[88:91]
    buffer_load_dwordx4 v194, s[8:11], s44 offen offset:2048 nt lds
    v_mfma_f32_16x16x32_bf16 a[120:123], a[248:251], v[104:107], a[120:123]
    v_exp_f32 v36, v36
    v_mfma_f32_16x16x32_bf16 a[92:95], a[252:255], v[96:99], a[92:95]
    buffer_load_dwordx4 v195, s[8:11], s44 offen offset:3072 nt lds
    v_mfma_f32_16x16x32_bf16 a[124:127], a[252:255], v[104:107], a[124:127]
    v_cvt_pk_bf16_f32 v33, v34, v35
    v_fma_f32 v37, v37, s45, v58
    v_mfma_f32_16x16x32_bf16 v[112:115], v[224:227], v[96:99], v[112:115]
    v_exp_f32 v37, v37
    v_fma_f32 v38, v38, s45, v58
    v_mfma_f32_16x16x32_bf16 v[116:119], v[224:227], v[104:107], v[116:119]
    v_exp_f32 v38, v38
    v_mfma_f32_16x16x32_bf16 v[96:99], a[192:195], v[64:67], 0
    v_cvt_pk_bf16_f32 v34, v36, v37
    v_fma_f32 v39, v39, s45, v58
    v_mfma_f32_16x16x32_bf16 v[96:99], a[196:199], v[72:75], v[96:99]
    v_exp_f32 v39, v39
    v_mfma_f32_16x16x32_bf16 v[96:99], a[200:203], v[80:83], v[96:99]
    v_cvt_pk_bf16_f32 v35, v38, v39
    v_fma_f32 v40, v40, s45, v59
    v_mfma_f32_16x16x32_bf16 v[96:99], a[204:207], v[88:91], v[96:99]
    v_exp_f32 v40, v40
    v_mfma_f32_16x16x32_bf16 v[100:103], a[208:211], v[64:67], 0
    v_fma_f32 v41, v41, s45, v59
    v_fma_f32 v42, v42, s45, v59
    v_mfma_f32_16x16x32_bf16 v[100:103], a[212:215], v[72:75], v[100:103]
    v_exp_f32 v41, v41
    v_fma_f32 v43, v43, s45, v59
    v_mfma_f32_16x16x32_bf16 v[100:103], a[216:219], v[80:83], v[100:103]
    v_exp_f32 v42, v42
    v_mfma_f32_16x16x32_bf16 v[100:103], a[220:223], v[88:91], v[100:103]
    v_exp_f32 v43, v43
    v_mfma_f32_16x16x32_bf16 v[104:107], a[192:195], v[68:71], 0
    v_cvt_pk_bf16_f32 v40, v40, v41
    v_cvt_pk_bf16_f32 v41, v42, v43
    v_mfma_f32_16x16x32_bf16 v[104:107], a[196:199], v[76:79], v[104:107]
    v_fma_f32 v44, v44, s45, v59
    v_fma_f32 v45, v45, s45, v59
    v_mfma_f32_16x16x32_bf16 v[104:107], a[200:203], v[84:87], v[104:107]
    v_exp_f32 v44, v44
    v_mfma_f32_16x16x32_bf16 v[104:107], a[204:207], v[92:95], v[104:107]
    v_exp_f32 v45, v45
    v_mfma_f32_16x16x32_bf16 v[108:111], a[208:211], v[68:71], 0
    v_cvt_pk_bf16_f32 v42, v44, v45
    v_fma_f32 v46, v46, s45, v59
    v_fma_f32 v47, v47, s45, v59
    v_mfma_f32_16x16x32_bf16 v[108:111], a[212:215], v[76:79], v[108:111]
    v_exp_f32 v46, v46
    v_mfma_f32_16x16x32_bf16 v[108:111], a[216:219], v[84:87], v[108:111]
    v_exp_f32 v47, v47
    v_mfma_f32_16x16x32_bf16 v[108:111], a[220:223], v[92:95], v[108:111]
    s_waitcnt vmcnt(10)
    s_barrier
    v_mfma_f32_16x16x32_bf16 a[128:131], a[224:227], v[160:163], a[128:131]
    v_cvt_pk_bf16_f32 v43, v46, v47
    v_fma_f32 v96, v96, s45, v122
    v_mfma_f32_16x16x32_bf16 a[160:163], a[224:227], v[168:171], a[160:163]
    ds_read_b64_tr_b16 a[224:225], v210 offset:16384
    v_fma_f32 v97, v97, s45, v122
    v_mfma_f32_16x16x32_bf16 a[132:135], a[228:231], v[160:163], a[132:135]
    v_exp_f32 v96, v96
    v_fma_f32 v98, v98, s45, v122
    v_mfma_f32_16x16x32_bf16 a[164:167], a[228:231], v[168:171], a[164:167]
    ds_read_b64_tr_b16 a[226:227], v210 offset:20480
    v_fma_f32 v99, v99, s45, v122
    v_mfma_f32_16x16x32_bf16 a[136:139], a[232:235], v[160:163], a[136:139]
    v_exp_f32 v97, v97
    v_mfma_f32_16x16x32_bf16 a[168:171], a[232:235], v[168:171], a[168:171]
    ds_read_b64_tr_b16 a[228:229], v211 offset:16384
    v_cvt_pk_bf16_f32 v96, v96, v97
    v_mfma_f32_16x16x32_bf16 a[140:143], a[236:239], v[160:163], a[140:143]
    v_exp_f32 v98, v98
    v_mfma_f32_16x16x32_bf16 a[172:175], a[236:239], v[168:171], a[172:175]
    ds_read_b64_tr_b16 a[230:231], v211 offset:20480
    v_fma_f32 v100, v100, s45, v122
    v_mfma_f32_16x16x32_bf16 a[144:147], a[240:243], v[160:163], a[144:147]
    v_exp_f32 v99, v99
    v_mfma_f32_16x16x32_bf16 a[176:179], a[240:243], v[168:171], a[176:179]
    ds_read_b64_tr_b16 a[232:233], v212 offset:16384
    v_exp_f32 v100, v100
    v_mfma_f32_16x16x32_bf16 a[148:151], a[244:247], v[160:163], a[148:151]
    v_cvt_pk_bf16_f32 v97, v98, v99
    v_fma_f32 v101, v101, s45, v122
    v_mfma_f32_16x16x32_bf16 a[180:183], a[244:247], v[168:171], a[180:183]
    ds_read_b64_tr_b16 a[234:235], v212 offset:20480
    v_fma_f32 v102, v102, s45, v122
    v_mfma_f32_16x16x32_bf16 a[152:155], a[248:251], v[160:163], a[152:155]
    v_exp_f32 v101, v101
    v_mfma_f32_16x16x32_bf16 a[184:187], a[248:251], v[168:171], a[184:187]
    ds_read_b64_tr_b16 a[236:237], v213 offset:16384
    v_cvt_pk_bf16_f32 v98, v100, v101
    v_mfma_f32_16x16x32_bf16 a[156:159], a[252:255], v[160:163], a[156:159]
    v_exp_f32 v102, v102
    v_mfma_f32_16x16x32_bf16 a[188:191], a[252:255], v[168:171], a[188:191]
    ds_read_b64_tr_b16 a[238:239], v213 offset:20480
    v_fma_f32 v103, v103, s45, v122
    v_mfma_f32_16x16x32_bf16 v[176:179], v[224:227], v[160:163], v[176:179]
    v_exp_f32 v103, v103
    v_fma_f32 v104, v104, s45, v123
    v_mfma_f32_16x16x32_bf16 v[180:183], v[224:227], v[168:171], v[180:183]
    ds_read_b64_tr_b16 a[240:241], v214 offset:16384
    v_cvt_pk_bf16_f32 v99, v102, v103
    v_mfma_f32_16x16x32_bf16 v[160:163], a[192:195], v[128:131], 0
    v_exp_f32 v104, v104
    v_mfma_f32_16x16x32_bf16 v[160:163], a[196:199], v[136:139], v[160:163]
    ds_read_b64_tr_b16 a[242:243], v214 offset:20480
    v_fma_f32 v105, v105, s45, v123
    v_mfma_f32_16x16x32_bf16 v[160:163], a[200:203], v[144:147], v[160:163]
    v_exp_f32 v105, v105
    v_mfma_f32_16x16x32_bf16 v[160:163], a[204:207], v[152:155], v[160:163]
    ds_read_b64_tr_b16 a[244:245], v215 offset:16384
    v_cvt_pk_bf16_f32 v104, v104, v105
    v_mfma_f32_16x16x32_bf16 v[164:167], a[208:211], v[128:131], 0
    v_fma_f32 v106, v106, s45, v123
    v_exp_f32 v106, v106
    v_mfma_f32_16x16x32_bf16 v[164:167], a[212:215], v[136:139], v[164:167]
    ds_read_b64_tr_b16 a[246:247], v215 offset:20480
    v_fma_f32 v107, v107, s45, v123
    v_mfma_f32_16x16x32_bf16 v[164:167], a[216:219], v[144:147], v[164:167]
    v_exp_f32 v107, v107
    v_mfma_f32_16x16x32_bf16 v[164:167], a[220:223], v[152:155], v[164:167]
    ds_read_b64_tr_b16 a[248:249], v216 offset:16384
    v_cvt_pk_bf16_f32 v105, v106, v107
    v_mfma_f32_16x16x32_bf16 v[168:171], a[192:195], v[132:135], 0
    ds_read_b128 a[192:195], v206
    v_fma_f32 v108, v108, s45, v123
    v_mfma_f32_16x16x32_bf16 v[168:171], a[196:199], v[140:143], v[168:171]
    ds_read_b64_tr_b16 a[250:251], v216 offset:20480
    v_fma_f32 v109, v109, s45, v123
    v_mfma_f32_16x16x32_bf16 v[168:171], a[200:203], v[148:151], v[168:171]
    ds_read_b128 a[196:199], v207
    v_fma_f32 v110, v110, s45, v123
    v_mfma_f32_16x16x32_bf16 v[168:171], a[204:207], v[156:159], v[168:171]
    s_add_u32 s43, s62, 114688
    ds_read_b64_tr_b16 a[252:253], v217 offset:16384
    v_exp_f32 v108, v108
    v_mfma_f32_16x16x32_bf16 v[172:175], a[208:211], v[132:135], 0
    s_and_b32 s43, s43, 0x1ffff
    ds_read_b128 a[200:203], v208
    v_fma_f32 v111, v111, s45, v123
    v_mfma_f32_16x16x32_bf16 v[172:175], a[212:215], v[140:143], v[172:175]
    s_add_u32 s43, s43, s36
    ds_read_b64_tr_b16 a[254:255], v217 offset:20480
    v_fma_f32 v160, v160, s45, v186
    v_mfma_f32_16x16x32_bf16 v[172:175], a[216:219], v[148:151], v[172:175]
    s_add_u32 m0, s39, 32768
    ds_read_b128 a[204:207], v209
    v_fma_f32 v161, v161, s45, v186
    v_mfma_f32_16x16x32_bf16 v[172:175], a[220:223], v[156:159], v[172:175]
    s_waitcnt lgkmcnt(6)
    buffer_load_dwordx4 v196, s[12:15], s43 offen nt lds
    buffer_load_dwordx4 v197, s[12:15], s43 offen offset:1024 nt lds
    buffer_load_dwordx4 v196, s[12:15], s43 offen offset:2048 nt lds
    v_mfma_f32_16x16x32_bf16 a[0:3], a[224:227], v[32:35], a[0:3]
    buffer_load_dwordx4 v197, s[12:15], s43 offen offset:3072 nt lds
    v_mfma_f32_16x16x32_bf16 a[32:35], a[224:227], v[40:43], a[32:35]
    ds_read_b128 a[208:211], v206 offset:4096
    v_fma_f32 v162, v162, s45, v186
    v_mfma_f32_16x16x32_bf16 a[4:7], a[228:231], v[32:35], a[4:7]
    v_exp_f32 v109, v109
    v_fma_f32 v163, v163, s45, v186
    v_mfma_f32_16x16x32_bf16 a[36:39], a[228:231], v[40:43], a[36:39]
    ds_read_b128 a[212:215], v207 offset:4096
    v_cvt_pk_bf16_f32 v106, v108, v109
    v_mfma_f32_16x16x32_bf16 a[8:11], a[232:235], v[32:35], a[8:11]
    v_exp_f32 v110, v110
    v_mfma_f32_16x16x32_bf16 a[40:43], a[232:235], v[40:43], a[40:43]
    ds_read_b128 a[216:219], v208 offset:4096
    v_fma_f32 v164, v164, s45, v186
    v_mfma_f32_16x16x32_bf16 a[12:15], a[236:239], v[32:35], a[12:15]
    v_exp_f32 v111, v111
    v_mfma_f32_16x16x32_bf16 a[44:47], a[236:239], v[40:43], a[44:47]
    ds_read_b128 a[220:223], v209 offset:4096
    v_cvt_pk_bf16_f32 v107, v110, v111
    v_mfma_f32_16x16x32_bf16 a[16:19], a[240:243], v[32:35], a[16:19]
    v_exp_f32 v160, v160
    v_fma_f32 v165, v165, s45, v186
    v_mfma_f32_16x16x32_bf16 a[48:51], a[240:243], v[40:43], a[48:51]
    v_exp_f32 v161, v161
    v_mfma_f32_16x16x32_bf16 a[20:23], a[244:247], v[32:35], a[20:23]
    v_exp_f32 v162, v162
    v_mfma_f32_16x16x32_bf16 a[52:55], a[244:247], v[40:43], a[52:55]
    s_waitcnt lgkmcnt(2)
    v_exp_f32 v163, v163
    v_mfma_f32_16x16x32_bf16 a[24:27], a[248:251], v[32:35], a[24:27]
    v_exp_f32 v164, v164
    v_mfma_f32_16x16x32_bf16 a[56:59], a[248:251], v[40:43], a[56:59]
    v_exp_f32 v165, v165
    v_mfma_f32_16x16x32_bf16 a[28:31], a[252:255], v[32:35], a[28:31]
    v_cvt_pk_bf16_f32 v160, v160, v161
    v_cvt_pk_bf16_f32 v161, v162, v163
    v_mfma_f32_16x16x32_bf16 a[60:63], a[252:255], v[40:43], a[60:63]
    v_cvt_pk_bf16_f32 v162, v164, v165
    v_fma_f32 v166, v166, s45, v186
    v_fma_f32 v167, v167, s45, v186
    v_mfma_f32_16x16x32_bf16 v[48:51], v[224:227], v[32:35], v[48:51]
    v_exp_f32 v166, v166
    v_mfma_f32_16x16x32_bf16 v[52:55], v[224:227], v[40:43], v[52:55]
    v_exp_f32 v167, v167
    v_mfma_f32_16x16x32_bf16 v[32:35], a[192:195], v[0:3], 0
    v_cvt_pk_bf16_f32 v163, v166, v167
    v_fma_f32 v168, v168, s45, v187
    v_fma_f32 v169, v169, s45, v187
    v_mfma_f32_16x16x32_bf16 v[32:35], a[196:199], v[8:11], v[32:35]
    s_lshl_b32 s71, s42, 23
    s_waitcnt vmcnt(8)
    v_readfirstlane_b32 s69, v255
    v_fma_f32 v170, v170, s45, v187
    v_mfma_f32_16x16x32_bf16 v[32:35], a[200:203], v[16:19], v[32:35]
    v_exp_f32 v168, v168
    v_mfma_f32_16x16x32_bf16 v[32:35], a[204:207], v[24:27], v[32:35]
    v_exp_f32 v169, v169
    v_fma_f32 v171, v171, s45, v187
    v_mfma_f32_16x16x32_bf16 v[36:39], a[208:211], v[0:3], 0
    s_cmp_lt_u32 s69, s71
    s_cbranch_scc1 L_spin3
L_spin3_back:
    v_mfma_f32_16x16x32_bf16 v[36:39], a[212:215], v[8:11], v[36:39]
    s_waitcnt lgkmcnt(0)
    v_exp_f32 v170, v170
    v_cvt_pk_bf16_f32 v168, v168, v169
    v_mfma_f32_16x16x32_bf16 v[36:39], a[216:219], v[16:19], v[36:39]
    v_exp_f32 v171, v171
    v_mfma_f32_16x16x32_bf16 v[36:39], a[220:223], v[24:27], v[36:39]
    v_cvt_pk_bf16_f32 v169, v170, v171
    v_fma_f32 v172, v172, s45, v187
    v_mfma_f32_16x16x32_bf16 v[40:43], a[192:195], v[4:7], 0
    v_exp_f32 v172, v172
    v_fma_f32 v173, v173, s45, v187
    v_mfma_f32_16x16x32_bf16 v[40:43], a[196:199], v[12:15], v[40:43]
    v_exp_f32 v173, v173
    v_mfma_f32_16x16x32_bf16 v[40:43], a[200:203], v[20:23], v[40:43]
    v_cvt_pk_bf16_f32 v170, v172, v173
    v_fma_f32 v174, v174, s45, v187
    v_fma_f32 v175, v175, s45, v187
    v_mfma_f32_16x16x32_bf16 v[40:43], a[204:207], v[28:31], v[40:43]
    v_exp_f32 v174, v174
    v_mfma_f32_16x16x32_bf16 v[44:47], a[208:211], v[4:7], 0
    v_exp_f32 v175, v175
    v_mfma_f32_16x16x32_bf16 v[44:47], a[212:215], v[12:15], v[44:47]
    v_cvt_pk_bf16_f32 v171, v174, v175
    v_fma_f32 v32, v32, s45, v58
    v_fma_f32 v33, v33, s45, v58
    v_mfma_f32_16x16x32_bf16 v[44:47], a[216:219], v[20:23], v[44:47]
    v_exp_f32 v32, v32
    v_mfma_f32_16x16x32_bf16 v[44:47], a[220:223], v[28:31], v[44:47]
    v_exp_f32 v33, v33
    v_fma_f32 v34, v34, s45, v58
    v_mfma_f32_16x16x32_bf16 a[64:67], a[224:227], v[96:99], a[64:67]
    v_exp_f32 v34, v34
    v_mfma_f32_16x16x32_bf16 a[96:99], a[224:227], v[104:107], a[96:99]
    v_cvt_pk_bf16_f32 v32, v32, v33
    v_fma_f32 v35, v35, s45, v58
    v_mfma_f32_16x16x32_bf16 a[68:71], a[228:231], v[96:99], a[68:71]
    v_exp_f32 v35, v35
    v_fma_f32 v36, v36, s45, v58
    v_mfma_f32_16x16x32_bf16 a[100:103], a[228:231], v[104:107], a[100:103]
    v_exp_f32 v36, v36
    v_mfma_f32_16x16x32_bf16 a[72:75], a[232:235], v[96:99], a[72:75]
    v_cvt_pk_bf16_f32 v33, v34, v35
    v_fma_f32 v37, v37, s45, v58
    v_fma_f32 v38, v38, s45, v58
    v_mfma_f32_16x16x32_bf16 a[104:107], a[232:235], v[104:107], a[104:107]
    v_exp_f32 v37, v37
    v_mfma_f32_16x16x32_bf16 a[76:79], a[236:239], v[96:99], a[76:79]
    v_exp_f32 v38, v38
    v_mfma_f32_16x16x32_bf16 a[108:111], a[236:239], v[104:107], a[108:111]
    v_cvt_pk_bf16_f32 v34, v36, v37
    v_fma_f32 v39, v39, s45, v58
    v_fma_f32 v40, v40, s45, v59
    v_mfma_f32_16x16x32_bf16 a[80:83], a[240:243], v[96:99], a[80:83]
    v_exp_f32 v39, v39
    v_mfma_f32_16x16x32_bf16 a[112:115], a[240:243], v[104:107], a[112:115]
    v_exp_f32 v40, v40
    v_cvt_pk_bf16_f32 v35, v38, v39
    v_mfma_f32_16x16x32_bf16 a[84:87], a[244:247], v[96:99], a[84:87]
    v_fma_f32 v41, v41, s45, v59
    v_fma_f32 v42, v42, s45, v59
    v_mfma_f32_16x16x32_bf16 a[116:119], a[244:247], v[104:107], a[116:119]
    s_add_u32 s44, s62, 122880
    v_exp_f32 v41, v41
    v_mfma_f32_16x16x32_bf16 a[88:91], a[248:251], v[96:99], a[88:91]
    s_and_b32 s44, s44, 0x1ffff
    v_exp_f32 v42, v42
    v_cvt_pk_bf16_f32 v40, v40, v41
    v_mfma_f32_16x16x32_bf16 a[120:123], a[248:251], v[104:107], a[120:123]
    s_add_u32 s44, s44, s36
    v_fma_f32 v43, v43, s45, v59
    v_fma_f32 v44, v44, s45, v59
    v_mfma_f32_16x16x32_bf16 a[92:95], a[252:255], v[96:99], a[92:95]
    s_add_u32 m0, s39, 16384
    v_exp_f32 v43, v43
    v_fma_f32 v45, v45, s45, v59
    v_mfma_f32_16x16x32_bf16 a[124:127], a[252:255], v[104:107], a[124:127]
    buffer_load_dwordx4 v192, s[8:11], s44 offen nt lds
    v_mfma_f32_16x16x32_bf16 v[112:115], v[224:227], v[96:99], v[112:115]
    v_exp_f32 v44, v44
    v_mfma_f32_16x16x32_bf16 v[116:119], v[224:227], v[104:107], v[116:119]
    buffer_load_dwordx4 v193, s[8:11], s44 offen offset:1024 nt lds
    v_mfma_f32_16x16x32_bf16 v[96:99], a[192:195], v[64:67], 0
    v_exp_f32 v45, v45
    v_mfma_f32_16x16x32_bf16 v[96:99], a[196:199], v[72:75], v[96:99]
    buffer_load_dwordx4 v194, s[8:11], s44 offen offset:2048 nt lds
    v_mfma_f32_16x16x32_bf16 v[96:99], a[200:203], v[80:83], v[96:99]
    v_cvt_pk_bf16_f32 v41, v42, v43
    v_cvt_pk_bf16_f32 v42, v44, v45
    v_mfma_f32_16x16x32_bf16 v[96:99], a[204:207], v[88:91], v[96:99]
    buffer_load_dwordx4 v195, s[8:11], s44 offen offset:3072 nt lds
    v_mfma_f32_16x16x32_bf16 v[100:103], a[208:211], v[64:67], 0
    v_fma_f32 v46, v46, s45, v59
    v_exp_f32 v46, v46
    v_mfma_f32_16x16x32_bf16 v[100:103], a[212:215], v[72:75], v[100:103]
    v_fma_f32 v47, v47, s45, v59
    v_mfma_f32_16x16x32_bf16 v[100:103], a[216:219], v[80:83], v[100:103]
    v_exp_f32 v47, v47
    v_mfma_f32_16x16x32_bf16 v[100:103], a[220:223], v[88:91], v[100:103]
    v_cvt_pk_bf16_f32 v43, v46, v47
    v_mfma_f32_16x16x32_bf16 v[104:107], a[192:195], v[68:71], 0
    v_mfma_f32_16x16x32_bf16 v[104:107], a[196:199], v[76:79], v[104:107]
    v_fma_f32 v96, v96, s45, v122
    v_exp_f32 v96, v96
    v_mfma_f32_16x16x32_bf16 v[104:107], a[200:203], v[84:87], v[104:107]
    v_fma_f32 v97, v97, s45, v122
    v_fma_f32 v98, v98, s45, v122
    v_mfma_f32_16x16x32_bf16 v[104:107], a[204:207], v[92:95], v[104:107]
    v_exp_f32 v97, v97
    v_fma_f32 v99, v99, s45, v122
    v_mfma_f32_16x16x32_bf16 v[108:111], a[208:211], v[68:71], 0
    v_exp_f32 v98, v98
    v_mfma_f32_16x16x32_bf16 v[108:111], a[212:215], v[76:79], v[108:111]
    v_exp_f32 v99, v99
    v_mfma_f32_16x16x32_bf16 v[108:111], a[216:219], v[84:87], v[108:111]
    v_cvt_pk_bf16_f32 v96, v96, v97
    v_cvt_pk_bf16_f32 v97, v98, v99
    v_fma_f32 v100, v100, s45, v122
    v_mfma_f32_16x16x32_bf16 v[108:111], a[220:223], v[92:95], v[108:111]
    s_waitcnt vmcnt(8)
    s_barrier
    s_cmp_eq_u32 s42, 1
    s_cbranch_scc1 L_tail2
L_tail1:
    v_mfma_f32_16x16x32_bf16 a[128:131], a[224:227], v[160:163], a[128:131]
    v_exp_f32 v100, v100
    v_fma_f32 v101, v101, s45, v122
    v_mfma_f32_16x16x32_bf16 a[160:163], a[224:227], v[168:171], a[160:163]
    ds_read_b64_tr_b16 a[224:225], v210 offset:32768
    v_fma_f32 v102, v102, s45, v122
    v_mfma_f32_16x16x32_bf16 a[132:135], a[228:231], v[160:163], a[132:135]
    v_exp_f32 v101, v101
    v_mfma_f32_16x16x32_bf16 a[164:167], a[228:231], v[168:171], a[164:167]
    s_add_u32 m0, s39, 0
    ds_read_b64_tr_b16 a[226:227], v210 offset:36864
    v_exp_f32 v102, v102
    v_mfma_f32_16x16x32_bf16 a[136:139], a[232:235], v[160:163], a[136:139]
    buffer_load_dwordx4 v198, s[20:23], s84 offen sc1 lds
    v_mfma_f32_16x16x32_bf16 a[168:171], a[232:235], v[168:171], a[168:171]
    ds_read_b64_tr_b16 a[228:229], v211 offset:32768
    v_cvt_pk_bf16_f32 v98, v100, v101
    v_fma_f32 v103, v103, s45, v122
    v_mfma_f32_16x16x32_bf16 a[140:143], a[236:239], v[160:163], a[140:143]
    v_exp_f32 v103, v103
    v_mfma_f32_16x16x32_bf16 a[172:175], a[236:239], v[168:171], a[172:175]
    ds_read_b64_tr_b16 a[230:231], v211 offset:36864
    v_cvt_pk_bf16_f32 v99, v102, v103
    v_mfma_f32_16x16x32_bf16 a[144:147], a[240:243], v[160:163], a[144:147]
    v_fma_f32 v104, v104, s45, v123
    v_exp_f32 v104, v104
    v_mfma_f32_16x16x32_bf16 a[176:179], a[240:243], v[168:171], a[176:179]
    ds_read_b64_tr_b16 a[232:233], v212 offset:32768
    v_fma_f32 v105, v105, s45, v123
    v_mfma_f32_16x16x32_bf16 a[148:151], a[244:247], v[160:163], a[148:151]
    v_exp_f32 v105, v105
    v_fma_f32 v106, v106, s45, v123
    v_mfma_f32_16x16x32_bf16 a[180:183], a[244:247], v[168:171], a[180:183]
    ds_read_b64_tr_b16 a[234:235], v212 offset:36864
    v_cvt_pk_bf16_f32 v104, v104, v105
    v_mfma_f32_16x16x32_bf16 a[152:155], a[248:251], v[160:163], a[152:155]
    v_exp_f32 v106, v106
    v_mfma_f32_16x16x32_bf16 a[184:187], a[248:251], v[168:171], a[184:187]
    ds_read_b64_tr_b16 a[236:237], v213 offset:32768
    v_fma_f32 v107, v107, s45, v123
    v_fma_f32 v108, v108, s45, v123
    v_mfma_f32_16x16x32_bf16 a[156:159], a[252:255], v[160:163], a[156:159]
    buffer_load_dwordx4 v199, s[20:23], s84 offen offset:1024 sc1 lds
    v_mfma_f32_16x16x32_bf16 a[188:191], a[252:255], v[168:171], a[188:191]
    ds_read_b64_tr_b16 a[238:239], v213 offset:36864
    v_exp_f32 v107, v107
    v_mfma_f32_16x16x32_bf16 v[176:179], v[224:227], v[160:163], v[176:179]
    v_exp_f32 v108, v108
    v_mfma_f32_16x16x32_bf16 v[180:183], v[224:227], v[168:171], v[180:183]
    ds_read_b64_tr_b16 a[240:241], v214 offset:32768
    v_cvt_pk_bf16_f32 v105, v106, v107
    v_mfma_f32_16x16x32_bf16 v[160:163], a[192:195], v[128:131], 0
    v_fma_f32 v109, v109, s45, v123
    v_exp_f32 v109, v109
    v_mfma_f32_16x16x32_bf16 v[160:163], a[196:199], v[136:139], v[160:163]
    ds_read_b64_tr_b16 a[242:243], v214 offset:36864
    v_cvt_pk_bf16_f32 v106, v108, v109
    v_mfma_f32_16x16x32_bf16 v[160:163], a[200:203], v[144:147], v[160:163]
    v_fma_f32 v110, v110, s45, v123
    v_exp_f32 v110, v110
    v_mfma_f32_16x16x32_bf16 v[160:163], a[204:207], v[152:155], v[160:163]
    ds_read_b64_tr_b16 a[244:245], v215 offset:32768
    v_fma_f32 v111, v111, s45, v123
    v_mfma_f32_16x16x32_bf16 v[164:167], a[208:211], v[128:131], 0
    v_exp_f32 v111, v111
    v_mfma_f32_16x16x32_bf16 v[164:167], a[212:215], v[136:139], v[164:167]
    ds_read_b64_tr_b16 a[246:247], v215 offset:36864
    v_cvt_pk_bf16_f32 v107, v110, v111
    v_mfma_f32_16x16x32_bf16 v[164:167], a[216:219], v[144:147], v[164:167]
    buffer_load_dwordx4 v200, s[20:23], s84 offen offset:2048 sc1 lds
    v_mfma_f32_16x16x32_bf16 v[164:167], a[220:223], v[152:155], v[164:167]
    ds_read_b64_tr_b16 a[248:249], v216 offset:32768
    v_mfma_f32_16x16x32_bf16 v[168:171], a[192:195], v[132:135], 0
    ds_read_b128 a[192:195], v206 offset:32768
    v_mfma_f32_16x16x32_bf16 v[168:171], a[196:199], v[140:143], v[168:171]
    ds_read_b64_tr_b16 a[250:251], v216 offset:36864
    v_fma_f32 v160, v160, s45, v186
    v_mfma_f32_16x16x32_bf16 v[168:171], a[200:203], v[148:151], v[168:171]
    ds_read_b128 a[196:199], v207 offset:32768
    v_exp_f32 v160, v160
    v_mfma_f32_16x16x32_bf16 v[168:171], a[204:207], v[156:159], v[168:171]
    ds_read_b64_tr_b16 a[252:253], v217 offset:32768
    v_fma_f32 v161, v161, s45, v186
    v_mfma_f32_16x16x32_bf16 v[172:175], a[208:211], v[132:135], 0
    ds_read_b128 a[200:203], v208 offset:32768
    v_exp_f32 v161, v161
    v_mfma_f32_16x16x32_bf16 v[172:175], a[212:215], v[140:143], v[172:175]
    ds_read_b64_tr_b16 a[254:255], v217 offset:36864
    v_cvt_pk_bf16_f32 v160, v160, v161
    v_mfma_f32_16x16x32_bf16 v[172:175], a[216:219], v[148:151], v[172:175]
    s_add_u32 s43, s62, 122880
    ds_read_b128 a[204:207], v209 offset:32768
    v_fma_f32 v162, v162, s45, v186
    v_mfma_f32_16x16x32_bf16 v[172:175], a[220:223], v[156:159], v[172:175]
    s_waitcnt lgkmcnt(7)
    s_and_b32 s43, s43, 0x1ffff
    buffer_load_dwordx4 v201, s[20:23], s84 offen offset:3072 sc1 lds
    v_mfma_f32_16x16x32_bf16 a[0:3], a[224:227], v[32:35], a[0:3]
    s_add_u32 s43, s43, s36
    v_exp_f32 v162, v162
    v_mfma_f32_16x16x32_bf16 a[32:35], a[224:227], v[40:43], a[32:35]
    s_add_u32 m0, s39, 49152
    ds_read_b128 a[208:211], v206 offset:36864
    v_fma_f32 v163, v163, s45, v186
    v_fma_f32 v164, v164, s45, v186
    v_mfma_f32_16x16x32_bf16 a[4:7], a[228:231], v[32:35], a[4:7]
    buffer_load_dwordx4 v196, s[12:15], s43 offen nt lds
    v_mfma_f32_16x16x32_bf16 a[36:39], a[228:231], v[40:43], a[36:39]
    ds_read_b128 a[212:215], v207 offset:36864
    v_fma_f32 v165, v165, s45, v186
    v_mfma_f32_16x16x32_bf16 a[8:11], a[232:235], v[32:35], a[8:11]
    buffer_load_dwordx4 v197, s[12:15], s43 offen offset:1024 nt lds
    v_mfma_f32_16x16x32_bf16 a[40:43], a[232:235], v[40:43], a[40:43]
    ds_read_b128 a[216:219], v208 offset:36864
    v_fma_f32 v166, v166, s45, v186
    v_mfma_f32_16x16x32_bf16 a[12:15], a[236:239], v[32:35], a[12:15]
    buffer_load_dwordx4 v196, s[12:15], s43 offen offset:2048 nt lds
    v_mfma_f32_16x16x32_bf16 a[44:47], a[236:239], v[40:43], a[44:47]
    ds_read_b128 a[220:223], v209 offset:36864
    v_fma_f32 v167, v167, s45, v186
    v_mfma_f32_16x16x32_bf16 a[16:19], a[240:243], v[32:35], a[16:19]
    buffer_load_dwordx4 v197, s[12:15], s43 offen offset:3072 nt lds
    v_mfma_f32_16x16x32_bf16 a[48:51], a[240:243], v[40:43], a[48:51]
    s_add_u32 m0, s40, 98304
    v_exp_f32 v163, v163
    v_fma_f32 v168, v168, s45, v187
    v_mfma_f32_16x16x32_bf16 a[20:23], a[244:247], v[32:35], a[20:23]
    buffer_load_dwordx4 v202, s[16:19], s86 offen sc1 lds
    v_mfma_f32_16x16x32_bf16 a[52:55], a[244:247], v[40:43], a[52:55]
    s_waitcnt lgkmcnt(2)
    v_exp_f32 v164, v164
    v_cvt_pk_bf16_f32 v161, v162, v163
    v_mfma_f32_16x16x32_bf16 a[24:27], a[248:251], v[32:35], a[24:27]
    v_exp_f32 v165, v165
    v_mfma_f32_16x16x32_bf16 a[56:59], a[248:251], v[40:43], a[56:59]
    v_exp_f32 v166, v166
    v_mfma_f32_16x16x32_bf16 a[28:31], a[252:255], v[32:35], a[28:31]
    v_exp_f32 v167, v167
    v_cvt_pk_bf16_f32 v162, v164, v165
    v_mfma_f32_16x16x32_bf16 a[60:63], a[252:255], v[40:43], a[60:63]
    v_exp_f32 v168, v168
    v_mfma_f32_16x16x32_bf16 v[48:51], v[224:227], v[32:35], v[48:51]
    v_cvt_pk_bf16_f32 v163, v166, v167
    v_fma_f32 v169, v169, s45, v187
    v_fma_f32 v170, v170, s45, v187
    v_mfma_f32_16x16x32_bf16 v[52:55], v[224:227], v[40:43], v[52:55]
    v_exp_f32 v169, v169
    v_mfma_f32_16x16x32_bf16 v[32:35], a[192:195], v[0:3], 0
    buffer_load_dwordx4 v203, s[16:19], s86 offen offset:1024 sc1 lds
    v_mfma_f32_16x16x32_bf16 v[32:35], a[196:199], v[8:11], v[32:35]
    v_exp_f32 v170, v170
    v_cvt_pk_bf16_f32 v168, v168, v169
    v_mfma_f32_16x16x32_bf16 v[32:35], a[200:203], v[16:19], v[32:35]
    v_fma_f32 v171, v171, s45, v187
    v_fma_f32 v172, v172, s45, v187
    v_mfma_f32_16x16x32_bf16 v[32:35], a[204:207], v[24:27], v[32:35]
    v_exp_f32 v171, v171
    v_fma_f32 v173, v173, s45, v187
    v_mfma_f32_16x16x32_bf16 v[36:39], a[208:211], v[0:3], 0
    v_exp_f32 v172, v172
    v_mfma_f32_16x16x32_bf16 v[36:39], a[212:215], v[8:11], v[36:39]
    s_waitcnt lgkmcnt(0)
    v_exp_f32 v173, v173
    v_mfma_f32_16x16x32_bf16 v[36:39], a[216:219], v[16:19], v[36:39]
    v_cvt_pk_bf16_f32 v169, v170, v171
    v_cvt_pk_bf16_f32 v170, v172, v173
    v_fma_f32 v174, v174, s45, v187
    v_mfma_f32_16x16x32_bf16 v[36:39], a[220:223], v[24:27], v[36:39]
    v_exp_f32 v174, v174
    v_mfma_f32_16x16x32_bf16 v[40:43], a[192:195], v[4:7], 0
    v_fma_f32 v175, v175, s45, v187
    v_exp_f32 v175, v175
    v_mfma_f32_16x16x32_bf16 v[40:43], a[196:199], v[12:15], v[40:43]
    buffer_load_dwordx4 v204, s[16:19], s86 offen offset:2048 sc1 lds
    v_add_u32 v206, 0xfffec000, v206
    v_add_u32 v207, 0xfffec000, v207
    v_mfma_f32_16x16x32_bf16 v[40:43], a[200:203], v[20:23], v[40:43]
    v_cvt_pk_bf16_f32 v171, v174, v175
    v_fma_f32 v32, v32, s45, v58
    v_mfma_f32_16x16x32_bf16 v[40:43], a[204:207], v[28:31], v[40:43]
    v_exp_f32 v32, v32
    v_fma_f32 v33, v33, s45, v58
    v_mfma_f32_16x16x32_bf16 v[44:47], a[208:211], v[4:7], 0
    v_add_u32 v208, 0xfffec000, v208
    v_add_u32 v209, 0xfffec000, v209
    v_mfma_f32_16x16x32_bf16 v[44:47], a[212:215], v[12:15], v[44:47]
    v_exp_f32 v33, v33
    v_fma_f32 v34, v34, s45, v58
    v_mfma_f32_16x16x32_bf16 v[44:47], a[216:219], v[20:23], v[44:47]
    v_exp_f32 v34, v34
    v_mfma_f32_16x16x32_bf16 v[44:47], a[220:223], v[28:31], v[44:47]
    v_cvt_pk_bf16_f32 v32, v32, v33
    v_fma_f32 v35, v35, s45, v58
    v_mfma_f32_16x16x32_bf16 a[64:67], a[224:227], v[96:99], a[64:67]
    v_exp_f32 v35, v35
    v_fma_f32 v36, v36, s45, v58
    v_mfma_f32_16x16x32_bf16 a[96:99], a[224:227], v[104:107], a[96:99]
    v_exp_f32 v36, v36
    v_mfma_f32_16x16x32_bf16 a[68:71], a[228:231], v[96:99], a[68:71]
    v_cvt_pk_bf16_f32 v33, v34, v35
    v_fma_f32 v37, v37, s45, v58
    v_fma_f32 v38, v38, s45, v58
    v_mfma_f32_16x16x32_bf16 a[100:103], a[228:231], v[104:107], a[100:103]
    buffer_load_dwordx4 v205, s[16:19], s86 offen offset:3072 sc1 lds
    v_mfma_f32_16x16x32_bf16 a[72:75], a[232:235], v[96:99], a[72:75]
    v_exp_f32 v37, v37
    v_mfma_f32_16x16x32_bf16 a[104:107], a[232:235], v[104:107], a[104:107]
    v_exp_f32 v38, v38
    v_cvt_pk_bf16_f32 v34, v36, v37
    v_mfma_f32_16x16x32_bf16 a[76:79], a[236:239], v[96:99], a[76:79]
    v_fma_f32 v39, v39, s45, v58
    v_fma_f32 v40, v40, s45, v59
    v_mfma_f32_16x16x32_bf16 a[108:111], a[236:239], v[104:107], a[108:111]
    v_exp_f32 v39, v39
    v_fma_f32 v41, v41, s45, v59
    v_mfma_f32_16x16x32_bf16 a[80:83], a[240:243], v[96:99], a[80:83]
    v_exp_f32 v40, v40
    v_mfma_f32_16x16x32_bf16 a[112:115], a[240:243], v[104:107], a[112:115]
    v_exp_f32 v41, v41
    v_mfma_f32_16x16x32_bf16 a[84:87], a[244:247], v[96:99], a[84:87]
    v_cvt_pk_bf16_f32 v35, v38, v39
    v_cvt_pk_bf16_f32 v40, v40, v41
    v_fma_f32 v42, v42, s45, v59
    v_mfma_f32_16x16x32_bf16 a[116:119], a[244:247], v[104:107], a[116:119]
    s_add_u32 m0, s40, 102400
    v_exp_f32 v42, v42
    v_mfma_f32_16x16x32_bf16 a[88:91], a[248:251], v[96:99], a[88:91]
    buffer_load_dwordx4 v202, s[16:19], s87 offen sc1 lds
    v_mfma_f32_16x16x32_bf16 a[120:123], a[248:251], v[104:107], a[120:123]
    v_fma_f32 v43, v43, s45, v59
    v_fma_f32 v44, v44, s45, v59
    v_mfma_f32_16x16x32_bf16 a[92:95], a[252:255], v[96:99], a[92:95]
    v_exp_f32 v43, v43
    v_mfma_f32_16x16x32_bf16 a[124:127], a[252:255], v[104:107], a[124:127]
    v_exp_f32 v44, v44
    v_cvt_pk_bf16_f32 v41, v42, v43
    v_mfma_f32_16x16x32_bf16 v[112:115], v[224:227], v[96:99], v[112:115]
    v_fma_f32 v45, v45, s45, v59
    v_fma_f32 v46, v46, s45, v59
    v_mfma_f32_16x16x32_bf16 v[116:119], v[224:227], v[104:107], v[116:119]
    s_add_u32 s36, s36, 262144
    v_exp_f32 v45, v45
    v_fma_f32 v47, v47, s45, v59
    v_mfma_f32_16x16x32_bf16 v[96:99], a[192:195], v[64:67], 0
    s_add_u32 s54, s62, 0
    v_exp_f32 v46, v46
    v_mfma_f32_16x16x32_bf16 v[96:99], a[196:199], v[72:75], v[96:99]
    s_and_b32 s54, s54, 0x1ffff
    v_exp_f32 v47, v47
    v_mfma_f32_16x16x32_bf16 v[96:99], a[200:203], v[80:83], v[96:99]
    s_add_u32 s54, s54, s36
    v_cvt_pk_bf16_f32 v42, v44, v45
    v_cvt_pk_bf16_f32 v43, v46, v47
    v_mfma_f32_16x16x32_bf16 v[96:99], a[204:207], v[88:91], v[96:99]
    s_add_u32 m0, s39, 81920
    v_mfma_f32_16x16x32_bf16 v[100:103], a[208:211], v[64:67], 0
    buffer_load_dwordx4 v192, s[8:11], s54 offen nt lds
    v_mfma_f32_16x16x32_bf16 v[100:103], a[212:215], v[72:75], v[100:103]
    v_mfma_f32_16x16x32_bf16 v[100:103], a[216:219], v[80:83], v[100:103]
    buffer_load_dwordx4 v193, s[8:11], s54 offen offset:1024 nt lds
    v_mfma_f32_16x16x32_bf16 v[100:103], a[220:223], v[88:91], v[100:103]
    v_mfma_f32_16x16x32_bf16 v[104:107], a[192:195], v[68:71], 0
    buffer_load_dwordx4 v194, s[8:11], s54 offen offset:2048 nt lds
    v_mfma_f32_16x16x32_bf16 v[104:107], a[196:199], v[76:79], v[104:107]
    v_fma_f32 v96, v96, s45, v122
    v_exp_f32 v96, v96
    v_mfma_f32_16x16x32_bf16 v[104:107], a[200:203], v[84:87], v[104:107]
    buffer_load_dwordx4 v195, s[8:11], s54 offen offset:3072 nt lds
    v_mfma_f32_16x16x32_bf16 v[104:107], a[204:207], v[92:95], v[104:107]
    s_add_u32 m0, s40, 102400
    v_fma_f32 v97, v97, s45, v122
    v_fma_f32 v98, v98, s45, v122
    v_mfma_f32_16x16x32_bf16 v[108:111], a[208:211], v[68:71], 0
    buffer_load_dwordx4 v203, s[16:19], s87 offen offset:1024 sc1 lds
    v_mfma_f32_16x16x32_bf16 v[108:111], a[212:215], v[76:79], v[108:111]
    v_exp_f32 v97, v97
    v_mfma_f32_16x16x32_bf16 v[108:111], a[216:219], v[84:87], v[108:111]
    v_exp_f32 v98, v98
    v_cvt_pk_bf16_f32 v96, v96, v97
    v_mfma_f32_16x16x32_bf16 v[108:111], a[220:223], v[92:95], v[108:111]
    s_waitcnt vmcnt(18)
    s_barrier
    v_mfma_f32_16x16x32_bf16 a[128:131], a[224:227], v[160:163], a[128:131]
    v_fma_f32 v99, v99, s45, v122
    v_fma_f32 v100, v100, s45, v122
    v_mfma_f32_16x16x32_bf16 a[160:163], a[224:227], v[168:171], a[160:163]
    ds_read_b64_tr_b16 a[224:225], v210
    v_exp_f32 v99, v99
    v_mfma_f32_16x16x32_bf16 a[132:135], a[228:231], v[160:163], a[132:135]
    v_exp_f32 v100, v100
    v_mfma_f32_16x16x32_bf16 a[164:167], a[228:231], v[168:171], a[164:167]
    s_add_u32 m0, s40, 122880
    ds_read_b64_tr_b16 a[226:227], v210 offset:4096
    v_cvt_pk_bf16_f32 v97, v98, v99
    v_fma_f32 v101, v101, s45, v122
    v_mfma_f32_16x16x32_bf16 a[136:139], a[232:235], v[160:163], a[136:139]
    buffer_load_dwordx4 v202, s[16:19], s98 offen sc1 lds
    v_mfma_f32_16x16x32_bf16 a[168:171], a[232:235], v[168:171], a[168:171]
    ds_read_b64_tr_b16 a[228:229], v211
    v_fma_f32 v102, v102, s45, v122
    v_mfma_f32_16x16x32_bf16 a[140:143], a[236:239], v[160:163], a[140:143]
    v_exp_f32 v101, v101
    v_fma_f32 v103, v103, s45, v122
    v_mfma_f32_16x16x32_bf16 a[172:175], a[236:239], v[168:171], a[172:175]
    ds_read_b64_tr_b16 a[230:231], v211 offset:4096
    v_cvt_pk_bf16_f32 v98, v100, v101
    v_mfma_f32_16x16x32_bf16 a[144:147], a[240:243], v[160:163], a[144:147]
    v_exp_f32 v102, v102
    v_fma_f32 v104, v104, s45, v123
    v_mfma_f32_16x16x32_bf16 a[176:179], a[240:243], v[168:171], a[176:179]
    ds_read_b64_tr_b16 a[232:233], v212
    v_fma_f32 v105, v105, s45, v123
    v_mfma_f32_16x16x32_bf16 a[148:151], a[244:247], v[160:163], a[148:151]
    v_exp_f32 v103, v103
    v_mfma_f32_16x16x32_bf16 a[180:183], a[244:247], v[168:171], a[180:183]
    ds_read_b64_tr_b16 a[234:235], v212 offset:4096
    v_exp_f32 v104, v104
    v_mfma_f32_16x16x32_bf16 a[152:155], a[248:251], v[160:163], a[152:155]
    v_exp_f32 v105, v105
    v_mfma_f32_16x16x32_bf16 a[184:187], a[248:251], v[168:171], a[184:187]
    ds_read_b64_tr_b16 a[236:237], v213
    v_cvt_pk_bf16_f32 v99, v102, v103
    v_cvt_pk_bf16_f32 v104, v104, v105
    v_mfma_f32_16x16x32_bf16 a[156:159], a[252:255], v[160:163], a[156:159]
    v_fma_f32 v106, v106, s45, v123
    v_fma_f32 v107, v107, s45, v123
    v_mfma_f32_16x16x32_bf16 a[188:191], a[252:255], v[168:171], a[188:191]
    ds_read_b64_tr_b16 a[238:239], v213 offset:4096
    v_fma_f32 v108, v108, s45, v123
    v_mfma_f32_16x16x32_bf16 v[176:179], v[224:227], v[160:163], v[176:179]
    v_exp_f32 v106, v106
    v_fma_f32 v109, v109, s45, v123
    v_mfma_f32_16x16x32_bf16 v[180:183], v[224:227], v[168:171], v[180:183]
    ds_read_b64_tr_b16 a[240:241], v214
    v_fma_f32 v110, v110, s45, v123
    v_mfma_f32_16x16x32_bf16 v[160:163], a[192:195], v[128:131], 0
    v_exp_f32 v107, v107
    v_fma_f32 v111, v111, s45, v123
    v_mfma_f32_16x16x32_bf16 v[160:163], a[196:199], v[136:139], v[160:163]
    ds_read_b64_tr_b16 a[242:243], v214 offset:4096
    v_cvt_pk_bf16_f32 v105, v106, v107
    v_mfma_f32_16x16x32_bf16 v[160:163], a[200:203], v[144:147], v[160:163]
    buffer_load_dwordx4 v203, s[16:19], s98 offen offset:1024 sc1 lds
    v_mfma_f32_16x16x32_bf16 v[160:163], a[204:207], v[152:155], v[160:163]
    ds_read_b64_tr_b16 a[244:245], v215
    v_exp_f32 v108, v108
    v_mfma_f32_16x16x32_bf16 v[164:167], a[208:211], v[128:131], 0
    v_exp_f32 v109, v109
    v_mfma_f32_16x16x32_bf16 v[164:167], a[212:215], v[136:139], v[164:167]
    ds_read_b64_tr_b16 a[246:247], v215 offset:4096
    v_exp_f32 v110, v110
    v_mfma_f32_16x16x32_bf16 v[164:167], a[216:219], v[144:147], v[164:167]
    v_exp_f32 v111, v111
    v_mfma_f32_16x16x32_bf16 v[164:167], a[220:223], v[152:155], v[164:167]
    ds_read_b64_tr_b16 a[248:249], v216
    v_cvt_pk_bf16_f32 v106, v108, v109
    v_mfma_f32_16x16x32_bf16 v[168:171], a[192:195], v[132:135], 0
    ds_read_b128 a[192:195], v206
    v_cvt_pk_bf16_f32 v107, v110, v111
    v_mfma_f32_16x16x32_bf16 v[168:171], a[196:199], v[140:143], v[168:171]
    ds_read_b64_tr_b16 a[250:251], v216 offset:4096
    v_fma_f32 v160, v160, s45, v186
    v_mfma_f32_16x16x32_bf16 v[168:171], a[200:203], v[148:151], v[168:171]
    ds_read_b128 a[196:199], v207
    v_exp_f32 v160, v160
    v_mfma_f32_16x16x32_bf16 v[168:171], a[204:207], v[156:159], v[168:171]
    ds_read_b64_tr_b16 a[252:253], v217
    v_fma_f32 v161, v161, s45, v186
    v_mfma_f32_16x16x32_bf16 v[172:175], a[208:211], v[132:135], 0
    ds_read_b128 a[200:203], v208
    v_fma_f32 v162, v162, s45, v186
    v_mfma_f32_16x16x32_bf16 v[172:175], a[212:215], v[140:143], v[172:175]
    ds_read_b64_tr_b16 a[254:255], v217 offset:4096
    v_exp_f32 v161, v161
    v_mfma_f32_16x16x32_bf16 v[172:175], a[216:219], v[148:151], v[172:175]
    ds_read_b128 a[204:207], v209
    v_cvt_pk_bf16_f32 v160, v160, v161
    v_mfma_f32_16x16x32_bf16 v[172:175], a[220:223], v[156:159], v[172:175]
    s_waitcnt lgkmcnt(7)
    v_exp_f32 v162, v162
    v_fma_f32 v163, v163, s45, v186
    v_mfma_f32_16x16x32_bf16 a[0:3], a[224:227], v[32:35], a[0:3]
    v_exp_f32 v163, v163
    v_mfma_f32_16x16x32_bf16 a[32:35], a[224:227], v[40:43], a[32:35]
    ds_read_b128 a[208:211], v206 offset:4096
    v_cvt_pk_bf16_f32 v161, v162, v163
    v_mfma_f32_16x16x32_bf16 a[4:7], a[228:231], v[32:35], a[4:7]
    buffer_load_dwordx4 v204, s[16:19], s98 offen offset:2048 sc1 lds
    v_mfma_f32_16x16x32_bf16 a[36:39], a[228:231], v[40:43], a[36:39]
    ds_read_b128 a[212:215], v207 offset:4096
    v_fma_f32 v164, v164, s45, v186
    v_mfma_f32_16x16x32_bf16 a[8:11], a[232:235], v[32:35], a[8:11]
    s_add_u32 s54, s62, 0
    v_exp_f32 v164, v164
    v_fma_f32 v165, v165, s45, v186
    v_mfma_f32_16x16x32_bf16 a[40:43], a[232:235], v[40:43], a[40:43]
    s_and_b32 s54, s54, 0x1ffff
    ds_read_b128 a[216:219], v208 offset:4096
    v_fma_f32 v166, v166, s45, v186
    v_mfma_f32_16x16x32_bf16 a[12:15], a[236:239], v[32:35], a[12:15]
    s_add_u32 s54, s54, s36
    v_exp_f32 v165, v165
    v_mfma_f32_16x16x32_bf16 a[44:47], a[236:239], v[40:43], a[44:47]
    s_add_u32 m0, s39, 147456
    ds_read_b128 a[220:223], v209 offset:4096
    v_exp_f32 v166, v166
    v_mfma_f32_16x16x32_bf16 a[16:19], a[240:243], v[32:35], a[16:19]
    buffer_load_dwordx4 v196, s[12:15], s54 offen nt lds
    v_mfma_f32_16x16x32_bf16 a[48:51], a[240:243], v[40:43], a[48:51]
    v_cvt_pk_bf16_f32 v162, v164, v165
    v_fma_f32 v167, v167, s45, v186
    v_fma_f32 v168, v168, s45, v187
    v_mfma_f32_16x16x32_bf16 a[20:23], a[244:247], v[32:35], a[20:23]
    buffer_load_dwordx4 v197, s[12:15], s54 offen offset:1024 nt lds
    v_mfma_f32_16x16x32_bf16 a[52:55], a[244:247], v[40:43], a[52:55]
    s_waitcnt lgkmcnt(2)
    v_exp_f32 v167, v167
    v_mfma_f32_16x16x32_bf16 a[24:27], a[248:251], v[32:35], a[24:27]
    buffer_load_dwordx4 v196, s[12:15], s54 offen offset:2048 nt lds
    v_mfma_f32_16x16x32_bf16 a[56:59], a[248:251], v[40:43], a[56:59]
    v_exp_f32 v168, v168
    v_mfma_f32_16x16x32_bf16 a[28:31], a[252:255], v[32:35], a[28:31]
    buffer_load_dwordx4 v197, s[12:15], s54 offen offset:3072 nt lds
    v_mfma_f32_16x16x32_bf16 a[60:63], a[252:255], v[40:43], a[60:63]
    v_cvt_pk_bf16_f32 v163, v166, v167
    v_fma_f32 v169, v169, s45, v187
    v_mfma_f32_16x16x32_bf16 v[48:51], v[224:227], v[32:35], v[48:51]
    v_exp_f32 v169, v169
    v_mfma_f32_16x16x32_bf16 v[52:55], v[224:227], v[40:43], v[52:55]
    s_add_u32 m0, s40, 122880
    v_cvt_pk_bf16_f32 v168, v168, v169
    v_fma_f32 v170, v170, s45, v187
    v_fma_f32 v171, v171, s45, v187
    v_mfma_f32_16x16x32_bf16 v[32:35], a[192:195], v[0:3], 0
    buffer_load_dwordx4 v205, s[16:19], s98 offen offset:3072 sc1 lds
    v_mfma_f32_16x16x32_bf16 v[32:35], a[196:199], v[8:11], v[32:35]
    v_exp_f32 v170, v170
    v_fma_f32 v172, v172, s45, v187
    v_mfma_f32_16x16x32_bf16 v[32:35], a[200:203], v[16:19], v[32:35]
    v_exp_f32 v171, v171
    v_mfma_f32_16x16x32_bf16 v[32:35], a[204:207], v[24:27], v[32:35]
    v_exp_f32 v172, v172
    v_mfma_f32_16x16x32_bf16 v[36:39], a[208:211], v[0:3], 0
    v_cvt_pk_bf16_f32 v169, v170, v171
    v_fma_f32 v173, v173, s45, v187
    v_fma_f32 v174, v174, s45, v187
    v_mfma_f32_16x16x32_bf16 v[36:39], a[212:215], v[8:11], v[36:39]
    s_waitcnt lgkmcnt(0)
    v_exp_f32 v173, v173
    v_mfma_f32_16x16x32_bf16 v[36:39], a[216:219], v[16:19], v[36:39]
    v_exp_f32 v174, v174
    v_cvt_pk_bf16_f32 v170, v172, v173
    v_mfma_f32_16x16x32_bf16 v[36:39], a[220:223], v[24:27], v[36:39]
    v_fma_f32 v175, v175, s45, v187
    v_mfma_f32_16x16x32_bf16 v[40:43], a[192:195], v[4:7], 0
    v_exp_f32 v175, v175
    v_mfma_f32_16x16x32_bf16 v[40:43], a[196:199], v[12:15], v[40:43]
    v_cvt_pk_bf16_f32 v171, v174, v175
    v_fma_f32 v32, v32, s45, v58
    v_fma_f32 v33, v33, s45, v58
    v_mfma_f32_16x16x32_bf16 v[40:43], a[200:203], v[20:23], v[40:43]
    v_exp_f32 v32, v32
    v_mfma_f32_16x16x32_bf16 v[40:43], a[204:207], v[28:31], v[40:43]
    v_exp_f32 v33, v33
    v_fma_f32 v34, v34, s45, v58
    v_mfma_f32_16x16x32_bf16 v[44:47], a[208:211], v[4:7], 0
    v_exp_f32 v34, v34
    v_mfma_f32_16x16x32_bf16 v[44:47], a[212:215], v[12:15], v[44:47]
    v_cvt_pk_bf16_f32 v32, v32, v33
    v_fma_f32 v35, v35, s45, v58
    v_mfma_f32_16x16x32_bf16 v[44:47], a[216:219], v[20:23], v[44:47]
    v_exp_f32 v35, v35
    v_fma_f32 v36, v36, s45, v58
    v_mfma_f32_16x16x32_bf16 v[44:47], a[220:223], v[28:31], v[44:47]
    s_add_u32 m0, s40, 126976
    v_exp_f32 v36, v36
    v_mfma_f32_16x16x32_bf16 a[64:67], a[224:227], v[96:99], a[64:67]
    buffer_load_dwordx4 v202, s[16:19], s99 offen sc1 lds
    v_mfma_f32_16x16x32_bf16 a[96:99], a[224:227], v[104:107], a[96:99]
    v_cvt_pk_bf16_f32 v33, v34, v35
    v_fma_f32 v37, v37, s45, v58
    v_mfma_f32_16x16x32_bf16 a[68:71], a[228:231], v[96:99], a[68:71]
    v_exp_f32 v37, v37
    v_mfma_f32_16x16x32_bf16 a[100:103], a[228:231], v[104:107], a[100:103]
    v_cvt_pk_bf16_f32 v34, v36, v37
    v_fma_f32 v38, v38, s45, v58
    v_fma_f32 v39, v39, s45, v58
    v_mfma_f32_16x16x32_bf16 a[72:75], a[232:235], v[96:99], a[72:75]
    v_exp_f32 v38, v38
    v_mfma_f32_16x16x32_bf16 a[104:107], a[232:235], v[104:107], a[104:107]
    v_exp_f32 v39, v39
    v_fma_f32 v40, v40, s45, v59
    v_mfma_f32_16x16x32_bf16 a[76:79], a[236:239], v[96:99], a[76:79]
    v_exp_f32 v40, v40
    v_mfma_f32_16x16x32_bf16 a[108:111], a[236:239], v[104:107], a[108:111]
    v_cvt_pk_bf16_f32 v35, v38, v39
    v_fma_f32 v41, v41, s45, v59
    v_mfma_f32_16x16x32_bf16 a[80:83], a[240:243], v[96:99], a[80:83]
    v_exp_f32 v41, v41
    v_fma_f32 v42, v42, s45, v59
    v_mfma_f32_16x16x32_bf16 a[112:115], a[240:243], v[104:107], a[112:115]
    v_exp_f32 v42, v42
    v_mfma_f32_16x16x32_bf16 a[84:87], a[244:247], v[96:99], a[84:87]
    v_cvt_pk_bf16_f32 v40, v40, v41
    v_fma_f32 v43, v43, s45, v59
    v_fma_f32 v44, v44, s45, v59
    v_mfma_f32_16x16x32_bf16 a[116:119], a[244:247], v[104:107], a[116:119]
    v_exp_f32 v43, v43
    v_mfma_f32_16x16x32_bf16 a[88:91], a[248:251], v[96:99], a[88:91]
    v_exp_f32 v44, v44
    v_mfma_f32_16x16x32_bf16 a[120:123], a[248:251], v[104:107], a[120:123]
    v_cvt_pk_bf16_f32 v41, v42, v43
    v_fma_f32 v45, v45, s45, v59
    v_fma_f32 v46, v46, s45, v59
    v_mfma_f32_16x16x32_bf16 a[92:95], a[252:255], v[96:99], a[92:95]
    v_exp_f32 v45, v45
    v_mfma_f32_16x16x32_bf16 a[124:127], a[252:255], v[104:107], a[124:127]
    v_exp_f32 v46, v46
    v_cvt_pk_bf16_f32 v42, v44, v45
    v_mfma_f32_16x16x32_bf16 v[112:115], v[224:227], v[96:99], v[112:115]
    buffer_load_dwordx4 v203, s[16:19], s99 offen offset:1024 sc1 lds
    v_mfma_f32_16x16x32_bf16 v[116:119], v[224:227], v[104:107], v[116:119]
    v_fma_f32 v47, v47, s45, v59
    v_mfma_f32_16x16x32_bf16 v[96:99], a[192:195], v[64:67], 0
    v_exp_f32 v47, v47
    v_mfma_f32_16x16x32_bf16 v[96:99], a[196:199], v[72:75], v[96:99]
    v_cvt_pk_bf16_f32 v43, v46, v47
    v_mfma_f32_16x16x32_bf16 v[96:99], a[200:203], v[80:83], v[96:99]
    v_mfma_f32_16x16x32_bf16 v[96:99], a[204:207], v[88:91], v[96:99]
    v_mfma_f32_16x16x32_bf16 v[100:103], a[208:211], v[64:67], 0
    v_mfma_f32_16x16x32_bf16 v[100:103], a[212:215], v[72:75], v[100:103]
    v_mfma_f32_16x16x32_bf16 v[100:103], a[216:219], v[80:83], v[100:103]
    s_add_u32 s54, s62, 8192
    v_mfma_f32_16x16x32_bf16 v[100:103], a[220:223], v[88:91], v[100:103]
    s_and_b32 s54, s54, 0x1ffff
    v_mfma_f32_16x16x32_bf16 v[104:107], a[192:195], v[68:71], 0
    s_add_u32 s54, s54, s36
    v_mfma_f32_16x16x32_bf16 v[104:107], a[196:199], v[76:79], v[104:107]
    s_add_u32 m0, s39, 65536
    v_fma_f32 v96, v96, s45, v122
    v_fma_f32 v97, v97, s45, v122
    v_mfma_f32_16x16x32_bf16 v[104:107], a[200:203], v[84:87], v[104:107]
    buffer_load_dwordx4 v192, s[8:11], s54 offen nt lds
    v_mfma_f32_16x16x32_bf16 v[104:107], a[204:207], v[92:95], v[104:107]
    v_exp_f32 v96, v96
    v_mfma_f32_16x16x32_bf16 v[108:111], a[208:211], v[68:71], 0
    buffer_load_dwordx4 v193, s[8:11], s54 offen offset:1024 nt lds
    v_mfma_f32_16x16x32_bf16 v[108:111], a[212:215], v[76:79], v[108:111]
    v_exp_f32 v97, v97
    v_mfma_f32_16x16x32_bf16 v[108:111], a[216:219], v[84:87], v[108:111]
    buffer_load_dwordx4 v194, s[8:11], s54 offen offset:2048 nt lds
    v_mfma_f32_16x16x32_bf16 v[108:111], a[220:223], v[92:95], v[108:111]
    s_waitcnt vmcnt(23)
    s_barrier
    v_mfma_f32_16x16x32_bf16 a[128:131], a[224:227], v[160:163], a[128:131]
    v_cvt_pk_bf16_f32 v96, v96, v97
    v_fma_f32 v98, v98, s45, v122
    v_mfma_f32_16x16x32_bf16 a[160:163], a[224:227], v[168:171], a[160:163]
    ds_read_b64_tr_b16 a[224:225], v210 offset:16384
    v_exp_f32 v98, v98
    v_mfma_f32_16x16x32_bf16 a[132:135], a[228:231], v[160:163], a[132:135]
    buffer_load_dwordx4 v195, s[8:11], s54 offen offset:3072 nt lds
    v_mfma_f32_16x16x32_bf16 a[164:167], a[228:231], v[168:171], a[164:167]
    s_add_u32 m0, s39, 16384
    ds_read_b64_tr_b16 a[226:227], v210 offset:20480
    v_fma_f32 v99, v99, s45, v122
    v_mfma_f32_16x16x32_bf16 a[136:139], a[232:235], v[160:163], a[136:139]
    buffer_load_dwordx4 v198, s[20:23], s85 offen sc1 lds
    v_mfma_f32_16x16x32_bf16 a[168:171], a[232:235], v[168:171], a[168:171]
    ds_read_b64_tr_b16 a[228:229], v211 offset:16384
    v_fma_f32 v100, v100, s45, v122
    v_mfma_f32_16x16x32_bf16 a[140:143], a[236:239], v[160:163], a[140:143]
    v_exp_f32 v99, v99
    v_fma_f32 v101, v101, s45, v122
    v_mfma_f32_16x16x32_bf16 a[172:175], a[236:239], v[168:171], a[172:175]
    ds_read_b64_tr_b16 a[230:231], v211 offset:20480
    v_cvt_pk_bf16_f32 v97, v98, v99
    v_mfma_f32_16x16x32_bf16 a[144:147], a[240:243], v[160:163], a[144:147]
    v_exp_f32 v100, v100
    v_mfma_f32_16x16x32_bf16 a[176:179], a[240:243], v[168:171], a[176:179]
    ds_read_b64_tr_b16 a[232:233], v212 offset:16384
    v_exp_f32 v101, v101
    v_mfma_f32_16x16x32_bf16 a[148:151], a[244:247], v[160:163], a[148:151]
    buffer_load_dwordx4 v199, s[20:23], s85 offen offset:1024 sc1 lds
    v_mfma_f32_16x16x32_bf16 a[180:183], a[244:247], v[168:171], a[180:183]
    ds_read_b64_tr_b16 a[234:235], v212 offset:20480
    v_cvt_pk_bf16_f32 v98, v100, v101
    v_fma_f32 v102, v102, s45, v122
    v_mfma_f32_16x16x32_bf16 a[152:155], a[248:251], v[160:163], a[152:155]
    v_exp_f32 v102, v102
    v_mfma_f32_16x16x32_bf16 a[184:187], a[248:251], v[168:171], a[184:187]
    ds_read_b64_tr_b16 a[236:237], v213 offset:16384
    v_fma_f32 v103, v103, s45, v122
    v_mfma_f32_16x16x32_bf16 a[156:159], a[252:255], v[160:163], a[156:159]
    v_exp_f32 v103, v103
    v_fma_f32 v104, v104, s45, v123
    v_mfma_f32_16x16x32_bf16 a[188:191], a[252:255], v[168:171], a[188:191]
    ds_read_b64_tr_b16 a[238:239], v213 offset:20480
    v_cvt_pk_bf16_f32 v99, v102, v103
    v_mfma_f32_16x16x32_bf16 v[176:179], v[224:227], v[160:163], v[176:179]
    buffer_load_dwordx4 v200, s[20:23], s85 offen offset:2048 sc1 lds
    v_mfma_f32_16x16x32_bf16 v[180:183], v[224:227], v[168:171], v[180:183]
    ds_read_b64_tr_b16 a[240:241], v214 offset:16384
    v_fma_f32 v105, v105, s45, v123
    v_mfma_f32_16x16x32_bf16 v[160:163], a[192:195], v[128:131], 0
    v_exp_f32 v104, v104
    v_mfma_f32_16x16x32_bf16 v[160:163], a[196:199], v[136:139], v[160:163]
    ds_read_b64_tr_b16 a[242:243], v214 offset:20480
    v_exp_f32 v105, v105
    v_mfma_f32_16x16x32_bf16 v[160:163], a[200:203], v[144:147], v[160:163]
    v_cvt_pk_bf16_f32 v104, v104, v105
    v_fma_f32 v106, v106, s45, v123
    v_mfma_f32_16x16x32_bf16 v[160:163], a[204:207], v[152:155], v[160:163]
    ds_read_b64_tr_b16 a[244:245], v215 offset:16384
    v_exp_f32 v106, v106
    v_mfma_f32_16x16x32_bf16 v[164:167], a[208:211], v[128:131], 0
    buffer_load_dwordx4 v201, s[20:23], s85 offen offset:3072 sc1 lds
    v_mfma_f32_16x16x32_bf16 v[164:167], a[212:215], v[136:139], v[164:167]
    ds_read_b64_tr_b16 a[246:247], v215 offset:20480
    v_fma_f32 v107, v107, s45, v123
    v_mfma_f32_16x16x32_bf16 v[164:167], a[216:219], v[144:147], v[164:167]
    v_exp_f32 v107, v107
    v_fma_f32 v108, v108, s45, v123
    v_mfma_f32_16x16x32_bf16 v[164:167], a[220:223], v[152:155], v[164:167]
    ds_read_b64_tr_b16 a[248:249], v216 offset:16384
    v_cvt_pk_bf16_f32 v105, v106, v107
    v_mfma_f32_16x16x32_bf16 v[168:171], a[192:195], v[132:135], 0
    v_exp_f32 v108, v108
    v_fma_f32 v109, v109, s45, v123
    v_mfma_f32_16x16x32_bf16 v[168:171], a[196:199], v[140:143], v[168:171]
    s_add_u32 m0, s39, 32768
    ds_read_b64_tr_b16 a[250:251], v216 offset:20480
    v_fma_f32 v110, v110, s45, v123
    v_mfma_f32_16x16x32_bf16 v[168:171], a[200:203], v[148:151], v[168:171]
    buffer_load_dwordx4 v198, s[20:23], s100 offen sc1 lds
    v_mfma_f32_16x16x32_bf16 v[168:171], a[204:207], v[156:159], v[168:171]
    ds_read_b64_tr_b16 a[252:253], v217 offset:16384
    v_exp_f32 v109, v109
    v_mfma_f32_16x16x32_bf16 v[172:175], a[208:211], v[132:135], 0
    v_exp_f32 v110, v110
    v_mfma_f32_16x16x32_bf16 v[172:175], a[212:215], v[140:143], v[172:175]
    ds_read_b64_tr_b16 a[254:255], v217 offset:20480
    v_cvt_pk_bf16_f32 v106, v108, v109
    v_fma_f32 v111, v111, s45, v123
    v_mfma_f32_16x16x32_bf16 v[172:175], a[216:219], v[148:151], v[172:175]
    buffer_load_dwordx4 v199, s[20:23], s100 offen offset:1024 sc1 lds
    v_mfma_f32_16x16x32_bf16 v[172:175], a[220:223], v[156:159], v[172:175]
    v_exp_f32 v111, v111
    v_mfma_f32_16x16x32_bf16 v[48:51], v[224:227], v[32:35], v[48:51]
    v_add_u32 v210, 0x10000, v210
    v_add_u32 v211, 0x10000, v211
    v_cvt_pk_bf16_f32 v107, v110, v111
    v_mfma_f32_16x16x32_bf16 v[52:55], v[224:227], v[40:43], v[52:55]
    s_waitcnt lgkmcnt(2)
    v_add_u32 v212, 0x10000, v212
    v_add_u32 v213, 0x10000, v213
    v_mfma_f32_16x16x32_bf16 a[0:3], a[224:227], v[32:35], a[0:3]
    v_add_u32 v214, 0x10000, v214
    v_add_u32 v215, 0x10000, v215
    v_fma_f32 v160, v160, s45, v186
    v_mfma_f32_16x16x32_bf16 a[32:35], a[224:227], v[40:43], a[32:35]
    v_add_u32 v216, 0x10000, v216
    v_add_u32 v217, 0x10000, v217
    v_mfma_f32_16x16x32_bf16 a[4:7], a[228:231], v[32:35], a[4:7]
    buffer_load_dwordx4 v200, s[20:23], s100 offen offset:2048 sc1 lds
    v_mfma_f32_16x16x32_bf16 a[36:39], a[228:231], v[40:43], a[36:39]
    v_exp_f32 v160, v160
    v_fma_f32 v161, v161, s45, v186
    v_mfma_f32_16x16x32_bf16 a[8:11], a[232:235], v[32:35], a[8:11]
    v_exp_f32 v161, v161
    v_mfma_f32_16x16x32_bf16 a[40:43], a[232:235], v[40:43], a[40:43]
    v_cvt_pk_bf16_f32 v160, v160, v161
    v_fma_f32 v162, v162, s45, v186
    v_fma_f32 v163, v163, s45, v186
    v_mfma_f32_16x16x32_bf16 a[12:15], a[236:239], v[32:35], a[12:15]
    v_exp_f32 v162, v162
    v_mfma_f32_16x16x32_bf16 a[44:47], a[236:239], v[40:43], a[44:47]
    v_exp_f32 v163, v163
    v_mfma_f32_16x16x32_bf16 a[16:19], a[240:243], v[32:35], a[16:19]
    buffer_load_dwordx4 v201, s[20:23], s100 offen offset:3072 sc1 lds
    v_mfma_f32_16x16x32_bf16 a[48:51], a[240:243], v[40:43], a[48:51]
    v_cvt_pk_bf16_f32 v161, v162, v163
    v_fma_f32 v164, v164, s45, v186
    v_mfma_f32_16x16x32_bf16 a[20:23], a[244:247], v[32:35], a[20:23]
    v_exp_f32 v164, v164
    v_fma_f32 v165, v165, s45, v186
    v_mfma_f32_16x16x32_bf16 a[52:55], a[244:247], v[40:43], a[52:55]
    v_exp_f32 v165, v165
    v_mfma_f32_16x16x32_bf16 a[24:27], a[248:251], v[32:35], a[24:27]
    v_cvt_pk_bf16_f32 v162, v164, v165
    v_fma_f32 v166, v166, s45, v186
    v_mfma_f32_16x16x32_bf16 a[56:59], a[248:251], v[40:43], a[56:59]
    s_waitcnt lgkmcnt(0)
    v_exp_f32 v166, v166
    v_fma_f32 v167, v167, s45, v186
    v_mfma_f32_16x16x32_bf16 a[28:31], a[252:255], v[32:35], a[28:31]
    v_exp_f32 v167, v167
    v_mfma_f32_16x16x32_bf16 a[60:63], a[252:255], v[40:43], a[60:63]
    s_waitcnt vmcnt(22)
    s_barrier
    v_mfma_f32_16x16x32_bf16 v[112:115], v[224:227], v[96:99], v[112:115]
    v_cvt_pk_bf16_f32 v163, v166, v167
    v_fma_f32 v168, v168, s45, v187
    v_mfma_f32_16x16x32_bf16 v[116:119], v[224:227], v[104:107], v[116:119]
    ds_read_b64_tr_b16 a[192:193], v218
    v_fma_f32 v169, v169, s45, v187
    v_mfma_f32_16x16x32_bf16 a[64:67], a[224:227], v[96:99], a[64:67]
    v_exp_f32 v168, v168
    v_fma_f32 v170, v170, s45, v187
    v_mfma_f32_16x16x32_bf16 a[96:99], a[224:227], v[104:107], a[96:99]
    ds_read_b64_tr_b16 a[194:195], v218 offset:512
    v_fma_f32 v171, v171, s45, v187
    v_mfma_f32_16x16x32_bf16 a[68:71], a[228:231], v[96:99], a[68:71]
    v_exp_f32 v169, v169
    v_fma_f32 v172, v172, s45, v187
    v_mfma_f32_16x16x32_bf16 a[100:103], a[228:231], v[104:107], a[100:103]
    ds_read_b128 a[200:203], v220
    v_cvt_pk_bf16_f32 v168, v168, v169
    v_mfma_f32_16x16x32_bf16 a[72:75], a[232:235], v[96:99], a[72:75]
    v_exp_f32 v170, v170
    v_mfma_f32_16x16x32_bf16 a[104:107], a[232:235], v[104:107], a[104:107]
    ds_read_b64_tr_b16 a[196:197], v218 offset:4096
    v_exp_f32 v171, v171
    v_mfma_f32_16x16x32_bf16 a[76:79], a[236:239], v[96:99], a[76:79]
    v_exp_f32 v172, v172
    v_mfma_f32_16x16x32_bf16 a[108:111], a[236:239], v[104:107], a[108:111]
    ds_read_b64_tr_b16 a[198:199], v218 offset:4608
    v_cvt_pk_bf16_f32 v169, v170, v171
    v_fma_f32 v173, v173, s45, v187
    v_mfma_f32_16x16x32_bf16 a[80:83], a[240:243], v[96:99], a[80:83]
    v_exp_f32 v173, v173
    v_mfma_f32_16x16x32_bf16 a[112:115], a[240:243], v[104:107], a[112:115]
    ds_read_b128 a[204:207], v221
    v_cvt_pk_bf16_f32 v170, v172, v173
    v_mfma_f32_16x16x32_bf16 a[84:87], a[244:247], v[96:99], a[84:87]
    v_mov_b32 v49, v48
    v_mov_b32 v53, v52
    v_fma_f32 v174, v174, s45, v187
    v_mfma_f32_16x16x32_bf16 a[116:119], a[244:247], v[104:107], a[116:119]
    ds_read_b128 a[208:211], v220 offset:2048
    v_permlane32_swap_b32 v49, v48
    v_mfma_f32_16x16x32_bf16 a[88:91], a[248:251], v[96:99], a[88:91]
    v_permlane32_swap_b32 v53, v52
    v_add_f32 v48, v48, v49
    v_fma_f32 v175, v175, s45, v187
    v_mfma_f32_16x16x32_bf16 a[120:123], a[248:251], v[104:107], a[120:123]
    ds_read_b128 a[212:215], v221 offset:2048
    v_add_f32 v52, v52, v53
    v_mfma_f32_16x16x32_bf16 a[92:95], a[252:255], v[96:99], a[92:95]
    ds_read_b128 a[216:219], v220 offset:4096
    v_mov_b32 v49, v48
    v_mfma_f32_16x16x32_bf16 a[124:127], a[252:255], v[104:107], a[124:127]
    ds_read_b128 a[220:223], v221 offset:4096
    v_mov_b32 v53, v52
    v_exp_f32 v174, v174
    v_exp_f32 v175, v175
    s_nop 0
    v_cvt_pk_bf16_f32 v171, v174, v175
    v_mfma_f32_16x16x32_bf16 v[176:179], v[224:227], v[160:163], v[176:179]
    v_permlane16_swap_b32 v49, v48
    v_permlane16_swap_b32 v53, v52
    v_mfma_f32_16x16x32_bf16 v[180:183], v[224:227], v[168:171], v[180:183]
    v_add_f32 v48, v48, v49
    v_add_f32 v52, v52, v53
    v_mfma_f32_16x16x32_bf16 a[128:131], a[224:227], v[160:163], a[128:131]
    v_mov_b32 v113, v112
    v_mov_b32 v117, v116
    v_mfma_f32_16x16x32_bf16 a[160:163], a[224:227], v[168:171], a[160:163]
    ds_read_b128 a[224:227], v220 offset:6144
    v_permlane32_swap_b32 v113, v112
    v_mfma_f32_16x16x32_bf16 a[132:135], a[228:231], v[160:163], a[132:135]
    v_permlane32_swap_b32 v117, v116
    v_add_f32 v112, v112, v113
    v_mfma_f32_16x16x32_bf16 a[164:167], a[228:231], v[168:171], a[164:167]
    ds_read_b128 a[228:231], v221 offset:6144
    v_add_f32 v116, v116, v117
    v_mfma_f32_16x16x32_bf16 a[136:139], a[232:235], v[160:163], a[136:139]
    v_mov_b32 v113, v112
    v_mov_b32 v117, v116
    v_mfma_f32_16x16x32_bf16 a[168:171], a[232:235], v[168:171], a[168:171]
    ds_read_b128 a[232:235], v220 offset:8192
    v_permlane16_swap_b32 v113, v112
    v_mfma_f32_16x16x32_bf16 a[140:143], a[236:239], v[160:163], a[140:143]
    v_permlane16_swap_b32 v117, v116
    v_add_f32 v112, v112, v113
    v_mfma_f32_16x16x32_bf16 a[172:175], a[236:239], v[168:171], a[172:175]
    ds_read_b128 a[236:239], v221 offset:8192
    v_add_f32 v116, v116, v117
    v_mfma_f32_16x16x32_bf16 a[144:147], a[240:243], v[160:163], a[144:147]
    v_mov_b32 v177, v176
    v_mov_b32 v181, v180
    v_mfma_f32_16x16x32_bf16 a[176:179], a[240:243], v[168:171], a[176:179]
    ds_read_b128 a[240:243], v220 offset:10240
    v_permlane32_swap_b32 v177, v176
    v_mfma_f32_16x16x32_bf16 a[148:151], a[244:247], v[160:163], a[148:151]
    v_permlane32_swap_b32 v181, v180
    v_add_f32 v176, v176, v177
    v_mfma_f32_16x16x32_bf16 a[180:183], a[244:247], v[168:171], a[180:183]
    ds_read_b128 a[244:247], v221 offset:10240
    v_add_f32 v180, v180, v181
    v_mfma_f32_16x16x32_bf16 a[152:155], a[248:251], v[160:163], a[152:155]
    v_mov_b32 v177, v176
    v_mov_b32 v181, v180
    v_mfma_f32_16x16x32_bf16 a[184:187], a[248:251], v[168:171], a[184:187]
    v_permlane16_swap_b32 v177, v176
    v_permlane16_swap_b32 v181, v180
    v_mfma_f32_16x16x32_bf16 a[156:159], a[252:255], v[160:163], a[156:159]
    v_add_f32 v176, v176, v177
    v_add_f32 v180, v180, v181
    v_mfma_f32_16x16x32_bf16 a[188:191], a[252:255], v[168:171], a[188:191]
    v_add_f32 v252, v48, v52
    v_add_f32 v253, v112, v116
    v_add_f32 v252, v252, v176
    v_add_f32 v253, v253, v180
    v_add_f32 v252, v252, v253
    v_cmp_ngt_f32 vcc, s51, v252
    s_nop 3
    s_cbranch_vccnz L_slow
L_back1:
    v_rcp_f32 v244, v48
    v_rcp_f32 v245, v52
    v_rcp_f32 v246, v112
    v_rcp_f32 v247, v116
    v_rcp_f32 v248, v176
    v_rcp_f32 v249, v180
    s_mov_b32 s42, 1
L_q2:
    s_waitcnt lgkmcnt(0)
    v_mfma_f32_16x16x32_bf16 v[0:3], a[192:195], a[200:203], 0
    v_accvgpr_read_b32 v228, a0
    v_accvgpr_read_b32 v229, a1
    v_mfma_f32_16x16x32_bf16 v[0:3], a[196:199], a[204:207], v[0:3]
    v_accvgpr_read_b32 v230, a2
    v_accvgpr_read_b32 v231, a3
    v_mfma_f32_16x16x32_bf16 v[8:11], a[192:195], a[208:211], 0
    v_accvgpr_read_b32 v232, a4
    v_accvgpr_read_b32 v233, a5
    v_mfma_f32_16x16x32_bf16 v[8:11], a[196:199], a[212:215], v[8:11]
    v_accvgpr_read_b32 v234, a6
    v_accvgpr_read_b32 v235, a7
    v_mfma_f32_16x16x32_bf16 v[64:67], a[192:195], a[216:219], 0
    ds_read_b64_tr_b16 a[248:249], v218 offset:8
    v_mul_f32 v228, v244, v228
    v_mfma_f32_16x16x32_bf16 v[64:67], a[196:199], a[220:223], v[64:67]
    ds_read_b64_tr_b16 a[250:251], v218 offset:520
    v_mul_f32 v229, v244, v229
    v_mfma_f32_16x16x32_bf16 v[72:75], a[192:195], a[224:227], 0
    ds_read_b64_tr_b16 a[252:253], v218 offset:4104
    v_mul_f32 v230, v244, v230
    v_mfma_f32_16x16x32_bf16 v[72:75], a[196:199], a[228:231], v[72:75]
    ds_read_b64_tr_b16 a[254:255], v218 offset:4616
    v_mul_f32 v231, v244, v231
    v_mfma_f32_16x16x32_bf16 v[128:131], a[192:195], a[232:235], 0
    s_add_u32 m0, s39, 49152
    v_mul_f32 v232, v244, v232
    v_mfma_f32_16x16x32_bf16 v[128:131], a[196:199], a[236:239], v[128:131]
    buffer_load_dwordx4 v198, s[20:23], s63 offen lds
    v_mfma_f32_16x16x32_bf16 v[136:139], a[192:195], a[240:243], 0
    v_mul_f32 v233, v244, v233
    v_mul_f32 v234, v244, v234
    v_mfma_f32_16x16x32_bf16 v[136:139], a[196:199], a[244:247], v[136:139]
    s_waitcnt lgkmcnt(2)
    v_mul_f32 v235, v244, v235
    v_cvt_pk_bf16_f32 v228, v228, v229
    v_mfma_f32_16x16x32_bf16 v[4:7], a[248:251], a[200:203], 0
    s_waitcnt lgkmcnt(0)
    ds_read_b64_tr_b16 a[192:193], v219
    v_cvt_pk_bf16_f32 v229, v230, v231
    v_mfma_f32_16x16x32_bf16 v[4:7], a[252:255], a[204:207], v[4:7]
    buffer_load_dwordx4 v199, s[20:23], s63 offen offset:1024 lds
    v_mfma_f32_16x16x32_bf16 v[12:15], a[248:251], a[208:211], 0
    ds_read_b64_tr_b16 a[194:195], v219 offset:512
    v_cvt_pk_bf16_f32 v230, v232, v233
    v_mfma_f32_16x16x32_bf16 v[12:15], a[252:255], a[212:215], v[12:15]
    ds_read_b64_tr_b16 a[196:197], v219 offset:4096
    v_cvt_pk_bf16_f32 v231, v234, v235
    v_mfma_f32_16x16x32_bf16 v[68:71], a[248:251], a[216:219], 0
    ds_read_b64_tr_b16 a[198:199], v219 offset:4608
    v_accvgpr_read_b32 v232, a8
    v_mfma_f32_16x16x32_bf16 v[68:71], a[252:255], a[220:223], v[68:71]
    buffer_load_dwordx4 v200, s[20:23], s63 offen offset:2048 lds
    v_mfma_f32_16x16x32_bf16 v[76:79], a[248:251], a[224:227], 0
    v_accvgpr_read_b32 v233, a9
    v_accvgpr_read_b32 v234, a10
    v_mfma_f32_16x16x32_bf16 v[76:79], a[252:255], a[228:231], v[76:79]
    v_accvgpr_read_b32 v235, a11
    v_accvgpr_read_b32 v236, a12
    v_mfma_f32_16x16x32_bf16 v[132:135], a[248:251], a[232:235], 0
    v_accvgpr_read_b32 v237, a13
    v_accvgpr_read_b32 v238, a14
    v_mfma_f32_16x16x32_bf16 v[132:135], a[252:255], a[236:239], v[132:135]
    buffer_load_dwordx4 v201, s[20:23], s63 offen offset:3072 lds
    v_mfma_f32_16x16x32_bf16 v[140:143], a[248:251], a[240:243], 0
    v_accvgpr_read_b32 v239, a15
    v_mul_f32 v232, v244, v232
    v_mfma_f32_16x16x32_bf16 v[140:143], a[252:255], a[244:247], v[140:143]
    s_waitcnt lgkmcnt(1)
    v_mul_f32 v233, v244, v233
    v_mul_f32 v234, v244, v234
    v_mfma_f32_16x16x32_bf16 v[16:19], a[192:195], a[200:203], 0
    s_waitcnt lgkmcnt(0)
    ds_read_b64_tr_b16 a[248:249], v219 offset:8
    v_mul_f32 v235, v244, v235
    v_mfma_f32_16x16x32_bf16 v[16:19], a[196:199], a[204:207], v[16:19]
    v_mul_f32 v236, v244, v236
    v_mul_f32 v237, v244, v237
    v_mfma_f32_16x16x32_bf16 v[24:27], a[192:195], a[208:211], 0
    s_bfe_u32 s95, s50, 0x40000
    ds_read_b64_tr_b16 a[250:251], v219 offset:520
    v_mul_f32 v238, v244, v238
    v_mfma_f32_16x16x32_bf16 v[24:27], a[196:199], a[212:215], v[24:27]
    s_lshl_b32 s67, s95, 19
    ds_read_b64_tr_b16 a[252:253], v219 offset:4104
    v_mul_f32 v239, v244, v239
    v_mfma_f32_16x16x32_bf16 v[80:83], a[192:195], a[216:219], 0
    s_add_u32 s67, s67, s37
    ds_read_b64_tr_b16 a[254:255], v219 offset:4616
    v_cvt_pk_bf16_f32 v232, v232, v233
    v_mfma_f32_16x16x32_bf16 v[80:83], a[196:199], a[220:223], v[80:83]
    s_lshl_b32 s95, s95, 7
    v_cvt_pk_bf16_f32 v233, v234, v235
    v_cvt_pk_bf16_f32 v234, v236, v237
    v_mfma_f32_16x16x32_bf16 v[88:91], a[192:195], a[224:227], 0
    s_add_u32 s95, s95, s38
    v_cvt_pk_bf16_f32 v235, v238, v239
    v_accvgpr_read_b32 v236, a32
    v_mfma_f32_16x16x32_bf16 v[88:91], a[196:199], a[228:231], v[88:91]
    s_add_u32 s63, s67, 128
    v_accvgpr_read_b32 v237, a33
    v_accvgpr_read_b32 v238, a34
    v_mfma_f32_16x16x32_bf16 v[144:147], a[192:195], a[232:235], 0
    v_accvgpr_read_b32 v239, a35
    v_accvgpr_read_b32 v240, a36
    v_mfma_f32_16x16x32_bf16 v[144:147], a[196:199], a[236:239], v[144:147]
    v_accvgpr_read_b32 v241, a37
    v_accvgpr_read_b32 v242, a38
    v_mfma_f32_16x16x32_bf16 v[152:155], a[192:195], a[240:243], 0
    v_accvgpr_read_b32 v243, a39
    v_mul_f32 v236, v245, v236
    v_mfma_f32_16x16x32_bf16 v[152:155], a[196:199], a[244:247], v[152:155]
    s_waitcnt lgkmcnt(1)
    s_waitcnt vmcnt(8) lgkmcnt(0)
    s_barrier
    v_mfma_f32_16x16x32_bf16 v[20:23], a[248:251], a[200:203], 0
    s_add_u32 m0, s39, 0
    ds_read_b64_tr_b16 a[192:193], v218 offset:16384
    v_mul_f32 v237, v245, v237
    v_mfma_f32_16x16x32_bf16 v[20:23], a[252:255], a[204:207], v[20:23]
    buffer_load_dwordx4 v198, s[20:23], s67 offen lds
    v_mfma_f32_16x16x32_bf16 v[28:31], a[248:251], a[208:211], 0
    ds_read_b64_tr_b16 a[194:195], v218 offset:16896
    v_mul_f32 v238, v245, v238
    v_mfma_f32_16x16x32_bf16 v[28:31], a[252:255], a[212:215], v[28:31]
    ds_read_b64_tr_b16 a[196:197], v218 offset:20480
    v_mul_f32 v239, v245, v239
    v_mfma_f32_16x16x32_bf16 v[84:87], a[248:251], a[216:219], 0
    ds_read_b64_tr_b16 a[198:199], v218 offset:20992
    v_mul_f32 v240, v245, v240
    v_mfma_f32_16x16x32_bf16 v[84:87], a[252:255], a[220:223], v[84:87]
    buffer_load_dwordx4 v199, s[20:23], s67 offen offset:1024 lds
    v_mfma_f32_16x16x32_bf16 v[92:95], a[248:251], a[224:227], 0
    v_mul_f32 v241, v245, v241
    v_mul_f32 v242, v245, v242
    v_mfma_f32_16x16x32_bf16 v[92:95], a[252:255], a[228:231], v[92:95]
    v_mul_f32 v243, v245, v243
    v_cvt_pk_bf16_f32 v236, v236, v237
    v_mfma_f32_16x16x32_bf16 v[148:151], a[248:251], a[232:235], 0
    v_cvt_pk_bf16_f32 v237, v238, v239
    v_cvt_pk_bf16_f32 v238, v240, v241
    v_mfma_f32_16x16x32_bf16 v[148:151], a[252:255], a[236:239], v[148:151]
    buffer_load_dwordx4 v200, s[20:23], s67 offen offset:2048 lds
    v_mfma_f32_16x16x32_bf16 v[156:159], a[248:251], a[240:243], 0
    v_cvt_pk_bf16_f32 v239, v242, v243
    v_mfma_f32_16x16x32_bf16 v[156:159], a[252:255], a[244:247], v[156:159]
    s_waitcnt lgkmcnt(1)
    v_mfma_f32_16x16x32_bf16 v[32:35], a[192:195], a[200:203], 0
    s_waitcnt lgkmcnt(0)
    ds_read_b64_tr_b16 a[248:249], v218 offset:16392
    v_mfma_f32_16x16x32_bf16 v[32:35], a[196:199], a[204:207], v[32:35]
    buffer_load_dwordx4 v201, s[20:23], s67 offen offset:3072 lds
    v_mfma_f32_16x16x32_bf16 v[40:43], a[192:195], a[208:211], 0
    ds_read_b64_tr_b16 a[250:251], v218 offset:16904
    v_mfma_f32_16x16x32_bf16 v[40:43], a[196:199], a[212:215], v[40:43]
    ds_read_b64_tr_b16 a[252:253], v218 offset:20488
    v_mfma_f32_16x16x32_bf16 v[96:99], a[192:195], a[216:219], 0
    s_add_u32 m0, s40, 98304
    ds_read_b64_tr_b16 a[254:255], v218 offset:21000
    v_mfma_f32_16x16x32_bf16 v[96:99], a[196:199], a[220:223], v[96:99]
    buffer_load_dwordx4 v202, s[16:19], s95 offen lds
    v_mfma_f32_16x16x32_bf16 v[104:107], a[192:195], a[224:227], 0
    v_mfma_f32_16x16x32_bf16 v[104:107], a[196:199], a[228:231], v[104:107]
    v_mfma_f32_16x16x32_bf16 v[160:163], a[192:195], a[232:235], 0
    v_mfma_f32_16x16x32_bf16 v[160:163], a[196:199], a[236:239], v[160:163]
    buffer_load_dwordx4 v203, s[16:19], s95 offen offset:1024 lds
    v_mfma_f32_16x16x32_bf16 v[168:171], a[192:195], a[240:243], 0
    v_mfma_f32_16x16x32_bf16 v[168:171], a[196:199], a[244:247], v[168:171]
    s_waitcnt lgkmcnt(1)
    v_mfma_f32_16x16x32_bf16 v[36:39], a[248:251], a[200:203], 0
    s_waitcnt lgkmcnt(0)
    ds_read_b64_tr_b16 a[192:193], v219 offset:16384
    v_mfma_f32_16x16x32_bf16 v[36:39], a[252:255], a[204:207], v[36:39]
    buffer_load_dwordx4 v204, s[16:19], s95 offen offset:2048 lds
    v_mfma_f32_16x16x32_bf16 v[44:47], a[248:251], a[208:211], 0
    ds_read_b64_tr_b16 a[194:195], v219 offset:16896
    v_mfma_f32_16x16x32_bf16 v[44:47], a[252:255], a[212:215], v[44:47]
    ds_read_b64_tr_b16 a[196:197], v219 offset:20480
    v_mfma_f32_16x16x32_bf16 v[100:103], a[248:251], a[216:219], 0
    ds_read_b64_tr_b16 a[198:199], v219 offset:20992
    v_mfma_f32_16x16x32_bf16 v[100:103], a[252:255], a[220:223], v[100:103]
    buffer_load_dwordx4 v205, s[16:19], s95 offen offset:3072 lds
    v_mfma_f32_16x16x32_bf16 v[108:111], a[248:251], a[224:227], 0
    v_mfma_f32_16x16x32_bf16 v[108:111], a[252:255], a[228:231], v[108:111]
    s_add_u32 s44, s95, 40960
    s_add_u32 s54, s41, 0
    v_mfma_f32_16x16x32_bf16 v[164:167], a[248:251], a[232:235], 0
    s_add_u32 m0, s40, 102400
    buffer_store_dwordx4 v[228:231], v223, s[24:27], s54 offen sc1
    v_mfma_f32_16x16x32_bf16 v[164:167], a[252:255], a[236:239], v[164:167]
    buffer_load_dwordx4 v202, s[16:19], s44 offen lds
    v_mfma_f32_16x16x32_bf16 v[172:175], a[248:251], a[240:243], 0
    buffer_store_dwordx4 v[232:235], v223, s[24:27], s54 offen offset:1024 sc1
    v_mfma_f32_16x16x32_bf16 v[172:175], a[252:255], a[244:247], v[172:175]
    s_waitcnt lgkmcnt(1)
    buffer_store_dwordx4 v[236:239], v223, s[24:27], s54 offen offset:2048 sc1
    v_mfma_f32_16x16x32_bf16 v[48:51], a[192:195], a[200:203], 0
    s_waitcnt lgkmcnt(0)
    ds_read_b64_tr_b16 a[248:249], v219 offset:16392
    v_mfma_f32_16x16x32_bf16 v[48:51], a[196:199], a[204:207], v[48:51]
    buffer_load_dwordx4 v203, s[16:19], s44 offen offset:1024 lds
    v_mfma_f32_16x16x32_bf16 v[56:59], a[192:195], a[208:211], 0
    ds_read_b64_tr_b16 a[250:251], v219 offset:16904
    v_mfma_f32_16x16x32_bf16 v[56:59], a[196:199], a[212:215], v[56:59]
    ds_read_b64_tr_b16 a[252:253], v219 offset:20488
    v_mfma_f32_16x16x32_bf16 v[112:115], a[192:195], a[216:219], 0
    ds_read_b64_tr_b16 a[254:255], v219 offset:21000
    v_mfma_f32_16x16x32_bf16 v[112:115], a[196:199], a[220:223], v[112:115]
    v_mfma_f32_16x16x32_bf16 v[120:123], a[192:195], a[224:227], 0
    v_mfma_f32_16x16x32_bf16 v[120:123], a[196:199], a[228:231], v[120:123]
    v_mfma_f32_16x16x32_bf16 v[176:179], a[192:195], a[232:235], 0
    v_mfma_f32_16x16x32_bf16 v[176:179], a[196:199], a[236:239], v[176:179]
    v_mfma_f32_16x16x32_bf16 v[184:187], a[192:195], a[240:243], 0
    v_mfma_f32_16x16x32_bf16 v[184:187], a[196:199], a[244:247], v[184:187]
    s_waitcnt lgkmcnt(1)
    s_waitcnt vmcnt(17) lgkmcnt(0)
    s_barrier
    v_mfma_f32_16x16x32_bf16 v[52:55], a[248:251], a[200:203], 0
    ds_read_b64_tr_b16 a[192:193], v218 offset:32768
    v_mfma_f32_16x16x32_bf16 v[52:55], a[252:255], a[204:207], v[52:55]
    ds_read_b64_tr_b16 a[194:195], v218 offset:33280
    v_mfma_f32_16x16x32_bf16 v[60:63], a[248:251], a[208:211], 0
    ds_read_b128 a[200:203], v220 offset:24576
    v_mfma_f32_16x16x32_bf16 v[60:63], a[252:255], a[212:215], v[60:63]
    ds_read_b64_tr_b16 a[196:197], v218 offset:36864
    v_mfma_f32_16x16x32_bf16 v[116:119], a[248:251], a[216:219], 0
    ds_read_b64_tr_b16 a[198:199], v218 offset:37376
    v_mfma_f32_16x16x32_bf16 v[116:119], a[252:255], a[220:223], v[116:119]
    ds_read_b128 a[204:207], v221 offset:24576
    v_mfma_f32_16x16x32_bf16 v[124:127], a[248:251], a[224:227], 0
    ds_read_b128 a[208:211], v220 offset:26624
    v_mfma_f32_16x16x32_bf16 v[124:127], a[252:255], a[228:231], v[124:127]
    ds_read_b128 a[212:215], v221 offset:26624
    v_mfma_f32_16x16x32_bf16 v[180:183], a[248:251], a[232:235], 0
    ds_read_b128 a[216:219], v220 offset:28672
    v_mfma_f32_16x16x32_bf16 v[180:183], a[252:255], a[236:239], v[180:183]
    ds_read_b128 a[220:223], v221 offset:28672
    v_mfma_f32_16x16x32_bf16 v[188:191], a[248:251], a[240:243], 0
    ds_read_b128 a[224:227], v220 offset:30720
    v_mfma_f32_16x16x32_bf16 v[188:191], a[252:255], a[244:247], v[188:191]
    s_waitcnt lgkmcnt(7)
    ds_read_b128 a[228:231], v221 offset:30720
    v_mfma_f32_16x16x32_bf16 v[0:3], a[192:195], a[200:203], v[0:3]
    s_waitcnt lgkmcnt(6)
    ds_read_b128 a[232:235], v220 offset:32768
    v_accvgpr_read_b32 v228, a40
    v_mfma_f32_16x16x32_bf16 v[0:3], a[196:199], a[204:207], v[0:3]
    s_waitcnt lgkmcnt(6)
    ds_read_b128 a[236:239], v221 offset:32768
    v_accvgpr_read_b32 v229, a41
    v_mfma_f32_16x16x32_bf16 v[8:11], a[192:195], a[208:211], v[8:11]
    s_waitcnt lgkmcnt(6)
    ds_read_b128 a[240:243], v220 offset:34816
    v_accvgpr_read_b32 v230, a42
    v_mfma_f32_16x16x32_bf16 v[8:11], a[196:199], a[212:215], v[8:11]
    s_waitcnt lgkmcnt(6)
    ds_read_b128 a[244:247], v221 offset:34816
    v_accvgpr_read_b32 v231, a43
    v_mfma_f32_16x16x32_bf16 v[64:67], a[192:195], a[216:219], v[64:67]
    s_waitcnt lgkmcnt(6)
    ds_read_b64_tr_b16 a[248:249], v218 offset:32776
    v_accvgpr_read_b32 v232, a44
    v_mfma_f32_16x16x32_bf16 v[64:67], a[196:199], a[220:223], v[64:67]
    s_waitcnt lgkmcnt(6)
    ds_read_b64_tr_b16 a[250:251], v218 offset:33288
    v_accvgpr_read_b32 v233, a45
    v_mfma_f32_16x16x32_bf16 v[72:75], a[192:195], a[224:227], v[72:75]
    s_waitcnt lgkmcnt(6)
    ds_read_b64_tr_b16 a[252:253], v218 offset:36872
    v_accvgpr_read_b32 v234, a46
    v_mfma_f32_16x16x32_bf16 v[72:75], a[196:199], a[228:231], v[72:75]
    s_waitcnt lgkmcnt(6)
    ds_read_b64_tr_b16 a[254:255], v218 offset:37384
    v_accvgpr_read_b32 v235, a47
    v_mfma_f32_16x16x32_bf16 v[128:131], a[192:195], a[232:235], v[128:131]
    s_waitcnt lgkmcnt(6)
    s_add_u32 m0, s39, 16384
    v_mul_f32 v228, v245, v228
    v_mfma_f32_16x16x32_bf16 v[128:131], a[196:199], a[236:239], v[128:131]
    s_waitcnt lgkmcnt(5)
    buffer_load_dwordx4 v198, s[20:23], s63 offen lds
    v_mfma_f32_16x16x32_bf16 v[136:139], a[192:195], a[240:243], v[136:139]
    s_waitcnt lgkmcnt(4)
    v_mul_f32 v229, v245, v229
    v_mul_f32 v230, v245, v230
    v_mfma_f32_16x16x32_bf16 v[136:139], a[196:199], a[244:247], v[136:139]
    s_waitcnt lgkmcnt(2)
    v_mul_f32 v231, v245, v231
    v_mul_f32 v232, v245, v232
    v_mfma_f32_16x16x32_bf16 v[4:7], a[248:251], a[200:203], v[4:7]
    s_waitcnt lgkmcnt(0)
    ds_read_b64_tr_b16 a[192:193], v219 offset:32768
    v_mul_f32 v233, v245, v233
    v_mfma_f32_16x16x32_bf16 v[4:7], a[252:255], a[204:207], v[4:7]
    buffer_load_dwordx4 v199, s[20:23], s63 offen offset:1024 lds
    v_mfma_f32_16x16x32_bf16 v[12:15], a[248:251], a[208:211], v[12:15]
    ds_read_b64_tr_b16 a[194:195], v219 offset:33280
    v_mul_f32 v234, v245, v234
    v_mfma_f32_16x16x32_bf16 v[12:15], a[252:255], a[212:215], v[12:15]
    ds_read_b64_tr_b16 a[196:197], v219 offset:36864
    v_mul_f32 v235, v245, v235
    v_mfma_f32_16x16x32_bf16 v[68:71], a[248:251], a[216:219], v[68:71]
    ds_read_b64_tr_b16 a[198:199], v219 offset:37376
    v_cvt_pk_bf16_f32 v228, v228, v229
    v_mfma_f32_16x16x32_bf16 v[68:71], a[252:255], a[220:223], v[68:71]
    buffer_load_dwordx4 v200, s[20:23], s63 offen offset:2048 lds
    v_mfma_f32_16x16x32_bf16 v[76:79], a[248:251], a[224:227], v[76:79]
    v_cvt_pk_bf16_f32 v229, v230, v231
    v_cvt_pk_bf16_f32 v230, v232, v233
    v_mfma_f32_16x16x32_bf16 v[76:79], a[252:255], a[228:231], v[76:79]
    v_cvt_pk_bf16_f32 v231, v234, v235
    v_accvgpr_read_b32 v232, a16
    v_mfma_f32_16x16x32_bf16 v[132:135], a[248:251], a[232:235], v[132:135]
    v_accvgpr_read_b32 v233, a17
    v_accvgpr_read_b32 v234, a18
    v_mfma_f32_16x16x32_bf16 v[132:135], a[252:255], a[236:239], v[132:135]
    buffer_load_dwordx4 v201, s[20:23], s63 offen offset:3072 lds
    v_mfma_f32_16x16x32_bf16 v[140:143], a[248:251], a[240:243], v[140:143]
    v_accvgpr_read_b32 v235, a19
    v_accvgpr_read_b32 v236, a20
    v_mfma_f32_16x16x32_bf16 v[140:143], a[252:255], a[244:247], v[140:143]
    s_waitcnt lgkmcnt(1)
    v_accvgpr_read_b32 v237, a21
    v_accvgpr_read_b32 v238, a22
    v_mfma_f32_16x16x32_bf16 v[16:19], a[192:195], a[200:203], v[16:19]
    s_waitcnt lgkmcnt(0)
    ds_read_b64_tr_b16 a[248:249], v219 offset:32776
    v_accvgpr_read_b32 v239, a23
    v_mfma_f32_16x16x32_bf16 v[16:19], a[196:199], a[204:207], v[16:19]
    v_mul_f32 v232, v244, v232
    v_mul_f32 v233, v244, v233
    v_mfma_f32_16x16x32_bf16 v[24:27], a[192:195], a[208:211], v[24:27]
    s_bfe_u32 s95, s50, 0x40004
    ds_read_b64_tr_b16 a[250:251], v219 offset:33288
    v_mul_f32 v234, v244, v234
    v_mfma_f32_16x16x32_bf16 v[24:27], a[196:199], a[212:215], v[24:27]
    s_lshl_b32 s67, s95, 19
    ds_read_b64_tr_b16 a[252:253], v219 offset:36872
    v_mul_f32 v235, v244, v235
    v_mfma_f32_16x16x32_bf16 v[80:83], a[192:195], a[216:219], v[80:83]
    s_add_u32 s67, s67, s37
    ds_read_b64_tr_b16 a[254:255], v219 offset:37384
    v_mul_f32 v236, v244, v236
    v_mfma_f32_16x16x32_bf16 v[80:83], a[196:199], a[220:223], v[80:83]
    s_lshl_b32 s95, s95, 7
    v_mul_f32 v237, v244, v237
    v_mul_f32 v238, v244, v238
    v_mfma_f32_16x16x32_bf16 v[88:91], a[192:195], a[224:227], v[88:91]
    s_add_u32 s95, s95, s38
    v_mul_f32 v239, v244, v239
    v_cvt_pk_bf16_f32 v232, v232, v233
    v_mfma_f32_16x16x32_bf16 v[88:91], a[196:199], a[228:231], v[88:91]
    s_add_u32 s63, s67, 128
    v_cvt_pk_bf16_f32 v233, v234, v235
    v_cvt_pk_bf16_f32 v234, v236, v237
    v_mfma_f32_16x16x32_bf16 v[144:147], a[192:195], a[232:235], v[144:147]
    v_cvt_pk_bf16_f32 v235, v238, v239
    v_accvgpr_read_b32 v236, a24
    v_mfma_f32_16x16x32_bf16 v[144:147], a[196:199], a[236:239], v[144:147]
    v_accvgpr_read_b32 v237, a25
    v_accvgpr_read_b32 v238, a26
    v_mfma_f32_16x16x32_bf16 v[152:155], a[192:195], a[240:243], v[152:155]
    v_accvgpr_read_b32 v239, a27
    v_accvgpr_read_b32 v240, a28
    v_mfma_f32_16x16x32_bf16 v[152:155], a[196:199], a[244:247], v[152:155]
    s_waitcnt lgkmcnt(1)
    s_waitcnt vmcnt(17) lgkmcnt(0)
    s_barrier
    v_mfma_f32_16x16x32_bf16 v[20:23], a[248:251], a[200:203], v[20:23]
    s_add_u32 m0, s39, 32768
    ds_read_b64_tr_b16 a[192:193], v218 offset:49152
    v_accvgpr_read_b32 v241, a29
    v_mfma_f32_16x16x32_bf16 v[20:23], a[252:255], a[204:207], v[20:23]
    buffer_load_dwordx4 v198, s[20:23], s67 offen lds
    v_mfma_f32_16x16x32_bf16 v[28:31], a[248:251], a[208:211], v[28:31]
    ds_read_b64_tr_b16 a[194:195], v218 offset:49664
    v_accvgpr_read_b32 v242, a30
    v_mfma_f32_16x16x32_bf16 v[28:31], a[252:255], a[212:215], v[28:31]
    ds_read_b64_tr_b16 a[196:197], v218 offset:53248
    v_accvgpr_read_b32 v243, a31
    v_mfma_f32_16x16x32_bf16 v[84:87], a[248:251], a[216:219], v[84:87]
    ds_read_b64_tr_b16 a[198:199], v218 offset:53760
    v_mul_f32 v236, v244, v236
    v_mfma_f32_16x16x32_bf16 v[84:87], a[252:255], a[220:223], v[84:87]
    buffer_load_dwordx4 v199, s[20:23], s67 offen offset:1024 lds
    v_mfma_f32_16x16x32_bf16 v[92:95], a[248:251], a[224:227], v[92:95]
    v_mul_f32 v237, v244, v237
    v_mul_f32 v238, v244, v238
    v_mfma_f32_16x16x32_bf16 v[92:95], a[252:255], a[228:231], v[92:95]
    v_mul_f32 v239, v244, v239
    v_mul_f32 v240, v244, v240
    v_mfma_f32_16x16x32_bf16 v[148:151], a[248:251], a[232:235], v[148:151]
    v_mul_f32 v241, v244, v241
    v_mul_f32 v242, v244, v242
    v_mfma_f32_16x16x32_bf16 v[148:151], a[252:255], a[236:239], v[148:151]
    buffer_load_dwordx4 v200, s[20:23], s67 offen offset:2048 lds
    v_mfma_f32_16x16x32_bf16 v[156:159], a[248:251], a[240:243], v[156:159]
    v_mul_f32 v243, v244, v243
    v_cvt_pk_bf16_f32 v236, v236, v237
    v_mfma_f32_16x16x32_bf16 v[156:159], a[252:255], a[244:247], v[156:159]
    s_waitcnt lgkmcnt(1)
    v_cvt_pk_bf16_f32 v237, v238, v239
    v_cvt_pk_bf16_f32 v238, v240, v241
    v_mfma_f32_16x16x32_bf16 v[32:35], a[192:195], a[200:203], v[32:35]
    s_waitcnt lgkmcnt(0)
    ds_read_b64_tr_b16 a[248:249], v218 offset:49160
    v_cvt_pk_bf16_f32 v239, v242, v243
    v_mfma_f32_16x16x32_bf16 v[32:35], a[196:199], a[204:207], v[32:35]
    buffer_load_dwordx4 v201, s[20:23], s67 offen offset:3072 lds
    v_mfma_f32_16x16x32_bf16 v[40:43], a[192:195], a[208:211], v[40:43]
    ds_read_b64_tr_b16 a[250:251], v218 offset:49672
    v_mfma_f32_16x16x32_bf16 v[40:43], a[196:199], a[212:215], v[40:43]
    ds_read_b64_tr_b16 a[252:253], v218 offset:53256
    v_mfma_f32_16x16x32_bf16 v[96:99], a[192:195], a[216:219], v[96:99]
    s_add_u32 m0, s40, 122880
    ds_read_b64_tr_b16 a[254:255], v218 offset:53768
    v_mfma_f32_16x16x32_bf16 v[96:99], a[196:199], a[220:223], v[96:99]
    buffer_load_dwordx4 v202, s[16:19], s95 offen lds
    v_mfma_f32_16x16x32_bf16 v[104:107], a[192:195], a[224:227], v[104:107]
    v_mfma_f32_16x16x32_bf16 v[104:107], a[196:199], a[228:231], v[104:107]
    v_mfma_f32_16x16x32_bf16 v[160:163], a[192:195], a[232:235], v[160:163]
    v_mfma_f32_16x16x32_bf16 v[160:163], a[196:199], a[236:239], v[160:163]
    buffer_load_dwordx4 v203, s[16:19], s95 offen offset:1024 lds
    v_mfma_f32_16x16x32_bf16 v[168:171], a[192:195], a[240:243], v[168:171]
    v_mfma_f32_16x16x32_bf16 v[168:171], a[196:199], a[244:247], v[168:171]
    s_waitcnt lgkmcnt(1)
    v_mfma_f32_16x16x32_bf16 v[36:39], a[248:251], a[200:203], v[36:39]
    s_waitcnt lgkmcnt(0)
    ds_read_b64_tr_b16 a[192:193], v219 offset:49152
    v_mfma_f32_16x16x32_bf16 v[36:39], a[252:255], a[204:207], v[36:39]
    buffer_load_dwordx4 v204, s[16:19], s95 offen offset:2048 lds
    v_mfma_f32_16x16x32_bf16 v[44:47], a[248:251], a[208:211], v[44:47]
    ds_read_b64_tr_b16 a[194:195], v219 offset:49664
    v_mfma_f32_16x16x32_bf16 v[44:47], a[252:255], a[212:215], v[44:47]
    ds_read_b64_tr_b16 a[196:197], v219 offset:53248
    v_mfma_f32_16x16x32_bf16 v[100:103], a[248:251], a[216:219], v[100:103]
    ds_read_b64_tr_b16 a[198:199], v219 offset:53760
    v_mfma_f32_16x16x32_bf16 v[100:103], a[252:255], a[220:223], v[100:103]
    buffer_load_dwordx4 v205, s[16:19], s95 offen offset:3072 lds
    v_mfma_f32_16x16x32_bf16 v[108:111], a[248:251], a[224:227], v[108:111]
    v_mfma_f32_16x16x32_bf16 v[108:111], a[252:255], a[228:231], v[108:111]
    s_add_u32 s43, s95, 40960
    buffer_store_dwordx4 v[228:231], v223, s[24:27], s54 offen offset:3072 sc1
    v_mfma_f32_16x16x32_bf16 v[164:167], a[248:251], a[232:235], v[164:167]
    s_add_u32 m0, s40, 126976
    s_add_u32 s54, s41, 12288
    v_mfma_f32_16x16x32_bf16 v[164:167], a[252:255], a[236:239], v[164:167]
    buffer_load_dwordx4 v202, s[16:19], s43 offen lds
    v_mfma_f32_16x16x32_bf16 v[172:175], a[248:251], a[240:243], v[172:175]
    buffer_store_dwordx4 v[232:235], v223, s[24:27], s54 offen sc1
    v_mfma_f32_16x16x32_bf16 v[172:175], a[252:255], a[244:247], v[172:175]
    s_waitcnt lgkmcnt(1)
    buffer_store_dwordx4 v[236:239], v223, s[24:27], s54 offen offset:1024 sc1
    v_mfma_f32_16x16x32_bf16 v[48:51], a[192:195], a[200:203], v[48:51]
    s_waitcnt lgkmcnt(0)
    ds_read_b64_tr_b16 a[248:249], v219 offset:49160
    v_mfma_f32_16x16x32_bf16 v[48:51], a[196:199], a[204:207], v[48:51]
    buffer_load_dwordx4 v203, s[16:19], s43 offen offset:1024 lds
    v_mfma_f32_16x16x32_bf16 v[56:59], a[192:195], a[208:211], v[56:59]
    ds_read_b64_tr_b16 a[250:251], v219 offset:49672
    v_mfma_f32_16x16x32_bf16 v[56:59], a[196:199], a[212:215], v[56:59]
    ds_read_b64_tr_b16 a[252:253], v219 offset:53256
    v_mfma_f32_16x16x32_bf16 v[112:115], a[192:195], a[216:219], v[112:115]
    ds_read_b64_tr_b16 a[254:255], v219 offset:53768
    v_mfma_f32_16x16x32_bf16 v[112:115], a[196:199], a[220:223], v[112:115]
    v_mfma_f32_16x16x32_bf16 v[120:123], a[192:195], a[224:227], v[120:123]
    v_mfma_f32_16x16x32_bf16 v[120:123], a[196:199], a[228:231], v[120:123]
    v_mfma_f32_16x16x32_bf16 v[176:179], a[192:195], a[232:235], v[176:179]
    v_mfma_f32_16x16x32_bf16 v[176:179], a[196:199], a[236:239], v[176:179]
    v_mfma_f32_16x16x32_bf16 v[184:187], a[192:195], a[240:243], v[184:187]
    v_mfma_f32_16x16x32_bf16 v[184:187], a[196:199], a[244:247], v[184:187]
    s_waitcnt lgkmcnt(1)
    s_waitcnt vmcnt(17) lgkmcnt(0)
    s_barrier
    v_mfma_f32_16x16x32_bf16 v[52:55], a[248:251], a[200:203], v[52:55]
    ds_read_b64_tr_b16 a[192:193], v218
    v_mfma_f32_16x16x32_bf16 v[52:55], a[252:255], a[204:207], v[52:55]
    ds_read_b64_tr_b16 a[194:195], v218 offset:512
    v_mfma_f32_16x16x32_bf16 v[60:63], a[248:251], a[208:211], v[60:63]
    ds_read_b128 a[200:203], v220
    v_mfma_f32_16x16x32_bf16 v[60:63], a[252:255], a[212:215], v[60:63]
    ds_read_b64_tr_b16 a[196:197], v218 offset:4096
    v_mfma_f32_16x16x32_bf16 v[116:119], a[248:251], a[216:219], v[116:119]
    ds_read_b64_tr_b16 a[198:199], v218 offset:4608
    v_mfma_f32_16x16x32_bf16 v[116:119], a[252:255], a[220:223], v[116:119]
    ds_read_b128 a[204:207], v221
    v_mfma_f32_16x16x32_bf16 v[124:127], a[248:251], a[224:227], v[124:127]
    ds_read_b128 a[208:211], v220 offset:2048
    v_mfma_f32_16x16x32_bf16 v[124:127], a[252:255], a[228:231], v[124:127]
    ds_read_b128 a[212:215], v221 offset:2048
    v_mfma_f32_16x16x32_bf16 v[180:183], a[248:251], a[232:235], v[180:183]
    ds_read_b128 a[216:219], v220 offset:4096
    v_mfma_f32_16x16x32_bf16 v[180:183], a[252:255], a[236:239], v[180:183]
    ds_read_b128 a[220:223], v221 offset:4096
    v_mfma_f32_16x16x32_bf16 v[188:191], a[248:251], a[240:243], v[188:191]
    ds_read_b128 a[224:227], v220 offset:6144
    v_mfma_f32_16x16x32_bf16 v[188:191], a[252:255], a[244:247], v[188:191]
    s_waitcnt lgkmcnt(7)
    ds_read_b128 a[228:231], v221 offset:6144
    v_mfma_f32_16x16x32_bf16 v[0:3], a[192:195], a[200:203], v[0:3]
    s_waitcnt lgkmcnt(6)
    ds_read_b128 a[232:235], v220 offset:8192
    v_accvgpr_read_b32 v228, a48
    v_mfma_f32_16x16x32_bf16 v[0:3], a[196:199], a[204:207], v[0:3]
    s_waitcnt lgkmcnt(6)
    ds_read_b128 a[236:239], v221 offset:8192
    v_accvgpr_read_b32 v229, a49
    v_mfma_f32_16x16x32_bf16 v[8:11], a[192:195], a[208:211], v[8:11]
    s_waitcnt lgkmcnt(6)
    ds_read_b128 a[240:243], v220 offset:10240
    v_accvgpr_read_b32 v230, a50
    v_mfma_f32_16x16x32_bf16 v[8:11], a[196:199], a[212:215], v[8:11]
    s_waitcnt lgkmcnt(6)
    ds_read_b128 a[244:247], v221 offset:10240
    v_accvgpr_read_b32 v231, a51
    v_mfma_f32_16x16x32_bf16 v[64:67], a[192:195], a[216:219], v[64:67]
    s_waitcnt lgkmcnt(6)
    ds_read_b64_tr_b16 a[248:249], v218 offset:8
    v_accvgpr_read_b32 v232, a52
    v_mfma_f32_16x16x32_bf16 v[64:67], a[196:199], a[220:223], v[64:67]
    s_waitcnt lgkmcnt(6)
    ds_read_b64_tr_b16 a[250:251], v218 offset:520
    v_accvgpr_read_b32 v233, a53
    v_mfma_f32_16x16x32_bf16 v[72:75], a[192:195], a[224:227], v[72:75]
    s_waitcnt lgkmcnt(6)
    ds_read_b64_tr_b16 a[252:253], v218 offset:4104
    v_accvgpr_read_b32 v234, a54
    v_mfma_f32_16x16x32_bf16 v[72:75], a[196:199], a[228:231], v[72:75]
    s_waitcnt lgkmcnt(6)
    ds_read_b64_tr_b16 a[254:255], v218 offset:4616
    v_accvgpr_read_b32 v235, a55
    v_mfma_f32_16x16x32_bf16 v[128:131], a[192:195], a[232:235], v[128:131]
    s_waitcnt lgkmcnt(6)
    s_add_u32 m0, s39, 49152
    v_mul_f32 v228, v245, v228
    v_mfma_f32_16x16x32_bf16 v[128:131], a[196:199], a[236:239], v[128:131]
    s_waitcnt lgkmcnt(5)
    buffer_load_dwordx4 v198, s[20:23], s63 offen lds
    v_mfma_f32_16x16x32_bf16 v[136:139], a[192:195], a[240:243], v[136:139]
    s_waitcnt lgkmcnt(4)
    v_mul_f32 v229, v245, v229
    v_mul_f32 v230, v245, v230
    v_mfma_f32_16x16x32_bf16 v[136:139], a[196:199], a[244:247], v[136:139]
    s_waitcnt lgkmcnt(2)
    v_mul_f32 v231, v245, v231
    v_mul_f32 v232, v245, v232
    v_mfma_f32_16x16x32_bf16 v[4:7], a[248:251], a[200:203], v[4:7]
    s_waitcnt lgkmcnt(0)
    ds_read_b64_tr_b16 a[192:193], v219
    v_mul_f32 v233, v245, v233
    v_mfma_f32_16x16x32_bf16 v[4:7], a[252:255], a[204:207], v[4:7]
    buffer_load_dwordx4 v199, s[20:23], s63 offen offset:1024 lds
    v_mfma_f32_16x16x32_bf16 v[12:15], a[248:251], a[208:211], v[12:15]
    ds_read_b64_tr_b16 a[194:195], v219 offset:512
    v_mul_f32 v234, v245, v234
    v_mfma_f32_16x16x32_bf16 v[12:15], a[252:255], a[212:215], v[12:15]
    ds_read_b64_tr_b16 a[196:197], v219 offset:4096
    v_mul_f32 v235, v245, v235
    v_mfma_f32_16x16x32_bf16 v[68:71], a[248:251], a[216:219], v[68:71]
    ds_read_b64_tr_b16 a[198:199], v219 offset:4608
    v_cvt_pk_bf16_f32 v228, v228, v229
    v_mfma_f32_16x16x32_bf16 v[68:71], a[252:255], a[220:223], v[68:71]
    buffer_load_dwordx4 v200, s[20:23], s63 offen offset:2048 lds
    v_mfma_f32_16x16x32_bf16 v[76:79], a[248:251], a[224:227], v[76:79]
    v_cvt_pk_bf16_f32 v229, v230, v231
    v_cvt_pk_bf16_f32 v230, v232, v233
    v_mfma_f32_16x16x32_bf16 v[76:79], a[252:255], a[228:231], v[76:79]
    v_cvt_pk_bf16_f32 v231, v234, v235
    v_accvgpr_read_b32 v232, a56
    v_mfma_f32_16x16x32_bf16 v[132:135], a[248:251], a[232:235], v[132:135]
    v_accvgpr_read_b32 v233, a57
    v_accvgpr_read_b32 v234, a58
    v_mfma_f32_16x16x32_bf16 v[132:135], a[252:255], a[236:239], v[132:135]
    buffer_load_dwordx4 v201, s[20:23], s63 offen offset:3072 lds
    v_mfma_f32_16x16x32_bf16 v[140:143], a[248:251], a[240:243], v[140:143]
    v_accvgpr_read_b32 v235, a59
    v_accvgpr_read_b32 v236, a60
    v_mfma_f32_16x16x32_bf16 v[140:143], a[252:255], a[244:247], v[140:143]
    s_waitcnt lgkmcnt(1)
    v_accvgpr_read_b32 v237, a61
    v_accvgpr_read_b32 v238, a62
    v_mfma_f32_16x16x32_bf16 v[16:19], a[192:195], a[200:203], v[16:19]
    s_waitcnt lgkmcnt(0)
    ds_read_b64_tr_b16 a[248:249], v219 offset:8
    v_accvgpr_read_b32 v239, a63
    v_mfma_f32_16x16x32_bf16 v[16:19], a[196:199], a[204:207], v[16:19]
    v_mul_f32 v232, v245, v232
    v_mul_f32 v233, v245, v233
    v_mfma_f32_16x16x32_bf16 v[24:27], a[192:195], a[208:211], v[24:27]
    s_bfe_u32 s95, s50, 0x40008
    ds_read_b64_tr_b16 a[250:251], v219 offset:520
    v_mul_f32 v234, v245, v234
    v_mfma_f32_16x16x32_bf16 v[24:27], a[196:199], a[212:215], v[24:27]
    s_lshl_b32 s67, s95, 19
    ds_read_b64_tr_b16 a[252:253], v219 offset:4104
    v_mul_f32 v235, v245, v235
    v_mfma_f32_16x16x32_bf16 v[80:83], a[192:195], a[216:219], v[80:83]
    s_add_u32 s67, s67, s37
    ds_read_b64_tr_b16 a[254:255], v219 offset:4616
    v_mul_f32 v236, v245, v236
    v_mfma_f32_16x16x32_bf16 v[80:83], a[196:199], a[220:223], v[80:83]
    s_lshl_b32 s95, s95, 7
    v_mul_f32 v237, v245, v237
    v_mul_f32 v238, v245, v238
    v_mfma_f32_16x16x32_bf16 v[88:91], a[192:195], a[224:227], v[88:91]
    s_add_u32 s95, s95, s38
    v_mul_f32 v239, v245, v239
    v_cvt_pk_bf16_f32 v232, v232, v233
    v_mfma_f32_16x16x32_bf16 v[88:91], a[196:199], a[228:231], v[88:91]
    s_add_u32 s63, s67, 128
    v_cvt_pk_bf16_f32 v233, v234, v235
    v_cvt_pk_bf16_f32 v234, v236, v237
    v_mfma_f32_16x16x32_bf16 v[144:147], a[192:195], a[232:235], v[144:147]
    v_cvt_pk_bf16_f32 v235, v238, v239
    v_accvgpr_read_b32 v236, a64
    v_mfma_f32_16x16x32_bf16 v[144:147], a[196:199], a[236:239], v[144:147]
    v_accvgpr_read_b32 v237, a65
    v_accvgpr_read_b32 v238, a66
    v_mfma_f32_16x16x32_bf16 v[152:155], a[192:195], a[240:243], v[152:155]
    v_accvgpr_read_b32 v239, a67
    v_accvgpr_read_b32 v240, a68
    v_mfma_f32_16x16x32_bf16 v[152:155], a[196:199], a[244:247], v[152:155]
    s_waitcnt lgkmcnt(1)
    s_waitcnt vmcnt(17) lgkmcnt(0)
    s_barrier
    v_mfma_f32_16x16x32_bf16 v[20:23], a[248:251], a[200:203], v[20:23]
    s_add_u32 m0, s39, 0
    ds_read_b64_tr_b16 a[192:193], v218 offset:16384
    v_accvgpr_read_b32 v241, a69
    v_mfma_f32_16x16x32_bf16 v[20:23], a[252:255], a[204:207], v[20:23]
    buffer_load_dwordx4 v198, s[20:23], s67 offen lds
    v_mfma_f32_16x16x32_bf16 v[28:31], a[248:251], a[208:211], v[28:31]
    ds_read_b64_tr_b16 a[194:195], v218 offset:16896
    v_accvgpr_read_b32 v242, a70
    v_mfma_f32_16x16x32_bf16 v[28:31], a[252:255], a[212:215], v[28:31]
    ds_read_b64_tr_b16 a[196:197], v218 offset:20480
    v_accvgpr_read_b32 v243, a71
    v_mfma_f32_16x16x32_bf16 v[84:87], a[248:251], a[216:219], v[84:87]
    ds_read_b64_tr_b16 a[198:199], v218 offset:20992
    v_mul_f32 v236, v246, v236
    v_mfma_f32_16x16x32_bf16 v[84:87], a[252:255], a[220:223], v[84:87]
    buffer_load_dwordx4 v199, s[20:23], s67 offen offset:1024 lds
    v_mfma_f32_16x16x32_bf16 v[92:95], a[248:251], a[224:227], v[92:95]
    v_mul_f32 v237, v246, v237
    v_mul_f32 v238, v246, v238
    v_mfma_f32_16x16x32_bf16 v[92:95], a[252:255], a[228:231], v[92:95]
    v_mul_f32 v239, v246, v239
    v_mul_f32 v240, v246, v240
    v_mfma_f32_16x16x32_bf16 v[148:151], a[248:251], a[232:235], v[148:151]
    v_mul_f32 v241, v246, v241
    v_mul_f32 v242, v246, v242
    v_mfma_f32_16x16x32_bf16 v[148:151], a[252:255], a[236:239], v[148:151]
    buffer_load_dwordx4 v200, s[20:23], s67 offen offset:2048 lds
    v_mfma_f32_16x16x32_bf16 v[156:159], a[248:251], a[240:243], v[156:159]
    v_mul_f32 v243, v246, v243
    v_cvt_pk_bf16_f32 v236, v236, v237
    v_mfma_f32_16x16x32_bf16 v[156:159], a[252:255], a[244:247], v[156:159]
    s_waitcnt lgkmcnt(1)
    v_cvt_pk_bf16_f32 v237, v238, v239
    v_cvt_pk_bf16_f32 v238, v240, v241
    v_mfma_f32_16x16x32_bf16 v[32:35], a[192:195], a[200:203], v[32:35]
    s_waitcnt lgkmcnt(0)
    ds_read_b64_tr_b16 a[248:249], v218 offset:16392
    v_cvt_pk_bf16_f32 v239, v242, v243
    v_mfma_f32_16x16x32_bf16 v[32:35], a[196:199], a[204:207], v[32:35]
    buffer_load_dwordx4 v201, s[20:23], s67 offen offset:3072 lds
    v_mfma_f32_16x16x32_bf16 v[40:43], a[192:195], a[208:211], v[40:43]
    ds_read_b64_tr_b16 a[250:251], v218 offset:16904
    v_mfma_f32_16x16x32_bf16 v[40:43], a[196:199], a[212:215], v[40:43]
    ds_read_b64_tr_b16 a[252:253], v218 offset:20488
    v_mfma_f32_16x16x32_bf16 v[96:99], a[192:195], a[216:219], v[96:99]
    s_add_u32 m0, s40, 98304
    ds_read_b64_tr_b16 a[254:255], v218 offset:21000
    v_mfma_f32_16x16x32_bf16 v[96:99], a[196:199], a[220:223], v[96:99]
    buffer_load_dwordx4 v202, s[16:19], s95 offen lds
    v_mfma_f32_16x16x32_bf16 v[104:107], a[192:195], a[224:227], v[104:107]
    v_mfma_f32_16x16x32_bf16 v[104:107], a[196:199], a[228:231], v[104:107]
    v_mfma_f32_16x16x32_bf16 v[160:163], a[192:195], a[232:235], v[160:163]
    v_mfma_f32_16x16x32_bf16 v[160:163], a[196:199], a[236:239], v[160:163]
    buffer_load_dwordx4 v203, s[16:19], s95 offen offset:1024 lds
    v_mfma_f32_16x16x32_bf16 v[168:171], a[192:195], a[240:243], v[168:171]
    v_mfma_f32_16x16x32_bf16 v[168:171], a[196:199], a[244:247], v[168:171]
    s_waitcnt lgkmcnt(1)
    v_mfma_f32_16x16x32_bf16 v[36:39], a[248:251], a[200:203], v[36:39]
    s_waitcnt lgkmcnt(0)
    ds_read_b64_tr_b16 a[192:193], v219 offset:16384
    v_mfma_f32_16x16x32_bf16 v[36:39], a[252:255], a[204:207], v[36:39]
    buffer_load_dwordx4 v204, s[16:19], s95 offen offset:2048 lds
    v_mfma_f32_16x16x32_bf16 v[44:47], a[248:251], a[208:211], v[44:47]
    ds_read_b64_tr_b16 a[194:195], v219 offset:16896
    v_mfma_f32_16x16x32_bf16 v[44:47], a[252:255], a[212:215], v[44:47]
    ds_read_b64_tr_b16 a[196:197], v219 offset:20480
    v_mfma_f32_16x16x32_bf16 v[100:103], a[248:251], a[216:219], v[100:103]
    ds_read_b64_tr_b16 a[198:199], v219 offset:20992
    v_mfma_f32_16x16x32_bf16 v[100:103], a[252:255], a[220:223], v[100:103]
    buffer_load_dwordx4 v205, s[16:19], s95 offen offset:3072 lds
    v_mfma_f32_16x16x32_bf16 v[108:111], a[248:251], a[224:227], v[108:111]
    v_mfma_f32_16x16x32_bf16 v[108:111], a[252:255], a[228:231], v[108:111]
    s_add_u32 s44, s95, 40960
    buffer_store_dwordx4 v[228:231], v223, s[24:27], s54 offen offset:2048 sc1
    v_mfma_f32_16x16x32_bf16 v[164:167], a[248:251], a[232:235], v[164:167]
    s_add_u32 m0, s40, 102400
    buffer_store_dwordx4 v[232:235], v223, s[24:27], s54 offen offset:3072 sc1
    v_mfma_f32_16x16x32_bf16 v[164:167], a[252:255], a[236:239], v[164:167]
    buffer_load_dwordx4 v202, s[16:19], s44 offen lds
    v_mfma_f32_16x16x32_bf16 v[172:175], a[248:251], a[240:243], v[172:175]
    s_add_u32 s54, s41, 4096
    buffer_store_dwordx4 v[236:239], v223, s[24:27], s54 offen sc1
    v_mfma_f32_16x16x32_bf16 v[172:175], a[252:255], a[244:247], v[172:175]
    s_waitcnt lgkmcnt(1)
    v_mfma_f32_16x16x32_bf16 v[48:51], a[192:195], a[200:203], v[48:51]
    s_waitcnt lgkmcnt(0)
    ds_read_b64_tr_b16 a[248:249], v219 offset:16392
    v_mfma_f32_16x16x32_bf16 v[48:51], a[196:199], a[204:207], v[48:51]
    buffer_load_dwordx4 v203, s[16:19], s44 offen offset:1024 lds
    v_mfma_f32_16x16x32_bf16 v[56:59], a[192:195], a[208:211], v[56:59]
    ds_read_b64_tr_b16 a[250:251], v219 offset:16904
    v_mfma_f32_16x16x32_bf16 v[56:59], a[196:199], a[212:215], v[56:59]
    ds_read_b64_tr_b16 a[252:253], v219 offset:20488
    v_mfma_f32_16x16x32_bf16 v[112:115], a[192:195], a[216:219], v[112:115]
    ds_read_b64_tr_b16 a[254:255], v219 offset:21000
    v_mfma_f32_16x16x32_bf16 v[112:115], a[196:199], a[220:223], v[112:115]
    v_mfma_f32_16x16x32_bf16 v[120:123], a[192:195], a[224:227], v[120:123]
    v_mfma_f32_16x16x32_bf16 v[120:123], a[196:199], a[228:231], v[120:123]
    v_mfma_f32_16x16x32_bf16 v[176:179], a[192:195], a[232:235], v[176:179]
    v_mfma_f32_16x16x32_bf16 v[176:179], a[196:199], a[236:239], v[176:179]
    v_mfma_f32_16x16x32_bf16 v[184:187], a[192:195], a[240:243], v[184:187]
    v_mfma_f32_16x16x32_bf16 v[184:187], a[196:199], a[244:247], v[184:187]
    s_waitcnt lgkmcnt(1)
    s_waitcnt vmcnt(17) lgkmcnt(0)
    s_barrier
    v_mfma_f32_16x16x32_bf16 v[52:55], a[248:251], a[200:203], v[52:55]
    ds_read_b64_tr_b16 a[192:193], v218 offset:32768
    v_mfma_f32_16x16x32_bf16 v[52:55], a[252:255], a[204:207], v[52:55]
    ds_read_b64_tr_b16 a[194:195], v218 offset:33280
    v_mfma_f32_16x16x32_bf16 v[60:63], a[248:251], a[208:211], v[60:63]
    ds_read_b128 a[200:203], v220 offset:24576
    v_mfma_f32_16x16x32_bf16 v[60:63], a[252:255], a[212:215], v[60:63]
    ds_read_b64_tr_b16 a[196:197], v218 offset:36864
    v_mfma_f32_16x16x32_bf16 v[116:119], a[248:251], a[216:219], v[116:119]
    ds_read_b64_tr_b16 a[198:199], v218 offset:37376
    v_mfma_f32_16x16x32_bf16 v[116:119], a[252:255], a[220:223], v[116:119]
    ds_read_b128 a[204:207], v221 offset:24576
    v_mfma_f32_16x16x32_bf16 v[124:127], a[248:251], a[224:227], v[124:127]
    ds_read_b128 a[208:211], v220 offset:26624
    v_mfma_f32_16x16x32_bf16 v[124:127], a[252:255], a[228:231], v[124:127]
    ds_read_b128 a[212:215], v221 offset:26624
    v_mfma_f32_16x16x32_bf16 v[180:183], a[248:251], a[232:235], v[180:183]
    ds_read_b128 a[216:219], v220 offset:28672
    v_mfma_f32_16x16x32_bf16 v[180:183], a[252:255], a[236:239], v[180:183]
    ds_read_b128 a[220:223], v221 offset:28672
    v_mfma_f32_16x16x32_bf16 v[188:191], a[248:251], a[240:243], v[188:191]
    ds_read_b128 a[224:227], v220 offset:30720
    v_mfma_f32_16x16x32_bf16 v[188:191], a[252:255], a[244:247], v[188:191]
    s_waitcnt lgkmcnt(7)
    ds_read_b128 a[228:231], v221 offset:30720
    v_mfma_f32_16x16x32_bf16 v[0:3], a[192:195], a[200:203], v[0:3]
    s_waitcnt lgkmcnt(6)
    ds_read_b128 a[232:235], v220 offset:32768
    v_accvgpr_read_b32 v228, a72
    v_mfma_f32_16x16x32_bf16 v[0:3], a[196:199], a[204:207], v[0:3]
    s_waitcnt lgkmcnt(6)
    ds_read_b128 a[236:239], v221 offset:32768
    v_accvgpr_read_b32 v229, a73
    v_mfma_f32_16x16x32_bf16 v[8:11], a[192:195], a[208:211], v[8:11]
    s_waitcnt lgkmcnt(6)
    ds_read_b128 a[240:243], v220 offset:34816
    v_accvgpr_read_b32 v230, a74
    v_mfma_f32_16x16x32_bf16 v[8:11], a[196:199], a[212:215], v[8:11]
    s_waitcnt lgkmcnt(6)
    ds_read_b128 a[244:247], v221 offset:34816
    v_accvgpr_read_b32 v231, a75
    v_mfma_f32_16x16x32_bf16 v[64:67], a[192:195], a[216:219], v[64:67]
    s_waitcnt lgkmcnt(6)
    ds_read_b64_tr_b16 a[248:249], v218 offset:32776
    v_accvgpr_read_b32 v232, a76
    v_mfma_f32_16x16x32_bf16 v[64:67], a[196:199], a[220:223], v[64:67]
    s_waitcnt lgkmcnt(6)
    ds_read_b64_tr_b16 a[250:251], v218 offset:33288
    v_accvgpr_read_b32 v233, a77
    v_mfma_f32_16x16x32_bf16 v[72:75], a[192:195], a[224:227], v[72:75]
    s_waitcnt lgkmcnt(6)
    ds_read_b64_tr_b16 a[252:253], v218 offset:36872
    v_accvgpr_read_b32 v234, a78
    v_mfma_f32_16x16x32_bf16 v[72:75], a[196:199], a[228:231], v[72:75]
    s_waitcnt lgkmcnt(6)
    ds_read_b64_tr_b16 a[254:255], v218 offset:37384
    v_accvgpr_read_b32 v235, a79
    v_mfma_f32_16x16x32_bf16 v[128:131], a[192:195], a[232:235], v[128:131]
    s_waitcnt lgkmcnt(6)
    s_add_u32 m0, s39, 16384
    v_mul_f32 v228, v246, v228
    v_mfma_f32_16x16x32_bf16 v[128:131], a[196:199], a[236:239], v[128:131]
    s_waitcnt lgkmcnt(5)
    buffer_load_dwordx4 v198, s[20:23], s63 offen lds
    v_mfma_f32_16x16x32_bf16 v[136:139], a[192:195], a[240:243], v[136:139]
    s_waitcnt lgkmcnt(4)
    v_mul_f32 v229, v246, v229
    v_mul_f32 v230, v246, v230
    v_mfma_f32_16x16x32_bf16 v[136:139], a[196:199], a[244:247], v[136:139]
    s_waitcnt lgkmcnt(2)
    v_mul_f32 v231, v246, v231
    v_mul_f32 v232, v246, v232
    v_mfma_f32_16x16x32_bf16 v[4:7], a[248:251], a[200:203], v[4:7]
    s_waitcnt lgkmcnt(0)
    ds_read_b64_tr_b16 a[192:193], v219 offset:32768
    v_mul_f32 v233, v246, v233
    v_mfma_f32_16x16x32_bf16 v[4:7], a[252:255], a[204:207], v[4:7]
    buffer_load_dwordx4 v199, s[20:23], s63 offen offset:1024 lds
    v_mfma_f32_16x16x32_bf16 v[12:15], a[248:251], a[208:211], v[12:15]
    ds_read_b64_tr_b16 a[194:195], v219 offset:33280
    v_mul_f32 v234, v246, v234
    v_mfma_f32_16x16x32_bf16 v[12:15], a[252:255], a[212:215], v[12:15]
    ds_read_b64_tr_b16 a[196:197], v219 offset:36864
    v_mul_f32 v235, v246, v235
    v_mfma_f32_16x16x32_bf16 v[68:71], a[248:251], a[216:219], v[68:71]
    ds_read_b64_tr_b16 a[198:199], v219 offset:37376
    v_cvt_pk_bf16_f32 v228, v228, v229
    v_mfma_f32_16x16x32_bf16 v[68:71], a[252:255], a[220:223], v[68:71]
    buffer_load_dwordx4 v200, s[20:23], s63 offen offset:2048 lds
    v_mfma_f32_16x16x32_bf16 v[76:79], a[248:251], a[224:227], v[76:79]
    v_cvt_pk_bf16_f32 v229, v230, v231
    v_cvt_pk_bf16_f32 v230, v232, v233
    v_mfma_f32_16x16x32_bf16 v[76:79], a[252:255], a[228:231], v[76:79]
    v_cvt_pk_bf16_f32 v231, v234, v235
    v_accvgpr_read_b32 v232, a96
    v_mfma_f32_16x16x32_bf16 v[132:135], a[248:251], a[232:235], v[132:135]
    v_accvgpr_read_b32 v233, a97
    v_accvgpr_read_b32 v234, a98
    v_mfma_f32_16x16x32_bf16 v[132:135], a[252:255], a[236:239], v[132:135]
    buffer_load_dwordx4 v201, s[20:23], s63 offen offset:3072 lds
    v_mfma_f32_16x16x32_bf16 v[140:143], a[248:251], a[240:243], v[140:143]
    v_accvgpr_read_b32 v235, a99
    v_accvgpr_read_b32 v236, a100
    v_mfma_f32_16x16x32_bf16 v[140:143], a[252:255], a[244:247], v[140:143]
    s_waitcnt lgkmcnt(1)
    v_accvgpr_read_b32 v237, a101
    v_accvgpr_read_b32 v238, a102
    v_mfma_f32_16x16x32_bf16 v[16:19], a[192:195], a[200:203], v[16:19]
    s_waitcnt lgkmcnt(0)
    ds_read_b64_tr_b16 a[248:249], v219 offset:32776
    v_accvgpr_read_b32 v239, a103
    v_mfma_f32_16x16x32_bf16 v[16:19], a[196:199], a[204:207], v[16:19]
    v_mul_f32 v232, v247, v232
    v_mul_f32 v233, v247, v233
    v_mfma_f32_16x16x32_bf16 v[24:27], a[192:195], a[208:211], v[24:27]
    s_bfe_u32 s95, s50, 0x4000c
    ds_read_b64_tr_b16 a[250:251], v219 offset:33288
    v_mul_f32 v234, v247, v234
    v_mfma_f32_16x16x32_bf16 v[24:27], a[196:199], a[212:215], v[24:27]
    s_lshl_b32 s67, s95, 19
    ds_read_b64_tr_b16 a[252:253], v219 offset:36872
    v_mul_f32 v235, v247, v235
    v_mfma_f32_16x16x32_bf16 v[80:83], a[192:195], a[216:219], v[80:83]
    s_add_u32 s67, s67, s37
    ds_read_b64_tr_b16 a[254:255], v219 offset:37384
    v_mul_f32 v236, v247, v236
    v_mfma_f32_16x16x32_bf16 v[80:83], a[196:199], a[220:223], v[80:83]
    s_lshl_b32 s95, s95, 7
    v_mul_f32 v237, v247, v237
    v_mul_f32 v238, v247, v238
    v_mfma_f32_16x16x32_bf16 v[88:91], a[192:195], a[224:227], v[88:91]
    s_add_u32 s95, s95, s38
    v_mul_f32 v239, v247, v239
    v_cvt_pk_bf16_f32 v232, v232, v233
    v_mfma_f32_16x16x32_bf16 v[88:91], a[196:199], a[228:231], v[88:91]
    s_add_u32 s63, s67, 128
    v_cvt_pk_bf16_f32 v233, v234, v235
    v_cvt_pk_bf16_f32 v234, v236, v237
    v_mfma_f32_16x16x32_bf16 v[144:147], a[192:195], a[232:235], v[144:147]
    v_cvt_pk_bf16_f32 v235, v238, v239
    v_accvgpr_read_b32 v236, a104
    v_mfma_f32_16x16x32_bf16 v[144:147], a[196:199], a[236:239], v[144:147]
    v_accvgpr_read_b32 v237, a105
    v_accvgpr_read_b32 v238, a106
    v_mfma_f32_16x16x32_bf16 v[152:155], a[192:195], a[240:243], v[152:155]
    v_accvgpr_read_b32 v239, a107
    v_accvgpr_read_b32 v240, a108
    v_mfma_f32_16x16x32_bf16 v[152:155], a[196:199], a[244:247], v[152:155]
    s_waitcnt lgkmcnt(1)
    s_waitcnt vmcnt(17) lgkmcnt(0)
    s_barrier
    v_mfma_f32_16x16x32_bf16 v[20:23], a[248:251], a[200:203], v[20:23]
    s_add_u32 m0, s39, 32768
    ds_read_b64_tr_b16 a[192:193], v218 offset:49152
    v_accvgpr_read_b32 v241, a109
    v_mfma_f32_16x16x32_bf16 v[20:23], a[252:255], a[204:207], v[20:23]
    buffer_load_dwordx4 v198, s[20:23], s67 offen lds
    v_mfma_f32_16x16x32_bf16 v[28:31], a[248:251], a[208:211], v[28:31]
    ds_read_b64_tr_b16 a[194:195], v218 offset:49664
    v_accvgpr_read_b32 v242, a110
    v_mfma_f32_16x16x32_bf16 v[28:31], a[252:255], a[212:215], v[28:31]
    ds_read_b64_tr_b16 a[196:197], v218 offset:53248
    v_accvgpr_read_b32 v243, a111
    v_mfma_f32_16x16x32_bf16 v[84:87], a[248:251], a[216:219], v[84:87]
    ds_read_b64_tr_b16 a[198:199], v218 offset:53760
    v_mul_f32 v236, v247, v236
    v_mfma_f32_16x16x32_bf16 v[84:87], a[252:255], a[220:223], v[84:87]
    buffer_load_dwordx4 v199, s[20:23], s67 offen offset:1024 lds
    v_mfma_f32_16x16x32_bf16 v[92:95], a[248:251], a[224:227], v[92:95]
    v_mul_f32 v237, v247, v237
    v_mul_f32 v238, v247, v238
    v_mfma_f32_16x16x32_bf16 v[92:95], a[252:255], a[228:231], v[92:95]
    v_mul_f32 v239, v247, v239
    v_mul_f32 v240, v247, v240
    v_mfma_f32_16x16x32_bf16 v[148:151], a[248:251], a[232:235], v[148:151]
    v_mul_f32 v241, v247, v241
    v_mul_f32 v242, v247, v242
    v_mfma_f32_16x16x32_bf16 v[148:151], a[252:255], a[236:239], v[148:151]
    buffer_load_dwordx4 v200, s[20:23], s67 offen offset:2048 lds
    v_mfma_f32_16x16x32_bf16 v[156:159], a[248:251], a[240:243], v[156:159]
    v_mul_f32 v243, v247, v243
    v_cvt_pk_bf16_f32 v236, v236, v237
    v_mfma_f32_16x16x32_bf16 v[156:159], a[252:255], a[244:247], v[156:159]
    s_waitcnt lgkmcnt(1)
    v_cvt_pk_bf16_f32 v237, v238, v239
    v_cvt_pk_bf16_f32 v238, v240, v241
    v_mfma_f32_16x16x32_bf16 v[32:35], a[192:195], a[200:203], v[32:35]
    s_waitcnt lgkmcnt(0)
    ds_read_b64_tr_b16 a[248:249], v218 offset:49160
    v_cvt_pk_bf16_f32 v239, v242, v243
    v_mfma_f32_16x16x32_bf16 v[32:35], a[196:199], a[204:207], v[32:35]
    buffer_load_dwordx4 v201, s[20:23], s67 offen offset:3072 lds
    v_mfma_f32_16x16x32_bf16 v[40:43], a[192:195], a[208:211], v[40:43]
    ds_read_b64_tr_b16 a[250:251], v218 offset:49672
    v_mfma_f32_16x16x32_bf16 v[40:43], a[196:199], a[212:215], v[40:43]
    ds_read_b64_tr_b16 a[252:253], v218 offset:53256
    v_mfma_f32_16x16x32_bf16 v[96:99], a[192:195], a[216:219], v[96:99]
    s_add_u32 m0, s40, 122880
    ds_read_b64_tr_b16 a[254:255], v218 offset:53768
    v_mfma_f32_16x16x32_bf16 v[96:99], a[196:199], a[220:223], v[96:99]
    buffer_load_dwordx4 v202, s[16:19], s95 offen lds
    v_mfma_f32_16x16x32_bf16 v[104:107], a[192:195], a[224:227], v[104:107]
    v_mfma_f32_16x16x32_bf16 v[104:107], a[196:199], a[228:231], v[104:107]
    v_mfma_f32_16x16x32_bf16 v[160:163], a[192:195], a[232:235], v[160:163]
    v_mfma_f32_16x16x32_bf16 v[160:163], a[196:199], a[236:239], v[160:163]
    buffer_load_dwordx4 v203, s[16:19], s95 offen offset:1024 lds
    v_mfma_f32_16x16x32_bf16 v[168:171], a[192:195], a[240:243], v[168:171]
    v_mfma_f32_16x16x32_bf16 v[168:171], a[196:199], a[244:247], v[168:171]
    s_waitcnt lgkmcnt(1)
    v_mfma_f32_16x16x32_bf16 v[36:39], a[248:251], a[200:203], v[36:39]
    s_waitcnt lgkmcnt(0)
    ds_read_b64_tr_b16 a[192:193], v219 offset:49152
    v_mfma_f32_16x16x32_bf16 v[36:39], a[252:255], a[204:207], v[36:39]
    buffer_load_dwordx4 v204, s[16:19], s95 offen offset:2048 lds
    v_mfma_f32_16x16x32_bf16 v[44:47], a[248:251], a[208:211], v[44:47]
    ds_read_b64_tr_b16 a[194:195], v219 offset:49664
    v_mfma_f32_16x16x32_bf16 v[44:47], a[252:255], a[212:215], v[44:47]
    ds_read_b64_tr_b16 a[196:197], v219 offset:53248
    v_mfma_f32_16x16x32_bf16 v[100:103], a[248:251], a[216:219], v[100:103]
    ds_read_b64_tr_b16 a[198:199], v219 offset:53760
    v_mfma_f32_16x16x32_bf16 v[100:103], a[252:255], a[220:223], v[100:103]
    buffer_load_dwordx4 v205, s[16:19], s95 offen offset:3072 lds
    v_mfma_f32_16x16x32_bf16 v[108:111], a[248:251], a[224:227], v[108:111]
    v_mfma_f32_16x16x32_bf16 v[108:111], a[252:255], a[228:231], v[108:111]
    s_add_u32 s43, s95, 40960
    buffer_store_dwordx4 v[228:231], v223, s[24:27], s54 offen offset:1024 sc1
    v_mfma_f32_16x16x32_bf16 v[164:167], a[248:251], a[232:235], v[164:167]
    s_add_u32 m0, s40, 126976
    buffer_store_dwordx4 v[232:235], v223, s[24:27], s54 offen offset:2048 sc1
    v_mfma_f32_16x16x32_bf16 v[164:167], a[252:255], a[236:239], v[164:167]
    buffer_load_dwordx4 v202, s[16:19], s43 offen lds
    v_mfma_f32_16x16x32_bf16 v[172:175], a[248:251], a[240:243], v[172:175]
    buffer_store_dwordx4 v[236:239], v223, s[24:27], s54 offen offset:3072 sc1
    v_mfma_f32_16x16x32_bf16 v[172:175], a[252:255], a[244:247], v[172:175]
    s_waitcnt lgkmcnt(1)
    v_mfma_f32_16x16x32_bf16 v[48:51], a[192:195], a[200:203], v[48:51]
    s_waitcnt lgkmcnt(0)
    ds_read_b64_tr_b16 a[248:249], v219 offset:49160
    v_mfma_f32_16x16x32_bf16 v[48:51], a[196:199], a[204:207], v[48:51]
    buffer_load_dwordx4 v203, s[16:19], s43 offen offset:1024 lds
    v_mfma_f32_16x16x32_bf16 v[56:59], a[192:195], a[208:211], v[56:59]
    ds_read_b64_tr_b16 a[250:251], v219 offset:49672
    v_mfma_f32_16x16x32_bf16 v[56:59], a[196:199], a[212:215], v[56:59]
    ds_read_b64_tr_b16 a[252:253], v219 offset:53256
    v_mfma_f32_16x16x32_bf16 v[112:115], a[192:195], a[216:219], v[112:115]
    ds_read_b64_tr_b16 a[254:255], v219 offset:53768
    v_mfma_f32_16x16x32_bf16 v[112:115], a[196:199], a[220:223], v[112:115]
    v_mfma_f32_16x16x32_bf16 v[120:123], a[192:195], a[224:227], v[120:123]
    v_mfma_f32_16x16x32_bf16 v[120:123], a[196:199], a[228:231], v[120:123]
    v_mfma_f32_16x16x32_bf16 v[176:179], a[192:195], a[232:235], v[176:179]
    v_mfma_f32_16x16x32_bf16 v[176:179], a[196:199], a[236:239], v[176:179]
    v_mfma_f32_16x16x32_bf16 v[184:187], a[192:195], a[240:243], v[184:187]
    v_mfma_f32_16x16x32_bf16 v[184:187], a[196:199], a[244:247], v[184:187]
    s_waitcnt lgkmcnt(1)
    s_waitcnt vmcnt(17) lgkmcnt(0)
    s_barrier
    v_mfma_f32_16x16x32_bf16 v[52:55], a[248:251], a[200:203], v[52:55]
    ds_read_b64_tr_b16 a[192:193], v218
    v_mfma_f32_16x16x32_bf16 v[52:55], a[252:255], a[204:207], v[52:55]
    ds_read_b64_tr_b16 a[194:195], v218 offset:512
    v_mfma_f32_16x16x32_bf16 v[60:63], a[248:251], a[208:211], v[60:63]
    ds_read_b128 a[200:203], v220
    v_mfma_f32_16x16x32_bf16 v[60:63], a[252:255], a[212:215], v[60:63]
    ds_read_b64_tr_b16 a[196:197], v218 offset:4096
    v_mfma_f32_16x16x32_bf16 v[116:119], a[248:251], a[216:219], v[116:119]
    ds_read_b64_tr_b16 a[198:199], v218 offset:4608
    v_mfma_f32_16x16x32_bf16 v[116:119], a[252:255], a[220:223], v[116:119]
    ds_read_b128 a[204:207], v221
    v_mfma_f32_16x16x32_bf16 v[124:127], a[248:251], a[224:227], v[124:127]
    ds_read_b128 a[208:211], v220 offset:2048
    v_mfma_f32_16x16x32_bf16 v[124:127], a[252:255], a[228:231], v[124:127]
    ds_read_b128 a[212:215], v221 offset:2048
    v_mfma_f32_16x16x32_bf16 v[180:183], a[248:251], a[232:235], v[180:183]
    ds_read_b128 a[216:219], v220 offset:4096
    v_mfma_f32_16x16x32_bf16 v[180:183], a[252:255], a[236:239], v[180:183]
    ds_read_b128 a[220:223], v221 offset:4096
    v_mfma_f32_16x16x32_bf16 v[188:191], a[248:251], a[240:243], v[188:191]
    ds_read_b128 a[224:227], v220 offset:6144
    v_mfma_f32_16x16x32_bf16 v[188:191], a[252:255], a[244:247], v[188:191]
    s_waitcnt lgkmcnt(7)
    ds_read_b128 a[228:231], v221 offset:6144
    v_mfma_f32_16x16x32_bf16 v[0:3], a[192:195], a[200:203], v[0:3]
    s_waitcnt lgkmcnt(6)
    ds_read_b128 a[232:235], v220 offset:8192
    v_accvgpr_read_b32 v228, a80
    v_mfma_f32_16x16x32_bf16 v[0:3], a[196:199], a[204:207], v[0:3]
    s_waitcnt lgkmcnt(6)
    ds_read_b128 a[236:239], v221 offset:8192
    v_accvgpr_read_b32 v229, a81
    v_mfma_f32_16x16x32_bf16 v[8:11], a[192:195], a[208:211], v[8:11]
    s_waitcnt lgkmcnt(6)
    ds_read_b128 a[240:243], v220 offset:10240
    v_accvgpr_read_b32 v230, a82
    v_mfma_f32_16x16x32_bf16 v[8:11], a[196:199], a[212:215], v[8:11]
    s_waitcnt lgkmcnt(6)
    ds_read_b128 a[244:247], v221 offset:10240
    v_accvgpr_read_b32 v231, a83
    v_mfma_f32_16x16x32_bf16 v[64:67], a[192:195], a[216:219], v[64:67]
    s_waitcnt lgkmcnt(6)
    ds_read_b64_tr_b16 a[248:249], v218 offset:8
    v_accvgpr_read_b32 v232, a84
    v_mfma_f32_16x16x32_bf16 v[64:67], a[196:199], a[220:223], v[64:67]
    s_waitcnt lgkmcnt(6)
    ds_read_b64_tr_b16 a[250:251], v218 offset:520
    v_accvgpr_read_b32 v233, a85
    v_mfma_f32_16x16x32_bf16 v[72:75], a[192:195], a[224:227], v[72:75]
    s_waitcnt lgkmcnt(6)
    ds_read_b64_tr_b16 a[252:253], v218 offset:4104
    v_accvgpr_read_b32 v234, a86
    v_mfma_f32_16x16x32_bf16 v[72:75], a[196:199], a[228:231], v[72:75]
    s_waitcnt lgkmcnt(6)
    ds_read_b64_tr_b16 a[254:255], v218 offset:4616
    v_accvgpr_read_b32 v235, a87
    v_mfma_f32_16x16x32_bf16 v[128:131], a[192:195], a[232:235], v[128:131]
    s_waitcnt lgkmcnt(6)
    s_add_u32 m0, s39, 49152
    v_mul_f32 v228, v246, v228
    v_mfma_f32_16x16x32_bf16 v[128:131], a[196:199], a[236:239], v[128:131]
    s_waitcnt lgkmcnt(5)
    buffer_load_dwordx4 v198, s[20:23], s63 offen lds
    v_mfma_f32_16x16x32_bf16 v[136:139], a[192:195], a[240:243], v[136:139]
    s_waitcnt lgkmcnt(4)
    v_mul_f32 v229, v246, v229
    v_mul_f32 v230, v246, v230
    v_mfma_f32_16x16x32_bf16 v[136:139], a[196:199], a[244:247], v[136:139]
    s_waitcnt lgkmcnt(2)
    v_mul_f32 v231, v246, v231
    v_mul_f32 v232, v246, v232
    v_mfma_f32_16x16x32_bf16 v[4:7], a[248:251], a[200:203], v[4:7]
    s_waitcnt lgkmcnt(0)
    ds_read_b64_tr_b16 a[192:193], v219
    v_mul_f32 v233, v246, v233
    v_mfma_f32_16x16x32_bf16 v[4:7], a[252:255], a[204:207], v[4:7]
    buffer_load_dwordx4 v199, s[20:23], s63 offen offset:1024 lds
    v_mfma_f32_16x16x32_bf16 v[12:15], a[248:251], a[208:211], v[12:15]
    ds_read_b64_tr_b16 a[194:195], v219 offset:512
    v_mul_f32 v234, v246, v234
    v_mfma_f32_16x16x32_bf16 v[12:15], a[252:255], a[212:215], v[12:15]
    ds_read_b64_tr_b16 a[196:197], v219 offset:4096
    v_mul_f32 v235, v246, v235
    v_mfma_f32_16x16x32_bf16 v[68:71], a[248:251], a[216:219], v[68:71]
    ds_read_b64_tr_b16 a[198:199], v219 offset:4608
    v_cvt_pk_bf16_f32 v228, v228, v229
    v_mfma_f32_16x16x32_bf16 v[68:71], a[252:255], a[220:223], v[68:71]
    buffer_load_dwordx4 v200, s[20:23], s63 offen offset:2048 lds
    v_mfma_f32_16x16x32_bf16 v[76:79], a[248:251], a[224:227], v[76:79]
    v_cvt_pk_bf16_f32 v229, v230, v231
    v_cvt_pk_bf16_f32 v230, v232, v233
    v_mfma_f32_16x16x32_bf16 v[76:79], a[252:255], a[228:231], v[76:79]
    v_cvt_pk_bf16_f32 v231, v234, v235
    v_accvgpr_read_b32 v232, a88
    v_mfma_f32_16x16x32_bf16 v[132:135], a[248:251], a[232:235], v[132:135]
    v_accvgpr_read_b32 v233, a89
    v_accvgpr_read_b32 v234, a90
    v_mfma_f32_16x16x32_bf16 v[132:135], a[252:255], a[236:239], v[132:135]
    buffer_load_dwordx4 v201, s[20:23], s63 offen offset:3072 lds
    v_mfma_f32_16x16x32_bf16 v[140:143], a[248:251], a[240:243], v[140:143]
    v_accvgpr_read_b32 v235, a91
    v_accvgpr_read_b32 v236, a92
    v_mfma_f32_16x16x32_bf16 v[140:143], a[252:255], a[244:247], v[140:143]
    s_waitcnt lgkmcnt(1)
    v_accvgpr_read_b32 v237, a93
    v_accvgpr_read_b32 v238, a94
    v_mfma_f32_16x16x32_bf16 v[16:19], a[192:195], a[200:203], v[16:19]
    s_waitcnt lgkmcnt(0)
    ds_read_b64_tr_b16 a[248:249], v219 offset:8
    v_accvgpr_read_b32 v239, a95
    v_mfma_f32_16x16x32_bf16 v[16:19], a[196:199], a[204:207], v[16:19]
    v_mul_f32 v232, v246, v232
    v_mul_f32 v233, v246, v233
    v_mfma_f32_16x16x32_bf16 v[24:27], a[192:195], a[208:211], v[24:27]
    s_bfe_u32 s95, s50, 0x40010
    ds_read_b64_tr_b16 a[250:251], v219 offset:520
    v_mul_f32 v234, v246, v234
    v_mfma_f32_16x16x32_bf16 v[24:27], a[196:199], a[212:215], v[24:27]
    s_lshl_b32 s67, s95, 19
    ds_read_b64_tr_b16 a[252:253], v219 offset:4104
    v_mul_f32 v235, v246, v235
    v_mfma_f32_16x16x32_bf16 v[80:83], a[192:195], a[216:219], v[80:83]
    s_add_u32 s67, s67, s37
    ds_read_b64_tr_b16 a[254:255], v219 offset:4616
    v_mul_f32 v236, v246, v236
    v_mfma_f32_16x16x32_bf16 v[80:83], a[196:199], a[220:223], v[80:83]
    s_lshl_b32 s95, s95, 7
    v_mul_f32 v237, v246, v237
    v_mul_f32 v238, v246, v238
    v_mfma_f32_16x16x32_bf16 v[88:91], a[192:195], a[224:227], v[88:91]
    s_add_u32 s95, s95, s38
    v_mul_f32 v239, v246, v239
    v_cvt_pk_bf16_f32 v232, v232, v233
    v_mfma_f32_16x16x32_bf16 v[88:91], a[196:199], a[228:231], v[88:91]
    s_add_u32 s63, s67, 128
    v_cvt_pk_bf16_f32 v233, v234, v235
    v_cvt_pk_bf16_f32 v234, v236, v237
    v_mfma_f32_16x16x32_bf16 v[144:147], a[192:195], a[232:235], v[144:147]
    v_cvt_pk_bf16_f32 v235, v238, v239
    v_accvgpr_read_b32 v236, a112
    v_mfma_f32_16x16x32_bf16 v[144:147], a[196:199], a[236:239], v[144:147]
    v_accvgpr_read_b32 v237, a113
    v_accvgpr_read_b32 v238, a114
    v_mfma_f32_16x16x32_bf16 v[152:155], a[192:195], a[240:243], v[152:155]
    v_accvgpr_read_b32 v239, a115
    v_accvgpr_read_b32 v240, a116
    v_mfma_f32_16x16x32_bf16 v[152:155], a[196:199], a[244:247], v[152:155]
    s_waitcnt lgkmcnt(1)
    s_waitcnt vmcnt(17) lgkmcnt(0)
    s_barrier
    v_mfma_f32_16x16x32_bf16 v[20:23], a[248:251], a[200:203], v[20:23]
    s_add_u32 m0, s39, 0
    ds_read_b64_tr_b16 a[192:193], v218 offset:16384
    v_accvgpr_read_b32 v241, a117
    v_mfma_f32_16x16x32_bf16 v[20:23], a[252:255], a[204:207], v[20:23]
    buffer_load_dwordx4 v198, s[20:23], s67 offen lds
    v_mfma_f32_16x16x32_bf16 v[28:31], a[248:251], a[208:211], v[28:31]
    ds_read_b64_tr_b16 a[194:195], v218 offset:16896
    v_accvgpr_read_b32 v242, a118
    v_mfma_f32_16x16x32_bf16 v[28:31], a[252:255], a[212:215], v[28:31]
    ds_read_b64_tr_b16 a[196:197], v218 offset:20480
    v_accvgpr_read_b32 v243, a119
    v_mfma_f32_16x16x32_bf16 v[84:87], a[248:251], a[216:219], v[84:87]
    ds_read_b64_tr_b16 a[198:199], v218 offset:20992
    v_mul_f32 v236, v247, v236
    v_mfma_f32_16x16x32_bf16 v[84:87], a[252:255], a[220:223], v[84:87]
    buffer_load_dwordx4 v199, s[20:23], s67 offen offset:1024 lds
    v_mfma_f32_16x16x32_bf16 v[92:95], a[248:251], a[224:227], v[92:95]
    v_mul_f32 v237, v247, v237
    v_mul_f32 v238, v247, v238
    v_mfma_f32_16x16x32_bf16 v[92:95], a[252:255], a[228:231], v[92:95]
    v_mul_f32 v239, v247, v239
    v_mul_f32 v240, v247, v240
    v_mfma_f32_16x16x32_bf16 v[148:151], a[248:251], a[232:235], v[148:151]
    v_mul_f32 v241, v247, v241
    v_mul_f32 v242, v247, v242
    v_mfma_f32_16x16x32_bf16 v[148:151], a[252:255], a[236:239], v[148:151]
    buffer_load_dwordx4 v200, s[20:23], s67 offen offset:2048 lds
    v_mfma_f32_16x16x32_bf16 v[156:159], a[248:251], a[240:243], v[156:159]
    v_mul_f32 v243, v247, v243
    v_cvt_pk_bf16_f32 v236, v236, v237
    v_mfma_f32_16x16x32_bf16 v[156:159], a[252:255], a[244:247], v[156:159]
    s_waitcnt lgkmcnt(1)
    v_cvt_pk_bf16_f32 v237, v238, v239
    v_cvt_pk_bf16_f32 v238, v240, v241
    v_mfma_f32_16x16x32_bf16 v[32:35], a[192:195], a[200:203], v[32:35]
    s_waitcnt lgkmcnt(0)
    ds_read_b64_tr_b16 a[248:249], v218 offset:16392
    v_cvt_pk_bf16_f32 v239, v242, v243
    v_mfma_f32_16x16x32_bf16 v[32:35], a[196:199], a[204:207], v[32:35]
    buffer_load_dwordx4 v201, s[20:23], s67 offen offset:3072 lds
    v_mfma_f32_16x16x32_bf16 v[40:43], a[192:195], a[208:211], v[40:43]
    ds_read_b64_tr_b16 a[250:251], v218 offset:16904
    v_mfma_f32_16x16x32_bf16 v[40:43], a[196:199], a[212:215], v[40:43]
    ds_read_b64_tr_b16 a[252:253], v218 offset:20488
    v_mfma_f32_16x16x32_bf16 v[96:99], a[192:195], a[216:219], v[96:99]
    s_add_u32 m0, s40, 98304
    ds_read_b64_tr_b16 a[254:255], v218 offset:21000
    v_mfma_f32_16x16x32_bf16 v[96:99], a[196:199], a[220:223], v[96:99]
    buffer_load_dwordx4 v202, s[16:19], s95 offen lds
    v_mfma_f32_16x16x32_bf16 v[104:107], a[192:195], a[224:227], v[104:107]
    v_mfma_f32_16x16x32_bf16 v[104:107], a[196:199], a[228:231], v[104:107]
    v_mfma_f32_16x16x32_bf16 v[160:163], a[192:195], a[232:235], v[160:163]
    v_mfma_f32_16x16x32_bf16 v[160:163], a[196:199], a[236:239], v[160:163]
    buffer_load_dwordx4 v203, s[16:19], s95 offen offset:1024 lds
    v_mfma_f32_16x16x32_bf16 v[168:171], a[192:195], a[240:243], v[168:171]
    v_mfma_f32_16x16x32_bf16 v[168:171], a[196:199], a[244:247], v[168:171]
    s_waitcnt lgkmcnt(1)
    v_mfma_f32_16x16x32_bf16 v[36:39], a[248:251], a[200:203], v[36:39]
    s_waitcnt lgkmcnt(0)
    ds_read_b64_tr_b16 a[192:193], v219 offset:16384
    v_mfma_f32_16x16x32_bf16 v[36:39], a[252:255], a[204:207], v[36:39]
    buffer_load_dwordx4 v204, s[16:19], s95 offen offset:2048 lds
    v_mfma_f32_16x16x32_bf16 v[44:47], a[248:251], a[208:211], v[44:47]
    ds_read_b64_tr_b16 a[194:195], v219 offset:16896
    v_mfma_f32_16x16x32_bf16 v[44:47], a[252:255], a[212:215], v[44:47]
    ds_read_b64_tr_b16 a[196:197], v219 offset:20480
    v_mfma_f32_16x16x32_bf16 v[100:103], a[248:251], a[216:219], v[100:103]
    ds_read_b64_tr_b16 a[198:199], v219 offset:20992
    v_mfma_f32_16x16x32_bf16 v[100:103], a[252:255], a[220:223], v[100:103]
    buffer_load_dwordx4 v205, s[16:19], s95 offen offset:3072 lds
    v_mfma_f32_16x16x32_bf16 v[108:111], a[248:251], a[224:227], v[108:111]
    v_mfma_f32_16x16x32_bf16 v[108:111], a[252:255], a[228:231], v[108:111]
    s_add_u32 s44, s95, 40960
    s_add_u32 s54, s41, 16384
    v_mfma_f32_16x16x32_bf16 v[164:167], a[248:251], a[232:235], v[164:167]
    s_add_u32 m0, s40, 102400
    buffer_store_dwordx4 v[228:231], v223, s[24:27], s54 offen sc1
    v_mfma_f32_16x16x32_bf16 v[164:167], a[252:255], a[236:239], v[164:167]
    buffer_load_dwordx4 v202, s[16:19], s44 offen lds
    v_mfma_f32_16x16x32_bf16 v[172:175], a[248:251], a[240:243], v[172:175]
    buffer_store_dwordx4 v[232:235], v223, s[24:27], s54 offen offset:1024 sc1
    v_mfma_f32_16x16x32_bf16 v[172:175], a[252:255], a[244:247], v[172:175]
    s_waitcnt lgkmcnt(1)
    buffer_store_dwordx4 v[236:239], v223, s[24:27], s54 offen offset:2048 sc1
    v_mfma_f32_16x16x32_bf16 v[48:51], a[192:195], a[200:203], v[48:51]
    s_waitcnt lgkmcnt(0)
    ds_read_b64_tr_b16 a[248:249], v219 offset:16392
    v_mfma_f32_16x16x32_bf16 v[48:51], a[196:199], a[204:207], v[48:51]
    buffer_load_dwordx4 v203, s[16:19], s44 offen offset:1024 lds
    v_mfma_f32_16x16x32_bf16 v[56:59], a[192:195], a[208:211], v[56:59]
    ds_read_b64_tr_b16 a[250:251], v219 offset:16904
    v_mfma_f32_16x16x32_bf16 v[56:59], a[196:199], a[212:215], v[56:59]
    ds_read_b64_tr_b16 a[252:253], v219 offset:20488
    v_mfma_f32_16x16x32_bf16 v[112:115], a[192:195], a[216:219], v[112:115]
    ds_read_b64_tr_b16 a[254:255], v219 offset:21000
    v_mfma_f32_16x16x32_bf16 v[112:115], a[196:199], a[220:223], v[112:115]
    v_mfma_f32_16x16x32_bf16 v[120:123], a[192:195], a[224:227], v[120:123]
    v_mfma_f32_16x16x32_bf16 v[120:123], a[196:199], a[228:231], v[120:123]
    v_mfma_f32_16x16x32_bf16 v[176:179], a[192:195], a[232:235], v[176:179]
    v_mfma_f32_16x16x32_bf16 v[176:179], a[196:199], a[236:239], v[176:179]
    v_mfma_f32_16x16x32_bf16 v[184:187], a[192:195], a[240:243], v[184:187]
    v_mfma_f32_16x16x32_bf16 v[184:187], a[196:199], a[244:247], v[184:187]
    s_waitcnt lgkmcnt(1)
    s_waitcnt vmcnt(17) lgkmcnt(0)
    s_barrier
    v_mfma_f32_16x16x32_bf16 v[52:55], a[248:251], a[200:203], v[52:55]
    ds_read_b64_tr_b16 a[192:193], v218 offset:32768
    v_mfma_f32_16x16x32_bf16 v[52:55], a[252:255], a[204:207], v[52:55]
    ds_read_b64_tr_b16 a[194:195], v218 offset:33280
    v_mfma_f32_16x16x32_bf16 v[60:63], a[248:251], a[208:211], v[60:63]
    ds_read_b128 a[200:203], v220 offset:24576
    v_mfma_f32_16x16x32_bf16 v[60:63], a[252:255], a[212:215], v[60:63]
    ds_read_b64_tr_b16 a[196:197], v218 offset:36864
    v_mfma_f32_16x16x32_bf16 v[116:119], a[248:251], a[216:219], v[116:119]
    ds_read_b64_tr_b16 a[198:199], v218 offset:37376
    v_mfma_f32_16x16x32_bf16 v[116:119], a[252:255], a[220:223], v[116:119]
    ds_read_b128 a[204:207], v221 offset:24576
    v_mfma_f32_16x16x32_bf16 v[124:127], a[248:251], a[224:227], v[124:127]
    ds_read_b128 a[208:211], v220 offset:26624
    v_mfma_f32_16x16x32_bf16 v[124:127], a[252:255], a[228:231], v[124:127]
    ds_read_b128 a[212:215], v221 offset:26624
    v_mfma_f32_16x16x32_bf16 v[180:183], a[248:251], a[232:235], v[180:183]
    ds_read_b128 a[216:219], v220 offset:28672
    v_mfma_f32_16x16x32_bf16 v[180:183], a[252:255], a[236:239], v[180:183]
    ds_read_b128 a[220:223], v221 offset:28672
    v_mfma_f32_16x16x32_bf16 v[188:191], a[248:251], a[240:243], v[188:191]
    ds_read_b128 a[224:227], v220 offset:30720
    v_mfma_f32_16x16x32_bf16 v[188:191], a[252:255], a[244:247], v[188:191]
    s_waitcnt lgkmcnt(7)
    ds_read_b128 a[228:231], v221 offset:30720
    v_mfma_f32_16x16x32_bf16 v[0:3], a[192:195], a[200:203], v[0:3]
    s_waitcnt lgkmcnt(6)
    ds_read_b128 a[232:235], v220 offset:32768
    v_accvgpr_read_b32 v228, a120
    v_mfma_f32_16x16x32_bf16 v[0:3], a[196:199], a[204:207], v[0:3]
    s_waitcnt lgkmcnt(6)
    ds_read_b128 a[236:239], v221 offset:32768
    v_accvgpr_read_b32 v229, a121
    v_mfma_f32_16x16x32_bf16 v[8:11], a[192:195], a[208:211], v[8:11]
    s_waitcnt lgkmcnt(6)
    ds_read_b128 a[240:243], v220 offset:34816
    v_accvgpr_read_b32 v230, a122
    v_mfma_f32_16x16x32_bf16 v[8:11], a[196:199], a[212:215], v[8:11]
    s_waitcnt lgkmcnt(6)
    ds_read_b128 a[244:247], v221 offset:34816
    v_accvgpr_read_b32 v231, a123
    v_mfma_f32_16x16x32_bf16 v[64:67], a[192:195], a[216:219], v[64:67]
    s_waitcnt lgkmcnt(6)
    ds_read_b64_tr_b16 a[248:249], v218 offset:32776
    v_accvgpr_read_b32 v232, a124
    v_mfma_f32_16x16x32_bf16 v[64:67], a[196:199], a[220:223], v[64:67]
    s_waitcnt lgkmcnt(6)
    ds_read_b64_tr_b16 a[250:251], v218 offset:33288
    v_accvgpr_read_b32 v233, a125
    v_mfma_f32_16x16x32_bf16 v[72:75], a[192:195], a[224:227], v[72:75]
    s_waitcnt lgkmcnt(6)
    ds_read_b64_tr_b16 a[252:253], v218 offset:36872
    v_accvgpr_read_b32 v234, a126
    v_mfma_f32_16x16x32_bf16 v[72:75], a[196:199], a[228:231], v[72:75]
    s_waitcnt lgkmcnt(6)
    ds_read_b64_tr_b16 a[254:255], v218 offset:37384
    v_accvgpr_read_b32 v235, a127
    v_mfma_f32_16x16x32_bf16 v[128:131], a[192:195], a[232:235], v[128:131]
    s_waitcnt lgkmcnt(6)
    s_add_u32 m0, s39, 16384
    v_mul_f32 v228, v247, v228
    v_mfma_f32_16x16x32_bf16 v[128:131], a[196:199], a[236:239], v[128:131]
    s_waitcnt lgkmcnt(5)
    buffer_load_dwordx4 v198, s[20:23], s63 offen lds
    v_mfma_f32_16x16x32_bf16 v[136:139], a[192:195], a[240:243], v[136:139]
    s_waitcnt lgkmcnt(4)
    v_mul_f32 v229, v247, v229
    v_mul_f32 v230, v247, v230
    v_mfma_f32_16x16x32_bf16 v[136:139], a[196:199], a[244:247], v[136:139]
    s_waitcnt lgkmcnt(2)
    v_mul_f32 v231, v247, v231
    v_mul_f32 v232, v247, v232
    v_mfma_f32_16x16x32_bf16 v[4:7], a[248:251], a[200:203], v[4:7]
    s_waitcnt lgkmcnt(0)
    ds_read_b64_tr_b16 a[192:193], v219 offset:32768
    v_mul_f32 v233, v247, v233
    v_mfma_f32_16x16x32_bf16 v[4:7], a[252:255], a[204:207], v[4:7]
    buffer_load_dwordx4 v199, s[20:23], s63 offen offset:1024 lds
    v_mfma_f32_16x16x32_bf16 v[12:15], a[248:251], a[208:211], v[12:15]
    ds_read_b64_tr_b16 a[194:195], v219 offset:33280
    v_mul_f32 v234, v247, v234
    v_mfma_f32_16x16x32_bf16 v[12:15], a[252:255], a[212:215], v[12:15]
    ds_read_b64_tr_b16 a[196:197], v219 offset:36864
    v_mul_f32 v235, v247, v235
    v_mfma_f32_16x16x32_bf16 v[68:71], a[248:251], a[216:219], v[68:71]
    ds_read_b64_tr_b16 a[198:199], v219 offset:37376
    v_cvt_pk_bf16_f32 v228, v228, v229
    v_mfma_f32_16x16x32_bf16 v[68:71], a[252:255], a[220:223], v[68:71]
    buffer_load_dwordx4 v200, s[20:23], s63 offen offset:2048 lds
    v_mfma_f32_16x16x32_bf16 v[76:79], a[248:251], a[224:227], v[76:79]
    v_cvt_pk_bf16_f32 v229, v230, v231
    v_cvt_pk_bf16_f32 v230, v232, v233
    v_mfma_f32_16x16x32_bf16 v[76:79], a[252:255], a[228:231], v[76:79]
    v_cvt_pk_bf16_f32 v231, v234, v235
    v_accvgpr_read_b32 v232, a128
    v_mfma_f32_16x16x32_bf16 v[132:135], a[248:251], a[232:235], v[132:135]
    v_accvgpr_read_b32 v233, a129
    v_accvgpr_read_b32 v234, a130
    v_mfma_f32_16x16x32_bf16 v[132:135], a[252:255], a[236:239], v[132:135]
    buffer_load_dwordx4 v201, s[20:23], s63 offen offset:3072 lds
    v_mfma_f32_16x16x32_bf16 v[140:143], a[248:251], a[240:243], v[140:143]
    v_accvgpr_read_b32 v235, a131
    v_accvgpr_read_b32 v236, a132
    v_mfma_f32_16x16x32_bf16 v[140:143], a[252:255], a[244:247], v[140:143]
    s_waitcnt lgkmcnt(1)
    v_accvgpr_read_b32 v237, a133
    v_accvgpr_read_b32 v238, a134
    v_mfma_f32_16x16x32_bf16 v[16:19], a[192:195], a[200:203], v[16:19]
    s_waitcnt lgkmcnt(0)
    ds_read_b64_tr_b16 a[248:249], v219 offset:32776
    v_accvgpr_read_b32 v239, a135
    v_mfma_f32_16x16x32_bf16 v[16:19], a[196:199], a[204:207], v[16:19]
    v_mul_f32 v232, v248, v232
    v_mul_f32 v233, v248, v233
    v_mfma_f32_16x16x32_bf16 v[24:27], a[192:195], a[208:211], v[24:27]
    s_bfe_u32 s95, s50, 0x40014
    ds_read_b64_tr_b16 a[250:251], v219 offset:33288
    v_mul_f32 v234, v248, v234
    v_mfma_f32_16x16x32_bf16 v[24:27], a[196:199], a[212:215], v[24:27]
    s_lshl_b32 s67, s95, 19
    ds_read_b64_tr_b16 a[252:253], v219 offset:36872
    v_mul_f32 v235, v248, v235
    v_mfma_f32_16x16x32_bf16 v[80:83], a[192:195], a[216:219], v[80:83]
    s_add_u32 s67, s67, s37
    ds_read_b64_tr_b16 a[254:255], v219 offset:37384
    v_mul_f32 v236, v248, v236
    v_mfma_f32_16x16x32_bf16 v[80:83], a[196:199], a[220:223], v[80:83]
    s_lshl_b32 s95, s95, 7
    v_mul_f32 v237, v248, v237
    v_mul_f32 v238, v248, v238
    v_mfma_f32_16x16x32_bf16 v[88:91], a[192:195], a[224:227], v[88:91]
    s_add_u32 s95, s95, s38
    v_mul_f32 v239, v248, v239
    v_cvt_pk_bf16_f32 v232, v232, v233
    v_mfma_f32_16x16x32_bf16 v[88:91], a[196:199], a[228:231], v[88:91]
    s_add_u32 s63, s67, 128
    v_cvt_pk_bf16_f32 v233, v234, v235
    v_cvt_pk_bf16_f32 v234, v236, v237
    v_mfma_f32_16x16x32_bf16 v[144:147], a[192:195], a[232:235], v[144:147]
    v_cvt_pk_bf16_f32 v235, v238, v239
    v_accvgpr_read_b32 v236, a136
    v_mfma_f32_16x16x32_bf16 v[144:147], a[196:199], a[236:239], v[144:147]
    v_accvgpr_read_b32 v237, a137
    v_accvgpr_read_b32 v238, a138
    v_mfma_f32_16x16x32_bf16 v[152:155], a[192:195], a[240:243], v[152:155]
    v_accvgpr_read_b32 v239, a139
    v_accvgpr_read_b32 v240, a140
    v_mfma_f32_16x16x32_bf16 v[152:155], a[196:199], a[244:247], v[152:155]
    s_waitcnt lgkmcnt(1)
    s_waitcnt vmcnt(17) lgkmcnt(0)
    s_barrier
    v_mfma_f32_16x16x32_bf16 v[20:23], a[248:251], a[200:203], v[20:23]
    s_add_u32 m0, s39, 32768
    ds_read_b64_tr_b16 a[192:193], v218 offset:49152
    v_accvgpr_read_b32 v241, a141
    v_mfma_f32_16x16x32_bf16 v[20:23], a[252:255], a[204:207], v[20:23]
    buffer_load_dwordx4 v198, s[20:23], s67 offen lds
    v_mfma_f32_16x16x32_bf16 v[28:31], a[248:251], a[208:211], v[28:31]
    ds_read_b64_tr_b16 a[194:195], v218 offset:49664
    v_accvgpr_read_b32 v242, a142
    v_mfma_f32_16x16x32_bf16 v[28:31], a[252:255], a[212:215], v[28:31]
    ds_read_b64_tr_b16 a[196:197], v218 offset:53248
    v_accvgpr_read_b32 v243, a143
    v_mfma_f32_16x16x32_bf16 v[84:87], a[248:251], a[216:219], v[84:87]
    ds_read_b64_tr_b16 a[198:199], v218 offset:53760
    v_mul_f32 v236, v248, v236
    v_mfma_f32_16x16x32_bf16 v[84:87], a[252:255], a[220:223], v[84:87]
    buffer_load_dwordx4 v199, s[20:23], s67 offen offset:1024 lds
    v_mfma_f32_16x16x32_bf16 v[92:95], a[248:251], a[224:227], v[92:95]
    v_mul_f32 v237, v248, v237
    v_mul_f32 v238, v248, v238
    v_mfma_f32_16x16x32_bf16 v[92:95], a[252:255], a[228:231], v[92:95]
    v_mul_f32 v239, v248, v239
    v_mul_f32 v240, v248, v240
    v_mfma_f32_16x16x32_bf16 v[148:151], a[248:251], a[232:235], v[148:151]
    v_mul_f32 v241, v248, v241
    v_mul_f32 v242, v248, v242
    v_mfma_f32_16x16x32_bf16 v[148:151], a[252:255], a[236:239], v[148:151]
    buffer_load_dwordx4 v200, s[20:23], s67 offen offset:2048 lds
    v_mfma_f32_16x16x32_bf16 v[156:159], a[248:251], a[240:243], v[156:159]
    v_mul_f32 v243, v248, v243
    v_cvt_pk_bf16_f32 v236, v236, v237
    v_mfma_f32_16x16x32_bf16 v[156:159], a[252:255], a[244:247], v[156:159]
    s_waitcnt lgkmcnt(1)
    v_cvt_pk_bf16_f32 v237, v238, v239
    v_cvt_pk_bf16_f32 v238, v240, v241
    v_mfma_f32_16x16x32_bf16 v[32:35], a[192:195], a[200:203], v[32:35]
    s_waitcnt lgkmcnt(0)
    ds_read_b64_tr_b16 a[248:249], v218 offset:49160
    v_cvt_pk_bf16_f32 v239, v242, v243
    v_mfma_f32_16x16x32_bf16 v[32:35], a[196:199], a[204:207], v[32:35]
    buffer_load_dwordx4 v201, s[20:23], s67 offen offset:3072 lds
    v_mfma_f32_16x16x32_bf16 v[40:43], a[192:195], a[208:211], v[40:43]
    ds_read_b64_tr_b16 a[250:251], v218 offset:49672
    v_mfma_f32_16x16x32_bf16 v[40:43], a[196:199], a[212:215], v[40:43]
    ds_read_b64_tr_b16 a[252:253], v218 offset:53256
    v_mfma_f32_16x16x32_bf16 v[96:99], a[192:195], a[216:219], v[96:99]
    s_add_u32 m0, s40, 122880
    ds_read_b64_tr_b16 a[254:255], v218 offset:53768
    v_mfma_f32_16x16x32_bf16 v[96:99], a[196:199], a[220:223], v[96:99]
    buffer_load_dwordx4 v202, s[16:19], s95 offen lds
    v_mfma_f32_16x16x32_bf16 v[104:107], a[192:195], a[224:227], v[104:107]
    v_mfma_f32_16x16x32_bf16 v[104:107], a[196:199], a[228:231], v[104:107]
    v_mfma_f32_16x16x32_bf16 v[160:163], a[192:195], a[232:235], v[160:163]
    v_mfma_f32_16x16x32_bf16 v[160:163], a[196:199], a[236:239], v[160:163]
    buffer_load_dwordx4 v203, s[16:19], s95 offen offset:1024 lds
    v_mfma_f32_16x16x32_bf16 v[168:171], a[192:195], a[240:243], v[168:171]
    v_mfma_f32_16x16x32_bf16 v[168:171], a[196:199], a[244:247], v[168:171]
    s_waitcnt lgkmcnt(1)
    v_mfma_f32_16x16x32_bf16 v[36:39], a[248:251], a[200:203], v[36:39]
    s_waitcnt lgkmcnt(0)
    ds_read_b64_tr_b16 a[192:193], v219 offset:49152
    v_mfma_f32_16x16x32_bf16 v[36:39], a[252:255], a[204:207], v[36:39]
    buffer_load_dwordx4 v204, s[16:19], s95 offen offset:2048 lds
    v_mfma_f32_16x16x32_bf16 v[44:47], a[248:251], a[208:211], v[44:47]
    ds_read_b64_tr_b16 a[194:195], v219 offset:49664
    v_mfma_f32_16x16x32_bf16 v[44:47], a[252:255], a[212:215], v[44:47]
    ds_read_b64_tr_b16 a[196:197], v219 offset:53248
    v_mfma_f32_16x16x32_bf16 v[100:103], a[248:251], a[216:219], v[100:103]
    ds_read_b64_tr_b16 a[198:199], v219 offset:53760
    v_mfma_f32_16x16x32_bf16 v[100:103], a[252:255], a[220:223], v[100:103]
    buffer_load_dwordx4 v205, s[16:19], s95 offen offset:3072 lds
    v_mfma_f32_16x16x32_bf16 v[108:111], a[248:251], a[224:227], v[108:111]
    v_mfma_f32_16x16x32_bf16 v[108:111], a[252:255], a[228:231], v[108:111]
    s_add_u32 s43, s95, 40960
    buffer_store_dwordx4 v[228:231], v223, s[24:27], s54 offen offset:3072 sc1
    v_mfma_f32_16x16x32_bf16 v[164:167], a[248:251], a[232:235], v[164:167]
    s_add_u32 m0, s40, 126976
    s_add_u32 s54, s41, 8192
    v_mfma_f32_16x16x32_bf16 v[164:167], a[252:255], a[236:239], v[164:167]
    buffer_load_dwordx4 v202, s[16:19], s43 offen lds
    v_mfma_f32_16x16x32_bf16 v[172:175], a[248:251], a[240:243], v[172:175]
    buffer_store_dwordx4 v[232:235], v223, s[24:27], s54 offen sc1
    v_mfma_f32_16x16x32_bf16 v[172:175], a[252:255], a[244:247], v[172:175]
    s_waitcnt lgkmcnt(1)
    buffer_store_dwordx4 v[236:239], v223, s[24:27], s54 offen offset:1024 sc1
    v_mfma_f32_16x16x32_bf16 v[48:51], a[192:195], a[200:203], v[48:51]
    s_waitcnt lgkmcnt(0)
    ds_read_b64_tr_b16 a[248:249], v219 offset:49160
    v_mfma_f32_16x16x32_bf16 v[48:51], a[196:199], a[204:207], v[48:51]
    buffer_load_dwordx4 v203, s[16:19], s43 offen offset:1024 lds
    v_mfma_f32_16x16x32_bf16 v[56:59], a[192:195], a[208:211], v[56:59]
    ds_read_b64_tr_b16 a[250:251], v219 offset:49672
    v_mfma_f32_16x16x32_bf16 v[56:59], a[196:199], a[212:215], v[56:59]
    ds_read_b64_tr_b16 a[252:253], v219 offset:53256
    v_mfma_f32_16x16x32_bf16 v[112:115], a[192:195], a[216:219], v[112:115]
    ds_read_b64_tr_b16 a[254:255], v219 offset:53768
    v_mfma_f32_16x16x32_bf16 v[112:115], a[196:199], a[220:223], v[112:115]
    v_mfma_f32_16x16x32_bf16 v[120:123], a[192:195], a[224:227], v[120:123]
    v_mfma_f32_16x16x32_bf16 v[120:123], a[196:199], a[228:231], v[120:123]
    v_mfma_f32_16x16x32_bf16 v[176:179], a[192:195], a[232:235], v[176:179]
    v_mfma_f32_16x16x32_bf16 v[176:179], a[196:199], a[236:239], v[176:179]
    v_mfma_f32_16x16x32_bf16 v[184:187], a[192:195], a[240:243], v[184:187]
    v_mfma_f32_16x16x32_bf16 v[184:187], a[196:199], a[244:247], v[184:187]
    s_waitcnt lgkmcnt(1)
    s_waitcnt vmcnt(17) lgkmcnt(0)
    s_barrier
    v_mfma_f32_16x16x32_bf16 v[52:55], a[248:251], a[200:203], v[52:55]
    ds_read_b64_tr_b16 a[192:193], v218
    v_mfma_f32_16x16x32_bf16 v[52:55], a[252:255], a[204:207], v[52:55]
    ds_read_b64_tr_b16 a[194:195], v218 offset:512
    v_mfma_f32_16x16x32_bf16 v[60:63], a[248:251], a[208:211], v[60:63]
    ds_read_b128 a[200:203], v220
    v_mfma_f32_16x16x32_bf16 v[60:63], a[252:255], a[212:215], v[60:63]
    ds_read_b64_tr_b16 a[196:197], v218 offset:4096
    v_mfma_f32_16x16x32_bf16 v[116:119], a[248:251], a[216:219], v[116:119]
    ds_read_b64_tr_b16 a[198:199], v218 offset:4608
    v_mfma_f32_16x16x32_bf16 v[116:119], a[252:255], a[220:223], v[116:119]
    ds_read_b128 a[204:207], v221
    v_mfma_f32_16x16x32_bf16 v[124:127], a[248:251], a[224:227], v[124:127]
    ds_read_b128 a[208:211], v220 offset:2048
    v_mfma_f32_16x16x32_bf16 v[124:127], a[252:255], a[228:231], v[124:127]
    ds_read_b128 a[212:215], v221 offset:2048
    v_mfma_f32_16x16x32_bf16 v[180:183], a[248:251], a[232:235], v[180:183]
    ds_read_b128 a[216:219], v220 offset:4096
    v_mfma_f32_16x16x32_bf16 v[180:183], a[252:255], a[236:239], v[180:183]
    ds_read_b128 a[220:223], v221 offset:4096
    v_mfma_f32_16x16x32_bf16 v[188:191], a[248:251], a[240:243], v[188:191]
    ds_read_b128 a[224:227], v220 offset:6144
    v_mfma_f32_16x16x32_bf16 v[188:191], a[252:255], a[244:247], v[188:191]
    s_waitcnt lgkmcnt(7)
    ds_read_b128 a[228:231], v221 offset:6144
    v_mfma_f32_16x16x32_bf16 v[0:3], a[192:195], a[200:203], v[0:3]
    s_waitcnt lgkmcnt(6)
    ds_read_b128 a[232:235], v220 offset:8192
    v_accvgpr_read_b32 v228, a160
    v_mfma_f32_16x16x32_bf16 v[0:3], a[196:199], a[204:207], v[0:3]
    s_waitcnt lgkmcnt(6)
    ds_read_b128 a[236:239], v221 offset:8192
    v_accvgpr_read_b32 v229, a161
    v_mfma_f32_16x16x32_bf16 v[8:11], a[192:195], a[208:211], v[8:11]
    s_waitcnt lgkmcnt(6)
    ds_read_b128 a[240:243], v220 offset:10240
    v_accvgpr_read_b32 v230, a162
    v_mfma_f32_16x16x32_bf16 v[8:11], a[196:199], a[212:215], v[8:11]
    s_waitcnt lgkmcnt(6)
    ds_read_b128 a[244:247], v221 offset:10240
    v_accvgpr_read_b32 v231, a163
    v_mfma_f32_16x16x32_bf16 v[64:67], a[192:195], a[216:219], v[64:67]
    s_waitcnt lgkmcnt(6)
    ds_read_b64_tr_b16 a[248:249], v218 offset:8
    v_accvgpr_read_b32 v232, a164
    v_mfma_f32_16x16x32_bf16 v[64:67], a[196:199], a[220:223], v[64:67]
    s_waitcnt lgkmcnt(6)
    ds_read_b64_tr_b16 a[250:251], v218 offset:520
    v_accvgpr_read_b32 v233, a165
    v_mfma_f32_16x16x32_bf16 v[72:75], a[192:195], a[224:227], v[72:75]
    s_waitcnt lgkmcnt(6)
    ds_read_b64_tr_b16 a[252:253], v218 offset:4104
    v_accvgpr_read_b32 v234, a166
    v_mfma_f32_16x16x32_bf16 v[72:75], a[196:199], a[228:231], v[72:75]
    s_waitcnt lgkmcnt(6)
    ds_read_b64_tr_b16 a[254:255], v218 offset:4616
    v_accvgpr_read_b32 v235, a167
    v_mfma_f32_16x16x32_bf16 v[128:131], a[192:195], a[232:235], v[128:131]
    s_waitcnt lgkmcnt(6)
    s_add_u32 m0, s39, 49152
    v_mul_f32 v228, v249, v228
    v_mfma_f32_16x16x32_bf16 v[128:131], a[196:199], a[236:239], v[128:131]
    s_waitcnt lgkmcnt(5)
    buffer_load_dwordx4 v198, s[20:23], s63 offen lds
    v_mfma_f32_16x16x32_bf16 v[136:139], a[192:195], a[240:243], v[136:139]
    s_waitcnt lgkmcnt(4)
    v_mul_f32 v229, v249, v229
    v_mul_f32 v230, v249, v230
    v_mfma_f32_16x16x32_bf16 v[136:139], a[196:199], a[244:247], v[136:139]
    s_waitcnt lgkmcnt(2)
    v_mul_f32 v231, v249, v231
    v_mul_f32 v232, v249, v232
    v_mfma_f32_16x16x32_bf16 v[4:7], a[248:251], a[200:203], v[4:7]
    s_waitcnt lgkmcnt(0)
    ds_read_b64_tr_b16 a[192:193], v219
    v_mul_f32 v233, v249, v233
    v_mfma_f32_16x16x32_bf16 v[4:7], a[252:255], a[204:207], v[4:7]
    buffer_load_dwordx4 v199, s[20:23], s63 offen offset:1024 lds
    v_mfma_f32_16x16x32_bf16 v[12:15], a[248:251], a[208:211], v[12:15]
    ds_read_b64_tr_b16 a[194:195], v219 offset:512
    v_mul_f32 v234, v249, v234
    v_mfma_f32_16x16x32_bf16 v[12:15], a[252:255], a[212:215], v[12:15]
    ds_read_b64_tr_b16 a[196:197], v219 offset:4096
    v_mul_f32 v235, v249, v235
    v_mfma_f32_16x16x32_bf16 v[68:71], a[248:251], a[216:219], v[68:71]
    ds_read_b64_tr_b16 a[198:199], v219 offset:4608
    v_cvt_pk_bf16_f32 v228, v228, v229
    v_mfma_f32_16x16x32_bf16 v[68:71], a[252:255], a[220:223], v[68:71]
    buffer_load_dwordx4 v200, s[20:23], s63 offen offset:2048 lds
    v_mfma_f32_16x16x32_bf16 v[76:79], a[248:251], a[224:227], v[76:79]
    v_cvt_pk_bf16_f32 v229, v230, v231
    v_cvt_pk_bf16_f32 v230, v232, v233
    v_mfma_f32_16x16x32_bf16 v[76:79], a[252:255], a[228:231], v[76:79]
    v_cvt_pk_bf16_f32 v231, v234, v235
    v_accvgpr_read_b32 v232, a168
    v_mfma_f32_16x16x32_bf16 v[132:135], a[248:251], a[232:235], v[132:135]
    v_accvgpr_read_b32 v233, a169
    v_accvgpr_read_b32 v234, a170
    v_mfma_f32_16x16x32_bf16 v[132:135], a[252:255], a[236:239], v[132:135]
    buffer_load_dwordx4 v201, s[20:23], s63 offen offset:3072 lds
    v_mfma_f32_16x16x32_bf16 v[140:143], a[248:251], a[240:243], v[140:143]
    v_accvgpr_read_b32 v235, a171
    v_accvgpr_read_b32 v236, a172
    v_mfma_f32_16x16x32_bf16 v[140:143], a[252:255], a[244:247], v[140:143]
    s_waitcnt lgkmcnt(1)
    v_accvgpr_read_b32 v237, a173
    v_accvgpr_read_b32 v238, a174
    v_mfma_f32_16x16x32_bf16 v[16:19], a[192:195], a[200:203], v[16:19]
    s_waitcnt lgkmcnt(0)
    ds_read_b64_tr_b16 a[248:249], v219 offset:8
    v_accvgpr_read_b32 v239, a175
    v_mfma_f32_16x16x32_bf16 v[16:19], a[196:199], a[204:207], v[16:19]
    v_mul_f32 v232, v249, v232
    v_mul_f32 v233, v249, v233
    v_mfma_f32_16x16x32_bf16 v[24:27], a[192:195], a[208:211], v[24:27]
    s_bfe_u32 s95, s50, 0x40018
    ds_read_b64_tr_b16 a[250:251], v219 offset:520
    v_mul_f32 v234, v249, v234
    v_mfma_f32_16x16x32_bf16 v[24:27], a[196:199], a[212:215], v[24:27]
    s_lshl_b32 s67, s95, 19
    ds_read_b64_tr_b16 a[252:253], v219 offset:4104
    v_mul_f32 v235, v249, v235
    v_mfma_f32_16x16x32_bf16 v[80:83], a[192:195], a[216:219], v[80:83]
    s_add_u32 s67, s67, s37
    ds_read_b64_tr_b16 a[254:255], v219 offset:4616
    v_mul_f32 v236, v249, v236
    v_mfma_f32_16x16x32_bf16 v[80:83], a[196:199], a[220:223], v[80:83]
    s_lshl_b32 s95, s95, 7
    v_mul_f32 v237, v249, v237
    v_mul_f32 v238, v249, v238
    v_mfma_f32_16x16x32_bf16 v[88:91], a[192:195], a[224:227], v[88:91]
    s_add_u32 s95, s95, s38
    v_mul_f32 v239, v249, v239
    v_cvt_pk_bf16_f32 v232, v232, v233
    v_mfma_f32_16x16x32_bf16 v[88:91], a[196:199], a[228:231], v[88:91]
    s_add_u32 s63, s67, 128
    v_cvt_pk_bf16_f32 v233, v234, v235
    v_cvt_pk_bf16_f32 v234, v236, v237
    v_mfma_f32_16x16x32_bf16 v[144:147], a[192:195], a[232:235], v[144:147]
    v_cvt_pk_bf16_f32 v235, v238, v239
    v_accvgpr_read_b32 v236, a144
    v_mfma_f32_16x16x32_bf16 v[144:147], a[196:199], a[236:239], v[144:147]
    v_accvgpr_read_b32 v237, a145
    v_accvgpr_read_b32 v238, a146
    v_mfma_f32_16x16x32_bf16 v[152:155], a[192:195], a[240:243], v[152:155]
    v_accvgpr_read_b32 v239, a147
    v_accvgpr_read_b32 v240, a148
    v_mfma_f32_16x16x32_bf16 v[152:155], a[196:199], a[244:247], v[152:155]
    s_waitcnt lgkmcnt(1)
    s_waitcnt vmcnt(17) lgkmcnt(0)
    s_barrier
    v_mfma_f32_16x16x32_bf16 v[20:23], a[248:251], a[200:203], v[20:23]
    s_add_u32 m0, s39, 0
    ds_read_b64_tr_b16 a[192:193], v218 offset:16384
    v_accvgpr_read_b32 v241, a149
    v_mfma_f32_16x16x32_bf16 v[20:23], a[252:255], a[204:207], v[20:23]
    buffer_load_dwordx4 v198, s[20:23], s67 offen lds
    v_mfma_f32_16x16x32_bf16 v[28:31], a[248:251], a[208:211], v[28:31]
    ds_read_b64_tr_b16 a[194:195], v218 offset:16896
    v_accvgpr_read_b32 v242, a150
    v_mfma_f32_16x16x32_bf16 v[28:31], a[252:255], a[212:215], v[28:31]
    ds_read_b64_tr_b16 a[196:197], v218 offset:20480
    v_accvgpr_read_b32 v243, a151
    v_mfma_f32_16x16x32_bf16 v[84:87], a[248:251], a[216:219], v[84:87]
    ds_read_b64_tr_b16 a[198:199], v218 offset:20992
    v_mul_f32 v236, v248, v236
    v_mfma_f32_16x16x32_bf16 v[84:87], a[252:255], a[220:223], v[84:87]
    buffer_load_dwordx4 v199, s[20:23], s67 offen offset:1024 lds
    v_mfma_f32_16x16x32_bf16 v[92:95], a[248:251], a[224:227], v[92:95]
    v_mul_f32 v237, v248, v237
    v_mul_f32 v238, v248, v238
    v_mfma_f32_16x16x32_bf16 v[92:95], a[252:255], a[228:231], v[92:95]
    v_mul_f32 v239, v248, v239
    v_mul_f32 v240, v248, v240
    v_mfma_f32_16x16x32_bf16 v[148:151], a[248:251], a[232:235], v[148:151]
    v_mul_f32 v241, v248, v241
    v_mul_f32 v242, v248, v242
    v_mfma_f32_16x16x32_bf16 v[148:151], a[252:255], a[236:239], v[148:151]
    buffer_load_dwordx4 v200, s[20:23], s67 offen offset:2048 lds
    v_mfma_f32_16x16x32_bf16 v[156:159], a[248:251], a[240:243], v[156:159]
    v_mul_f32 v243, v248, v243
    v_cvt_pk_bf16_f32 v236, v236, v237
    v_mfma_f32_16x16x32_bf16 v[156:159], a[252:255], a[244:247], v[156:159]
    s_waitcnt lgkmcnt(1)
    v_cvt_pk_bf16_f32 v237, v238, v239
    v_cvt_pk_bf16_f32 v238, v240, v241
    v_mfma_f32_16x16x32_bf16 v[32:35], a[192:195], a[200:203], v[32:35]
    s_waitcnt lgkmcnt(0)
    ds_read_b64_tr_b16 a[248:249], v218 offset:16392
    v_cvt_pk_bf16_f32 v239, v242, v243
    v_mfma_f32_16x16x32_bf16 v[32:35], a[196:199], a[204:207], v[32:35]
    buffer_load_dwordx4 v201, s[20:23], s67 offen offset:3072 lds
    v_mfma_f32_16x16x32_bf16 v[40:43], a[192:195], a[208:211], v[40:43]
    ds_read_b64_tr_b16 a[250:251], v218 offset:16904
    v_mfma_f32_16x16x32_bf16 v[40:43], a[196:199], a[212:215], v[40:43]
    ds_read_b64_tr_b16 a[252:253], v218 offset:20488
    v_mfma_f32_16x16x32_bf16 v[96:99], a[192:195], a[216:219], v[96:99]
    s_add_u32 m0, s40, 98304
    ds_read_b64_tr_b16 a[254:255], v218 offset:21000
    v_mfma_f32_16x16x32_bf16 v[96:99], a[196:199], a[220:223], v[96:99]
    buffer_load_dwordx4 v202, s[16:19], s95 offen lds
    v_mfma_f32_16x16x32_bf16 v[104:107], a[192:195], a[224:227], v[104:107]
    v_mfma_f32_16x16x32_bf16 v[104:107], a[196:199], a[228:231], v[104:107]
    v_mfma_f32_16x16x32_bf16 v[160:163], a[192:195], a[232:235], v[160:163]
    v_mfma_f32_16x16x32_bf16 v[160:163], a[196:199], a[236:239], v[160:163]
    buffer_load_dwordx4 v203, s[16:19], s95 offen offset:1024 lds
    v_mfma_f32_16x16x32_bf16 v[168:171], a[192:195], a[240:243], v[168:171]
    v_mfma_f32_16x16x32_bf16 v[168:171], a[196:199], a[244:247], v[168:171]
    s_waitcnt lgkmcnt(1)
    v_mfma_f32_16x16x32_bf16 v[36:39], a[248:251], a[200:203], v[36:39]
    s_waitcnt lgkmcnt(0)
    ds_read_b64_tr_b16 a[192:193], v219 offset:16384
    v_mfma_f32_16x16x32_bf16 v[36:39], a[252:255], a[204:207], v[36:39]
    buffer_load_dwordx4 v204, s[16:19], s95 offen offset:2048 lds
    v_mfma_f32_16x16x32_bf16 v[44:47], a[248:251], a[208:211], v[44:47]
    ds_read_b64_tr_b16 a[194:195], v219 offset:16896
    v_mfma_f32_16x16x32_bf16 v[44:47], a[252:255], a[212:215], v[44:47]
    ds_read_b64_tr_b16 a[196:197], v219 offset:20480
    v_mfma_f32_16x16x32_bf16 v[100:103], a[248:251], a[216:219], v[100:103]
    ds_read_b64_tr_b16 a[198:199], v219 offset:20992
    v_mfma_f32_16x16x32_bf16 v[100:103], a[252:255], a[220:223], v[100:103]
    buffer_load_dwordx4 v205, s[16:19], s95 offen offset:3072 lds
    v_mfma_f32_16x16x32_bf16 v[108:111], a[248:251], a[224:227], v[108:111]
    v_mfma_f32_16x16x32_bf16 v[108:111], a[252:255], a[228:231], v[108:111]
    s_add_u32 s44, s95, 40960
    buffer_store_dwordx4 v[228:231], v223, s[24:27], s54 offen offset:2048 sc1
    v_mfma_f32_16x16x32_bf16 v[164:167], a[248:251], a[232:235], v[164:167]
    s_add_u32 m0, s40, 102400
    buffer_store_dwordx4 v[232:235], v223, s[24:27], s54 offen offset:3072 sc1
    v_mfma_f32_16x16x32_bf16 v[164:167], a[252:255], a[236:239], v[164:167]
    buffer_load_dwordx4 v202, s[16:19], s44 offen lds
    v_mfma_f32_16x16x32_bf16 v[172:175], a[248:251], a[240:243], v[172:175]
    s_add_u32 s54, s41, 20480
    buffer_store_dwordx4 v[236:239], v223, s[24:27], s54 offen sc1
    v_mfma_f32_16x16x32_bf16 v[172:175], a[252:255], a[244:247], v[172:175]
    s_waitcnt lgkmcnt(1)
    v_mfma_f32_16x16x32_bf16 v[48:51], a[192:195], a[200:203], v[48:51]
    s_waitcnt lgkmcnt(0)
    ds_read_b64_tr_b16 a[248:249], v219 offset:16392
    v_mfma_f32_16x16x32_bf16 v[48:51], a[196:199], a[204:207], v[48:51]
    buffer_load_dwordx4 v203, s[16:19], s44 offen offset:1024 lds
    v_mfma_f32_16x16x32_bf16 v[56:59], a[192:195], a[208:211], v[56:59]
    ds_read_b64_tr_b16 a[250:251], v219 offset:16904
    v_mfma_f32_16x16x32_bf16 v[56:59], a[196:199], a[212:215], v[56:59]
    ds_read_b64_tr_b16 a[252:253], v219 offset:20488
    v_mfma_f32_16x16x32_bf16 v[112:115], a[192:195], a[216:219], v[112:115]
    ds_read_b64_tr_b16 a[254:255], v219 offset:21000
    v_mfma_f32_16x16x32_bf16 v[112:115], a[196:199], a[220:223], v[112:115]
    v_mfma_f32_16x16x32_bf16 v[120:123], a[192:195], a[224:227], v[120:123]
    v_mfma_f32_16x16x32_bf16 v[120:123], a[196:199], a[228:231], v[120:123]
    v_mfma_f32_16x16x32_bf16 v[176:179], a[192:195], a[232:235], v[176:179]
    v_mfma_f32_16x16x32_bf16 v[176:179], a[196:199], a[236:239], v[176:179]
    v_mfma_f32_16x16x32_bf16 v[184:187], a[192:195], a[240:243], v[184:187]
    v_mfma_f32_16x16x32_bf16 v[184:187], a[196:199], a[244:247], v[184:187]
    s_waitcnt lgkmcnt(1)
    s_waitcnt vmcnt(17) lgkmcnt(0)
    s_barrier
    v_mfma_f32_16x16x32_bf16 v[52:55], a[248:251], a[200:203], v[52:55]
    ds_read_b64_tr_b16 a[192:193], v218 offset:32768
    v_mfma_f32_16x16x32_bf16 v[52:55], a[252:255], a[204:207], v[52:55]
    ds_read_b64_tr_b16 a[194:195], v218 offset:33280
    v_mfma_f32_16x16x32_bf16 v[60:63], a[248:251], a[208:211], v[60:63]
    ds_read_b128 a[200:203], v220 offset:24576
    v_mfma_f32_16x16x32_bf16 v[60:63], a[252:255], a[212:215], v[60:63]
    ds_read_b64_tr_b16 a[196:197], v218 offset:36864
    v_mfma_f32_16x16x32_bf16 v[116:119], a[248:251], a[216:219], v[116:119]
    ds_read_b64_tr_b16 a[198:199], v218 offset:37376
    v_mfma_f32_16x16x32_bf16 v[116:119], a[252:255], a[220:223], v[116:119]
    ds_read_b128 a[204:207], v221 offset:24576
    v_mfma_f32_16x16x32_bf16 v[124:127], a[248:251], a[224:227], v[124:127]
    ds_read_b128 a[208:211], v220 offset:26624
    v_mfma_f32_16x16x32_bf16 v[124:127], a[252:255], a[228:231], v[124:127]
    ds_read_b128 a[212:215], v221 offset:26624
    v_mfma_f32_16x16x32_bf16 v[180:183], a[248:251], a[232:235], v[180:183]
    ds_read_b128 a[216:219], v220 offset:28672
    v_mfma_f32_16x16x32_bf16 v[180:183], a[252:255], a[236:239], v[180:183]
    ds_read_b128 a[220:223], v221 offset:28672
    v_mfma_f32_16x16x32_bf16 v[188:191], a[248:251], a[240:243], v[188:191]
    ds_read_b128 a[224:227], v220 offset:30720
    v_mfma_f32_16x16x32_bf16 v[188:191], a[252:255], a[244:247], v[188:191]
    s_waitcnt lgkmcnt(7)
    ds_read_b128 a[228:231], v221 offset:30720
    v_mfma_f32_16x16x32_bf16 v[0:3], a[192:195], a[200:203], v[0:3]
    s_waitcnt lgkmcnt(6)
    ds_read_b128 a[232:235], v220 offset:32768
    v_accvgpr_read_b32 v228, a152
    v_mfma_f32_16x16x32_bf16 v[0:3], a[196:199], a[204:207], v[0:3]
    s_waitcnt lgkmcnt(6)
    ds_read_b128 a[236:239], v221 offset:32768
    v_accvgpr_read_b32 v229, a153
    v_mfma_f32_16x16x32_bf16 v[8:11], a[192:195], a[208:211], v[8:11]
    s_waitcnt lgkmcnt(6)
    ds_read_b128 a[240:243], v220 offset:34816
    v_accvgpr_read_b32 v230, a154
    v_mfma_f32_16x16x32_bf16 v[8:11], a[196:199], a[212:215], v[8:11]
    s_waitcnt lgkmcnt(6)
    ds_read_b128 a[244:247], v221 offset:34816
    v_accvgpr_read_b32 v231, a155
    v_mfma_f32_16x16x32_bf16 v[64:67], a[192:195], a[216:219], v[64:67]
    s_waitcnt lgkmcnt(6)
    ds_read_b64_tr_b16 a[248:249], v218 offset:32776
    v_accvgpr_read_b32 v232, a156
    v_mfma_f32_16x16x32_bf16 v[64:67], a[196:199], a[220:223], v[64:67]
    s_waitcnt lgkmcnt(6)
    ds_read_b64_tr_b16 a[250:251], v218 offset:33288
    v_accvgpr_read_b32 v233, a157
    v_mfma_f32_16x16x32_bf16 v[72:75], a[192:195], a[224:227], v[72:75]
    s_waitcnt lgkmcnt(6)
    ds_read_b64_tr_b16 a[252:253], v218 offset:36872
    v_accvgpr_read_b32 v234, a158
    v_mfma_f32_16x16x32_bf16 v[72:75], a[196:199], a[228:231], v[72:75]
    s_waitcnt lgkmcnt(6)
    ds_read_b64_tr_b16 a[254:255], v218 offset:37384
    v_accvgpr_read_b32 v235, a159
    v_mfma_f32_16x16x32_bf16 v[128:131], a[192:195], a[232:235], v[128:131]
    s_waitcnt lgkmcnt(6)
    s_add_u32 m0, s39, 16384
    v_mul_f32 v228, v248, v228
    v_mfma_f32_16x16x32_bf16 v[128:131], a[196:199], a[236:239], v[128:131]
    s_waitcnt lgkmcnt(5)
    buffer_load_dwordx4 v198, s[20:23], s63 offen lds
    v_mfma_f32_16x16x32_bf16 v[136:139], a[192:195], a[240:243], v[136:139]
    s_waitcnt lgkmcnt(4)
    v_mul_f32 v229, v248, v229
    v_mul_f32 v230, v248, v230
    v_mfma_f32_16x16x32_bf16 v[136:139], a[196:199], a[244:247], v[136:139]
    s_waitcnt lgkmcnt(2)
    v_mul_f32 v231, v248, v231
    v_mul_f32 v232, v248, v232
    v_mfma_f32_16x16x32_bf16 v[4:7], a[248:251], a[200:203], v[4:7]
    s_waitcnt lgkmcnt(0)
    ds_read_b64_tr_b16 a[192:193], v219 offset:32768
    v_mul_f32 v233, v248, v233
    v_mfma_f32_16x16x32_bf16 v[4:7], a[252:255], a[204:207], v[4:7]
    buffer_load_dwordx4 v199, s[20:23], s63 offen offset:1024 lds
    v_mfma_f32_16x16x32_bf16 v[12:15], a[248:251], a[208:211], v[12:15]
    ds_read_b64_tr_b16 a[194:195], v219 offset:33280
    v_mul_f32 v234, v248, v234
    v_mfma_f32_16x16x32_bf16 v[12:15], a[252:255], a[212:215], v[12:15]
    ds_read_b64_tr_b16 a[196:197], v219 offset:36864
    v_mul_f32 v235, v248, v235
    v_mfma_f32_16x16x32_bf16 v[68:71], a[248:251], a[216:219], v[68:71]
    ds_read_b64_tr_b16 a[198:199], v219 offset:37376
    v_cvt_pk_bf16_f32 v228, v228, v229
    v_mfma_f32_16x16x32_bf16 v[68:71], a[252:255], a[220:223], v[68:71]
    buffer_load_dwordx4 v200, s[20:23], s63 offen offset:2048 lds
    v_mfma_f32_16x16x32_bf16 v[76:79], a[248:251], a[224:227], v[76:79]
    v_cvt_pk_bf16_f32 v229, v230, v231
    v_cvt_pk_bf16_f32 v230, v232, v233
    v_mfma_f32_16x16x32_bf16 v[76:79], a[252:255], a[228:231], v[76:79]
    v_cvt_pk_bf16_f32 v231, v234, v235
    v_accvgpr_read_b32 v232, a176
    v_mfma_f32_16x16x32_bf16 v[132:135], a[248:251], a[232:235], v[132:135]
    v_accvgpr_read_b32 v233, a177
    v_accvgpr_read_b32 v234, a178
    v_mfma_f32_16x16x32_bf16 v[132:135], a[252:255], a[236:239], v[132:135]
    buffer_load_dwordx4 v201, s[20:23], s63 offen offset:3072 lds
    v_mfma_f32_16x16x32_bf16 v[140:143], a[248:251], a[240:243], v[140:143]
    v_accvgpr_read_b32 v235, a179
    v_accvgpr_read_b32 v236, a180
    v_mfma_f32_16x16x32_bf16 v[140:143], a[252:255], a[244:247], v[140:143]
    s_waitcnt lgkmcnt(1)
    v_accvgpr_read_b32 v237, a181
    v_accvgpr_read_b32 v238, a182
    v_mfma_f32_16x16x32_bf16 v[16:19], a[192:195], a[200:203], v[16:19]
    s_waitcnt lgkmcnt(0)
    ds_read_b64_tr_b16 a[248:249], v219 offset:32776
    v_accvgpr_read_b32 v239, a183
    v_mfma_f32_16x16x32_bf16 v[16:19], a[196:199], a[204:207], v[16:19]
    v_mul_f32 v232, v249, v232
    v_mul_f32 v233, v249, v233
    v_mfma_f32_16x16x32_bf16 v[24:27], a[192:195], a[208:211], v[24:27]
    s_bfe_u32 s95, s50, 0x4001c
    ds_read_b64_tr_b16 a[250:251], v219 offset:33288
    v_mul_f32 v234, v249, v234
    v_mfma_f32_16x16x32_bf16 v[24:27], a[196:199], a[212:215], v[24:27]
    s_lshl_b32 s67, s95, 19
    ds_read_b64_tr_b16 a[252:253], v219 offset:36872
    v_mul_f32 v235, v249, v235
    v_mfma_f32_16x16x32_bf16 v[80:83], a[192:195], a[216:219], v[80:83]
    s_add_u32 s67, s67, s37
    ds_read_b64_tr_b16 a[254:255], v219 offset:37384
    v_mul_f32 v236, v249, v236
    v_mfma_f32_16x16x32_bf16 v[80:83], a[196:199], a[220:223], v[80:83]
    s_lshl_b32 s95, s95, 7
    v_mul_f32 v237, v249, v237
    v_mul_f32 v238, v249, v238
    v_mfma_f32_16x16x32_bf16 v[88:91], a[192:195], a[224:227], v[88:91]
    s_add_u32 s95, s95, s38
    v_mul_f32 v239, v249, v239
    v_cvt_pk_bf16_f32 v232, v232, v233
    v_mfma_f32_16x16x32_bf16 v[88:91], a[196:199], a[228:231], v[88:91]
    s_add_u32 s63, s67, 128
    v_cvt_pk_bf16_f32 v233, v234, v235
    v_cvt_pk_bf16_f32 v234, v236, v237
    v_mfma_f32_16x16x32_bf16 v[144:147], a[192:195], a[232:235], v[144:147]
    v_cvt_pk_bf16_f32 v235, v238, v239
    v_accvgpr_read_b32 v236, a184
    v_mfma_f32_16x16x32_bf16 v[144:147], a[196:199], a[236:239], v[144:147]
    v_accvgpr_read_b32 v237, a185
    v_accvgpr_read_b32 v238, a186
    v_mfma_f32_16x16x32_bf16 v[152:155], a[192:195], a[240:243], v[152:155]
    v_accvgpr_read_b32 v239, a187
    v_accvgpr_read_b32 v240, a188
    v_mfma_f32_16x16x32_bf16 v[152:155], a[196:199], a[244:247], v[152:155]
    s_waitcnt lgkmcnt(1)
    s_waitcnt vmcnt(17) lgkmcnt(0)
    s_barrier
    v_mfma_f32_16x16x32_bf16 v[20:23], a[248:251], a[200:203], v[20:23]
    s_add_u32 m0, s39, 32768
    ds_read_b64_tr_b16 a[192:193], v218 offset:49152
    v_accvgpr_read_b32 v241, a189
    v_mfma_f32_16x16x32_bf16 v[20:23], a[252:255], a[204:207], v[20:23]
    buffer_load_dwordx4 v198, s[20:23], s67 offen lds
    v_mfma_f32_16x16x32_bf16 v[28:31], a[248:251], a[208:211], v[28:31]
    ds_read_b64_tr_b16 a[194:195], v218 offset:49664
    v_accvgpr_read_b32 v242, a190
    v_mfma_f32_16x16x32_bf16 v[28:31], a[252:255], a[212:215], v[28:31]
    ds_read_b64_tr_b16 a[196:197], v218 offset:53248
    v_accvgpr_read_b32 v243, a191
    v_mfma_f32_16x16x32_bf16 v[84:87], a[248:251], a[216:219], v[84:87]
    ds_read_b64_tr_b16 a[198:199], v218 offset:53760
    v_mul_f32 v236, v249, v236
    v_mfma_f32_16x16x32_bf16 v[84:87], a[252:255], a[220:223], v[84:87]
    buffer_load_dwordx4 v199, s[20:23], s67 offen offset:1024 lds
    v_mfma_f32_16x16x32_bf16 v[92:95], a[248:251], a[224:227], v[92:95]
    v_mul_f32 v237, v249, v237
    v_mul_f32 v238, v249, v238
    v_mfma_f32_16x16x32_bf16 v[92:95], a[252:255], a[228:231], v[92:95]
    v_mul_f32 v239, v249, v239
    v_mul_f32 v240, v249, v240
    v_mfma_f32_16x16x32_bf16 v[148:151], a[248:251], a[232:235], v[148:151]
    v_mul_f32 v241, v249, v241
    v_mul_f32 v242, v249, v242
    v_mfma_f32_16x16x32_bf16 v[148:151], a[252:255], a[236:239], v[148:151]
    buffer_load_dwordx4 v200, s[20:23], s67 offen offset:2048 lds
    v_mfma_f32_16x16x32_bf16 v[156:159], a[248:251], a[240:243], v[156:159]
    v_mul_f32 v243, v249, v243
    v_cvt_pk_bf16_f32 v236, v236, v237
    v_mfma_f32_16x16x32_bf16 v[156:159], a[252:255], a[244:247], v[156:159]
    s_waitcnt lgkmcnt(1)
    v_cvt_pk_bf16_f32 v237, v238, v239
    v_cvt_pk_bf16_f32 v238, v240, v241
    v_mfma_f32_16x16x32_bf16 v[32:35], a[192:195], a[200:203], v[32:35]
    s_waitcnt lgkmcnt(0)
    ds_read_b64_tr_b16 a[248:249], v218 offset:49160
    v_cvt_pk_bf16_f32 v239, v242, v243
    v_mfma_f32_16x16x32_bf16 v[32:35], a[196:199], a[204:207], v[32:35]
    buffer_load_dwordx4 v201, s[20:23], s67 offen offset:3072 lds
    v_mfma_f32_16x16x32_bf16 v[40:43], a[192:195], a[208:211], v[40:43]
    ds_read_b64_tr_b16 a[250:251], v218 offset:49672
    v_mfma_f32_16x16x32_bf16 v[40:43], a[196:199], a[212:215], v[40:43]
    ds_read_b64_tr_b16 a[252:253], v218 offset:53256
    v_mfma_f32_16x16x32_bf16 v[96:99], a[192:195], a[216:219], v[96:99]
    s_add_u32 m0, s40, 122880
    ds_read_b64_tr_b16 a[254:255], v218 offset:53768
    v_mfma_f32_16x16x32_bf16 v[96:99], a[196:199], a[220:223], v[96:99]
    buffer_load_dwordx4 v202, s[16:19], s95 offen lds
    v_mfma_f32_16x16x32_bf16 v[104:107], a[192:195], a[224:227], v[104:107]
    v_mfma_f32_16x16x32_bf16 v[104:107], a[196:199], a[228:231], v[104:107]
    v_mfma_f32_16x16x32_bf16 v[160:163], a[192:195], a[232:235], v[160:163]
    v_mfma_f32_16x16x32_bf16 v[160:163], a[196:199], a[236:239], v[160:163]
    buffer_load_dwordx4 v203, s[16:19], s95 offen offset:1024 lds
    v_mfma_f32_16x16x32_bf16 v[168:171], a[192:195], a[240:243], v[168:171]
    v_mfma_f32_16x16x32_bf16 v[168:171], a[196:199], a[244:247], v[168:171]
    s_waitcnt lgkmcnt(1)
    v_mfma_f32_16x16x32_bf16 v[36:39], a[248:251], a[200:203], v[36:39]
    s_waitcnt lgkmcnt(0)
    ds_read_b64_tr_b16 a[192:193], v219 offset:49152
    v_mfma_f32_16x16x32_bf16 v[36:39], a[252:255], a[204:207], v[36:39]
    buffer_load_dwordx4 v204, s[16:19], s95 offen offset:2048 lds
    v_mfma_f32_16x16x32_bf16 v[44:47], a[248:251], a[208:211], v[44:47]
    ds_read_b64_tr_b16 a[194:195], v219 offset:49664
    v_mfma_f32_16x16x32_bf16 v[44:47], a[252:255], a[212:215], v[44:47]
    ds_read_b64_tr_b16 a[196:197], v219 offset:53248
    v_mfma_f32_16x16x32_bf16 v[100:103], a[248:251], a[216:219], v[100:103]
    ds_read_b64_tr_b16 a[198:199], v219 offset:53760
    v_mfma_f32_16x16x32_bf16 v[100:103], a[252:255], a[220:223], v[100:103]
    buffer_load_dwordx4 v205, s[16:19], s95 offen offset:3072 lds
    v_mfma_f32_16x16x32_bf16 v[108:111], a[248:251], a[224:227], v[108:111]
    v_mfma_f32_16x16x32_bf16 v[108:111], a[252:255], a[228:231], v[108:111]
    s_add_u32 s43, s95, 40960
    buffer_store_dwordx4 v[228:231], v223, s[24:27], s54 offen offset:1024 sc1
    v_mfma_f32_16x16x32_bf16 v[164:167], a[248:251], a[232:235], v[164:167]
    s_add_u32 m0, s40, 126976
    buffer_store_dwordx4 v[232:235], v223, s[24:27], s54 offen offset:2048 sc1
    v_mfma_f32_16x16x32_bf16 v[164:167], a[252:255], a[236:239], v[164:167]
    buffer_load_dwordx4 v202, s[16:19], s43 offen lds
    v_mfma_f32_16x16x32_bf16 v[172:175], a[248:251], a[240:243], v[172:175]
    buffer_store_dwordx4 v[236:239], v223, s[24:27], s54 offen offset:3072 sc1
    v_mfma_f32_16x16x32_bf16 v[172:175], a[252:255], a[244:247], v[172:175]
    s_waitcnt lgkmcnt(1)
    v_mfma_f32_16x16x32_bf16 v[48:51], a[192:195], a[200:203], v[48:51]
    s_waitcnt lgkmcnt(0)
    ds_read_b64_tr_b16 a[248:249], v219 offset:49160
    v_mfma_f32_16x16x32_bf16 v[48:51], a[196:199], a[204:207], v[48:51]
    buffer_load_dwordx4 v203, s[16:19], s43 offen offset:1024 lds
    v_mfma_f32_16x16x32_bf16 v[56:59], a[192:195], a[208:211], v[56:59]
    ds_read_b64_tr_b16 a[250:251], v219 offset:49672
    v_mfma_f32_16x16x32_bf16 v[56:59], a[196:199], a[212:215], v[56:59]
    ds_read_b64_tr_b16 a[252:253], v219 offset:53256
    v_mfma_f32_16x16x32_bf16 v[112:115], a[192:195], a[216:219], v[112:115]
    ds_read_b64_tr_b16 a[254:255], v219 offset:53768
    v_mfma_f32_16x16x32_bf16 v[112:115], a[196:199], a[220:223], v[112:115]
    v_mfma_f32_16x16x32_bf16 v[120:123], a[192:195], a[224:227], v[120:123]
    v_mfma_f32_16x16x32_bf16 v[120:123], a[196:199], a[228:231], v[120:123]
    v_mfma_f32_16x16x32_bf16 v[176:179], a[192:195], a[232:235], v[176:179]
    v_mfma_f32_16x16x32_bf16 v[176:179], a[196:199], a[236:239], v[176:179]
    v_mfma_f32_16x16x32_bf16 v[184:187], a[192:195], a[240:243], v[184:187]
    v_mfma_f32_16x16x32_bf16 v[184:187], a[196:199], a[244:247], v[184:187]
    s_waitcnt lgkmcnt(1)
    s_waitcnt vmcnt(17) lgkmcnt(0)
    s_barrier
    v_mfma_f32_16x16x32_bf16 v[52:55], a[248:251], a[200:203], v[52:55]
    ds_read_b64_tr_b16 a[192:193], v218
    v_mfma_f32_16x16x32_bf16 v[52:55], a[252:255], a[204:207], v[52:55]
    ds_read_b64_tr_b16 a[194:195], v218 offset:512
    v_mfma_f32_16x16x32_bf16 v[60:63], a[248:251], a[208:211], v[60:63]
    ds_read_b128 a[200:203], v220
    v_mfma_f32_16x16x32_bf16 v[60:63], a[252:255], a[212:215], v[60:63]
    ds_read_b64_tr_b16 a[196:197], v218 offset:4096
    v_mfma_f32_16x16x32_bf16 v[116:119], a[248:251], a[216:219], v[116:119]
    ds_read_b64_tr_b16 a[198:199], v218 offset:4608
    v_mfma_f32_16x16x32_bf16 v[116:119], a[252:255], a[220:223], v[116:119]
    ds_read_b128 a[204:207], v221
    v_mfma_f32_16x16x32_bf16 v[124:127], a[248:251], a[224:227], v[124:127]
    ds_read_b128 a[208:211], v220 offset:2048
    v_mfma_f32_16x16x32_bf16 v[124:127], a[252:255], a[228:231], v[124:127]
    ds_read_b128 a[212:215], v221 offset:2048
    v_mfma_f32_16x16x32_bf16 v[180:183], a[248:251], a[232:235], v[180:183]
    ds_read_b128 a[216:219], v220 offset:4096
    v_mfma_f32_16x16x32_bf16 v[180:183], a[252:255], a[236:239], v[180:183]
    ds_read_b128 a[220:223], v221 offset:4096
    v_mfma_f32_16x16x32_bf16 v[188:191], a[248:251], a[240:243], v[188:191]
    ds_read_b128 a[224:227], v220 offset:6144
    v_mfma_f32_16x16x32_bf16 v[188:191], a[252:255], a[244:247], v[188:191]
    s_waitcnt lgkmcnt(7)
    ds_read_b128 a[228:231], v221 offset:6144
    v_mfma_f32_16x16x32_bf16 v[0:3], a[192:195], a[200:203], v[0:3]
    s_waitcnt lgkmcnt(6)
    ds_read_b128 a[232:235], v220 offset:8192
    v_mfma_f32_16x16x32_bf16 v[0:3], a[196:199], a[204:207], v[0:3]
    s_waitcnt lgkmcnt(6)
    ds_read_b128 a[236:239], v221 offset:8192
    v_mfma_f32_16x16x32_bf16 v[8:11], a[192:195], a[208:211], v[8:11]
    s_waitcnt lgkmcnt(6)
    ds_read_b128 a[240:243], v220 offset:10240
    v_mfma_f32_16x16x32_bf16 v[8:11], a[196:199], a[212:215], v[8:11]
    s_waitcnt lgkmcnt(6)
    ds_read_b128 a[244:247], v221 offset:10240
    v_mfma_f32_16x16x32_bf16 v[64:67], a[192:195], a[216:219], v[64:67]
    s_waitcnt lgkmcnt(6)
    ds_read_b64_tr_b16 a[248:249], v218 offset:8
    v_mfma_f32_16x16x32_bf16 v[64:67], a[196:199], a[220:223], v[64:67]
    s_waitcnt lgkmcnt(6)
    ds_read_b64_tr_b16 a[250:251], v218 offset:520
    v_mfma_f32_16x16x32_bf16 v[72:75], a[192:195], a[224:227], v[72:75]
    s_waitcnt lgkmcnt(6)
    ds_read_b64_tr_b16 a[252:253], v218 offset:4104
    v_mfma_f32_16x16x32_bf16 v[72:75], a[196:199], a[228:231], v[72:75]
    s_waitcnt lgkmcnt(6)
    ds_read_b64_tr_b16 a[254:255], v218 offset:4616
    v_mfma_f32_16x16x32_bf16 v[128:131], a[192:195], a[232:235], v[128:131]
    s_waitcnt lgkmcnt(6)
    s_add_u32 m0, s39, 49152
    v_mfma_f32_16x16x32_bf16 v[128:131], a[196:199], a[236:239], v[128:131]
    s_waitcnt lgkmcnt(5)
    buffer_load_dwordx4 v198, s[20:23], s63 offen lds
    v_mfma_f32_16x16x32_bf16 v[136:139], a[192:195], a[240:243], v[136:139]
    s_waitcnt lgkmcnt(4)
    v_mfma_f32_16x16x32_bf16 v[136:139], a[196:199], a[244:247], v[136:139]
    s_waitcnt lgkmcnt(2)
    v_mfma_f32_16x16x32_bf16 v[4:7], a[248:251], a[200:203], v[4:7]
    s_waitcnt lgkmcnt(0)
    ds_read_b64_tr_b16 a[192:193], v219
    v_mfma_f32_16x16x32_bf16 v[4:7], a[252:255], a[204:207], v[4:7]
    buffer_load_dwordx4 v199, s[20:23], s63 offen offset:1024 lds
    v_mfma_f32_16x16x32_bf16 v[12:15], a[248:251], a[208:211], v[12:15]
    ds_read_b64_tr_b16 a[194:195], v219 offset:512
    v_mfma_f32_16x16x32_bf16 v[12:15], a[252:255], a[212:215], v[12:15]
    ds_read_b64_tr_b16 a[196:197], v219 offset:4096
    v_mfma_f32_16x16x32_bf16 v[68:71], a[248:251], a[216:219], v[68:71]
    ds_read_b64_tr_b16 a[198:199], v219 offset:4608
    v_mfma_f32_16x16x32_bf16 v[68:71], a[252:255], a[220:223], v[68:71]
    buffer_load_dwordx4 v200, s[20:23], s63 offen offset:2048 lds
    v_mfma_f32_16x16x32_bf16 v[76:79], a[248:251], a[224:227], v[76:79]
    v_mfma_f32_16x16x32_bf16 v[76:79], a[252:255], a[228:231], v[76:79]
    v_mfma_f32_16x16x32_bf16 v[132:135], a[248:251], a[232:235], v[132:135]
    v_mfma_f32_16x16x32_bf16 v[132:135], a[252:255], a[236:239], v[132:135]
    buffer_load_dwordx4 v201, s[20:23], s63 offen offset:3072 lds
    v_mfma_f32_16x16x32_bf16 v[140:143], a[248:251], a[240:243], v[140:143]
    v_mfma_f32_16x16x32_bf16 v[140:143], a[252:255], a[244:247], v[140:143]
    s_waitcnt lgkmcnt(1)
    v_mfma_f32_16x16x32_bf16 v[16:19], a[192:195], a[200:203], v[16:19]
    s_waitcnt lgkmcnt(0)
    ds_read_b64_tr_b16 a[248:249], v219 offset:8
    v_mfma_f32_16x16x32_bf16 v[16:19], a[196:199], a[204:207], v[16:19]
    v_mfma_f32_16x16x32_bf16 v[24:27], a[192:195], a[208:211], v[24:27]
    ds_read_b64_tr_b16 a[250:251], v219 offset:520
    v_mfma_f32_16x16x32_bf16 v[24:27], a[196:199], a[212:215], v[24:27]
    ds_read_b64_tr_b16 a[252:253], v219 offset:4104
    v_mfma_f32_16x16x32_bf16 v[80:83], a[192:195], a[216:219], v[80:83]
    ds_read_b64_tr_b16 a[254:255], v219 offset:4616
    v_mfma_f32_16x16x32_bf16 v[80:83], a[196:199], a[220:223], v[80:83]
    v_mfma_f32_16x16x32_bf16 v[88:91], a[192:195], a[224:227], v[88:91]
    v_mfma_f32_16x16x32_bf16 v[88:91], a[196:199], a[228:231], v[88:91]
    v_mfma_f32_16x16x32_bf16 v[144:147], a[192:195], a[232:235], v[144:147]
    v_mfma_f32_16x16x32_bf16 v[144:147], a[196:199], a[236:239], v[144:147]
    v_mfma_f32_16x16x32_bf16 v[152:155], a[192:195], a[240:243], v[152:155]
    v_mfma_f32_16x16x32_bf16 v[152:155], a[196:199], a[244:247], v[152:155]
    s_waitcnt lgkmcnt(1)
    s_waitcnt vmcnt(17) lgkmcnt(0)
    s_barrier
    s_add_u32 s43, s62, 16384
    s_and_b32 s43, s43, 0x1ffff
    s_add_u32 s43, s43, s36
    v_mfma_f32_16x16x32_bf16 v[20:23], a[248:251], a[200:203], v[20:23]
    s_add_u32 m0, s39, 0
    ds_read_b64_tr_b16 a[192:193], v218 offset:16384
    v_mfma_f32_16x16x32_bf16 v[20:23], a[252:255], a[204:207], v[20:23]
    buffer_load_dwordx4 v192, s[8:11], s43 offen nt lds
    v_mfma_f32_16x16x32_bf16 v[28:31], a[248:251], a[208:211], v[28:31]
    ds_read_b64_tr_b16 a[194:195], v218 offset:16896
    v_mfma_f32_16x16x32_bf16 v[28:31], a[252:255], a[212:215], v[28:31]
    ds_read_b64_tr_b16 a[196:197], v218 offset:20480
    v_mfma_f32_16x16x32_bf16 v[84:87], a[248:251], a[216:219], v[84:87]
    ds_read_b64_tr_b16 a[198:199], v218 offset:20992
    v_mfma_f32_16x16x32_bf16 v[84:87], a[252:255], a[220:223], v[84:87]
    v_mfma_f32_16x16x32_bf16 v[92:95], a[248:251], a[224:227], v[92:95]
    v_mfma_f32_16x16x32_bf16 v[92:95], a[252:255], a[228:231], v[92:95]
    v_mfma_f32_16x16x32_bf16 v[148:151], a[248:251], a[232:235], v[148:151]
    v_mfma_f32_16x16x32_bf16 v[148:151], a[252:255], a[236:239], v[148:151]
    buffer_load_dwordx4 v193, s[8:11], s43 offen offset:1024 nt lds
    v_mfma_f32_16x16x32_bf16 v[156:159], a[248:251], a[240:243], v[156:159]
    v_mfma_f32_16x16x32_bf16 v[156:159], a[252:255], a[244:247], v[156:159]
    s_waitcnt lgkmcnt(1)
    v_mfma_f32_16x16x32_bf16 v[32:35], a[192:195], a[200:203], v[32:35]
    s_waitcnt lgkmcnt(0)
    ds_read_b64_tr_b16 a[248:249], v218 offset:16392
    v_mfma_f32_16x16x32_bf16 v[32:35], a[196:199], a[204:207], v[32:35]
    buffer_load_dwordx4 v194, s[8:11], s43 offen offset:2048 nt lds
    v_mfma_f32_16x16x32_bf16 v[40:43], a[192:195], a[208:211], v[40:43]
    ds_read_b64_tr_b16 a[250:251], v218 offset:16904
    v_mfma_f32_16x16x32_bf16 v[40:43], a[196:199], a[212:215], v[40:43]
    ds_read_b64_tr_b16 a[252:253], v218 offset:20488
    v_mfma_f32_16x16x32_bf16 v[96:99], a[192:195], a[216:219], v[96:99]
    ds_read_b64_tr_b16 a[254:255], v218 offset:21000
    v_mfma_f32_16x16x32_bf16 v[96:99], a[196:199], a[220:223], v[96:99]
    v_mfma_f32_16x16x32_bf16 v[104:107], a[192:195], a[224:227], v[104:107]
    v_mfma_f32_16x16x32_bf16 v[104:107], a[196:199], a[228:231], v[104:107]
    v_mfma_f32_16x16x32_bf16 v[160:163], a[192:195], a[232:235], v[160:163]
    v_mfma_f32_16x16x32_bf16 v[160:163], a[196:199], a[236:239], v[160:163]
    s_add_u32 s44, s62, 8192
    buffer_load_dwordx4 v195, s[8:11], s43 offen offset:3072 nt lds
    v_mfma_f32_16x16x32_bf16 v[168:171], a[192:195], a[240:243], v[168:171]
    s_and_b32 s44, s44, 0x1ffff
    v_mfma_f32_16x16x32_bf16 v[168:171], a[196:199], a[244:247], v[168:171]
    s_waitcnt lgkmcnt(1)
    s_add_u32 s44, s44, s36
    v_mfma_f32_16x16x32_bf16 v[36:39], a[248:251], a[200:203], v[36:39]
    s_waitcnt lgkmcnt(0)
    s_add_u32 m0, s39, 98304
    ds_read_b64_tr_b16 a[192:193], v219 offset:16384
    v_mfma_f32_16x16x32_bf16 v[36:39], a[252:255], a[204:207], v[36:39]
    buffer_load_dwordx4 v196, s[12:15], s44 offen nt lds
    v_mfma_f32_16x16x32_bf16 v[44:47], a[248:251], a[208:211], v[44:47]
    ds_read_b64_tr_b16 a[194:195], v219 offset:16896
    v_mfma_f32_16x16x32_bf16 v[44:47], a[252:255], a[212:215], v[44:47]
    ds_read_b64_tr_b16 a[196:197], v219 offset:20480
    v_mfma_f32_16x16x32_bf16 v[100:103], a[248:251], a[216:219], v[100:103]
    ds_read_b64_tr_b16 a[198:199], v219 offset:20992
    v_mfma_f32_16x16x32_bf16 v[100:103], a[252:255], a[220:223], v[100:103]
    v_mfma_f32_16x16x32_bf16 v[108:111], a[248:251], a[224:227], v[108:111]
    v_mfma_f32_16x16x32_bf16 v[108:111], a[252:255], a[228:231], v[108:111]
    v_mfma_f32_16x16x32_bf16 v[164:167], a[248:251], a[232:235], v[164:167]
    v_mfma_f32_16x16x32_bf16 v[164:167], a[252:255], a[236:239], v[164:167]
    buffer_load_dwordx4 v197, s[12:15], s44 offen offset:1024 nt lds
    v_mfma_f32_16x16x32_bf16 v[172:175], a[248:251], a[240:243], v[172:175]
    v_mfma_f32_16x16x32_bf16 v[172:175], a[252:255], a[244:247], v[172:175]
    s_waitcnt lgkmcnt(1)
    v_mfma_f32_16x16x32_bf16 v[48:51], a[192:195], a[200:203], v[48:51]
    s_waitcnt lgkmcnt(0)
    ds_read_b64_tr_b16 a[248:249], v219 offset:16392
    v_mfma_f32_16x16x32_bf16 v[48:51], a[196:199], a[204:207], v[48:51]
    buffer_load_dwordx4 v196, s[12:15], s44 offen offset:2048 nt lds
    v_mfma_f32_16x16x32_bf16 v[56:59], a[192:195], a[208:211], v[56:59]
    ds_read_b64_tr_b16 a[250:251], v219 offset:16904
    v_mfma_f32_16x16x32_bf16 v[56:59], a[196:199], a[212:215], v[56:59]
    ds_read_b64_tr_b16 a[252:253], v219 offset:20488
    v_mfma_f32_16x16x32_bf16 v[112:115], a[192:195], a[216:219], v[112:115]
    ds_read_b64_tr_b16 a[254:255], v219 offset:21000
    v_mfma_f32_16x16x32_bf16 v[112:115], a[196:199], a[220:223], v[112:115]
    v_mfma_f32_16x16x32_bf16 v[120:123], a[192:195], a[224:227], v[120:123]
    v_mfma_f32_16x16x32_bf16 v[120:123], a[196:199], a[228:231], v[120:123]
    v_mfma_f32_16x16x32_bf16 v[176:179], a[192:195], a[232:235], v[176:179]
    v_mfma_f32_16x16x32_bf16 v[176:179], a[196:199], a[236:239], v[176:179]
    buffer_load_dwordx4 v197, s[12:15], s44 offen offset:3072 nt lds
    v_mfma_f32_16x16x32_bf16 v[184:187], a[192:195], a[240:243], v[184:187]
    v_mfma_f32_16x16x32_bf16 v[184:187], a[196:199], a[244:247], v[184:187]
    s_waitcnt lgkmcnt(1)
    s_waitcnt vmcnt(12) lgkmcnt(0)
    s_barrier
    v_mfma_f32_16x16x32_bf16 v[52:55], a[248:251], a[200:203], v[52:55]
    ds_read_b64_tr_b16 a[192:193], v218 offset:32768
    v_mfma_f32_16x16x32_bf16 v[52:55], a[252:255], a[204:207], v[52:55]
    ds_read_b64_tr_b16 a[194:195], v218 offset:33280
    v_mfma_f32_16x16x32_bf16 v[60:63], a[248:251], a[208:211], v[60:63]
    ds_read_b128 a[200:203], v220 offset:24576
    v_mfma_f32_16x16x32_bf16 v[60:63], a[252:255], a[212:215], v[60:63]
    ds_read_b64_tr_b16 a[196:197], v218 offset:36864
    v_mfma_f32_16x16x32_bf16 v[116:119], a[248:251], a[216:219], v[116:119]
    ds_read_b64_tr_b16 a[198:199], v218 offset:37376
    v_mfma_f32_16x16x32_bf16 v[116:119], a[252:255], a[220:223], v[116:119]
    ds_read_b128 a[204:207], v221 offset:24576
    v_mfma_f32_16x16x32_bf16 v[124:127], a[248:251], a[224:227], v[124:127]
    ds_read_b128 a[208:211], v220 offset:26624
    v_mfma_f32_16x16x32_bf16 v[124:127], a[252:255], a[228:231], v[124:127]
    ds_read_b128 a[212:215], v221 offset:26624
    v_mfma_f32_16x16x32_bf16 v[180:183], a[248:251], a[232:235], v[180:183]
    ds_read_b128 a[216:219], v220 offset:28672
    v_mfma_f32_16x16x32_bf16 v[180:183], a[252:255], a[236:239], v[180:183]
    ds_read_b128 a[220:223], v221 offset:28672
    v_mfma_f32_16x16x32_bf16 v[188:191], a[248:251], a[240:243], v[188:191]
    ds_read_b128 a[224:227], v220 offset:30720
    v_mfma_f32_16x16x32_bf16 v[188:191], a[252:255], a[244:247], v[188:191]
    s_waitcnt lgkmcnt(7)
    ds_read_b128 a[228:231], v221 offset:30720
    v_mfma_f32_16x16x32_bf16 v[0:3], a[192:195], a[200:203], v[0:3]
    s_waitcnt lgkmcnt(6)
    ds_read_b128 a[232:235], v220 offset:32768
    v_mfma_f32_16x16x32_bf16 v[0:3], a[196:199], a[204:207], v[0:3]
    s_waitcnt lgkmcnt(6)
    ds_read_b128 a[236:239], v221 offset:32768
    v_mfma_f32_16x16x32_bf16 v[8:11], a[192:195], a[208:211], v[8:11]
    s_waitcnt lgkmcnt(6)
    s_add_u32 s41, s41, 98304
    ds_read_b128 a[240:243], v220 offset:34816
    s_and_b32 s68, s4, 3
    v_mfma_f32_16x16x32_bf16 v[8:11], a[196:199], a[212:215], v[8:11]
    s_waitcnt lgkmcnt(6)
    s_mul_i32 s68, s68, 1310720
    ds_read_b128 a[244:247], v221 offset:34816
    v_mfma_f32_16x16x32_bf16 v[64:67], a[192:195], a[216:219], v[64:67]
    s_waitcnt lgkmcnt(6)
    s_mul_i32 s69, s5, 5242880
    ds_read_b64_tr_b16 a[248:249], v218 offset:32776
    v_mfma_f32_16x16x32_bf16 v[64:67], a[196:199], a[220:223], v[64:67]
    s_waitcnt lgkmcnt(6)
    s_add_u32 s68, s68, s69
    ds_read_b64_tr_b16 a[250:251], v218 offset:33288
    v_mfma_f32_16x16x32_bf16 v[72:75], a[192:195], a[224:227], v[72:75]
    s_waitcnt lgkmcnt(6)
    s_add_u32 s68, s68, 50331648
    ds_read_b64_tr_b16 a[252:253], v218 offset:36872
    v_mfma_f32_16x16x32_bf16 v[72:75], a[196:199], a[228:231], v[72:75]
    s_waitcnt lgkmcnt(6)
    ds_read_b64_tr_b16 a[254:255], v218 offset:37384
    s_add_u32 s20, s90, s68
    s_addc_u32 s69, s91, 0
    v_mfma_f32_16x16x32_bf16 v[128:131], a[192:195], a[232:235], v[128:131]
    s_waitcnt lgkmcnt(6)
    s_and_b32 s21, s69, 0xffff
    v_mov_b32 v198, v223
    v_mfma_f32_16x16x32_bf16 v[128:131], a[196:199], a[236:239], v[128:131]
    s_waitcnt lgkmcnt(5)
    s_mov_b32 s22, 1310720
    v_mov_b32 v199, v223
    v_mfma_f32_16x16x32_bf16 v[136:139], a[192:195], a[240:243], v[136:139]
    s_waitcnt lgkmcnt(4)
    s_mov_b32 s16, s20
    v_mov_b32 v200, v223
    v_mfma_f32_16x16x32_bf16 v[136:139], a[196:199], a[244:247], v[136:139]
    s_waitcnt lgkmcnt(2)
    s_mov_b32 s17, s21
    v_mov_b32 v201, v223
    v_mfma_f32_16x16x32_bf16 v[4:7], a[248:251], a[200:203], v[4:7]
    s_waitcnt lgkmcnt(0)
    s_mov_b32 s18, 1310720
    ds_read_b64_tr_b16 a[192:193], v219 offset:32768
    v_mfma_f32_16x16x32_bf16 v[4:7], a[252:255], a[204:207], v[4:7]
    s_lshr_b32 s70, s46, 1
    v_mov_b32 v202, v223
    v_mov_b32 v203, v223
    v_mfma_f32_16x16x32_bf16 v[12:15], a[248:251], a[208:211], v[12:15]
    s_mul_i32 s68, s46, 327680
    ds_read_b64_tr_b16 a[194:195], v219 offset:33280
    v_mov_b32 v204, v223
    v_mfma_f32_16x16x32_bf16 v[12:15], a[252:255], a[212:215], v[12:15]
    s_lshl_b32 s69, s70, 14
    ds_read_b64_tr_b16 a[196:197], v219 offset:36864
    v_mov_b32 v205, v223
    v_mfma_f32_16x16x32_bf16 v[68:71], a[248:251], a[216:219], v[68:71]
    s_add_u32 s68, s68, s69
    ds_read_b64_tr_b16 a[198:199], v219 offset:37376
    v_cvt_pk_bf16_f32 v0, v0, v1
    v_mfma_f32_16x16x32_bf16 v[68:71], a[252:255], a[220:223], v[68:71]
    s_lshl_b32 s69, s70, 13
    v_cvt_pk_bf16_f32 v1, v2, v3
    v_cvt_pk_bf16_f32 v2, v4, v5
    v_mfma_f32_16x16x32_bf16 v[76:79], a[248:251], a[224:227], v[76:79]
    s_sub_u32 s69, 4096, s69
    v_cvt_pk_bf16_f32 v3, v6, v7
    v_cvt_pk_bf16_f32 v4, v8, v9
    v_mfma_f32_16x16x32_bf16 v[76:79], a[252:255], a[228:231], v[76:79]
    s_add_u32 s70, s3, s4
    v_cvt_pk_bf16_f32 v5, v10, v11
    v_cvt_pk_bf16_f32 v6, v12, v13
    v_mfma_f32_16x16x32_bf16 v[132:135], a[248:251], a[232:235], v[132:135]
    s_and_b32 s70, s70, 3
    v_cvt_pk_bf16_f32 v7, v14, v15
    v_cvt_pk_bf16_f32 v64, v64, v65
    v_mfma_f32_16x16x32_bf16 v[132:135], a[252:255], a[236:239], v[132:135]
    s_mov_b32 s34, 0x75436120
    v_cvt_pk_bf16_f32 v65, v66, v67
    v_cvt_pk_bf16_f32 v66, v68, v69
    v_mfma_f32_16x16x32_bf16 v[140:143], a[248:251], a[240:243], v[140:143]
    s_mov_b32 s35, 0xfdecb9a8
    v_cvt_pk_bf16_f32 v67, v70, v71
    v_cvt_pk_bf16_f32 v68, v72, v73
    v_mfma_f32_16x16x32_bf16 v[140:143], a[252:255], a[244:247], v[140:143]
    s_waitcnt lgkmcnt(1)
    s_cmp_eq_u32 s70, 1
    s_cselect_b32 s34, 0x65472310, s34
    s_cselect_b32 s35, 0xefdcab98, s35
    v_mfma_f32_16x16x32_bf16 v[16:19], a[192:195], a[200:203], v[16:19]
    s_waitcnt lgkmcnt(0)
    ds_read_b64_tr_b16 a[248:249], v219 offset:32776
    s_cmp_eq_u32 s70, 2
    s_cselect_b32 s34, 0x86532401, s34
    s_cselect_b32 s35, 0xfedbca97, s35
    v_mfma_f32_16x16x32_bf16 v[16:19], a[196:199], a[204:207], v[16:19]
    s_cmp_eq_u32 s70, 3
    s_cselect_b32 s34, 0x76435201, s34
    s_cselect_b32 s35, 0xfecdba89, s35
    v_mfma_f32_16x16x32_bf16 v[24:27], a[192:195], a[208:211], v[24:27]
    s_and_b32 s70, s34, 15
    ds_read_b64_tr_b16 a[250:251], v219 offset:33288
    v_cvt_pk_bf16_f32 v69, v74, v75
    v_mfma_f32_16x16x32_bf16 v[24:27], a[196:199], a[212:215], v[24:27]
    s_mul_i32 s70, s70, 20480
    ds_read_b64_tr_b16 a[252:253], v219 offset:36872
    v_cvt_pk_bf16_f32 v70, v76, v77
    v_mfma_f32_16x16x32_bf16 v[80:83], a[192:195], a[216:219], v[80:83]
    s_add_u32 s70, s70, s68
    ds_read_b64_tr_b16 a[254:255], v219 offset:37384
    v_cvt_pk_bf16_f32 v71, v78, v79
    v_mfma_f32_16x16x32_bf16 v[80:83], a[196:199], a[220:223], v[80:83]
    s_bfe_u32 s71, s34, 0x40004
    v_cvt_pk_bf16_f32 v128, v128, v129
    v_cvt_pk_bf16_f32 v129, v130, v131
    v_mfma_f32_16x16x32_bf16 v[88:91], a[192:195], a[224:227], v[88:91]
    s_mul_i32 s71, s71, 20480
    v_cvt_pk_bf16_f32 v130, v132, v133
    v_cvt_pk_bf16_f32 v131, v134, v135
    v_mfma_f32_16x16x32_bf16 v[88:91], a[196:199], a[228:231], v[88:91]
    s_add_u32 s71, s71, s68
    v_cvt_pk_bf16_f32 v132, v136, v137
    v_cvt_pk_bf16_f32 v133, v138, v139
    v_mfma_f32_16x16x32_bf16 v[144:147], a[192:195], a[232:235], v[144:147]
    s_mul_i32 s84, s69, 0
    v_cvt_pk_bf16_f32 v134, v140, v141
    v_cvt_pk_bf16_f32 v135, v142, v143
    v_mfma_f32_16x16x32_bf16 v[144:147], a[196:199], a[236:239], v[144:147]
    s_add_u32 s84, s84, s70
    v_mfma_f32_16x16x32_bf16 v[152:155], a[192:195], a[240:243], v[152:155]
    s_mul_i32 s86, s69, 1
    v_mfma_f32_16x16x32_bf16 v[152:155], a[196:199], a[244:247], v[152:155]
    s_waitcnt lgkmcnt(1)
    s_waitcnt vmcnt(8) lgkmcnt(0)
    s_barrier
    s_add_u32 s43, s62, 16384
    s_and_b32 s43, s43, 0x1ffff
    s_add_u32 s43, s43, s36
    v_mfma_f32_16x16x32_bf16 v[20:23], a[248:251], a[200:203], v[20:23]
    s_add_u32 s86, s86, s70
    ds_read_b64_tr_b16 a[192:193], v218 offset:49152
    s_add_u32 m0, s39, 114688
    v_mfma_f32_16x16x32_bf16 v[20:23], a[252:255], a[204:207], v[20:23]
    s_mul_i32 s60, s69, 2
    buffer_load_dwordx4 v196, s[12:15], s43 offen nt lds
    v_mfma_f32_16x16x32_bf16 v[28:31], a[248:251], a[208:211], v[28:31]
    s_add_u32 s60, s60, s70
    ds_read_b64_tr_b16 a[194:195], v218 offset:49664
    v_mfma_f32_16x16x32_bf16 v[28:31], a[252:255], a[212:215], v[28:31]
    s_mul_i32 s101, s69, 3
    ds_read_b64_tr_b16 a[196:197], v218 offset:53248
    v_cvt_pk_bf16_f32 v8, v16, v17
    v_mfma_f32_16x16x32_bf16 v[84:87], a[248:251], a[216:219], v[84:87]
    s_add_u32 s101, s101, s70
    ds_read_b64_tr_b16 a[198:199], v218 offset:53760
    v_cvt_pk_bf16_f32 v9, v18, v19
    v_mfma_f32_16x16x32_bf16 v[84:87], a[252:255], a[220:223], v[84:87]
    s_mul_i32 s98, s69, 4
    v_cvt_pk_bf16_f32 v10, v20, v21
    v_cvt_pk_bf16_f32 v11, v22, v23
    v_mfma_f32_16x16x32_bf16 v[92:95], a[248:251], a[224:227], v[92:95]
    s_add_u32 s98, s98, s70
    v_cvt_pk_bf16_f32 v12, v24, v25
    v_cvt_pk_bf16_f32 v13, v26, v27
    v_mfma_f32_16x16x32_bf16 v[92:95], a[252:255], a[228:231], v[92:95]
    s_mul_i32 s61, s69, 0
    v_cvt_pk_bf16_f32 v14, v28, v29
    v_cvt_pk_bf16_f32 v15, v30, v31
    v_mfma_f32_16x16x32_bf16 v[148:151], a[248:251], a[232:235], v[148:151]
    s_add_u32 s61, s61, s71
    v_cvt_pk_bf16_f32 v72, v80, v81
    v_cvt_pk_bf16_f32 v73, v82, v83
    v_mfma_f32_16x16x32_bf16 v[148:151], a[252:255], a[236:239], v[148:151]
    s_mul_i32 s87, s69, 1
    v_cvt_pk_bf16_f32 v74, v84, v85
    v_cvt_pk_bf16_f32 v75, v86, v87
    v_mfma_f32_16x16x32_bf16 v[156:159], a[248:251], a[240:243], v[156:159]
    s_add_u32 s87, s87, s71
    v_cvt_pk_bf16_f32 v76, v88, v89
    v_cvt_pk_bf16_f32 v77, v90, v91
    v_mfma_f32_16x16x32_bf16 v[156:159], a[252:255], a[244:247], v[156:159]
    s_waitcnt lgkmcnt(1)
    s_mul_i32 s99, s69, 1
    v_cvt_pk_bf16_f32 v78, v92, v93
    v_mfma_f32_16x16x32_bf16 v[32:35], a[192:195], a[200:203], v[32:35]
    s_waitcnt lgkmcnt(0)
    s_add_u32 s99, s99, s71
    ds_read_b64_tr_b16 a[248:249], v218 offset:49160
    v_mfma_f32_16x16x32_bf16 v[32:35], a[196:199], a[204:207], v[32:35]
    s_add_u32 s99, s99, 2048
    v_cvt_pk_bf16_f32 v79, v94, v95
    v_cvt_pk_bf16_f32 v136, v144, v145
    v_mfma_f32_16x16x32_bf16 v[40:43], a[192:195], a[208:211], v[40:43]
    s_mul_i32 s85, s69, 2
    ds_read_b64_tr_b16 a[250:251], v218 offset:49672
    v_cvt_pk_bf16_f32 v137, v146, v147
    v_mfma_f32_16x16x32_bf16 v[40:43], a[196:199], a[212:215], v[40:43]
    s_add_u32 s85, s85, s71
    ds_read_b64_tr_b16 a[252:253], v218 offset:53256
    v_cvt_pk_bf16_f32 v138, v148, v149
    v_mfma_f32_16x16x32_bf16 v[96:99], a[192:195], a[216:219], v[96:99]
    s_mul_i32 s100, s69, 3
    ds_read_b64_tr_b16 a[254:255], v218 offset:53768
    v_cvt_pk_bf16_f32 v139, v150, v151
    v_mfma_f32_16x16x32_bf16 v[96:99], a[196:199], a[220:223], v[96:99]
    s_add_u32 s100, s100, s71
    buffer_load_dwordx4 v197, s[12:15], s43 offen offset:1024 nt lds
    v_mfma_f32_16x16x32_bf16 v[104:107], a[192:195], a[224:227], v[104:107]
    v_cvt_pk_bf16_f32 v140, v152, v153
    v_cvt_pk_bf16_f32 v141, v154, v155
    v_mfma_f32_16x16x32_bf16 v[104:107], a[196:199], a[228:231], v[104:107]
    v_cvt_pk_bf16_f32 v142, v156, v157
    v_cvt_pk_bf16_f32 v143, v158, v159
    v_mfma_f32_16x16x32_bf16 v[160:163], a[192:195], a[232:235], v[160:163]
    v_mfma_f32_16x16x32_bf16 v[160:163], a[196:199], a[236:239], v[160:163]
    v_mfma_f32_16x16x32_bf16 v[168:171], a[192:195], a[240:243], v[168:171]
    v_mfma_f32_16x16x32_bf16 v[168:171], a[196:199], a[244:247], v[168:171]
    s_waitcnt lgkmcnt(1)
    v_mfma_f32_16x16x32_bf16 v[36:39], a[248:251], a[200:203], v[36:39]
    s_waitcnt lgkmcnt(0)
    ds_read_b64_tr_b16 a[192:193], v219 offset:49152
    v_mfma_f32_16x16x32_bf16 v[36:39], a[252:255], a[204:207], v[36:39]
    v_mfma_f32_16x16x32_bf16 v[44:47], a[248:251], a[208:211], v[44:47]
    ds_read_b64_tr_b16 a[194:195], v219 offset:49664
    v_mfma_f32_16x16x32_bf16 v[44:47], a[252:255], a[212:215], v[44:47]
    ds_read_b64_tr_b16 a[196:197], v219 offset:53248
    v_cvt_pk_bf16_f32 v16, v32, v33
    v_mfma_f32_16x16x32_bf16 v[100:103], a[248:251], a[216:219], v[100:103]
    ds_read_b64_tr_b16 a[198:199], v219 offset:53760
    v_cvt_pk_bf16_f32 v17, v34, v35
    v_mfma_f32_16x16x32_bf16 v[100:103], a[252:255], a[220:223], v[100:103]
    v_cvt_pk_bf16_f32 v18, v36, v37
    v_cvt_pk_bf16_f32 v19, v38, v39
    v_mfma_f32_16x16x32_bf16 v[108:111], a[248:251], a[224:227], v[108:111]
    v_cvt_pk_bf16_f32 v20, v40, v41
    v_cvt_pk_bf16_f32 v21, v42, v43
    v_mfma_f32_16x16x32_bf16 v[108:111], a[252:255], a[228:231], v[108:111]
    buffer_load_dwordx4 v196, s[12:15], s43 offen offset:2048 nt lds
    v_mfma_f32_16x16x32_bf16 v[164:167], a[248:251], a[232:235], v[164:167]
    v_cvt_pk_bf16_f32 v22, v44, v45
    v_cvt_pk_bf16_f32 v23, v46, v47
    v_mfma_f32_16x16x32_bf16 v[164:167], a[252:255], a[236:239], v[164:167]
    v_cvt_pk_bf16_f32 v80, v96, v97
    v_cvt_pk_bf16_f32 v81, v98, v99
    v_mfma_f32_16x16x32_bf16 v[172:175], a[248:251], a[240:243], v[172:175]
    v_cvt_pk_bf16_f32 v82, v100, v101
    v_cvt_pk_bf16_f32 v83, v102, v103
    v_mfma_f32_16x16x32_bf16 v[172:175], a[252:255], a[244:247], v[172:175]
    s_waitcnt lgkmcnt(1)
    v_cvt_pk_bf16_f32 v84, v104, v105
    v_cvt_pk_bf16_f32 v85, v106, v107
    v_mfma_f32_16x16x32_bf16 v[48:51], a[192:195], a[200:203], v[48:51]
    s_waitcnt lgkmcnt(0)
    ds_read_b64_tr_b16 a[248:249], v219 offset:49160
    v_cvt_pk_bf16_f32 v86, v108, v109
    v_mfma_f32_16x16x32_bf16 v[48:51], a[196:199], a[204:207], v[48:51]
    v_cvt_pk_bf16_f32 v87, v110, v111
    v_cvt_pk_bf16_f32 v144, v160, v161
    v_mfma_f32_16x16x32_bf16 v[56:59], a[192:195], a[208:211], v[56:59]
    ds_read_b64_tr_b16 a[250:251], v219 offset:49672
    v_cvt_pk_bf16_f32 v145, v162, v163
    v_mfma_f32_16x16x32_bf16 v[56:59], a[196:199], a[212:215], v[56:59]
    ds_read_b64_tr_b16 a[252:253], v219 offset:53256
    v_cvt_pk_bf16_f32 v146, v164, v165
    v_mfma_f32_16x16x32_bf16 v[112:115], a[192:195], a[216:219], v[112:115]
    ds_read_b64_tr_b16 a[254:255], v219 offset:53768
    v_cvt_pk_bf16_f32 v147, v166, v167
    v_mfma_f32_16x16x32_bf16 v[112:115], a[196:199], a[220:223], v[112:115]
    v_cvt_pk_bf16_f32 v148, v168, v169
    v_cvt_pk_bf16_f32 v149, v170, v171
    v_mfma_f32_16x16x32_bf16 v[120:123], a[192:195], a[224:227], v[120:123]
    v_cvt_pk_bf16_f32 v150, v172, v173
    v_cvt_pk_bf16_f32 v151, v174, v175
    v_mfma_f32_16x16x32_bf16 v[120:123], a[196:199], a[228:231], v[120:123]
    v_mfma_f32_16x16x32_bf16 v[176:179], a[192:195], a[232:235], v[176:179]
    v_add_u32 v206, 0xc000, v206
    v_add_u32 v207, 0xc000, v207
    v_mfma_f32_16x16x32_bf16 v[176:179], a[196:199], a[236:239], v[176:179]
    buffer_load_dwordx4 v197, s[12:15], s43 offen offset:3072 nt lds
    v_mfma_f32_16x16x32_bf16 v[184:187], a[192:195], a[240:243], v[184:187]
    v_add_u32 v208, 0xc000, v208
    v_add_u32 v209, 0xc000, v209
    v_mfma_f32_16x16x32_bf16 v[184:187], a[196:199], a[244:247], v[184:187]
    s_waitcnt lgkmcnt(1)
    s_waitcnt lgkmcnt(0)
    s_barrier
    v_mfma_f32_16x16x32_bf16 v[52:55], a[248:251], a[200:203], v[52:55]
    ds_read_b128 a[192:195], v206 offset:16384
    v_mfma_f32_16x16x32_bf16 v[52:55], a[252:255], a[204:207], v[52:55]
    ds_read_b128 a[196:199], v207 offset:16384
    v_mfma_f32_16x16x32_bf16 v[60:63], a[248:251], a[208:211], v[60:63]
    ds_read_b128 a[200:203], v208 offset:16384
    v_mfma_f32_16x16x32_bf16 v[60:63], a[252:255], a[212:215], v[60:63]
    ds_read_b128 a[204:207], v209 offset:16384
    v_cvt_pk_bf16_f32 v24, v48, v49
    v_mfma_f32_16x16x32_bf16 v[116:119], a[248:251], a[216:219], v[116:119]
    ds_read_b128 a[208:211], v206 offset:20480
    v_cvt_pk_bf16_f32 v25, v50, v51
    v_mfma_f32_16x16x32_bf16 v[116:119], a[252:255], a[220:223], v[116:119]
    ds_read_b128 a[212:215], v207 offset:20480
    v_cvt_pk_bf16_f32 v26, v52, v53
    v_mfma_f32_16x16x32_bf16 v[124:127], a[248:251], a[224:227], v[124:127]
    ds_read_b128 a[216:219], v208 offset:20480
    v_cvt_pk_bf16_f32 v27, v54, v55
    v_mfma_f32_16x16x32_bf16 v[124:127], a[252:255], a[228:231], v[124:127]
    ds_read_b128 a[220:223], v209 offset:20480
    v_cvt_pk_bf16_f32 v28, v56, v57
    v_mfma_f32_16x16x32_bf16 v[180:183], a[248:251], a[232:235], v[180:183]
    v_cvt_pk_bf16_f32 v29, v58, v59
    v_cvt_pk_bf16_f32 v30, v60, v61
    v_mfma_f32_16x16x32_bf16 v[180:183], a[252:255], a[236:239], v[180:183]
    v_cvt_pk_bf16_f32 v31, v62, v63
    v_mfma_f32_16x16x32_bf16 v[188:191], a[248:251], a[240:243], v[188:191]
    v_mfma_f32_16x16x32_bf16 v[188:191], a[252:255], a[244:247], v[188:191]
    s_branch L_att
.p2align 3
L_tail2:
    v_mfma_f32_16x16x32_bf16 a[128:131], a[224:227], v[160:163], a[128:131]
    v_exp_f32 v100, v100
    v_fma_f32 v101, v101, s45, v122
    v_mfma_f32_16x16x32_bf16 a[160:163], a[224:227], v[168:171], a[160:163]
    ds_read_b64_tr_b16 a[224:225], v210 offset:32768
    v_fma_f32 v102, v102, s45, v122
    v_mfma_f32_16x16x32_bf16 a[132:135], a[228:231], v[160:163], a[132:135]
    v_exp_f32 v101, v101
    v_mfma_f32_16x16x32_bf16 a[164:167], a[228:231], v[168:171], a[164:167]
    s_add_u32 m0, s39, 0
    ds_read_b64_tr_b16 a[226:227], v210 offset:36864
    v_exp_f32 v102, v102
    v_mfma_f32_16x16x32_bf16 a[136:139], a[232:235], v[160:163], a[136:139]
    buffer_load_dwordx4 v198, s[20:23], s84 offen sc1 lds
    v_mfma_f32_16x16x32_bf16 a[168:171], a[232:235], v[168:171], a[168:171]
    ds_read_b64_tr_b16 a[228:229], v211 offset:32768
    v_cvt_pk_bf16_f32 v98, v100, v101
    v_fma_f32 v103, v103, s45, v122
    v_mfma_f32_16x16x32_bf16 a[140:143], a[236:239], v[160:163], a[140:143]
    v_exp_f32 v103, v103
    v_mfma_f32_16x16x32_bf16 a[172:175], a[236:239], v[168:171], a[172:175]
    ds_read_b64_tr_b16 a[230:231], v211 offset:36864
    v_cvt_pk_bf16_f32 v99, v102, v103
    v_mfma_f32_16x16x32_bf16 a[144:147], a[240:243], v[160:163], a[144:147]
    v_fma_f32 v104, v104, s45, v123
    v_exp_f32 v104, v104
    v_mfma_f32_16x16x32_bf16 a[176:179], a[240:243], v[168:171], a[176:179]
    ds_read_b64_tr_b16 a[232:233], v212 offset:32768
    v_fma_f32 v105, v105, s45, v123
    v_mfma_f32_16x16x32_bf16 a[148:151], a[244:247], v[160:163], a[148:151]
    v_exp_f32 v105, v105
    v_fma_f32 v106, v106, s45, v123
    v_mfma_f32_16x16x32_bf16 a[180:183], a[244:247], v[168:171], a[180:183]
    ds_read_b64_tr_b16 a[234:235], v212 offset:36864
    v_cvt_pk_bf16_f32 v104, v104, v105
    v_mfma_f32_16x16x32_bf16 a[152:155], a[248:251], v[160:163], a[152:155]
    v_exp_f32 v106, v106
    v_mfma_f32_16x16x32_bf16 a[184:187], a[248:251], v[168:171], a[184:187]
    ds_read_b64_tr_b16 a[236:237], v213 offset:32768
    v_fma_f32 v107, v107, s45, v123
    v_fma_f32 v108, v108, s45, v123
    v_mfma_f32_16x16x32_bf16 a[156:159], a[252:255], v[160:163], a[156:159]
    buffer_load_dwordx4 v199, s[20:23], s84 offen offset:1024 sc1 lds
    v_mfma_f32_16x16x32_bf16 a[188:191], a[252:255], v[168:171], a[188:191]
    ds_read_b64_tr_b16 a[238:239], v213 offset:36864
    v_exp_f32 v107, v107
    v_mfma_f32_16x16x32_bf16 v[176:179], v[224:227], v[160:163], v[176:179]
    v_exp_f32 v108, v108
    v_mfma_f32_16x16x32_bf16 v[180:183], v[224:227], v[168:171], v[180:183]
    ds_read_b64_tr_b16 a[240:241], v214 offset:32768
    v_cvt_pk_bf16_f32 v105, v106, v107
    v_mfma_f32_16x16x32_bf16 v[160:163], a[192:195], v[128:131], 0
    v_fma_f32 v109, v109, s45, v123
    v_exp_f32 v109, v109
    v_mfma_f32_16x16x32_bf16 v[160:163], a[196:199], v[136:139], v[160:163]
    ds_read_b64_tr_b16 a[242:243], v214 offset:36864
    v_cvt_pk_bf16_f32 v106, v108, v109
    v_mfma_f32_16x16x32_bf16 v[160:163], a[200:203], v[144:147], v[160:163]
    v_fma_f32 v110, v110, s45, v123
    v_exp_f32 v110, v110
    v_mfma_f32_16x16x32_bf16 v[160:163], a[204:207], v[152:155], v[160:163]
    ds_read_b64_tr_b16 a[244:245], v215 offset:32768
    v_fma_f32 v111, v111, s45, v123
    v_mfma_f32_16x16x32_bf16 v[164:167], a[208:211], v[128:131], 0
    v_exp_f32 v111, v111
    v_mfma_f32_16x16x32_bf16 v[164:167], a[212:215], v[136:139], v[164:167]
    ds_read_b64_tr_b16 a[246:247], v215 offset:36864
    v_cvt_pk_bf16_f32 v107, v110, v111
    v_mfma_f32_16x16x32_bf16 v[164:167], a[216:219], v[144:147], v[164:167]
    buffer_load_dwordx4 v200, s[20:23], s84 offen offset:2048 sc1 lds
    v_mfma_f32_16x16x32_bf16 v[164:167], a[220:223], v[152:155], v[164:167]
    ds_read_b64_tr_b16 a[248:249], v216 offset:32768
    v_mfma_f32_16x16x32_bf16 v[168:171], a[192:195], v[132:135], 0
    ds_read_b128 a[192:195], v206 offset:32768
    v_mfma_f32_16x16x32_bf16 v[168:171], a[196:199], v[140:143], v[168:171]
    ds_read_b64_tr_b16 a[250:251], v216 offset:36864
    v_fma_f32 v160, v160, s45, v186
    v_mfma_f32_16x16x32_bf16 v[168:171], a[200:203], v[148:151], v[168:171]
    ds_read_b128 a[196:199], v207 offset:32768
    v_exp_f32 v160, v160
    v_mfma_f32_16x16x32_bf16 v[168:171], a[204:207], v[156:159], v[168:171]
    ds_read_b64_tr_b16 a[252:253], v217 offset:32768
    v_fma_f32 v161, v161, s45, v186
    v_mfma_f32_16x16x32_bf16 v[172:175], a[208:211], v[132:135], 0
    ds_read_b128 a[200:203], v208 offset:32768
    v_exp_f32 v161, v161
    v_mfma_f32_16x16x32_bf16 v[172:175], a[212:215], v[140:143], v[172:175]
    ds_read_b64_tr_b16 a[254:255], v217 offset:36864
    v_cvt_pk_bf16_f32 v160, v160, v161
    v_mfma_f32_16x16x32_bf16 v[172:175], a[216:219], v[148:151], v[172:175]
    s_add_u32 s43, s62, 122880
    ds_read_b128 a[204:207], v209 offset:32768
    v_fma_f32 v162, v162, s45, v186
    v_mfma_f32_16x16x32_bf16 v[172:175], a[220:223], v[156:159], v[172:175]
    s_waitcnt lgkmcnt(7)
    s_and_b32 s43, s43, 0x1ffff
    buffer_load_dwordx4 v201, s[20:23], s84 offen offset:3072 sc1 lds
    v_mfma_f32_16x16x32_bf16 a[0:3], a[224:227], v[32:35], a[0:3]
    s_add_u32 s43, s43, s36
    v_exp_f32 v162, v162
    v_mfma_f32_16x16x32_bf16 a[32:35], a[224:227], v[40:43], a[32:35]
    s_add_u32 m0, s39, 49152
    ds_read_b128 a[208:211], v206 offset:36864
    v_fma_f32 v163, v163, s45, v186
    v_fma_f32 v164, v164, s45, v186
    v_mfma_f32_16x16x32_bf16 a[4:7], a[228:231], v[32:35], a[4:7]
    buffer_load_dwordx4 v196, s[12:15], s43 offen nt lds
    v_mfma_f32_16x16x32_bf16 a[36:39], a[228:231], v[40:43], a[36:39]
    ds_read_b128 a[212:215], v207 offset:36864
    v_fma_f32 v165, v165, s45, v186
    v_mfma_f32_16x16x32_bf16 a[8:11], a[232:235], v[32:35], a[8:11]
    buffer_load_dwordx4 v197, s[12:15], s43 offen offset:1024 nt lds
    v_mfma_f32_16x16x32_bf16 a[40:43], a[232:235], v[40:43], a[40:43]
    ds_read_b128 a[216:219], v208 offset:36864
    v_fma_f32 v166, v166, s45, v186
    v_mfma_f32_16x16x32_bf16 a[12:15], a[236:239], v[32:35], a[12:15]
    buffer_load_dwordx4 v196, s[12:15], s43 offen offset:2048 nt lds
    v_mfma_f32_16x16x32_bf16 a[44:47], a[236:239], v[40:43], a[44:47]
    ds_read_b128 a[220:223], v209 offset:36864
    v_fma_f32 v167, v167, s45, v186
    v_mfma_f32_16x16x32_bf16 a[16:19], a[240:243], v[32:35], a[16:19]
    buffer_load_dwordx4 v197, s[12:15], s43 offen offset:3072 nt lds
    v_mfma_f32_16x16x32_bf16 a[48:51], a[240:243], v[40:43], a[48:51]
    s_add_u32 m0, s40, 98304
    v_exp_f32 v163, v163
    v_fma_f32 v168, v168, s45, v187
    v_mfma_f32_16x16x32_bf16 a[20:23], a[244:247], v[32:35], a[20:23]
    buffer_load_dwordx4 v202, s[16:19], s86 offen sc1 lds
    v_mfma_f32_16x16x32_bf16 a[52:55], a[244:247], v[40:43], a[52:55]
    s_waitcnt lgkmcnt(2)
    v_exp_f32 v164, v164
    v_cvt_pk_bf16_f32 v161, v162, v163
    v_mfma_f32_16x16x32_bf16 a[24:27], a[248:251], v[32:35], a[24:27]
    v_exp_f32 v165, v165
    v_mfma_f32_16x16x32_bf16 a[56:59], a[248:251], v[40:43], a[56:59]
    v_exp_f32 v166, v166
    v_mfma_f32_16x16x32_bf16 a[28:31], a[252:255], v[32:35], a[28:31]
    v_exp_f32 v167, v167
    v_cvt_pk_bf16_f32 v162, v164, v165
    v_mfma_f32_16x16x32_bf16 a[60:63], a[252:255], v[40:43], a[60:63]
    v_exp_f32 v168, v168
    v_mfma_f32_16x16x32_bf16 v[48:51], v[224:227], v[32:35], v[48:51]
    v_cvt_pk_bf16_f32 v163, v166, v167
    v_fma_f32 v169, v169, s45, v187
    v_fma_f32 v170, v170, s45, v187
    v_mfma_f32_16x16x32_bf16 v[52:55], v[224:227], v[40:43], v[52:55]
    v_exp_f32 v169, v169
    v_mfma_f32_16x16x32_bf16 v[32:35], a[192:195], v[0:3], 0
    buffer_load_dwordx4 v203, s[16:19], s86 offen offset:1024 sc1 lds
    v_mfma_f32_16x16x32_bf16 v[32:35], a[196:199], v[8:11], v[32:35]
    v_exp_f32 v170, v170
    v_cvt_pk_bf16_f32 v168, v168, v169
    v_mfma_f32_16x16x32_bf16 v[32:35], a[200:203], v[16:19], v[32:35]
    v_fma_f32 v171, v171, s45, v187
    v_fma_f32 v172, v172, s45, v187
    v_mfma_f32_16x16x32_bf16 v[32:35], a[204:207], v[24:27], v[32:35]
    v_exp_f32 v171, v171
    v_fma_f32 v173, v173, s45, v187
    v_mfma_f32_16x16x32_bf16 v[36:39], a[208:211], v[0:3], 0
    v_exp_f32 v172, v172
    v_mfma_f32_16x16x32_bf16 v[36:39], a[212:215], v[8:11], v[36:39]
    s_waitcnt lgkmcnt(0)
    v_exp_f32 v173, v173
    v_mfma_f32_16x16x32_bf16 v[36:39], a[216:219], v[16:19], v[36:39]
    v_cvt_pk_bf16_f32 v169, v170, v171
    v_cvt_pk_bf16_f32 v170, v172, v173
    v_fma_f32 v174, v174, s45, v187
    v_mfma_f32_16x16x32_bf16 v[36:39], a[220:223], v[24:27], v[36:39]
    v_exp_f32 v174, v174
    v_mfma_f32_16x16x32_bf16 v[40:43], a[192:195], v[4:7], 0
    v_fma_f32 v175, v175, s45, v187
    v_exp_f32 v175, v175
    v_mfma_f32_16x16x32_bf16 v[40:43], a[196:199], v[12:15], v[40:43]
    buffer_load_dwordx4 v204, s[16:19], s86 offen offset:2048 sc1 lds
    v_add_u32 v206, 0xfffec000, v206
    v_add_u32 v207, 0xfffec000, v207
    v_mfma_f32_16x16x32_bf16 v[40:43], a[200:203], v[20:23], v[40:43]
    v_cvt_pk_bf16_f32 v171, v174, v175
    v_fma_f32 v32, v32, s45, v58
    v_mfma_f32_16x16x32_bf16 v[40:43], a[204:207], v[28:31], v[40:43]
    v_exp_f32 v32, v32
    v_fma_f32 v33, v33, s45, v58
    v_mfma_f32_16x16x32_bf16 v[44:47], a[208:211], v[4:7], 0
    v_add_u32 v208, 0xfffec000, v208
    v_add_u32 v209, 0xfffec000, v209
    v_mfma_f32_16x16x32_bf16 v[44:47], a[212:215], v[12:15], v[44:47]
    v_exp_f32 v33, v33
    v_fma_f32 v34, v34, s45, v58
    v_mfma_f32_16x16x32_bf16 v[44:47], a[216:219], v[20:23], v[44:47]
    v_exp_f32 v34, v34
    v_mfma_f32_16x16x32_bf16 v[44:47], a[220:223], v[28:31], v[44:47]
    v_cvt_pk_bf16_f32 v32, v32, v33
    v_fma_f32 v35, v35, s45, v58
    v_mfma_f32_16x16x32_bf16 a[64:67], a[224:227], v[96:99], a[64:67]
    v_exp_f32 v35, v35
    v_fma_f32 v36, v36, s45, v58
    v_mfma_f32_16x16x32_bf16 a[96:99], a[224:227], v[104:107], a[96:99]
    v_exp_f32 v36, v36
    v_mfma_f32_16x16x32_bf16 a[68:71], a[228:231], v[96:99], a[68:71]
    v_cvt_pk_bf16_f32 v33, v34, v35
    v_fma_f32 v37, v37, s45, v58
    v_fma_f32 v38, v38, s45, v58
    v_mfma_f32_16x16x32_bf16 a[100:103], a[228:231], v[104:107], a[100:103]
    buffer_load_dwordx4 v205, s[16:19], s86 offen offset:3072 sc1 lds
    v_mfma_f32_16x16x32_bf16 a[72:75], a[232:235], v[96:99], a[72:75]
    v_exp_f32 v37, v37
    v_mfma_f32_16x16x32_bf16 a[104:107], a[232:235], v[104:107], a[104:107]
    v_exp_f32 v38, v38
    v_cvt_pk_bf16_f32 v34, v36, v37
    v_mfma_f32_16x16x32_bf16 a[76:79], a[236:239], v[96:99], a[76:79]
    v_fma_f32 v39, v39, s45, v58
    v_fma_f32 v40, v40, s45, v59
    v_mfma_f32_16x16x32_bf16 a[108:111], a[236:239], v[104:107], a[108:111]
    v_exp_f32 v39, v39
    v_fma_f32 v41, v41, s45, v59
    v_mfma_f32_16x16x32_bf16 a[80:83], a[240:243], v[96:99], a[80:83]
    v_exp_f32 v40, v40
    v_mfma_f32_16x16x32_bf16 a[112:115], a[240:243], v[104:107], a[112:115]
    v_exp_f32 v41, v41
    v_mfma_f32_16x16x32_bf16 a[84:87], a[244:247], v[96:99], a[84:87]
    v_cvt_pk_bf16_f32 v35, v38, v39
    v_cvt_pk_bf16_f32 v40, v40, v41
    v_fma_f32 v42, v42, s45, v59
    v_mfma_f32_16x16x32_bf16 a[116:119], a[244:247], v[104:107], a[116:119]
    s_add_u32 m0, s40, 102400
    v_exp_f32 v42, v42
    v_mfma_f32_16x16x32_bf16 a[88:91], a[248:251], v[96:99], a[88:91]
    buffer_load_dwordx4 v202, s[16:19], s87 offen sc1 lds
    v_mfma_f32_16x16x32_bf16 a[120:123], a[248:251], v[104:107], a[120:123]
    v_fma_f32 v43, v43, s45, v59
    v_fma_f32 v44, v44, s45, v59
    v_mfma_f32_16x16x32_bf16 a[92:95], a[252:255], v[96:99], a[92:95]
    v_exp_f32 v43, v43
    v_mfma_f32_16x16x32_bf16 a[124:127], a[252:255], v[104:107], a[124:127]
    v_exp_f32 v44, v44
    v_cvt_pk_bf16_f32 v41, v42, v43
    v_mfma_f32_16x16x32_bf16 v[112:115], v[224:227], v[96:99], v[112:115]
    v_fma_f32 v45, v45, s45, v59
    v_fma_f32 v46, v46, s45, v59
    v_mfma_f32_16x16x32_bf16 v[116:119], v[224:227], v[104:107], v[116:119]
    s_add_u32 s36, s36, 262144
    v_exp_f32 v45, v45
    v_fma_f32 v47, v47, s45, v59
    v_mfma_f32_16x16x32_bf16 v[96:99], a[192:195], v[64:67], 0
    v_exp_f32 v46, v46
    v_mfma_f32_16x16x32_bf16 v[96:99], a[196:199], v[72:75], v[96:99]
    v_exp_f32 v47, v47
    v_mfma_f32_16x16x32_bf16 v[96:99], a[200:203], v[80:83], v[96:99]
    v_cvt_pk_bf16_f32 v42, v44, v45
    v_cvt_pk_bf16_f32 v43, v46, v47
    v_mfma_f32_16x16x32_bf16 v[96:99], a[204:207], v[88:91], v[96:99]
    s_add_u32 m0, s39, 81920
    v_mfma_f32_16x16x32_bf16 v[100:103], a[208:211], v[64:67], 0
    buffer_load_dwordx4 v198, s[20:23], s60 offen sc1 lds
    v_mfma_f32_16x16x32_bf16 v[100:103], a[212:215], v[72:75], v[100:103]
    v_mfma_f32_16x16x32_bf16 v[100:103], a[216:219], v[80:83], v[100:103]
    buffer_load_dwordx4 v199, s[20:23], s60 offen offset:1024 sc1 lds
    v_mfma_f32_16x16x32_bf16 v[100:103], a[220:223], v[88:91], v[100:103]
    v_mfma_f32_16x16x32_bf16 v[104:107], a[192:195], v[68:71], 0
    buffer_load_dwordx4 v200, s[20:23], s60 offen offset:2048 sc1 lds
    v_mfma_f32_16x16x32_bf16 v[104:107], a[196:199], v[76:79], v[104:107]
    v_fma_f32 v96, v96, s45, v122
    v_exp_f32 v96, v96
    v_mfma_f32_16x16x32_bf16 v[104:107], a[200:203], v[84:87], v[104:107]
    buffer_load_dwordx4 v201, s[20:23], s60 offen offset:3072 sc1 lds
    v_mfma_f32_16x16x32_bf16 v[104:107], a[204:207], v[92:95], v[104:107]
    s_add_u32 m0, s40, 102400
    v_fma_f32 v97, v97, s45, v122
    v_fma_f32 v98, v98, s45, v122
    v_mfma_f32_16x16x32_bf16 v[108:111], a[208:211], v[68:71], 0
    buffer_load_dwordx4 v203, s[16:19], s87 offen offset:1024 sc1 lds
    v_mfma_f32_16x16x32_bf16 v[108:111], a[212:215], v[76:79], v[108:111]
    v_exp_f32 v97, v97
    v_mfma_f32_16x16x32_bf16 v[108:111], a[216:219], v[84:87], v[108:111]
    v_exp_f32 v98, v98
    v_cvt_pk_bf16_f32 v96, v96, v97
    v_mfma_f32_16x16x32_bf16 v[108:111], a[220:223], v[92:95], v[108:111]
    s_waitcnt vmcnt(18)
    s_barrier
    v_mfma_f32_16x16x32_bf16 a[128:131], a[224:227], v[160:163], a[128:131]
    v_fma_f32 v99, v99, s45, v122
    v_fma_f32 v100, v100, s45, v122
    v_mfma_f32_16x16x32_bf16 a[160:163], a[224:227], v[168:171], a[160:163]
    ds_read_b64_tr_b16 a[224:225], v210
    v_exp_f32 v99, v99
    v_mfma_f32_16x16x32_bf16 a[132:135], a[228:231], v[160:163], a[132:135]
    v_exp_f32 v100, v100
    v_mfma_f32_16x16x32_bf16 a[164:167], a[228:231], v[168:171], a[164:167]
    s_add_u32 m0, s40, 122880
    ds_read_b64_tr_b16 a[226:227], v210 offset:4096
    v_cvt_pk_bf16_f32 v97, v98, v99
    v_fma_f32 v101, v101, s45, v122
    v_mfma_f32_16x16x32_bf16 a[136:139], a[232:235], v[160:163], a[136:139]
    buffer_load_dwordx4 v202, s[16:19], s98 offen sc1 lds
    v_mfma_f32_16x16x32_bf16 a[168:171], a[232:235], v[168:171], a[168:171]
    ds_read_b64_tr_b16 a[228:229], v211
    v_fma_f32 v102, v102, s45, v122
    v_mfma_f32_16x16x32_bf16 a[140:143], a[236:239], v[160:163], a[140:143]
    v_exp_f32 v101, v101
    v_fma_f32 v103, v103, s45, v122
    v_mfma_f32_16x16x32_bf16 a[172:175], a[236:239], v[168:171], a[172:175]
    ds_read_b64_tr_b16 a[230:231], v211 offset:4096
    v_cvt_pk_bf16_f32 v98, v100, v101
    v_mfma_f32_16x16x32_bf16 a[144:147], a[240:243], v[160:163], a[144:147]
    v_exp_f32 v102, v102
    v_fma_f32 v104, v104, s45, v123
    v_mfma_f32_16x16x32_bf16 a[176:179], a[240:243], v[168:171], a[176:179]
    ds_read_b64_tr_b16 a[232:233], v212
    v_fma_f32 v105, v105, s45, v123
    v_mfma_f32_16x16x32_bf16 a[148:151], a[244:247], v[160:163], a[148:151]
    v_exp_f32 v103, v103
    v_mfma_f32_16x16x32_bf16 a[180:183], a[244:247], v[168:171], a[180:183]
    ds_read_b64_tr_b16 a[234:235], v212 offset:4096
    v_exp_f32 v104, v104
    v_mfma_f32_16x16x32_bf16 a[152:155], a[248:251], v[160:163], a[152:155]
    v_exp_f32 v105, v105
    v_mfma_f32_16x16x32_bf16 a[184:187], a[248:251], v[168:171], a[184:187]
    ds_read_b64_tr_b16 a[236:237], v213
    v_cvt_pk_bf16_f32 v99, v102, v103
    v_cvt_pk_bf16_f32 v104, v104, v105
    v_mfma_f32_16x16x32_bf16 a[156:159], a[252:255], v[160:163], a[156:159]
    v_fma_f32 v106, v106, s45, v123
    v_fma_f32 v107, v107, s45, v123
    v_mfma_f32_16x16x32_bf16 a[188:191], a[252:255], v[168:171], a[188:191]
    ds_read_b64_tr_b16 a[238:239], v213 offset:4096
    v_fma_f32 v108, v108, s45, v123
    v_mfma_f32_16x16x32_bf16 v[176:179], v[224:227], v[160:163], v[176:179]
    v_exp_f32 v106, v106
    v_fma_f32 v109, v109, s45, v123
    v_mfma_f32_16x16x32_bf16 v[180:183], v[224:227], v[168:171], v[180:183]
    ds_read_b64_tr_b16 a[240:241], v214
    v_fma_f32 v110, v110, s45, v123
    v_mfma_f32_16x16x32_bf16 v[160:163], a[192:195], v[128:131], 0
    v_exp_f32 v107, v107
    v_fma_f32 v111, v111, s45, v123
    v_mfma_f32_16x16x32_bf16 v[160:163], a[196:199], v[136:139], v[160:163]
    ds_read_b64_tr_b16 a[242:243], v214 offset:4096
    v_cvt_pk_bf16_f32 v105, v106, v107
    v_mfma_f32_16x16x32_bf16 v[160:163], a[200:203], v[144:147], v[160:163]
    buffer_load_dwordx4 v203, s[16:19], s98 offen offset:1024 sc1 lds
    v_mfma_f32_16x16x32_bf16 v[160:163], a[204:207], v[152:155], v[160:163]
    ds_read_b64_tr_b16 a[244:245], v215
    v_exp_f32 v108, v108
    v_mfma_f32_16x16x32_bf16 v[164:167], a[208:211], v[128:131], 0
    v_exp_f32 v109, v109
    v_mfma_f32_16x16x32_bf16 v[164:167], a[212:215], v[136:139], v[164:167]
    ds_read_b64_tr_b16 a[246:247], v215 offset:4096
    v_exp_f32 v110, v110
    v_mfma_f32_16x16x32_bf16 v[164:167], a[216:219], v[144:147], v[164:167]
    v_exp_f32 v111, v111
    v_mfma_f32_16x16x32_bf16 v[164:167], a[220:223], v[152:155], v[164:167]
    ds_read_b64_tr_b16 a[248:249], v216
    v_cvt_pk_bf16_f32 v106, v108, v109
    v_mfma_f32_16x16x32_bf16 v[168:171], a[192:195], v[132:135], 0
    ds_read_b128 a[192:195], v206
    v_cvt_pk_bf16_f32 v107, v110, v111
    v_mfma_f32_16x16x32_bf16 v[168:171], a[196:199], v[140:143], v[168:171]
    ds_read_b64_tr_b16 a[250:251], v216 offset:4096
    v_fma_f32 v160, v160, s45, v186
    v_mfma_f32_16x16x32_bf16 v[168:171], a[200:203], v[148:151], v[168:171]
    ds_read_b128 a[196:199], v207
    v_exp_f32 v160, v160
    v_mfma_f32_16x16x32_bf16 v[168:171], a[204:207], v[156:159], v[168:171]
    ds_read_b64_tr_b16 a[252:253], v217
    v_fma_f32 v161, v161, s45, v186
    v_mfma_f32_16x16x32_bf16 v[172:175], a[208:211], v[132:135], 0
    ds_read_b128 a[200:203], v208
    v_fma_f32 v162, v162, s45, v186
    v_mfma_f32_16x16x32_bf16 v[172:175], a[212:215], v[140:143], v[172:175]
    ds_read_b64_tr_b16 a[254:255], v217 offset:4096
    v_exp_f32 v161, v161
    v_mfma_f32_16x16x32_bf16 v[172:175], a[216:219], v[148:151], v[172:175]
    ds_read_b128 a[204:207], v209
    v_cvt_pk_bf16_f32 v160, v160, v161
    v_mfma_f32_16x16x32_bf16 v[172:175], a[220:223], v[156:159], v[172:175]
    s_waitcnt lgkmcnt(7)
    v_exp_f32 v162, v162
    v_fma_f32 v163, v163, s45, v186
    v_mfma_f32_16x16x32_bf16 a[0:3], a[224:227], v[32:35], a[0:3]
    v_exp_f32 v163, v163
    v_mfma_f32_16x16x32_bf16 a[32:35], a[224:227], v[40:43], a[32:35]
    ds_read_b128 a[208:211], v206 offset:4096
    v_cvt_pk_bf16_f32 v161, v162, v163
    v_mfma_f32_16x16x32_bf16 a[4:7], a[228:231], v[32:35], a[4:7]
    buffer_load_dwordx4 v204, s[16:19], s98 offen offset:2048 sc1 lds
    v_mfma_f32_16x16x32_bf16 a[36:39], a[228:231], v[40:43], a[36:39]
    ds_read_b128 a[212:215], v207 offset:4096
    v_fma_f32 v164, v164, s45, v186
    v_mfma_f32_16x16x32_bf16 a[8:11], a[232:235], v[32:35], a[8:11]
    v_exp_f32 v164, v164
    v_fma_f32 v165, v165, s45, v186
    v_mfma_f32_16x16x32_bf16 a[40:43], a[232:235], v[40:43], a[40:43]
    ds_read_b128 a[216:219], v208 offset:4096
    v_fma_f32 v166, v166, s45, v186
    v_mfma_f32_16x16x32_bf16 a[12:15], a[236:239], v[32:35], a[12:15]
    v_exp_f32 v165, v165
    v_mfma_f32_16x16x32_bf16 a[44:47], a[236:239], v[40:43], a[44:47]
    s_add_u32 m0, s39, 147456
    ds_read_b128 a[220:223], v209 offset:4096
    v_exp_f32 v166, v166
    v_mfma_f32_16x16x32_bf16 a[16:19], a[240:243], v[32:35], a[16:19]
    buffer_load_dwordx4 v198, s[20:23], s61 offen sc1 lds
    v_mfma_f32_16x16x32_bf16 a[48:51], a[240:243], v[40:43], a[48:51]
    v_cvt_pk_bf16_f32 v162, v164, v165
    v_fma_f32 v167, v167, s45, v186
    v_fma_f32 v168, v168, s45, v187
    v_mfma_f32_16x16x32_bf16 a[20:23], a[244:247], v[32:35], a[20:23]
    buffer_load_dwordx4 v199, s[20:23], s61 offen offset:1024 sc1 lds
    v_mfma_f32_16x16x32_bf16 a[52:55], a[244:247], v[40:43], a[52:55]
    s_waitcnt lgkmcnt(2)
    v_exp_f32 v167, v167
    v_mfma_f32_16x16x32_bf16 a[24:27], a[248:251], v[32:35], a[24:27]
    buffer_load_dwordx4 v200, s[20:23], s61 offen offset:2048 sc1 lds
    v_mfma_f32_16x16x32_bf16 a[56:59], a[248:251], v[40:43], a[56:59]
    v_exp_f32 v168, v168
    v_mfma_f32_16x16x32_bf16 a[28:31], a[252:255], v[32:35], a[28:31]
    buffer_load_dwordx4 v201, s[20:23], s61 offen offset:3072 sc1 lds
    v_mfma_f32_16x16x32_bf16 a[60:63], a[252:255], v[40:43], a[60:63]
    v_cvt_pk_bf16_f32 v163, v166, v167
    v_fma_f32 v169, v169, s45, v187
    v_mfma_f32_16x16x32_bf16 v[48:51], v[224:227], v[32:35], v[48:51]
    v_exp_f32 v169, v169
    v_mfma_f32_16x16x32_bf16 v[52:55], v[224:227], v[40:43], v[52:55]
    s_add_u32 m0, s40, 122880
    v_cvt_pk_bf16_f32 v168, v168, v169
    v_fma_f32 v170, v170, s45, v187
    v_fma_f32 v171, v171, s45, v187
    v_mfma_f32_16x16x32_bf16 v[32:35], a[192:195], v[0:3], 0
    buffer_load_dwordx4 v205, s[16:19], s98 offen offset:3072 sc1 lds
    v_mfma_f32_16x16x32_bf16 v[32:35], a[196:199], v[8:11], v[32:35]
    v_exp_f32 v170, v170
    v_fma_f32 v172, v172, s45, v187
    v_mfma_f32_16x16x32_bf16 v[32:35], a[200:203], v[16:19], v[32:35]
    v_exp_f32 v171, v171
    v_mfma_f32_16x16x32_bf16 v[32:35], a[204:207], v[24:27], v[32:35]
    v_exp_f32 v172, v172
    v_mfma_f32_16x16x32_bf16 v[36:39], a[208:211], v[0:3], 0
    v_cvt_pk_bf16_f32 v169, v170, v171
    v_fma_f32 v173, v173, s45, v187
    v_fma_f32 v174, v174, s45, v187
    v_mfma_f32_16x16x32_bf16 v[36:39], a[212:215], v[8:11], v[36:39]
    s_waitcnt lgkmcnt(0)
    v_exp_f32 v173, v173
    v_mfma_f32_16x16x32_bf16 v[36:39], a[216:219], v[16:19], v[36:39]
    v_exp_f32 v174, v174
    v_cvt_pk_bf16_f32 v170, v172, v173
    v_mfma_f32_16x16x32_bf16 v[36:39], a[220:223], v[24:27], v[36:39]
    v_fma_f32 v175, v175, s45, v187
    v_mfma_f32_16x16x32_bf16 v[40:43], a[192:195], v[4:7], 0
    v_exp_f32 v175, v175
    v_mfma_f32_16x16x32_bf16 v[40:43], a[196:199], v[12:15], v[40:43]
    v_cvt_pk_bf16_f32 v171, v174, v175
    v_fma_f32 v32, v32, s45, v58
    v_fma_f32 v33, v33, s45, v58
    v_mfma_f32_16x16x32_bf16 v[40:43], a[200:203], v[20:23], v[40:43]
    v_exp_f32 v32, v32
    v_mfma_f32_16x16x32_bf16 v[40:43], a[204:207], v[28:31], v[40:43]
    v_exp_f32 v33, v33
    v_fma_f32 v34, v34, s45, v58
    v_mfma_f32_16x16x32_bf16 v[44:47], a[208:211], v[4:7], 0
    v_exp_f32 v34, v34
    v_mfma_f32_16x16x32_bf16 v[44:47], a[212:215], v[12:15], v[44:47]
    v_cvt_pk_bf16_f32 v32, v32, v33
    v_fma_f32 v35, v35, s45, v58
    v_mfma_f32_16x16x32_bf16 v[44:47], a[216:219], v[20:23], v[44:47]
    v_exp_f32 v35, v35
    v_fma_f32 v36, v36, s45, v58
    v_mfma_f32_16x16x32_bf16 v[44:47], a[220:223], v[28:31], v[44:47]
    s_add_u32 m0, s40, 126976
    v_exp_f32 v36, v36
    v_mfma_f32_16x16x32_bf16 a[64:67], a[224:227], v[96:99], a[64:67]
    buffer_load_dwordx4 v202, s[16:19], s99 offen sc1 lds
    v_mfma_f32_16x16x32_bf16 a[96:99], a[224:227], v[104:107], a[96:99]
    v_cvt_pk_bf16_f32 v33, v34, v35
    v_fma_f32 v37, v37, s45, v58
    v_mfma_f32_16x16x32_bf16 a[68:71], a[228:231], v[96:99], a[68:71]
    v_exp_f32 v37, v37
    v_mfma_f32_16x16x32_bf16 a[100:103], a[228:231], v[104:107], a[100:103]
    v_cvt_pk_bf16_f32 v34, v36, v37
    v_fma_f32 v38, v38, s45, v58
    v_fma_f32 v39, v39, s45, v58
    v_mfma_f32_16x16x32_bf16 a[72:75], a[232:235], v[96:99], a[72:75]
    v_exp_f32 v38, v38
    v_mfma_f32_16x16x32_bf16 a[104:107], a[232:235], v[104:107], a[104:107]
    v_exp_f32 v39, v39
    v_fma_f32 v40, v40, s45, v59
    v_mfma_f32_16x16x32_bf16 a[76:79], a[236:239], v[96:99], a[76:79]
    v_exp_f32 v40, v40
    v_mfma_f32_16x16x32_bf16 a[108:111], a[236:239], v[104:107], a[108:111]
    v_cvt_pk_bf16_f32 v35, v38, v39
    v_fma_f32 v41, v41, s45, v59
    v_mfma_f32_16x16x32_bf16 a[80:83], a[240:243], v[96:99], a[80:83]
    v_exp_f32 v41, v41
    v_fma_f32 v42, v42, s45, v59
    v_mfma_f32_16x16x32_bf16 a[112:115], a[240:243], v[104:107], a[112:115]
    v_exp_f32 v42, v42
    v_mfma_f32_16x16x32_bf16 a[84:87], a[244:247], v[96:99], a[84:87]
    v_cvt_pk_bf16_f32 v40, v40, v41
    v_fma_f32 v43, v43, s45, v59
    v_fma_f32 v44, v44, s45, v59
    v_mfma_f32_16x16x32_bf16 a[116:119], a[244:247], v[104:107], a[116:119]
    v_exp_f32 v43, v43
    v_mfma_f32_16x16x32_bf16 a[88:91], a[248:251], v[96:99], a[88:91]
    v_exp_f32 v44, v44
    v_mfma_f32_16x16x32_bf16 a[120:123], a[248:251], v[104:107], a[120:123]
    v_cvt_pk_bf16_f32 v41, v42, v43
    v_fma_f32 v45, v45, s45, v59
    v_fma_f32 v46, v46, s45, v59
    v_mfma_f32_16x16x32_bf16 a[92:95], a[252:255], v[96:99], a[92:95]
    v_exp_f32 v45, v45
    v_mfma_f32_16x16x32_bf16 a[124:127], a[252:255], v[104:107], a[124:127]
    v_exp_f32 v46, v46
    v_cvt_pk_bf16_f32 v42, v44, v45
    v_mfma_f32_16x16x32_bf16 v[112:115], v[224:227], v[96:99], v[112:115]
    buffer_load_dwordx4 v203, s[16:19], s99 offen offset:1024 sc1 lds
    v_mfma_f32_16x16x32_bf16 v[116:119], v[224:227], v[104:107], v[116:119]
    v_fma_f32 v47, v47, s45, v59
    v_mfma_f32_16x16x32_bf16 v[96:99], a[192:195], v[64:67], 0
    v_exp_f32 v47, v47
    v_mfma_f32_16x16x32_bf16 v[96:99], a[196:199], v[72:75], v[96:99]
    v_cvt_pk_bf16_f32 v43, v46, v47
    v_mfma_f32_16x16x32_bf16 v[96:99], a[200:203], v[80:83], v[96:99]
    v_mfma_f32_16x16x32_bf16 v[96:99], a[204:207], v[88:91], v[96:99]
    v_mfma_f32_16x16x32_bf16 v[100:103], a[208:211], v[64:67], 0
    v_mfma_f32_16x16x32_bf16 v[100:103], a[212:215], v[72:75], v[100:103]
    v_mfma_f32_16x16x32_bf16 v[100:103], a[216:219], v[80:83], v[100:103]
    v_mfma_f32_16x16x32_bf16 v[100:103], a[220:223], v[88:91], v[100:103]
    v_mfma_f32_16x16x32_bf16 v[104:107], a[192:195], v[68:71], 0
    v_mfma_f32_16x16x32_bf16 v[104:107], a[196:199], v[76:79], v[104:107]
    s_add_u32 m0, s39, 65536
    v_fma_f32 v96, v96, s45, v122
    v_fma_f32 v97, v97, s45, v122
    v_mfma_f32_16x16x32_bf16 v[104:107], a[200:203], v[84:87], v[104:107]
    buffer_load_dwordx4 v198, s[20:23], s101 offen sc1 lds
    v_mfma_f32_16x16x32_bf16 v[104:107], a[204:207], v[92:95], v[104:107]
    v_exp_f32 v96, v96
    v_mfma_f32_16x16x32_bf16 v[108:111], a[208:211], v[68:71], 0
    buffer_load_dwordx4 v199, s[20:23], s101 offen offset:1024 sc1 lds
    v_mfma_f32_16x16x32_bf16 v[108:111], a[212:215], v[76:79], v[108:111]
    v_exp_f32 v97, v97
    v_mfma_f32_16x16x32_bf16 v[108:111], a[216:219], v[84:87], v[108:111]
    buffer_load_dwordx4 v200, s[20:23], s101 offen offset:2048 sc1 lds
    v_mfma_f32_16x16x32_bf16 v[108:111], a[220:223], v[92:95], v[108:111]
    s_waitcnt vmcnt(23)
    s_barrier
    v_mfma_f32_16x16x32_bf16 a[128:131], a[224:227], v[160:163], a[128:131]
    v_cvt_pk_bf16_f32 v96, v96, v97
    v_fma_f32 v98, v98, s45, v122
    v_mfma_f32_16x16x32_bf16 a[160:163], a[224:227], v[168:171], a[160:163]
    ds_read_b64_tr_b16 a[224:225], v210 offset:16384
    buffer_load_dword v254, off, s[80:83], s65 sc1
    v_mfma_f32_16x16x32_bf16 a[132:135], a[228:231], v[160:163], a[132:135]
    s_lshr_b32 s84, s4, 2
    buffer_load_dwordx4 v201, s[20:23], s101 offen offset:3072 sc1 lds
    v_mfma_f32_16x16x32_bf16 a[164:167], a[228:231], v[168:171], a[164:167]
    s_mul_i32 s7, s3, 1572864
    ds_read_b64_tr_b16 a[226:227], v210 offset:20480
    s_add_u32 m0, s39, 16384
    v_mfma_f32_16x16x32_bf16 a[136:139], a[232:235], v[160:163], a[136:139]
    s_mul_i32 s58, s84, 786432
    buffer_load_dwordx4 v198, s[20:23], s85 offen sc1 lds
    v_mfma_f32_16x16x32_bf16 a[168:171], a[232:235], v[168:171], a[168:171]
    s_add_u32 s7, s7, s58
    ds_read_b64_tr_b16 a[228:229], v211 offset:16384
    v_fma_f32 v99, v99, s45, v122
    v_mfma_f32_16x16x32_bf16 a[140:143], a[236:239], v[160:163], a[140:143]
    s_add_u32 s16, s90, s7
    s_addc_u32 s59, s91, 0
    v_exp_f32 v98, v98
    v_mfma_f32_16x16x32_bf16 a[172:175], a[236:239], v[168:171], a[172:175]
    s_and_b32 s17, s59, 0xffff
    ds_read_b64_tr_b16 a[230:231], v211 offset:20480
    v_fma_f32 v100, v100, s45, v122
    v_mfma_f32_16x16x32_bf16 a[144:147], a[240:243], v[160:163], a[144:147]
    s_mov_b32 s18, 786432
    v_exp_f32 v99, v99
    v_mfma_f32_16x16x32_bf16 a[176:179], a[240:243], v[168:171], a[176:179]
    s_mul_i32 s44, s46, 196608
    ds_read_b64_tr_b16 a[232:233], v212 offset:16384
    v_exp_f32 v100, v100
    v_mfma_f32_16x16x32_bf16 a[148:151], a[244:247], v[160:163], a[148:151]
    s_mov_b64 s[62:63], s[34:35]
    buffer_load_dwordx4 v199, s[20:23], s85 offen offset:1024 sc1 lds
    v_mfma_f32_16x16x32_bf16 a[180:183], a[244:247], v[168:171], a[180:183]
    s_and_b32 s29, s62, 15
    ds_read_b64_tr_b16 a[234:235], v212 offset:20480
    v_cvt_pk_bf16_f32 v97, v98, v99
    v_fma_f32 v101, v101, s45, v122
    v_mfma_f32_16x16x32_bf16 a[152:155], a[248:251], v[160:163], a[152:155]
    s_lshr_b64 s[62:63], s[62:63], 4
    v_exp_f32 v101, v101
    v_mfma_f32_16x16x32_bf16 a[184:187], a[248:251], v[168:171], a[184:187]
    s_mul_i32 s29, s29, 12288
    ds_read_b64_tr_b16 a[236:237], v213 offset:16384
    v_cvt_pk_bf16_f32 v98, v100, v101
    v_mfma_f32_16x16x32_bf16 a[156:159], a[252:255], v[160:163], a[156:159]
    s_add_u32 s29, s29, s44
    v_fma_f32 v102, v102, s45, v122
    v_exp_f32 v102, v102
    v_mfma_f32_16x16x32_bf16 a[188:191], a[252:255], v[168:171], a[188:191]
    s_and_b32 s58, s46, 1
    ds_read_b64_tr_b16 a[238:239], v213 offset:20480
    v_fma_f32 v103, v103, s45, v122
    v_mfma_f32_16x16x32_bf16 v[176:179], v[224:227], v[160:163], v[176:179]
    s_mul_i32 s58, s58, 6144
    buffer_load_dwordx4 v200, s[20:23], s85 offen offset:2048 sc1 lds
    v_mfma_f32_16x16x32_bf16 v[180:183], v[224:227], v[168:171], v[180:183]
    s_sub_u32 s59, 6144, s58
    ds_read_b64_tr_b16 a[240:241], v214 offset:16384
    v_fma_f32 v104, v104, s45, v123
    v_mfma_f32_16x16x32_bf16 v[160:163], a[192:195], v[128:131], 0
    s_lshr_b32 s86, s46, 1
    v_exp_f32 v103, v103
    v_mfma_f32_16x16x32_bf16 v[160:163], a[196:199], v[136:139], v[160:163]
    s_lshl_b32 s86, s86, 12
    ds_read_b64_tr_b16 a[242:243], v214 offset:20480
    v_exp_f32 v104, v104
    v_mfma_f32_16x16x32_bf16 v[160:163], a[200:203], v[144:147], v[160:163]
    s_add_u32 s58, s58, s86
    v_cvt_pk_bf16_f32 v99, v102, v103
    v_fma_f32 v105, v105, s45, v123
    v_mfma_f32_16x16x32_bf16 v[160:163], a[204:207], v[152:155], v[160:163]
    s_add_u32 s59, s59, s86
    ds_read_b64_tr_b16 a[244:245], v215 offset:16384
    v_exp_f32 v105, v105
    v_mfma_f32_16x16x32_bf16 v[164:167], a[208:211], v[128:131], 0
    s_sub_u32 s86, 2048, s86
    buffer_load_dwordx4 v201, s[20:23], s85 offen offset:3072 sc1 lds
    v_mfma_f32_16x16x32_bf16 v[164:167], a[212:215], v[136:139], v[164:167]
    ds_read_b64_tr_b16 a[246:247], v215 offset:20480
    v_add_u32 v245, s58, v223
    v_mfma_f32_16x16x32_bf16 v[164:167], a[216:219], v[144:147], v[164:167]
    v_add_u32 v248, s59, v223
    v_add_u32 v246, s86, v245
    v_cvt_pk_bf16_f32 v104, v104, v105
    v_mfma_f32_16x16x32_bf16 v[164:167], a[220:223], v[152:155], v[164:167]
    ds_read_b64_tr_b16 a[248:249], v216 offset:16384
    v_add_u32 v249, s86, v248
    v_mfma_f32_16x16x32_bf16 v[168:171], a[192:195], v[132:135], 0
    v_add_u32 v247, s86, v246
    v_add_u32 v251, s86, v249
    v_fma_f32 v106, v106, s45, v123
    v_mfma_f32_16x16x32_bf16 v[168:171], a[196:199], v[140:143], v[168:171]
    s_add_u32 m0, s39, 32768
    ds_read_b64_tr_b16 a[250:251], v216 offset:20480
    v_fma_f32 v107, v107, s45, v123
    v_mfma_f32_16x16x32_bf16 v[168:171], a[200:203], v[148:151], v[168:171]
    buffer_load_dwordx4 v198, s[20:23], s100 offen sc1 lds
    v_mfma_f32_16x16x32_bf16 v[168:171], a[204:207], v[156:159], v[168:171]
    ds_read_b64_tr_b16 a[252:253], v217 offset:16384
    v_exp_f32 v106, v106
    v_mfma_f32_16x16x32_bf16 v[172:175], a[208:211], v[132:135], 0
    v_exp_f32 v107, v107
    v_mfma_f32_16x16x32_bf16 v[172:175], a[212:215], v[140:143], v[172:175]
    ds_read_b64_tr_b16 a[254:255], v217 offset:20480
    v_cvt_pk_bf16_f32 v105, v106, v107
    v_fma_f32 v108, v108, s45, v123
    v_mfma_f32_16x16x32_bf16 v[172:175], a[216:219], v[148:151], v[172:175]
    buffer_load_dwordx4 v199, s[20:23], s100 offen offset:1024 sc1 lds
    v_mfma_f32_16x16x32_bf16 v[172:175], a[220:223], v[156:159], v[172:175]
    v_exp_f32 v108, v108
    v_mfma_f32_16x16x32_bf16 v[48:51], v[224:227], v[32:35], v[48:51]
    v_fma_f32 v109, v109, s45, v123
    v_exp_f32 v109, v109
    v_mfma_f32_16x16x32_bf16 v[52:55], v[224:227], v[40:43], v[52:55]
    s_waitcnt lgkmcnt(2)
    v_cvt_pk_bf16_f32 v106, v108, v109
    v_fma_f32 v110, v110, s45, v123
    v_mfma_f32_16x16x32_bf16 a[0:3], a[224:227], v[32:35], a[0:3]
    v_exp_f32 v110, v110
    v_fma_f32 v111, v111, s45, v123
    v_mfma_f32_16x16x32_bf16 a[32:35], a[224:227], v[40:43], a[32:35]
    v_exp_f32 v111, v111
    v_mfma_f32_16x16x32_bf16 a[4:7], a[228:231], v[32:35], a[4:7]
    buffer_load_dwordx4 v200, s[20:23], s100 offen offset:2048 sc1 lds
    v_mfma_f32_16x16x32_bf16 a[36:39], a[228:231], v[40:43], a[36:39]
    v_cvt_pk_bf16_f32 v107, v110, v111
    v_fma_f32 v160, v160, s45, v186
    v_fma_f32 v161, v161, s45, v186
    v_mfma_f32_16x16x32_bf16 a[8:11], a[232:235], v[32:35], a[8:11]
    v_exp_f32 v160, v160
    v_mfma_f32_16x16x32_bf16 a[40:43], a[232:235], v[40:43], a[40:43]
    v_exp_f32 v161, v161
    v_fma_f32 v162, v162, s45, v186
    v_mfma_f32_16x16x32_bf16 a[12:15], a[236:239], v[32:35], a[12:15]
    v_exp_f32 v162, v162
    v_mfma_f32_16x16x32_bf16 a[44:47], a[236:239], v[40:43], a[44:47]
    v_cvt_pk_bf16_f32 v160, v160, v161
    v_fma_f32 v163, v163, s45, v186
    v_mfma_f32_16x16x32_bf16 a[16:19], a[240:243], v[32:35], a[16:19]
    buffer_load_dwordx4 v201, s[20:23], s100 offen offset:3072 sc1 lds
    v_mfma_f32_16x16x32_bf16 a[48:51], a[240:243], v[40:43], a[48:51]
    v_exp_f32 v163, v163
    v_mfma_f32_16x16x32_bf16 a[20:23], a[244:247], v[32:35], a[20:23]
    s_waitcnt vmcnt(9)
    v_readfirstlane_b32 s69, v254
    v_cvt_pk_bf16_f32 v161, v162, v163
    v_fma_f32 v164, v164, s45, v186
    v_mfma_f32_16x16x32_bf16 a[52:55], a[244:247], v[40:43], a[52:55]
    v_exp_f32 v164, v164
    v_mfma_f32_16x16x32_bf16 a[24:27], a[248:251], v[32:35], a[24:27]
    v_fma_f32 v165, v165, s45, v186
    v_fma_f32 v166, v166, s45, v186
    v_mfma_f32_16x16x32_bf16 a[56:59], a[248:251], v[40:43], a[56:59]
    s_waitcnt lgkmcnt(0)
    s_and_b32 s69, s69, 0xff
    s_cmp_lt_u32 s69, 8
    s_cbranch_scc1 L_spin1
L_spin1_back:
    v_mfma_f32_16x16x32_bf16 a[28:31], a[252:255], v[32:35], a[28:31]
    v_exp_f32 v165, v165
    v_mfma_f32_16x16x32_bf16 a[60:63], a[252:255], v[40:43], a[60:63]
    v_exp_f32 v166, v166
    v_cvt_pk_bf16_f32 v162, v164, v165
    v_mfma_f32_16x16x32_bf16 v[112:115], v[224:227], v[96:99], v[112:115]
    v_fma_f32 v167, v167, s45, v186
    v_fma_f32 v168, v168, s45, v187
    v_mfma_f32_16x16x32_bf16 v[116:119], v[224:227], v[104:107], v[116:119]
    buffer_load_dwordx4 a[192:195], v245, s[16:19], s29 offen sc1
    v_mfma_f32_16x16x32_bf16 a[64:67], a[224:227], v[96:99], a[64:67]
    v_exp_f32 v167, v167
    v_fma_f32 v169, v169, s45, v187
    v_mfma_f32_16x16x32_bf16 a[96:99], a[224:227], v[104:107], a[96:99]
    buffer_load_dwordx4 a[196:199], v245, s[16:19], s29 offen offset:1024 sc1
    v_mfma_f32_16x16x32_bf16 a[68:71], a[228:231], v[96:99], a[68:71]
    v_exp_f32 v168, v168
    v_cvt_pk_bf16_f32 v163, v166, v167
    v_mfma_f32_16x16x32_bf16 a[100:103], a[228:231], v[104:107], a[100:103]
    buffer_load_dwordx4 a[200:203], v246, s[16:19], s29 offen sc1
    v_mfma_f32_16x16x32_bf16 a[72:75], a[232:235], v[96:99], a[72:75]
    v_exp_f32 v169, v169
    v_mfma_f32_16x16x32_bf16 a[104:107], a[232:235], v[104:107], a[104:107]
    buffer_load_dwordx4 a[204:207], v246, s[16:19], s29 offen offset:1024 sc1
    v_mfma_f32_16x16x32_bf16 a[76:79], a[236:239], v[96:99], a[76:79]
    v_cvt_pk_bf16_f32 v168, v168, v169
    v_fma_f32 v170, v170, s45, v187
    v_mfma_f32_16x16x32_bf16 a[108:111], a[236:239], v[104:107], a[108:111]
    buffer_load_dwordx4 a[208:211], v247, s[16:19], s29 offen sc1
    v_mfma_f32_16x16x32_bf16 a[80:83], a[240:243], v[96:99], a[80:83]
    v_exp_f32 v170, v170
    v_mfma_f32_16x16x32_bf16 a[112:115], a[240:243], v[104:107], a[112:115]
    buffer_load_dwordx4 a[212:215], v247, s[16:19], s29 offen offset:1024 sc1
    v_mfma_f32_16x16x32_bf16 a[84:87], a[244:247], v[96:99], a[84:87]
    v_mov_b32 v49, v48
    v_mov_b32 v53, v52
    v_fma_f32 v171, v171, s45, v187
    v_mfma_f32_16x16x32_bf16 a[116:119], a[244:247], v[104:107], a[116:119]
    buffer_load_dwordx4 a[216:219], v248, s[16:19], s29 offen sc1
    v_mfma_f32_16x16x32_bf16 a[88:91], a[248:251], v[96:99], a[88:91]
    v_permlane32_swap_b32 v49, v48
    v_permlane32_swap_b32 v53, v52
    v_fma_f32 v172, v172, s45, v187
    v_mfma_f32_16x16x32_bf16 a[120:123], a[248:251], v[104:107], a[120:123]
    buffer_load_dwordx4 a[220:223], v248, s[16:19], s29 offen offset:1024 sc1
    v_mfma_f32_16x16x32_bf16 a[92:95], a[252:255], v[96:99], a[92:95]
    v_add_f32 v48, v48, v49
    v_add_f32 v52, v52, v53
    v_mfma_f32_16x16x32_bf16 a[124:127], a[252:255], v[104:107], a[124:127]
    v_mov_b32 v49, v48
    v_mov_b32 v53, v52
    v_exp_f32 v171, v171
    s_nop 0
    v_cvt_pk_bf16_f32 v169, v170, v171
    v_exp_f32 v172, v172
    v_fma_f32 v173, v173, s45, v187
    v_exp_f32 v173, v173
    s_nop 0
    v_cvt_pk_bf16_f32 v170, v172, v173
    v_fma_f32 v174, v174, s45, v187
    v_exp_f32 v174, v174
    v_fma_f32 v175, v175, s45, v187
    v_exp_f32 v175, v175
    s_nop 0
    v_cvt_pk_bf16_f32 v171, v174, v175
    v_mfma_f32_16x16x32_bf16 v[176:179], v[224:227], v[160:163], v[176:179]
    v_permlane16_swap_b32 v49, v48
    v_permlane16_swap_b32 v53, v52
    v_mfma_f32_16x16x32_bf16 v[180:183], v[224:227], v[168:171], v[180:183]
    v_add_f32 v48, v48, v49
    v_add_f32 v52, v52, v53
    v_mfma_f32_16x16x32_bf16 a[128:131], a[224:227], v[160:163], a[128:131]
    v_mov_b32 v113, v112
    v_mov_b32 v117, v116
    v_mfma_f32_16x16x32_bf16 a[160:163], a[224:227], v[168:171], a[160:163]
    buffer_load_dwordx4 a[224:227], v249, s[16:19], s29 offen sc1
    v_mfma_f32_16x16x32_bf16 a[132:135], a[228:231], v[160:163], a[132:135]
    v_permlane32_swap_b32 v113, v112
    v_permlane32_swap_b32 v117, v116
    v_mfma_f32_16x16x32_bf16 a[164:167], a[228:231], v[168:171], a[164:167]
    v_add_f32 v112, v112, v113
    v_add_f32 v116, v116, v117
    v_mfma_f32_16x16x32_bf16 a[136:139], a[232:235], v[160:163], a[136:139]
    buffer_load_dwordx4 a[228:231], v249, s[16:19], s29 offen offset:1024 sc1
    v_mfma_f32_16x16x32_bf16 a[168:171], a[232:235], v[168:171], a[168:171]
    v_mov_b32 v113, v112
    v_mov_b32 v117, v116
    v_mfma_f32_16x16x32_bf16 a[140:143], a[236:239], v[160:163], a[140:143]
    v_permlane16_swap_b32 v113, v112
    v_permlane16_swap_b32 v117, v116
    v_mfma_f32_16x16x32_bf16 a[172:175], a[236:239], v[168:171], a[172:175]
    buffer_load_dwordx4 a[232:235], v251, s[16:19], s29 offen sc1
    v_mfma_f32_16x16x32_bf16 a[144:147], a[240:243], v[160:163], a[144:147]
    v_add_f32 v112, v112, v113
    v_add_f32 v116, v116, v117
    v_mfma_f32_16x16x32_bf16 a[176:179], a[240:243], v[168:171], a[176:179]
    v_mov_b32 v177, v176
    v_mov_b32 v181, v180
    v_mfma_f32_16x16x32_bf16 a[148:151], a[244:247], v[160:163], a[148:151]
    buffer_load_dwordx4 a[236:239], v251, s[16:19], s29 offen offset:1024 sc1
    v_mfma_f32_16x16x32_bf16 a[180:183], a[244:247], v[168:171], a[180:183]
    v_permlane32_swap_b32 v177, v176
    v_permlane32_swap_b32 v181, v180
    v_mfma_f32_16x16x32_bf16 a[152:155], a[248:251], v[160:163], a[152:155]
    v_add_f32 v176, v176, v177
    v_add_f32 v180, v180, v181
    v_mfma_f32_16x16x32_bf16 a[184:187], a[248:251], v[168:171], a[184:187]
    v_mov_b32 v177, v176
    v_mov_b32 v181, v180
    v_mfma_f32_16x16x32_bf16 a[156:159], a[252:255], v[160:163], a[156:159]
    v_permlane16_swap_b32 v177, v176
    v_permlane16_swap_b32 v181, v180
    v_mfma_f32_16x16x32_bf16 a[188:191], a[252:255], v[168:171], a[188:191]
    v_add_f32 v176, v176, v177
    v_add_f32 v180, v180, v181
    v_add_f32 v252, v48, v52
    v_add_f32 v253, v112, v116
    v_add_f32 v252, v252, v176
    v_add_f32 v253, v253, v180
    v_add_f32 v252, v252, v253
    v_cmp_ngt_f32 vcc, s51, v252
    s_nop 3
    s_cbranch_vccnz L_slow
L_back2:
    v_rcp_f32 v16, v48
    v_rcp_f32 v17, v52
    v_rcp_f32 v18, v112
    v_rcp_f32 v19, v116
    v_rcp_f32 v20, v176
    v_rcp_f32 v21, v180
    v_mov_b32 v252, v223
    s_and_b32 s85, s4, 3
    s_and_b32 s32, s46, 1
    s_lshr_b32 s33, s46, 1
    s_mul_i32 s43, s46, 327680
    s_lshr_b64 s[56:57], s[34:35], 4
    s_and_b32 s29, s62, 15
    s_lshr_b64 s[62:63], s[62:63], 4
    s_mul_i32 s29, s29, 12288
    s_add_u32 s29, s29, s44
    v_add_u32 v254, s39, v252
    s_add_u32 s7, s40, 98304
    v_add_u32 v253, s7, v252
    v_add_u32 v255, 65536, v254
    s_cmp_eq_u32 s33, 0
    s_cselect_b32 s47, 0, 2
    s_cselect_b32 s48, 1, 1
    s_cselect_b32 s49, 2, 0
    s_cselect_b32 s36, 0, 4
    s_cselect_b32 s37, 1, 3
    s_cselect_b32 s38, 2, 2
    s_cselect_b32 s39, 3, 1
    s_cselect_b32 s40, 4, 0
    s_mul_i32 s34, s32, 3
    s_add_u32 s47, s47, s34
    s_add_u32 s48, s48, s34
    s_add_u32 s49, s49, s34
    v_accvgpr_read_b32 v0, a0
    v_accvgpr_read_b32 v1, a1
    v_accvgpr_read_b32 v2, a2
    v_accvgpr_read_b32 v3, a3
    v_accvgpr_read_b32 v4, a4
    v_accvgpr_read_b32 v5, a5
    v_accvgpr_read_b32 v6, a6
    v_accvgpr_read_b32 v7, a7
    v_mul_f32 v0, v16, v0
    v_mul_f32 v1, v16, v1
    v_mul_f32 v2, v16, v2
    v_mul_f32 v3, v16, v3
    v_mul_f32 v4, v16, v4
    v_mul_f32 v5, v16, v5
    v_mul_f32 v6, v16, v6
    v_mul_f32 v7, v16, v7
    v_cvt_pk_bf16_f32 v32, v0, v1
    v_cvt_pk_bf16_f32 v33, v2, v3
    v_cvt_pk_bf16_f32 v34, v4, v5
    v_cvt_pk_bf16_f32 v35, v6, v7
    s_add_u32 s54, s41, 0
    buffer_store_dwordx4 v[32:35], v252, s[24:27], s54 offen sc1
    v_accvgpr_read_b32 v4, a8
    v_accvgpr_read_b32 v5, a9
    v_accvgpr_read_b32 v6, a10
    v_accvgpr_read_b32 v7, a11
    v_accvgpr_read_b32 v8, a12
    v_accvgpr_read_b32 v9, a13
    v_accvgpr_read_b32 v10, a14
    v_accvgpr_read_b32 v11, a15
    v_mul_f32 v4, v16, v4
    v_mul_f32 v5, v16, v5
    v_mul_f32 v6, v16, v6
    v_mul_f32 v7, v16, v7
    v_mul_f32 v8, v16, v8
    v_mul_f32 v9, v16, v9
    v_mul_f32 v10, v16, v10
    v_mul_f32 v11, v16, v11
    v_cvt_pk_bf16_f32 v36, v4, v5
    v_cvt_pk_bf16_f32 v37, v6, v7
    v_cvt_pk_bf16_f32 v38, v8, v9
    v_cvt_pk_bf16_f32 v39, v10, v11
    v_accvgpr_read_b32 v8, a32
    v_accvgpr_read_b32 v9, a33
    v_accvgpr_read_b32 v10, a34
    v_accvgpr_read_b32 v11, a35
    v_accvgpr_read_b32 v12, a36
    v_accvgpr_read_b32 v13, a37
    v_accvgpr_read_b32 v14, a38
    v_accvgpr_read_b32 v15, a39
    v_mul_f32 v8, v17, v8
    v_mul_f32 v9, v17, v9
    v_mul_f32 v10, v17, v10
    v_mul_f32 v11, v17, v11
    v_mul_f32 v12, v17, v12
    v_mul_f32 v13, v17, v13
    v_mul_f32 v14, v17, v14
    v_mul_f32 v15, v17, v15
    v_cvt_pk_bf16_f32 v40, v8, v9
    v_cvt_pk_bf16_f32 v41, v10, v11
    v_cvt_pk_bf16_f32 v42, v12, v13
    v_cvt_pk_bf16_f32 v43, v14, v15
    buffer_store_dwordx4 v[36:39], v252, s[24:27], s54 offen offset:1024 sc1
    v_accvgpr_read_b32 v0, a40
    v_accvgpr_read_b32 v1, a41
    v_accvgpr_read_b32 v2, a42
    v_accvgpr_read_b32 v3, a43
    v_accvgpr_read_b32 v4, a44
    v_accvgpr_read_b32 v5, a45
    v_accvgpr_read_b32 v6, a46
    v_accvgpr_read_b32 v7, a47
    v_mul_f32 v0, v17, v0
    v_mul_f32 v1, v17, v1
    v_mul_f32 v2, v17, v2
    v_mul_f32 v3, v17, v3
    v_mul_f32 v4, v17, v4
    v_mul_f32 v5, v17, v5
    v_mul_f32 v6, v17, v6
    v_mul_f32 v7, v17, v7
    v_cvt_pk_bf16_f32 v44, v0, v1
    v_cvt_pk_bf16_f32 v45, v2, v3
    v_cvt_pk_bf16_f32 v46, v4, v5
    v_cvt_pk_bf16_f32 v47, v6, v7
    v_accvgpr_read_b32 v4, a16
    v_accvgpr_read_b32 v5, a17
    v_accvgpr_read_b32 v6, a18
    v_accvgpr_read_b32 v7, a19
    v_accvgpr_read_b32 v8, a20
    v_accvgpr_read_b32 v9, a21
    v_accvgpr_read_b32 v10, a22
    v_accvgpr_read_b32 v11, a23
    v_mul_f32 v4, v16, v4
    v_mul_f32 v5, v16, v5
    v_mul_f32 v6, v16, v6
    v_mul_f32 v7, v16, v7
    v_mul_f32 v8, v16, v8
    v_mul_f32 v9, v16, v9
    v_mul_f32 v10, v16, v10
    v_mul_f32 v11, v16, v11
    v_cvt_pk_bf16_f32 v48, v4, v5
    v_cvt_pk_bf16_f32 v49, v6, v7
    v_cvt_pk_bf16_f32 v50, v8, v9
    v_cvt_pk_bf16_f32 v51, v10, v11
    buffer_store_dwordx4 v[40:43], v252, s[24:27], s54 offen offset:2048 sc1
    v_accvgpr_read_b32 v8, a24
    v_accvgpr_read_b32 v9, a25
    v_accvgpr_read_b32 v10, a26
    v_accvgpr_read_b32 v11, a27
    v_accvgpr_read_b32 v12, a28
    v_accvgpr_read_b32 v13, a29
    v_accvgpr_read_b32 v14, a30
    v_accvgpr_read_b32 v15, a31
    v_mul_f32 v8, v16, v8
    v_mul_f32 v9, v16, v9
    v_mul_f32 v10, v16, v10
    v_mul_f32 v11, v16, v11
    v_mul_f32 v12, v16, v12
    v_mul_f32 v13, v16, v13
    v_mul_f32 v14, v16, v14
    v_mul_f32 v15, v16, v15
    v_cvt_pk_bf16_f32 v52, v8, v9
    v_cvt_pk_bf16_f32 v53, v10, v11
    v_cvt_pk_bf16_f32 v54, v12, v13
    v_cvt_pk_bf16_f32 v55, v14, v15
    v_accvgpr_read_b32 v0, a48
    v_accvgpr_read_b32 v1, a49
    v_accvgpr_read_b32 v2, a50
    v_accvgpr_read_b32 v3, a51
    v_accvgpr_read_b32 v4, a52
    v_accvgpr_read_b32 v5, a53
    v_accvgpr_read_b32 v6, a54
    v_accvgpr_read_b32 v7, a55
    v_mul_f32 v0, v17, v0
    v_mul_f32 v1, v17, v1
    v_mul_f32 v2, v17, v2
    v_mul_f32 v3, v17, v3
    v_mul_f32 v4, v17, v4
    v_mul_f32 v5, v17, v5
    v_mul_f32 v6, v17, v6
    v_mul_f32 v7, v17, v7
    v_cvt_pk_bf16_f32 v56, v0, v1
    v_cvt_pk_bf16_f32 v57, v2, v3
    v_cvt_pk_bf16_f32 v58, v4, v5
    v_cvt_pk_bf16_f32 v59, v6, v7
    buffer_store_dwordx4 v[44:47], v252, s[24:27], s54 offen offset:3072 sc1
    v_accvgpr_read_b32 v4, a56
    v_accvgpr_read_b32 v5, a57
    v_accvgpr_read_b32 v6, a58
    v_accvgpr_read_b32 v7, a59
    v_accvgpr_read_b32 v8, a60
    v_accvgpr_read_b32 v9, a61
    v_accvgpr_read_b32 v10, a62
    v_accvgpr_read_b32 v11, a63
    v_mul_f32 v4, v17, v4
    v_mul_f32 v5, v17, v5
    v_mul_f32 v6, v17, v6
    v_mul_f32 v7, v17, v7
    v_mul_f32 v8, v17, v8
    v_mul_f32 v9, v17, v9
    v_mul_f32 v10, v17, v10
    v_mul_f32 v11, v17, v11
    v_cvt_pk_bf16_f32 v60, v4, v5
    v_cvt_pk_bf16_f32 v61, v6, v7
    v_cvt_pk_bf16_f32 v62, v8, v9
    v_cvt_pk_bf16_f32 v63, v10, v11
    v_accvgpr_read_b32 v8, a64
    v_accvgpr_read_b32 v9, a65
    v_accvgpr_read_b32 v10, a66
    v_accvgpr_read_b32 v11, a67
    v_accvgpr_read_b32 v12, a68
    v_accvgpr_read_b32 v13, a69
    v_accvgpr_read_b32 v14, a70
    v_accvgpr_read_b32 v15, a71
    buffer_load_dwordx4 a[0:3], v245, s[16:19], s29 offen sc1
    v_mul_f32 v8, v18, v8
    v_mul_f32 v9, v18, v9
    v_mul_f32 v10, v18, v10
    v_mul_f32 v11, v18, v11
    v_mul_f32 v12, v18, v12
    v_mul_f32 v13, v18, v13
    v_mul_f32 v14, v18, v14
    v_mul_f32 v15, v18, v15
    buffer_load_dwordx4 a[4:7], v245, s[16:19], s29 offen offset:1024 sc1
    v_cvt_pk_bf16_f32 v64, v8, v9
    v_cvt_pk_bf16_f32 v65, v10, v11
    v_cvt_pk_bf16_f32 v66, v12, v13
    v_cvt_pk_bf16_f32 v67, v14, v15
    s_add_u32 s54, s41, 12288
    buffer_store_dwordx4 v[48:51], v252, s[24:27], s54 offen sc1
    v_accvgpr_read_b32 v0, a72
    v_accvgpr_read_b32 v1, a73
    v_accvgpr_read_b32 v2, a74
    v_accvgpr_read_b32 v3, a75
    v_accvgpr_read_b32 v4, a76
    v_accvgpr_read_b32 v5, a77
    v_accvgpr_read_b32 v6, a78
    v_accvgpr_read_b32 v7, a79
    buffer_load_dwordx4 a[8:11], v246, s[16:19], s29 offen sc1
    v_mul_f32 v0, v18, v0
    v_mul_f32 v1, v18, v1
    v_mul_f32 v2, v18, v2
    v_mul_f32 v3, v18, v3
    v_mul_f32 v4, v18, v4
    v_mul_f32 v5, v18, v5
    v_mul_f32 v6, v18, v6
    v_mul_f32 v7, v18, v7
    buffer_load_dwordx4 a[12:15], v246, s[16:19], s29 offen offset:1024 sc1
    v_cvt_pk_bf16_f32 v68, v0, v1
    v_cvt_pk_bf16_f32 v69, v2, v3
    v_cvt_pk_bf16_f32 v70, v4, v5
    v_cvt_pk_bf16_f32 v71, v6, v7
    v_accvgpr_read_b32 v4, a96
    v_accvgpr_read_b32 v5, a97
    v_accvgpr_read_b32 v6, a98
    v_accvgpr_read_b32 v7, a99
    v_accvgpr_read_b32 v8, a100
    v_accvgpr_read_b32 v9, a101
    v_accvgpr_read_b32 v10, a102
    v_accvgpr_read_b32 v11, a103
    buffer_load_dwordx4 a[16:19], v247, s[16:19], s29 offen sc1
    v_mul_f32 v4, v19, v4
    v_mul_f32 v5, v19, v5
    v_mul_f32 v6, v19, v6
    v_mul_f32 v7, v19, v7
    v_mul_f32 v8, v19, v8
    v_mul_f32 v9, v19, v9
    v_mul_f32 v10, v19, v10
    v_mul_f32 v11, v19, v11
    buffer_load_dwordx4 a[20:23], v247, s[16:19], s29 offen offset:1024 sc1
    v_cvt_pk_bf16_f32 v72, v4, v5
    v_cvt_pk_bf16_f32 v73, v6, v7
    v_cvt_pk_bf16_f32 v74, v8, v9
    v_cvt_pk_bf16_f32 v75, v10, v11
    buffer_store_dwordx4 v[52:55], v252, s[24:27], s54 offen offset:1024 sc1
    v_accvgpr_read_b32 v8, a104
    v_accvgpr_read_b32 v9, a105
    v_accvgpr_read_b32 v10, a106
    v_accvgpr_read_b32 v11, a107
    v_accvgpr_read_b32 v12, a108
    v_accvgpr_read_b32 v13, a109
    v_accvgpr_read_b32 v14, a110
    v_accvgpr_read_b32 v15, a111
    buffer_load_dwordx4 a[24:27], v248, s[16:19], s29 offen sc1
    v_mul_f32 v8, v19, v8
    v_mul_f32 v9, v19, v9
    v_mul_f32 v10, v19, v10
    v_mul_f32 v11, v19, v11
    v_mul_f32 v12, v19, v12
    v_mul_f32 v13, v19, v13
    v_mul_f32 v14, v19, v14
    v_mul_f32 v15, v19, v15
    buffer_load_dwordx4 a[28:31], v248, s[16:19], s29 offen offset:1024 sc1
    v_cvt_pk_bf16_f32 v76, v8, v9
    v_cvt_pk_bf16_f32 v77, v10, v11
    v_cvt_pk_bf16_f32 v78, v12, v13
    v_cvt_pk_bf16_f32 v79, v14, v15
    v_accvgpr_read_b32 v0, a80
    v_accvgpr_read_b32 v1, a81
    v_accvgpr_read_b32 v2, a82
    v_accvgpr_read_b32 v3, a83
    v_accvgpr_read_b32 v4, a84
    v_accvgpr_read_b32 v5, a85
    v_accvgpr_read_b32 v6, a86
    v_accvgpr_read_b32 v7, a87
    buffer_load_dwordx4 a[32:35], v249, s[16:19], s29 offen sc1
    v_mul_f32 v0, v18, v0
    v_mul_f32 v1, v18, v1
    v_mul_f32 v2, v18, v2
    v_mul_f32 v3, v18, v3
    v_mul_f32 v4, v18, v4
    v_mul_f32 v5, v18, v5
    v_mul_f32 v6, v18, v6
    v_mul_f32 v7, v18, v7
    buffer_load_dwordx4 a[36:39], v249, s[16:19], s29 offen offset:1024 sc1
    v_cvt_pk_bf16_f32 v192, v0, v1
    v_cvt_pk_bf16_f32 v193, v2, v3
    v_cvt_pk_bf16_f32 v194, v4, v5
    v_cvt_pk_bf16_f32 v195, v6, v7
    buffer_store_dwordx4 v[56:59], v252, s[24:27], s54 offen offset:2048 sc1
    v_accvgpr_read_b32 v4, a88
    v_accvgpr_read_b32 v5, a89
    v_accvgpr_read_b32 v6, a90
    v_accvgpr_read_b32 v7, a91
    v_accvgpr_read_b32 v8, a92
    v_accvgpr_read_b32 v9, a93
    v_accvgpr_read_b32 v10, a94
    v_accvgpr_read_b32 v11, a95
    buffer_load_dwordx4 a[40:43], v251, s[16:19], s29 offen sc1
    v_mul_f32 v4, v18, v4
    v_mul_f32 v5, v18, v5
    v_mul_f32 v6, v18, v6
    v_mul_f32 v7, v18, v7
    v_mul_f32 v8, v18, v8
    v_mul_f32 v9, v18, v9
    v_mul_f32 v10, v18, v10
    v_mul_f32 v11, v18, v11
    buffer_load_dwordx4 a[44:47], v251, s[16:19], s29 offen offset:1024 sc1
    v_cvt_pk_bf16_f32 v196, v4, v5
    v_cvt_pk_bf16_f32 v197, v6, v7
    v_cvt_pk_bf16_f32 v198, v8, v9
    v_cvt_pk_bf16_f32 v199, v10, v11
    v_accvgpr_read_b32 v8, a112
    v_accvgpr_read_b32 v9, a113
    v_accvgpr_read_b32 v10, a114
    v_accvgpr_read_b32 v11, a115
    v_accvgpr_read_b32 v12, a116
    v_accvgpr_read_b32 v13, a117
    v_accvgpr_read_b32 v14, a118
    v_accvgpr_read_b32 v15, a119
    v_mul_f32 v8, v19, v8
    v_mul_f32 v9, v19, v9
    v_mul_f32 v10, v19, v10
    v_mul_f32 v11, v19, v11
    v_mul_f32 v12, v19, v12
    v_mul_f32 v13, v19, v13
    v_mul_f32 v14, v19, v14
    v_mul_f32 v15, v19, v15
    v_cvt_pk_bf16_f32 v200, v8, v9
    v_cvt_pk_bf16_f32 v201, v10, v11
    v_cvt_pk_bf16_f32 v202, v12, v13
    v_cvt_pk_bf16_f32 v203, v14, v15
    buffer_store_dwordx4 v[60:63], v252, s[24:27], s54 offen offset:3072 sc1
    v_accvgpr_read_b32 v0, a120
    v_accvgpr_read_b32 v1, a121
    v_accvgpr_read_b32 v2, a122
    v_accvgpr_read_b32 v3, a123
    v_accvgpr_read_b32 v4, a124
    v_accvgpr_read_b32 v5, a125
    v_accvgpr_read_b32 v6, a126
    v_accvgpr_read_b32 v7, a127
    v_mul_f32 v0, v19, v0
    v_mul_f32 v1, v19, v1
    v_mul_f32 v2, v19, v2
    v_mul_f32 v3, v19, v3
    v_mul_f32 v4, v19, v4
    v_mul_f32 v5, v19, v5
    v_mul_f32 v6, v19, v6
    v_mul_f32 v7, v19, v7
    v_cvt_pk_bf16_f32 v204, v0, v1
    v_cvt_pk_bf16_f32 v205, v2, v3
    v_cvt_pk_bf16_f32 v206, v4, v5
    v_cvt_pk_bf16_f32 v207, v6, v7
    s_waitcnt vmcnt(32)
    s_lshl_b32 s7, s36, 12
    v_add_u32 v240, s7, v252
    s_lshl_b32 s7, s37, 12
    v_add_u32 v241, s7, v252
    s_lshl_b32 s7, s38, 12
    v_add_u32 v242, s7, v252
    s_lshl_b32 s7, s39, 12
    v_add_u32 v243, s7, v252
    s_lshl_b32 s7, s40, 12
    v_add_u32 v244, s7, v252
    s_and_b32 s30, s56, 15
    s_lshr_b64 s[56:57], s[56:57], 4
    s_mul_i32 s30, s30, 20480
    s_add_u32 s30, s30, s43
    s_and_b32 s68, s56, 15
    s_lshr_b64 s[56:57], s[56:57], 4
    s_mul_i32 s68, s68, 20480
    s_add_u32 s68, s68, s43
    s_and_b32 s28, s56, 15
    s_lshr_b64 s[56:57], s[56:57], 4
    s_mul_i32 s28, s28, 20480
    s_add_u32 s28, s28, s43
    v_accvgpr_read_b32 v4, a128
    v_accvgpr_read_b32 v5, a129
    v_accvgpr_read_b32 v6, a130
    v_accvgpr_read_b32 v7, a131
    v_accvgpr_read_b32 v8, a132
    v_accvgpr_read_b32 v9, a133
    v_accvgpr_read_b32 v10, a134
    v_accvgpr_read_b32 v11, a135
    v_mul_f32 v4, v20, v4
    v_mul_f32 v5, v20, v5
    v_mul_f32 v6, v20, v6
    v_mul_f32 v7, v20, v7
    v_mul_f32 v8, v20, v8
    v_mul_f32 v9, v20, v9
    v_mul_f32 v10, v20, v10
    v_mul_f32 v11, v20, v11
    v_cvt_pk_bf16_f32 v208, v4, v5
    v_cvt_pk_bf16_f32 v209, v6, v7
    v_cvt_pk_bf16_f32 v210, v8, v9
    v_cvt_pk_bf16_f32 v211, v10, v11
    s_add_u32 s54, s41, 4096
    buffer_store_dwordx4 v[64:67], v252, s[24:27], s54 offen sc1
    ds_read_b128 a[240:243], v254
    ds_read_b128 a[248:251], v254 offset:2048
    ds_read_b128 a[244:247], v254 offset:1024
    ds_read_b128 a[252:255], v254 offset:3072
    v_accvgpr_read_b32 v8, a136
    v_accvgpr_read_b32 v9, a137
    v_accvgpr_read_b32 v10, a138
    v_accvgpr_read_b32 v11, a139
    v_accvgpr_read_b32 v12, a140
    v_accvgpr_read_b32 v13, a141
    v_accvgpr_read_b32 v14, a142
    v_accvgpr_read_b32 v15, a143
    v_mul_f32 v8, v20, v8
    v_mul_f32 v9, v20, v9
    v_mul_f32 v10, v20, v10
    v_mul_f32 v11, v20, v11
    v_mul_f32 v12, v20, v12
    v_mul_f32 v13, v20, v13
    v_mul_f32 v14, v20, v14
    v_mul_f32 v15, v20, v15
    v_cvt_pk_bf16_f32 v212, v8, v9
    v_cvt_pk_bf16_f32 v213, v10, v11
    v_cvt_pk_bf16_f32 v214, v12, v13
    v_cvt_pk_bf16_f32 v215, v14, v15
    ds_read_b128 a[64:67], v253
    ds_read_b128 a[72:75], v253 offset:2048
    ds_read_b128 a[68:71], v253 offset:1024
    ds_read_b128 a[76:79], v253 offset:3072
    v_accvgpr_read_b32 v0, a160
    v_accvgpr_read_b32 v1, a161
    v_accvgpr_read_b32 v2, a162
    v_accvgpr_read_b32 v3, a163
    v_accvgpr_read_b32 v4, a164
    v_accvgpr_read_b32 v5, a165
    v_accvgpr_read_b32 v6, a166
    v_accvgpr_read_b32 v7, a167
    v_mul_f32 v0, v21, v0
    v_mul_f32 v1, v21, v1
    v_mul_f32 v2, v21, v2
    v_mul_f32 v3, v21, v3
    v_mul_f32 v4, v21, v4
    v_mul_f32 v5, v21, v5
    v_mul_f32 v6, v21, v6
    v_mul_f32 v7, v21, v7
    v_cvt_pk_bf16_f32 v216, v0, v1
    v_cvt_pk_bf16_f32 v217, v2, v3
    v_cvt_pk_bf16_f32 v218, v4, v5
    v_cvt_pk_bf16_f32 v219, v6, v7
    buffer_store_dwordx4 v[68:71], v252, s[24:27], s54 offen offset:1024 sc1
    ds_read_b128 a[80:83], v255 offset:16384
    ds_read_b128 a[88:91], v255 offset:18432
    ds_read_b128 a[84:87], v255 offset:17408
    ds_read_b128 a[92:95], v255 offset:19456
    v_accvgpr_read_b32 v4, a168
    v_accvgpr_read_b32 v5, a169
    v_accvgpr_read_b32 v6, a170
    v_accvgpr_read_b32 v7, a171
    v_accvgpr_read_b32 v8, a172
    v_accvgpr_read_b32 v9, a173
    v_accvgpr_read_b32 v10, a174
    v_accvgpr_read_b32 v11, a175
    v_mul_f32 v4, v21, v4
    v_mul_f32 v5, v21, v5
    v_mul_f32 v6, v21, v6
    v_mul_f32 v7, v21, v7
    v_mul_f32 v8, v21, v8
    v_mul_f32 v9, v21, v9
    v_mul_f32 v10, v21, v10
    v_mul_f32 v11, v21, v11
    v_cvt_pk_bf16_f32 v220, v4, v5
    v_cvt_pk_bf16_f32 v221, v6, v7
    v_cvt_pk_bf16_f32 v222, v8, v9
    v_cvt_pk_bf16_f32 v223, v10, v11
    ds_read_b128 a[96:99], v255
    ds_read_b128 a[104:107], v255 offset:2048
    ds_read_b128 a[100:103], v255 offset:1024
    ds_read_b128 a[108:111], v255 offset:3072
    v_accvgpr_read_b32 v8, a144
    v_accvgpr_read_b32 v9, a145
    v_accvgpr_read_b32 v10, a146
    v_accvgpr_read_b32 v11, a147
    v_accvgpr_read_b32 v12, a148
    v_accvgpr_read_b32 v13, a149
    v_accvgpr_read_b32 v14, a150
    v_accvgpr_read_b32 v15, a151
    v_mul_f32 v8, v20, v8
    v_mul_f32 v9, v20, v9
    v_mul_f32 v10, v20, v10
    v_mul_f32 v11, v20, v11
    v_mul_f32 v12, v20, v12
    v_mul_f32 v13, v20, v13
    v_mul_f32 v14, v20, v14
    v_mul_f32 v15, v20, v15
    v_cvt_pk_bf16_f32 v224, v8, v9
    v_cvt_pk_bf16_f32 v225, v10, v11
    v_cvt_pk_bf16_f32 v226, v12, v13
    v_cvt_pk_bf16_f32 v227, v14, v15
    buffer_store_dwordx4 v[72:75], v252, s[24:27], s54 offen offset:2048 sc1
    ds_read_b128 a[112:115], v253 offset:24576
    ds_read_b128 a[120:123], v253 offset:26624
    ds_read_b128 a[116:119], v253 offset:25600
    ds_read_b128 a[124:127], v253 offset:27648
    v_accvgpr_read_b32 v0, a152
    v_accvgpr_read_b32 v1, a153
    v_accvgpr_read_b32 v2, a154
    v_accvgpr_read_b32 v3, a155
    v_accvgpr_read_b32 v4, a156
    v_accvgpr_read_b32 v5, a157
    v_accvgpr_read_b32 v6, a158
    v_accvgpr_read_b32 v7, a159
    v_mul_f32 v0, v20, v0
    v_mul_f32 v1, v20, v1
    v_mul_f32 v2, v20, v2
    v_mul_f32 v3, v20, v3
    v_mul_f32 v4, v20, v4
    v_mul_f32 v5, v20, v5
    v_mul_f32 v6, v20, v6
    v_mul_f32 v7, v20, v7
    v_cvt_pk_bf16_f32 v228, v0, v1
    v_cvt_pk_bf16_f32 v229, v2, v3
    v_cvt_pk_bf16_f32 v230, v4, v5
    v_cvt_pk_bf16_f32 v231, v6, v7
    v_accvgpr_read_b32 v4, a176
    v_accvgpr_read_b32 v5, a177
    v_accvgpr_read_b32 v6, a178
    v_accvgpr_read_b32 v7, a179
    v_accvgpr_read_b32 v8, a180
    v_accvgpr_read_b32 v9, a181
    v_accvgpr_read_b32 v10, a182
    v_accvgpr_read_b32 v11, a183
    v_mul_f32 v4, v21, v4
    v_mul_f32 v5, v21, v5
    v_mul_f32 v6, v21, v6
    v_mul_f32 v7, v21, v7
    v_mul_f32 v8, v21, v8
    v_mul_f32 v9, v21, v9
    v_mul_f32 v10, v21, v10
    v_mul_f32 v11, v21, v11
    v_cvt_pk_bf16_f32 v232, v4, v5
    v_cvt_pk_bf16_f32 v233, v6, v7
    v_cvt_pk_bf16_f32 v234, v8, v9
    v_cvt_pk_bf16_f32 v235, v10, v11
    buffer_store_dwordx4 v[76:79], v252, s[24:27], s54 offen offset:3072 sc1
    v_accvgpr_read_b32 v8, a184
    v_accvgpr_read_b32 v9, a185
    v_accvgpr_read_b32 v10, a186
    v_accvgpr_read_b32 v11, a187
    v_accvgpr_read_b32 v12, a188
    v_accvgpr_read_b32 v13, a189
    v_accvgpr_read_b32 v14, a190
    v_accvgpr_read_b32 v15, a191
    v_mul_f32 v8, v21, v8
    v_mul_f32 v9, v21, v9
    v_mul_f32 v10, v21, v10
    v_mul_f32 v11, v21, v11
    v_mul_f32 v12, v21, v12
    v_mul_f32 v13, v21, v13
    v_mul_f32 v14, v21, v14
    v_mul_f32 v15, v21, v15
    v_cvt_pk_bf16_f32 v236, v8, v9
    v_cvt_pk_bf16_f32 v237, v10, v11
    v_cvt_pk_bf16_f32 v238, v12, v13
    v_cvt_pk_bf16_f32 v239, v14, v15
    buffer_load_dwordx4 a[176:179], v244, s[20:23], s30 offen sc1
    buffer_load_dwordx4 a[184:187], v244, s[20:23], s30 offen offset:2048 sc1
    buffer_load_dwordx4 a[180:183], v244, s[20:23], s30 offen offset:1024 sc1
    buffer_load_dwordx4 a[188:191], v244, s[20:23], s30 offen offset:3072 sc1
    v_add_u32 v255, 81920, v255
    s_and_b32 s29, s62, 15
    s_lshr_b64 s[62:63], s[62:63], 4
    s_mul_i32 s29, s29, 12288
    s_add_u32 s29, s29, s44
    s_mov_b32 s71, 0
    s_mov_b32 s8, s92
    s_and_b32 s9, s93, 0xffff
    s_mov_b32 s10, 7864320
    s_mov_b32 s11, 0x20000
    s_mul_i32 s31, s6, 491520
    s_mul_i32 s7, s84, 245760
    s_add_u32 s31, s31, s7
    s_mul_i32 s7, s5, 1280
    s_add_u32 s31, s31, s7
    s_mul_i32 s7, s85, 320
    s_add_u32 s31, s31, s7
    s_mov_b32 s67, 6
    s_waitcnt vmcnt(39) lgkmcnt(0)
    v_mfma_f32_16x16x32_bf16 v[0:3], a[240:243], a[192:195], 0
    s_waitcnt vmcnt(38)
    v_mfma_f32_16x16x32_bf16 v[0:3], a[248:251], a[196:199], v[0:3]
    s_waitcnt vmcnt(37)
    v_mfma_f32_16x16x32_bf16 v[8:11], a[240:243], a[200:203], 0
    s_waitcnt vmcnt(36)
    s_add_u32 s54, s41, 16384
    v_mfma_f32_16x16x32_bf16 v[8:11], a[248:251], a[204:207], v[8:11]
    s_waitcnt vmcnt(35)
    buffer_store_dwordx4 v[192:195], v252, s[24:27], s54 offen sc1
    v_mfma_f32_16x16x32_bf16 v[16:19], a[240:243], a[208:211], 0
    s_waitcnt vmcnt(35)
    v_mfma_f32_16x16x32_bf16 v[16:19], a[248:251], a[212:215], v[16:19]
    s_waitcnt vmcnt(34)
    ds_read_b128 a[48:51], v255
    v_mfma_f32_16x16x32_bf16 v[24:27], a[240:243], a[216:219], 0
    s_waitcnt vmcnt(33)
    v_mfma_f32_16x16x32_bf16 v[24:27], a[248:251], a[220:223], v[24:27]
    s_waitcnt vmcnt(32)
    v_mfma_f32_16x16x32_bf16 v[32:35], a[240:243], a[224:227], 0
    s_waitcnt vmcnt(31)
    v_mfma_f32_16x16x32_bf16 v[32:35], a[248:251], a[228:231], v[32:35]
    s_waitcnt vmcnt(30)
    ds_read_b128 a[56:59], v255 offset:2048
    v_mfma_f32_16x16x32_bf16 v[40:43], a[240:243], a[232:235], 0
    s_waitcnt vmcnt(29)
    v_mfma_f32_16x16x32_bf16 v[40:43], a[248:251], a[236:239], v[40:43]
    buffer_load_dwordx4 a[240:243], v240, s[20:23], s68 offen sc1
    v_mfma_f32_16x16x32_bf16 v[4:7], a[244:247], a[192:195], 0
    v_mfma_f32_16x16x32_bf16 v[4:7], a[252:255], a[196:199], v[4:7]
    ds_read_b128 a[52:55], v255 offset:1024
    v_mfma_f32_16x16x32_bf16 v[12:15], a[244:247], a[200:203], 0
    buffer_load_dwordx4 a[248:251], v240, s[20:23], s68 offen offset:2048 sc1
    v_mfma_f32_16x16x32_bf16 v[12:15], a[252:255], a[204:207], v[12:15]
    v_mfma_f32_16x16x32_bf16 v[20:23], a[244:247], a[208:211], 0
    buffer_store_dwordx4 v[196:199], v252, s[24:27], s54 offen offset:1024 sc1
    v_mfma_f32_16x16x32_bf16 v[20:23], a[252:255], a[212:215], v[20:23]
    ds_read_b128 a[60:63], v255 offset:3072
    v_mfma_f32_16x16x32_bf16 v[28:31], a[244:247], a[216:219], 0
    v_mfma_f32_16x16x32_bf16 v[28:31], a[252:255], a[220:223], v[28:31]
    v_mfma_f32_16x16x32_bf16 v[36:39], a[244:247], a[224:227], 0
    v_mfma_f32_16x16x32_bf16 v[36:39], a[252:255], a[228:231], v[36:39]
    ds_read_b128 a[128:131], v253 offset:4096
    v_mfma_f32_16x16x32_bf16 v[44:47], a[244:247], a[232:235], 0
    v_mfma_f32_16x16x32_bf16 v[44:47], a[252:255], a[236:239], v[44:47]
    buffer_load_dwordx4 a[244:247], v240, s[20:23], s68 offen offset:1024 sc1
    v_mfma_f32_16x16x32_bf16 v[48:51], a[64:67], a[192:195], 0
    v_mfma_f32_16x16x32_bf16 v[48:51], a[72:75], a[196:199], v[48:51]
    ds_read_b128 a[136:139], v253 offset:28672
    v_mfma_f32_16x16x32_bf16 v[56:59], a[64:67], a[200:203], 0
    buffer_load_dwordx4 a[252:255], v240, s[20:23], s68 offen offset:3072 sc1
    v_mfma_f32_16x16x32_bf16 v[56:59], a[72:75], a[204:207], v[56:59]
    v_mfma_f32_16x16x32_bf16 v[64:67], a[64:67], a[208:211], 0
    v_mfma_f32_16x16x32_bf16 v[64:67], a[72:75], a[212:215], v[64:67]
    buffer_store_dwordx4 v[200:203], v252, s[24:27], s54 offen offset:2048 sc1
    v_mfma_f32_16x16x32_bf16 v[72:75], a[64:67], a[216:219], 0
    ds_read_b128 a[132:135], v253 offset:5120
    v_mfma_f32_16x16x32_bf16 v[72:75], a[72:75], a[220:223], v[72:75]
    v_mfma_f32_16x16x32_bf16 v[80:83], a[64:67], a[224:227], 0
    v_mfma_f32_16x16x32_bf16 v[80:83], a[72:75], a[228:231], v[80:83]
    v_mfma_f32_16x16x32_bf16 v[88:91], a[64:67], a[232:235], 0
    ds_read_b128 a[140:143], v253 offset:29696
    v_mfma_f32_16x16x32_bf16 v[88:91], a[72:75], a[236:239], v[88:91]
    buffer_load_dwordx4 a[64:67], v241, s[20:23], s68 offen sc1
    v_mfma_f32_16x16x32_bf16 v[52:55], a[68:71], a[192:195], 0
    v_mfma_f32_16x16x32_bf16 v[52:55], a[76:79], a[196:199], v[52:55]
    v_mfma_f32_16x16x32_bf16 v[60:63], a[68:71], a[200:203], 0
    ds_read_b128 a[144:147], v254 offset:16384
    v_mfma_f32_16x16x32_bf16 v[60:63], a[76:79], a[204:207], v[60:63]
    buffer_load_dwordx4 a[72:75], v241, s[20:23], s68 offen offset:2048 sc1
    v_mfma_f32_16x16x32_bf16 v[68:71], a[68:71], a[208:211], 0
    v_mfma_f32_16x16x32_bf16 v[68:71], a[76:79], a[212:215], v[68:71]
    v_mfma_f32_16x16x32_bf16 v[76:79], a[68:71], a[216:219], 0
    buffer_store_dwordx4 v[204:207], v252, s[24:27], s54 offen offset:3072 sc1
    v_mfma_f32_16x16x32_bf16 v[76:79], a[76:79], a[220:223], v[76:79]
    ds_read_b128 a[152:155], v254 offset:18432
    v_mfma_f32_16x16x32_bf16 v[84:87], a[68:71], a[224:227], 0
    v_mfma_f32_16x16x32_bf16 v[84:87], a[76:79], a[228:231], v[84:87]
    v_mfma_f32_16x16x32_bf16 v[92:95], a[68:71], a[232:235], 0
    v_mfma_f32_16x16x32_bf16 v[92:95], a[76:79], a[236:239], v[92:95]
    ds_read_b128 a[148:151], v254 offset:17408
    v_mfma_f32_16x16x32_bf16 v[96:99], a[80:83], a[192:195], 0
    buffer_load_dwordx4 a[68:71], v241, s[20:23], s68 offen offset:1024 sc1
    v_mfma_f32_16x16x32_bf16 v[96:99], a[88:91], a[196:199], v[96:99]
    v_mfma_f32_16x16x32_bf16 v[104:107], a[80:83], a[200:203], 0
    v_mfma_f32_16x16x32_bf16 v[104:107], a[88:91], a[204:207], v[104:107]
    ds_read_b128 a[156:159], v254 offset:19456
    v_mfma_f32_16x16x32_bf16 v[112:115], a[80:83], a[208:211], 0
    buffer_load_dwordx4 a[76:79], v241, s[20:23], s68 offen offset:3072 sc1
    v_mfma_f32_16x16x32_bf16 v[112:115], a[88:91], a[212:215], v[112:115]
    v_mfma_f32_16x16x32_bf16 v[120:123], a[80:83], a[216:219], 0
    s_add_u32 s54, s41, 8192
    v_mfma_f32_16x16x32_bf16 v[120:123], a[88:91], a[220:223], v[120:123]
    buffer_store_dwordx4 v[208:211], v252, s[24:27], s54 offen sc1
    v_mfma_f32_16x16x32_bf16 v[128:131], a[80:83], a[224:227], 0
    ds_read_b128 a[160:163], v254 offset:32768
    v_mfma_f32_16x16x32_bf16 v[128:131], a[88:91], a[228:231], v[128:131]
    v_mfma_f32_16x16x32_bf16 v[136:139], a[80:83], a[232:235], 0
    v_mfma_f32_16x16x32_bf16 v[136:139], a[88:91], a[236:239], v[136:139]
    buffer_load_dwordx4 a[80:83], v242, s[20:23], s68 offen sc1
    v_mfma_f32_16x16x32_bf16 v[100:103], a[84:87], a[192:195], 0
    ds_read_b128 a[168:171], v254 offset:34816
    v_mfma_f32_16x16x32_bf16 v[100:103], a[92:95], a[196:199], v[100:103]
    v_mfma_f32_16x16x32_bf16 v[108:111], a[84:87], a[200:203], 0
    buffer_load_dwordx4 a[88:91], v242, s[20:23], s68 offen offset:2048 sc1
    v_mfma_f32_16x16x32_bf16 v[108:111], a[92:95], a[204:207], v[108:111]
    v_mfma_f32_16x16x32_bf16 v[116:119], a[84:87], a[208:211], 0
    ds_read_b128 a[164:167], v254 offset:33792
    v_mfma_f32_16x16x32_bf16 v[116:119], a[92:95], a[212:215], v[116:119]
    v_mfma_f32_16x16x32_bf16 v[124:127], a[84:87], a[216:219], 0
    v_mfma_f32_16x16x32_bf16 v[124:127], a[92:95], a[220:223], v[124:127]
    v_mfma_f32_16x16x32_bf16 v[132:135], a[84:87], a[224:227], 0
    buffer_store_dwordx4 v[212:215], v252, s[24:27], s54 offen offset:1024 sc1
    v_mfma_f32_16x16x32_bf16 v[132:135], a[92:95], a[228:231], v[132:135]
    ds_read_b128 a[172:175], v254 offset:35840
    v_mfma_f32_16x16x32_bf16 v[140:143], a[84:87], a[232:235], 0
    v_mfma_f32_16x16x32_bf16 v[140:143], a[92:95], a[236:239], v[140:143]
    buffer_load_dwordx4 a[84:87], v242, s[20:23], s68 offen offset:1024 sc1
    v_mfma_f32_16x16x32_bf16 v[144:147], a[96:99], a[192:195], 0
    v_mfma_f32_16x16x32_bf16 v[144:147], a[104:107], a[196:199], v[144:147]
    v_mfma_f32_16x16x32_bf16 v[152:155], a[96:99], a[200:203], 0
    buffer_load_dwordx4 a[92:95], v242, s[20:23], s68 offen offset:3072 sc1
    v_mfma_f32_16x16x32_bf16 v[152:155], a[104:107], a[204:207], v[152:155]
    v_mfma_f32_16x16x32_bf16 v[160:163], a[96:99], a[208:211], 0
    v_mfma_f32_16x16x32_bf16 v[160:163], a[104:107], a[212:215], v[160:163]
    v_mfma_f32_16x16x32_bf16 v[168:171], a[96:99], a[216:219], 0
    v_mfma_f32_16x16x32_bf16 v[168:171], a[104:107], a[220:223], v[168:171]
    v_mfma_f32_16x16x32_bf16 v[176:179], a[96:99], a[224:227], 0
    v_mfma_f32_16x16x32_bf16 v[176:179], a[104:107], a[228:231], v[176:179]
    buffer_store_dwordx4 v[216:219], v252, s[24:27], s54 offen offset:2048 sc1
    v_mfma_f32_16x16x32_bf16 v[184:187], a[96:99], a[232:235], 0
    v_mfma_f32_16x16x32_bf16 v[184:187], a[104:107], a[236:239], v[184:187]
    v_mfma_f32_16x16x32_bf16 v[148:151], a[100:103], a[192:195], 0
    buffer_load_dwordx4 a[96:99], v243, s[20:23], s68 offen sc1
    v_mfma_f32_16x16x32_bf16 v[148:151], a[108:111], a[196:199], v[148:151]
    v_mfma_f32_16x16x32_bf16 v[156:159], a[100:103], a[200:203], 0
    v_mfma_f32_16x16x32_bf16 v[156:159], a[108:111], a[204:207], v[156:159]
    buffer_load_dwordx4 a[104:107], v243, s[20:23], s68 offen offset:2048 sc1
    v_mfma_f32_16x16x32_bf16 v[164:167], a[100:103], a[208:211], 0
    v_mfma_f32_16x16x32_bf16 v[164:167], a[108:111], a[212:215], v[164:167]
    v_mfma_f32_16x16x32_bf16 v[172:175], a[100:103], a[216:219], 0
    v_mfma_f32_16x16x32_bf16 v[172:175], a[108:111], a[220:223], v[172:175]
    v_mfma_f32_16x16x32_bf16 v[180:183], a[100:103], a[224:227], 0
    v_mfma_f32_16x16x32_bf16 v[180:183], a[108:111], a[228:231], v[180:183]
    v_mfma_f32_16x16x32_bf16 v[188:191], a[100:103], a[232:235], 0
    buffer_store_dwordx4 v[220:223], v252, s[24:27], s54 offen offset:3072 sc1
    v_mfma_f32_16x16x32_bf16 v[188:191], a[108:111], a[236:239], v[188:191]
    s_waitcnt vmcnt(45) lgkmcnt(0)
    v_mfma_f32_16x16x32_bf16 v[0:3], a[48:51], a[0:3], v[0:3]
    s_waitcnt vmcnt(44)
    v_mfma_f32_16x16x32_bf16 v[0:3], a[56:59], a[4:7], v[0:3]
    s_waitcnt vmcnt(42)
    buffer_load_dwordx4 a[100:103], v243, s[20:23], s68 offen offset:1024 sc1
    v_mfma_f32_16x16x32_bf16 v[8:11], a[48:51], a[8:11], v[8:11]
    s_waitcnt vmcnt(42)
    v_mfma_f32_16x16x32_bf16 v[8:11], a[56:59], a[12:15], v[8:11]
    s_waitcnt vmcnt(41)
    v_mfma_f32_16x16x32_bf16 v[16:19], a[48:51], a[16:19], v[16:19]
    s_waitcnt vmcnt(40)
    buffer_load_dwordx4 a[108:111], v243, s[20:23], s68 offen offset:3072 sc1
    v_mfma_f32_16x16x32_bf16 v[16:19], a[56:59], a[20:23], v[16:19]
    s_waitcnt vmcnt(39)
    v_mfma_f32_16x16x32_bf16 v[24:27], a[48:51], a[24:27], v[24:27]
    s_waitcnt vmcnt(38)
    v_mfma_f32_16x16x32_bf16 v[24:27], a[56:59], a[28:31], v[24:27]
    s_waitcnt vmcnt(37)
    v_mfma_f32_16x16x32_bf16 v[32:35], a[48:51], a[32:35], v[32:35]
    s_waitcnt vmcnt(36)
    v_mfma_f32_16x16x32_bf16 v[32:35], a[56:59], a[36:39], v[32:35]
    s_waitcnt vmcnt(34)
    v_mfma_f32_16x16x32_bf16 v[40:43], a[48:51], a[40:43], v[40:43]
    s_waitcnt vmcnt(33)
    s_add_u32 s54, s41, 20480
    v_mfma_f32_16x16x32_bf16 v[40:43], a[56:59], a[44:47], v[40:43]
    buffer_store_dwordx4 v[224:227], v252, s[24:27], s54 offen sc1
    v_mfma_f32_16x16x32_bf16 v[4:7], a[52:55], a[0:3], v[4:7]
    v_mfma_f32_16x16x32_bf16 v[4:7], a[60:63], a[4:7], v[4:7]
    v_mfma_f32_16x16x32_bf16 v[12:15], a[52:55], a[8:11], v[12:15]
    buffer_load_dwordx4 a[48:51], v240, s[20:23], s28 offen sc1
    v_mfma_f32_16x16x32_bf16 v[12:15], a[60:63], a[12:15], v[12:15]
    v_mfma_f32_16x16x32_bf16 v[20:23], a[52:55], a[16:19], v[20:23]
    v_mfma_f32_16x16x32_bf16 v[20:23], a[60:63], a[20:23], v[20:23]
    buffer_load_dwordx4 a[56:59], v240, s[20:23], s28 offen offset:2048 sc1
    v_mfma_f32_16x16x32_bf16 v[28:31], a[52:55], a[24:27], v[28:31]
    v_mfma_f32_16x16x32_bf16 v[28:31], a[60:63], a[28:31], v[28:31]
    v_mfma_f32_16x16x32_bf16 v[36:39], a[52:55], a[32:35], v[36:39]
    v_mfma_f32_16x16x32_bf16 v[36:39], a[60:63], a[36:39], v[36:39]
    v_mfma_f32_16x16x32_bf16 v[44:47], a[52:55], a[40:43], v[44:47]
    v_mfma_f32_16x16x32_bf16 v[44:47], a[60:63], a[44:47], v[44:47]
    v_mfma_f32_16x16x32_bf16 v[48:51], a[128:131], a[0:3], v[48:51]
    buffer_store_dwordx4 v[228:231], v252, s[24:27], s54 offen offset:1024 sc1
    v_mfma_f32_16x16x32_bf16 v[48:51], a[136:139], a[4:7], v[48:51]
    v_mfma_f32_16x16x32_bf16 v[56:59], a[128:131], a[8:11], v[56:59]
    v_mfma_f32_16x16x32_bf16 v[56:59], a[136:139], a[12:15], v[56:59]
    buffer_load_dwordx4 a[52:55], v240, s[20:23], s28 offen offset:1024 sc1
    v_mfma_f32_16x16x32_bf16 v[64:67], a[128:131], a[16:19], v[64:67]
    v_mfma_f32_16x16x32_bf16 v[64:67], a[136:139], a[20:23], v[64:67]
    v_mfma_f32_16x16x32_bf16 v[72:75], a[128:131], a[24:27], v[72:75]
    buffer_load_dwordx4 a[60:63], v240, s[20:23], s28 offen offset:3072 sc1
    v_mfma_f32_16x16x32_bf16 v[72:75], a[136:139], a[28:31], v[72:75]
    v_mfma_f32_16x16x32_bf16 v[80:83], a[128:131], a[32:35], v[80:83]
    v_mfma_f32_16x16x32_bf16 v[80:83], a[136:139], a[36:39], v[80:83]
    v_mfma_f32_16x16x32_bf16 v[88:91], a[128:131], a[40:43], v[88:91]
    v_mfma_f32_16x16x32_bf16 v[88:91], a[136:139], a[44:47], v[88:91]
    buffer_load_dwordx4 a[128:131], v241, s[20:23], s28 offen sc1
    v_mfma_f32_16x16x32_bf16 v[52:55], a[132:135], a[0:3], v[52:55]
    v_mfma_f32_16x16x32_bf16 v[52:55], a[140:143], a[4:7], v[52:55]
    buffer_store_dwordx4 v[232:235], v252, s[24:27], s54 offen offset:2048 sc1
    v_mfma_f32_16x16x32_bf16 v[60:63], a[132:135], a[8:11], v[60:63]
    v_mfma_f32_16x16x32_bf16 v[60:63], a[140:143], a[12:15], v[60:63]
    v_mfma_f32_16x16x32_bf16 v[68:71], a[132:135], a[16:19], v[68:71]
    buffer_load_dwordx4 a[136:139], v241, s[20:23], s28 offen offset:2048 sc1
    v_mfma_f32_16x16x32_bf16 v[68:71], a[140:143], a[20:23], v[68:71]
    v_mfma_f32_16x16x32_bf16 v[76:79], a[132:135], a[24:27], v[76:79]
    v_mfma_f32_16x16x32_bf16 v[76:79], a[140:143], a[28:31], v[76:79]
    v_mfma_f32_16x16x32_bf16 v[84:87], a[132:135], a[32:35], v[84:87]
    v_mfma_f32_16x16x32_bf16 v[84:87], a[140:143], a[36:39], v[84:87]
    v_mfma_f32_16x16x32_bf16 v[92:95], a[132:135], a[40:43], v[92:95]
    v_mfma_f32_16x16x32_bf16 v[92:95], a[140:143], a[44:47], v[92:95]
    buffer_load_dwordx4 a[132:135], v241, s[20:23], s28 offen offset:1024 sc1
    v_mfma_f32_16x16x32_bf16 v[96:99], a[144:147], a[0:3], v[96:99]
    v_mfma_f32_16x16x32_bf16 v[96:99], a[152:155], a[4:7], v[96:99]
    v_mfma_f32_16x16x32_bf16 v[104:107], a[144:147], a[8:11], v[104:107]
    buffer_store_dwordx4 v[236:239], v252, s[24:27], s54 offen offset:3072 sc1
    v_mfma_f32_16x16x32_bf16 v[104:107], a[152:155], a[12:15], v[104:107]
    v_mfma_f32_16x16x32_bf16 v[112:115], a[144:147], a[16:19], v[112:115]
    v_mfma_f32_16x16x32_bf16 v[112:115], a[152:155], a[20:23], v[112:115]
    buffer_load_dwordx4 a[140:143], v241, s[20:23], s28 offen offset:3072 sc1
    v_mfma_f32_16x16x32_bf16 v[120:123], a[144:147], a[24:27], v[120:123]
    v_mfma_f32_16x16x32_bf16 v[120:123], a[152:155], a[28:31], v[120:123]
    v_mfma_f32_16x16x32_bf16 v[128:131], a[144:147], a[32:35], v[128:131]
    v_mfma_f32_16x16x32_bf16 v[128:131], a[152:155], a[36:39], v[128:131]
    v_mfma_f32_16x16x32_bf16 v[136:139], a[144:147], a[40:43], v[136:139]
    v_mfma_f32_16x16x32_bf16 v[136:139], a[152:155], a[44:47], v[136:139]
    buffer_load_dwordx4 a[144:147], v242, s[20:23], s28 offen sc1
    v_mfma_f32_16x16x32_bf16 v[100:103], a[148:151], a[0:3], v[100:103]
    v_mfma_f32_16x16x32_bf16 v[100:103], a[156:159], a[4:7], v[100:103]
    v_mfma_f32_16x16x32_bf16 v[108:111], a[148:151], a[8:11], v[108:111]
    buffer_load_dwordx4 a[152:155], v242, s[20:23], s28 offen offset:2048 sc1
    v_mfma_f32_16x16x32_bf16 v[108:111], a[156:159], a[12:15], v[108:111]
    v_mfma_f32_16x16x32_bf16 v[116:119], a[148:151], a[16:19], v[116:119]
    v_mfma_f32_16x16x32_bf16 v[116:119], a[156:159], a[20:23], v[116:119]
    v_mfma_f32_16x16x32_bf16 v[124:127], a[148:151], a[24:27], v[124:127]
    v_mfma_f32_16x16x32_bf16 v[124:127], a[156:159], a[28:31], v[124:127]
    v_mfma_f32_16x16x32_bf16 v[132:135], a[148:151], a[32:35], v[132:135]
    v_mfma_f32_16x16x32_bf16 v[132:135], a[156:159], a[36:39], v[132:135]
    v_mfma_f32_16x16x32_bf16 v[140:143], a[148:151], a[40:43], v[140:143]
    v_mfma_f32_16x16x32_bf16 v[140:143], a[156:159], a[44:47], v[140:143]
    buffer_load_dwordx4 a[148:151], v242, s[20:23], s28 offen offset:1024 sc1
    v_mfma_f32_16x16x32_bf16 v[192:195], a[112:115], a[192:195], 0
    v_mfma_f32_16x16x32_bf16 v[192:195], a[120:123], a[196:199], v[192:195]
    v_mfma_f32_16x16x32_bf16 v[200:203], a[112:115], a[200:203], 0
    buffer_load_dwordx4 a[156:159], v242, s[20:23], s28 offen offset:3072 sc1
    v_mfma_f32_16x16x32_bf16 v[200:203], a[120:123], a[204:207], v[200:203]
    v_mfma_f32_16x16x32_bf16 v[208:211], a[112:115], a[208:211], 0
    v_mfma_f32_16x16x32_bf16 v[208:211], a[120:123], a[212:215], v[208:211]
    v_mfma_f32_16x16x32_bf16 v[216:219], a[112:115], a[216:219], 0
    v_mfma_f32_16x16x32_bf16 v[216:219], a[120:123], a[220:223], v[216:219]
    v_mfma_f32_16x16x32_bf16 v[224:227], a[112:115], a[224:227], 0
    v_mfma_f32_16x16x32_bf16 v[224:227], a[120:123], a[228:231], v[224:227]
    v_mfma_f32_16x16x32_bf16 v[232:235], a[112:115], a[232:235], 0
    v_mfma_f32_16x16x32_bf16 v[232:235], a[120:123], a[236:239], v[232:235]
    buffer_load_dwordx4 a[112:115], v244, s[20:23], s68 offen sc1
    v_mfma_f32_16x16x32_bf16 v[196:199], a[116:119], a[192:195], 0
    v_mfma_f32_16x16x32_bf16 v[196:199], a[124:127], a[196:199], v[196:199]
    buffer_load_dwordx4 a[192:195], v245, s[16:19], s29 offen sc1
    v_mfma_f32_16x16x32_bf16 v[204:207], a[116:119], a[200:203], 0
    v_mfma_f32_16x16x32_bf16 v[204:207], a[124:127], a[204:207], v[204:207]
    buffer_load_dwordx4 a[196:199], v245, s[16:19], s29 offen offset:1024 sc1
    v_mfma_f32_16x16x32_bf16 v[212:215], a[116:119], a[208:211], 0
    v_mfma_f32_16x16x32_bf16 v[212:215], a[124:127], a[212:215], v[212:215]
    buffer_load_dwordx4 a[200:203], v246, s[16:19], s29 offen sc1
    v_mfma_f32_16x16x32_bf16 v[220:223], a[116:119], a[216:219], 0
    v_mfma_f32_16x16x32_bf16 v[220:223], a[124:127], a[220:223], v[220:223]
    buffer_load_dwordx4 a[204:207], v246, s[16:19], s29 offen offset:1024 sc1
    v_mfma_f32_16x16x32_bf16 v[228:231], a[116:119], a[224:227], 0
    v_mfma_f32_16x16x32_bf16 v[228:231], a[124:127], a[228:231], v[228:231]
    buffer_load_dwordx4 a[208:211], v247, s[16:19], s29 offen sc1
    v_mfma_f32_16x16x32_bf16 v[236:239], a[116:119], a[232:235], 0
    v_mfma_f32_16x16x32_bf16 v[236:239], a[124:127], a[236:239], v[236:239]
    buffer_load_dwordx4 a[212:215], v247, s[16:19], s29 offen offset:1024 sc1
    v_mfma_f32_16x16x32_bf16 v[144:147], a[160:163], a[0:3], v[144:147]
    v_mfma_f32_16x16x32_bf16 v[144:147], a[168:171], a[4:7], v[144:147]
    buffer_load_dwordx4 a[216:219], v248, s[16:19], s29 offen sc1
    v_mfma_f32_16x16x32_bf16 v[152:155], a[160:163], a[8:11], v[152:155]
    v_mfma_f32_16x16x32_bf16 v[152:155], a[168:171], a[12:15], v[152:155]
    buffer_load_dwordx4 a[220:223], v248, s[16:19], s29 offen offset:1024 sc1
    v_mfma_f32_16x16x32_bf16 v[160:163], a[160:163], a[16:19], v[160:163]
    v_mfma_f32_16x16x32_bf16 v[160:163], a[168:171], a[20:23], v[160:163]
    buffer_load_dwordx4 a[224:227], v249, s[16:19], s29 offen sc1
    v_mfma_f32_16x16x32_bf16 v[168:171], a[160:163], a[24:27], v[168:171]
    v_mfma_f32_16x16x32_bf16 v[168:171], a[168:171], a[28:31], v[168:171]
    buffer_load_dwordx4 a[228:231], v249, s[16:19], s29 offen offset:1024 sc1
    v_mfma_f32_16x16x32_bf16 v[176:179], a[160:163], a[32:35], v[176:179]
    v_mfma_f32_16x16x32_bf16 v[176:179], a[168:171], a[36:39], v[176:179]
    buffer_load_dwordx4 a[232:235], v251, s[16:19], s29 offen sc1
    v_mfma_f32_16x16x32_bf16 v[184:187], a[160:163], a[40:43], v[184:187]
    v_mfma_f32_16x16x32_bf16 v[184:187], a[168:171], a[44:47], v[184:187]
    buffer_load_dwordx4 a[236:239], v251, s[16:19], s29 offen offset:1024 sc1
    v_mfma_f32_16x16x32_bf16 v[148:151], a[164:167], a[0:3], v[148:151]
    s_and_b32 s29, s62, 15
    v_mfma_f32_16x16x32_bf16 v[148:151], a[172:175], a[4:7], v[148:151]
    s_lshr_b64 s[62:63], s[62:63], 4
    buffer_load_dwordx4 a[120:123], v244, s[20:23], s68 offen offset:2048 sc1
    v_mfma_f32_16x16x32_bf16 v[156:159], a[164:167], a[8:11], v[156:159]
    s_mul_i32 s29, s29, 12288
    v_mfma_f32_16x16x32_bf16 v[156:159], a[172:175], a[12:15], v[156:159]
    s_add_u32 s29, s29, s44
    buffer_load_dwordx4 a[116:119], v244, s[20:23], s68 offen offset:1024 sc1
    v_mfma_f32_16x16x32_bf16 v[164:167], a[164:167], a[16:19], v[164:167]
    v_mfma_f32_16x16x32_bf16 v[164:167], a[172:175], a[20:23], v[164:167]
    buffer_load_dwordx4 a[124:127], v244, s[20:23], s68 offen offset:3072 sc1
    v_mfma_f32_16x16x32_bf16 v[172:175], a[164:167], a[24:27], v[172:175]
    v_mfma_f32_16x16x32_bf16 v[172:175], a[172:175], a[28:31], v[172:175]
    buffer_load_dwordx4 a[160:163], v243, s[20:23], s28 offen sc1
    v_mfma_f32_16x16x32_bf16 v[180:183], a[164:167], a[32:35], v[180:183]
    v_mfma_f32_16x16x32_bf16 v[180:183], a[172:175], a[36:39], v[180:183]
    buffer_load_dwordx4 a[168:171], v243, s[20:23], s28 offen offset:2048 sc1
    v_mfma_f32_16x16x32_bf16 v[188:191], a[164:167], a[40:43], v[188:191]
    v_mfma_f32_16x16x32_bf16 v[188:191], a[172:175], a[44:47], v[188:191]
    s_waitcnt vmcnt(61)
    buffer_load_dwordx4 a[164:167], v243, s[20:23], s28 offen offset:1024 sc1
    v_mfma_f32_16x16x32_bf16 v[192:195], a[176:179], a[0:3], v[192:195]
    s_waitcnt vmcnt(61)
    v_mfma_f32_16x16x32_bf16 v[192:195], a[184:187], a[4:7], v[192:195]
    buffer_load_dwordx4 a[172:175], v243, s[20:23], s28 offen offset:3072 sc1
    v_mfma_f32_16x16x32_bf16 v[200:203], a[176:179], a[8:11], v[200:203]
    v_mfma_f32_16x16x32_bf16 v[200:203], a[184:187], a[12:15], v[200:203]
    v_mfma_f32_16x16x32_bf16 v[208:211], a[176:179], a[16:19], v[208:211]
    v_mfma_f32_16x16x32_bf16 v[208:211], a[184:187], a[20:23], v[208:211]
    v_mfma_f32_16x16x32_bf16 v[216:219], a[176:179], a[24:27], v[216:219]
    v_mfma_f32_16x16x32_bf16 v[216:219], a[184:187], a[28:31], v[216:219]
    v_mfma_f32_16x16x32_bf16 v[224:227], a[176:179], a[32:35], v[224:227]
    v_mfma_f32_16x16x32_bf16 v[224:227], a[184:187], a[36:39], v[224:227]
    v_mfma_f32_16x16x32_bf16 v[232:235], a[176:179], a[40:43], v[232:235]
    v_mfma_f32_16x16x32_bf16 v[232:235], a[184:187], a[44:47], v[232:235]
    s_waitcnt vmcnt(61)
    buffer_load_dwordx4 a[176:179], v244, s[20:23], s28 offen sc1
    v_mfma_f32_16x16x32_bf16 v[196:199], a[180:183], a[0:3], v[196:199]
    s_waitcnt vmcnt(61)
    v_mfma_f32_16x16x32_bf16 v[196:199], a[188:191], a[4:7], v[196:199]
    buffer_load_dwordx4 a[184:187], v244, s[20:23], s28 offen offset:2048 sc1
    v_mfma_f32_16x16x32_bf16 v[204:207], a[180:183], a[8:11], v[204:207]
    s_waitcnt vmcnt(27)
    s_barrier
    v_mfma_f32_16x16x32_bf16 v[204:207], a[188:191], a[12:15], v[204:207]
    v_mov_b32 v255, 0x100
    v_mfma_f32_16x16x32_bf16 v[212:215], a[180:183], a[16:19], v[212:215]
    v_mfma_f32_16x16x32_bf16 v[212:215], a[188:191], a[20:23], v[212:215]
    buffer_atomic_add v255, v250, s[80:83], s65 offen sc1
    v_mfma_f32_16x16x32_bf16 v[220:223], a[180:183], a[24:27], v[220:223]
    v_mfma_f32_16x16x32_bf16 v[220:223], a[188:191], a[28:31], v[220:223]
    v_mfma_f32_16x16x32_bf16 v[228:231], a[180:183], a[32:35], v[228:231]
    v_mfma_f32_16x16x32_bf16 v[228:231], a[188:191], a[36:39], v[228:231]
    v_mfma_f32_16x16x32_bf16 v[236:239], a[180:183], a[40:43], v[236:239]
    v_mfma_f32_16x16x32_bf16 v[236:239], a[188:191], a[44:47], v[236:239]
.p2align 3
L_k2:
    s_waitcnt vmcnt(21)
    v_mfma_f32_16x16x32_bf16 v[0:3], a[240:243], a[192:195], v[0:3]
    s_waitcnt vmcnt(20)
    buffer_load_dwordx4 a[180:183], v244, s[20:23], s28 offen offset:1024 sc1
    v_mfma_f32_16x16x32_bf16 v[0:3], a[248:251], a[196:199], v[0:3]
    s_waitcnt vmcnt(20)
    v_readfirstlane_b32 s69, v255
    v_mfma_f32_16x16x32_bf16 v[8:11], a[240:243], a[200:203], v[8:11]
    s_waitcnt vmcnt(19)
    v_mfma_f32_16x16x32_bf16 v[8:11], a[248:251], a[204:207], v[8:11]
    s_waitcnt vmcnt(18)
    v_mfma_f32_16x16x32_bf16 v[16:19], a[240:243], a[208:211], v[16:19]
    s_waitcnt vmcnt(17)
    buffer_load_dwordx4 a[188:191], v244, s[20:23], s28 offen offset:3072 sc1
    v_mfma_f32_16x16x32_bf16 v[16:19], a[248:251], a[212:215], v[16:19]
    s_waitcnt vmcnt(17)
    s_and_b32 s28, s56, 15
    v_mfma_f32_16x16x32_bf16 v[24:27], a[240:243], a[216:219], v[24:27]
    s_waitcnt vmcnt(16)
    s_lshr_b64 s[56:57], s[56:57], 4
    s_bfe_u32 s69, s69, 0x80008
    s_cmp_lt_u32 s69, s71
    s_cbranch_scc1 L_spin2
L_spin2_back:
    v_mfma_f32_16x16x32_bf16 v[24:27], a[248:251], a[220:223], v[24:27]
    s_waitcnt vmcnt(15)
    s_mul_i32 s28, s28, 20480
    v_mfma_f32_16x16x32_bf16 v[32:35], a[240:243], a[224:227], v[32:35]
    s_waitcnt vmcnt(14)
    s_add_u32 s28, s28, s43
    buffer_load_dwordx4 a[0:3], v245, s[16:19], s29 offen sc1
    v_mfma_f32_16x16x32_bf16 v[32:35], a[248:251], a[228:231], v[32:35]
    s_waitcnt vmcnt(14)
    v_mfma_f32_16x16x32_bf16 v[40:43], a[240:243], a[232:235], v[40:43]
    s_waitcnt vmcnt(13)
    v_mfma_f32_16x16x32_bf16 v[40:43], a[248:251], a[236:239], v[40:43]
    buffer_load_dwordx4 a[4:7], v245, s[16:19], s29 offen offset:1024 sc1
    v_mfma_f32_16x16x32_bf16 v[4:7], a[244:247], a[192:195], v[4:7]
    v_mfma_f32_16x16x32_bf16 v[4:7], a[252:255], a[196:199], v[4:7]
    v_mfma_f32_16x16x32_bf16 v[12:15], a[244:247], a[200:203], v[12:15]
    v_mfma_f32_16x16x32_bf16 v[12:15], a[252:255], a[204:207], v[12:15]
    buffer_load_dwordx4 a[8:11], v246, s[16:19], s29 offen sc1
    v_mfma_f32_16x16x32_bf16 v[20:23], a[244:247], a[208:211], v[20:23]
    v_mfma_f32_16x16x32_bf16 v[20:23], a[252:255], a[212:215], v[20:23]
    v_mfma_f32_16x16x32_bf16 v[28:31], a[244:247], a[216:219], v[28:31]
    v_mfma_f32_16x16x32_bf16 v[28:31], a[252:255], a[220:223], v[28:31]
    buffer_load_dwordx4 a[12:15], v246, s[16:19], s29 offen offset:1024 sc1
    v_mfma_f32_16x16x32_bf16 v[36:39], a[244:247], a[224:227], v[36:39]
    v_mfma_f32_16x16x32_bf16 v[36:39], a[252:255], a[228:231], v[36:39]
    v_mfma_f32_16x16x32_bf16 v[44:47], a[244:247], a[232:235], v[44:47]
    v_mfma_f32_16x16x32_bf16 v[44:47], a[252:255], a[236:239], v[44:47]
    buffer_load_dwordx4 a[16:19], v247, s[16:19], s29 offen sc1
    v_mfma_f32_16x16x32_bf16 v[48:51], a[64:67], a[192:195], v[48:51]
    v_mfma_f32_16x16x32_bf16 v[48:51], a[72:75], a[196:199], v[48:51]
    v_mfma_f32_16x16x32_bf16 v[56:59], a[64:67], a[200:203], v[56:59]
    buffer_load_dwordx4 a[20:23], v247, s[16:19], s29 offen offset:1024 sc1
    v_mfma_f32_16x16x32_bf16 v[56:59], a[72:75], a[204:207], v[56:59]
    v_mfma_f32_16x16x32_bf16 v[64:67], a[64:67], a[208:211], v[64:67]
    v_mfma_f32_16x16x32_bf16 v[64:67], a[72:75], a[212:215], v[64:67]
    v_mfma_f32_16x16x32_bf16 v[72:75], a[64:67], a[216:219], v[72:75]
    buffer_load_dwordx4 a[24:27], v248, s[16:19], s29 offen sc1
    v_mfma_f32_16x16x32_bf16 v[72:75], a[72:75], a[220:223], v[72:75]
    v_mfma_f32_16x16x32_bf16 v[80:83], a[64:67], a[224:227], v[80:83]
    v_mfma_f32_16x16x32_bf16 v[80:83], a[72:75], a[228:231], v[80:83]
    v_mfma_f32_16x16x32_bf16 v[88:91], a[64:67], a[232:235], v[88:91]
    buffer_load_dwordx4 a[28:31], v248, s[16:19], s29 offen offset:1024 sc1
    v_mfma_f32_16x16x32_bf16 v[88:91], a[72:75], a[236:239], v[88:91]
    v_mfma_f32_16x16x32_bf16 v[52:55], a[68:71], a[192:195], v[52:55]
    v_mfma_f32_16x16x32_bf16 v[52:55], a[76:79], a[196:199], v[52:55]
    v_mfma_f32_16x16x32_bf16 v[60:63], a[68:71], a[200:203], v[60:63]
    buffer_load_dwordx4 a[32:35], v249, s[16:19], s29 offen sc1
    v_mfma_f32_16x16x32_bf16 v[60:63], a[76:79], a[204:207], v[60:63]
    v_mfma_f32_16x16x32_bf16 v[68:71], a[68:71], a[208:211], v[68:71]
    v_mfma_f32_16x16x32_bf16 v[68:71], a[76:79], a[212:215], v[68:71]
    buffer_load_dwordx4 a[36:39], v249, s[16:19], s29 offen offset:1024 sc1
    v_mfma_f32_16x16x32_bf16 v[76:79], a[68:71], a[216:219], v[76:79]
    v_mfma_f32_16x16x32_bf16 v[76:79], a[76:79], a[220:223], v[76:79]
    v_mfma_f32_16x16x32_bf16 v[84:87], a[68:71], a[224:227], v[84:87]
    v_mfma_f32_16x16x32_bf16 v[84:87], a[76:79], a[228:231], v[84:87]
    buffer_load_dwordx4 a[40:43], v251, s[16:19], s29 offen sc1
    v_mfma_f32_16x16x32_bf16 v[92:95], a[68:71], a[232:235], v[92:95]
    v_mfma_f32_16x16x32_bf16 v[92:95], a[76:79], a[236:239], v[92:95]
    v_mfma_f32_16x16x32_bf16 v[96:99], a[80:83], a[192:195], v[96:99]
    v_mfma_f32_16x16x32_bf16 v[96:99], a[88:91], a[196:199], v[96:99]
    buffer_load_dwordx4 a[44:47], v251, s[16:19], s29 offen offset:1024 sc1
    v_mfma_f32_16x16x32_bf16 v[104:107], a[80:83], a[200:203], v[104:107]
    s_and_b32 s29, s62, 15
    v_mfma_f32_16x16x32_bf16 v[104:107], a[88:91], a[204:207], v[104:107]
    s_lshr_b64 s[62:63], s[62:63], 4
    v_mfma_f32_16x16x32_bf16 v[112:115], a[80:83], a[208:211], v[112:115]
    s_mul_i32 s29, s29, 12288
    v_mfma_f32_16x16x32_bf16 v[112:115], a[88:91], a[212:215], v[112:115]
    s_add_u32 s29, s29, s44
    buffer_load_dwordx4 a[240:243], v240, s[20:23], s28 offen sc1
    v_mfma_f32_16x16x32_bf16 v[120:123], a[80:83], a[216:219], v[120:123]
    v_mfma_f32_16x16x32_bf16 v[120:123], a[88:91], a[220:223], v[120:123]
    v_mfma_f32_16x16x32_bf16 v[128:131], a[80:83], a[224:227], v[128:131]
    buffer_load_dwordx4 a[248:251], v240, s[20:23], s28 offen offset:2048 sc1
    v_mfma_f32_16x16x32_bf16 v[128:131], a[88:91], a[228:231], v[128:131]
    v_mfma_f32_16x16x32_bf16 v[136:139], a[80:83], a[232:235], v[136:139]
    v_mfma_f32_16x16x32_bf16 v[136:139], a[88:91], a[236:239], v[136:139]
    v_mfma_f32_16x16x32_bf16 v[100:103], a[84:87], a[192:195], v[100:103]
    buffer_load_dwordx4 a[244:247], v240, s[20:23], s28 offen offset:1024 sc1
    v_mfma_f32_16x16x32_bf16 v[100:103], a[92:95], a[196:199], v[100:103]
    v_mfma_f32_16x16x32_bf16 v[108:111], a[84:87], a[200:203], v[108:111]
    v_mfma_f32_16x16x32_bf16 v[108:111], a[92:95], a[204:207], v[108:111]
    v_mfma_f32_16x16x32_bf16 v[116:119], a[84:87], a[208:211], v[116:119]
    buffer_load_dwordx4 a[252:255], v240, s[20:23], s28 offen offset:3072 sc1
    v_mfma_f32_16x16x32_bf16 v[116:119], a[92:95], a[212:215], v[116:119]
    v_mfma_f32_16x16x32_bf16 v[124:127], a[84:87], a[216:219], v[124:127]
    v_mfma_f32_16x16x32_bf16 v[124:127], a[92:95], a[220:223], v[124:127]
    v_mfma_f32_16x16x32_bf16 v[132:135], a[84:87], a[224:227], v[132:135]
    buffer_load_dwordx4 a[64:67], v241, s[20:23], s28 offen sc1
    v_mfma_f32_16x16x32_bf16 v[132:135], a[92:95], a[228:231], v[132:135]
    v_mfma_f32_16x16x32_bf16 v[140:143], a[84:87], a[232:235], v[140:143]
    v_mfma_f32_16x16x32_bf16 v[140:143], a[92:95], a[236:239], v[140:143]
    buffer_load_dwordx4 a[72:75], v241, s[20:23], s28 offen offset:2048 sc1
    v_mfma_f32_16x16x32_bf16 v[144:147], a[96:99], a[192:195], v[144:147]
    v_mfma_f32_16x16x32_bf16 v[144:147], a[104:107], a[196:199], v[144:147]
    v_mfma_f32_16x16x32_bf16 v[152:155], a[96:99], a[200:203], v[152:155]
    v_mfma_f32_16x16x32_bf16 v[152:155], a[104:107], a[204:207], v[152:155]
    buffer_load_dwordx4 a[68:71], v241, s[20:23], s28 offen offset:1024 sc1
    v_mfma_f32_16x16x32_bf16 v[160:163], a[96:99], a[208:211], v[160:163]
    v_mfma_f32_16x16x32_bf16 v[160:163], a[104:107], a[212:215], v[160:163]
    v_mfma_f32_16x16x32_bf16 v[168:171], a[96:99], a[216:219], v[168:171]
    v_mfma_f32_16x16x32_bf16 v[168:171], a[104:107], a[220:223], v[168:171]
    buffer_load_dwordx4 a[76:79], v241, s[20:23], s28 offen offset:3072 sc1
    v_mfma_f32_16x16x32_bf16 v[176:179], a[96:99], a[224:227], v[176:179]
    v_mfma_f32_16x16x32_bf16 v[176:179], a[104:107], a[228:231], v[176:179]
    v_mfma_f32_16x16x32_bf16 v[184:187], a[96:99], a[232:235], v[184:187]
    v_mfma_f32_16x16x32_bf16 v[184:187], a[104:107], a[236:239], v[184:187]
    buffer_load_dwordx4 a[80:83], v242, s[20:23], s28 offen sc1
    v_mfma_f32_16x16x32_bf16 v[148:151], a[100:103], a[192:195], v[148:151]
    v_mfma_f32_16x16x32_bf16 v[148:151], a[108:111], a[196:199], v[148:151]
    v_mfma_f32_16x16x32_bf16 v[156:159], a[100:103], a[200:203], v[156:159]
    buffer_load_dwordx4 a[88:91], v242, s[20:23], s28 offen offset:2048 sc1
    v_mfma_f32_16x16x32_bf16 v[156:159], a[108:111], a[204:207], v[156:159]
    v_mfma_f32_16x16x32_bf16 v[164:167], a[100:103], a[208:211], v[164:167]
    v_mfma_f32_16x16x32_bf16 v[164:167], a[108:111], a[212:215], v[164:167]
    v_mfma_f32_16x16x32_bf16 v[172:175], a[100:103], a[216:219], v[172:175]
    buffer_load_dwordx4 a[84:87], v242, s[20:23], s28 offen offset:1024 sc1
    v_mfma_f32_16x16x32_bf16 v[172:175], a[108:111], a[220:223], v[172:175]
    v_mfma_f32_16x16x32_bf16 v[180:183], a[100:103], a[224:227], v[180:183]
    v_mfma_f32_16x16x32_bf16 v[180:183], a[108:111], a[228:231], v[180:183]
    v_mfma_f32_16x16x32_bf16 v[188:191], a[100:103], a[232:235], v[188:191]
    buffer_load_dwordx4 a[92:95], v242, s[20:23], s28 offen offset:3072 sc1
    v_mfma_f32_16x16x32_bf16 v[188:191], a[108:111], a[236:239], v[188:191]
    v_mfma_f32_16x16x32_bf16 v[192:195], a[112:115], a[192:195], v[192:195]
    s_waitcnt vmcnt(35)
    v_mfma_f32_16x16x32_bf16 v[192:195], a[120:123], a[196:199], v[192:195]
    v_mfma_f32_16x16x32_bf16 v[200:203], a[112:115], a[200:203], v[200:203]
    buffer_load_dwordx4 a[96:99], v243, s[20:23], s28 offen sc1
    v_mfma_f32_16x16x32_bf16 v[200:203], a[120:123], a[204:207], v[200:203]
    v_mfma_f32_16x16x32_bf16 v[208:211], a[112:115], a[208:211], v[208:211]
    v_mfma_f32_16x16x32_bf16 v[208:211], a[120:123], a[212:215], v[208:211]
    buffer_load_dwordx4 a[104:107], v243, s[20:23], s28 offen offset:2048 sc1
    v_mfma_f32_16x16x32_bf16 v[216:219], a[112:115], a[216:219], v[216:219]
    v_mfma_f32_16x16x32_bf16 v[216:219], a[120:123], a[220:223], v[216:219]
    v_mfma_f32_16x16x32_bf16 v[224:227], a[112:115], a[224:227], v[224:227]
    v_mfma_f32_16x16x32_bf16 v[224:227], a[120:123], a[228:231], v[224:227]
    buffer_load_dwordx4 a[100:103], v243, s[20:23], s28 offen offset:1024 sc1
    v_mfma_f32_16x16x32_bf16 v[232:235], a[112:115], a[232:235], v[232:235]
    v_mfma_f32_16x16x32_bf16 v[232:235], a[120:123], a[236:239], v[232:235]
    s_waitcnt vmcnt(37)
    v_mfma_f32_16x16x32_bf16 v[196:199], a[116:119], a[192:195], v[196:199]
    s_waitcnt vmcnt(36)
    v_mfma_f32_16x16x32_bf16 v[196:199], a[124:127], a[196:199], v[196:199]
    buffer_load_dwordx4 a[108:111], v243, s[20:23], s28 offen offset:3072 sc1
    v_mfma_f32_16x16x32_bf16 v[204:207], a[116:119], a[200:203], v[204:207]
    v_mfma_f32_16x16x32_bf16 v[204:207], a[124:127], a[204:207], v[204:207]
    v_mfma_f32_16x16x32_bf16 v[212:215], a[116:119], a[208:211], v[212:215]
    v_mfma_f32_16x16x32_bf16 v[212:215], a[124:127], a[212:215], v[212:215]
    buffer_load_dwordx4 a[112:115], v244, s[20:23], s28 offen sc1
    v_mfma_f32_16x16x32_bf16 v[220:223], a[116:119], a[216:219], v[220:223]
    v_mfma_f32_16x16x32_bf16 v[220:223], a[124:127], a[220:223], v[220:223]
    v_mfma_f32_16x16x32_bf16 v[228:231], a[116:119], a[224:227], v[228:231]
    buffer_load_dwordx4 a[120:123], v244, s[20:23], s28 offen offset:2048 sc1
    v_mfma_f32_16x16x32_bf16 v[228:231], a[124:127], a[228:231], v[228:231]
    v_mfma_f32_16x16x32_bf16 v[236:239], a[116:119], a[232:235], v[236:239]
    v_mfma_f32_16x16x32_bf16 v[236:239], a[124:127], a[236:239], v[236:239]
    s_waitcnt vmcnt(29)
    v_mfma_f32_16x16x32_bf16 v[0:3], a[48:51], a[0:3], v[0:3]
    s_waitcnt vmcnt(28)
    buffer_load_dwordx4 a[116:119], v244, s[20:23], s28 offen offset:1024 sc1
    v_mfma_f32_16x16x32_bf16 v[0:3], a[56:59], a[4:7], v[0:3]
    s_waitcnt vmcnt(28)
    s_cmp_eq_u32 s67, 5
    s_cselect_b32 s71, 8, 0
    s_cselect_b32 s30, s65, 0x1000
    v_mfma_f32_16x16x32_bf16 v[8:11], a[48:51], a[8:11], v[8:11]
    s_waitcnt vmcnt(27)
    buffer_load_dword v255, off, s[80:83], s30 sc1
    v_mfma_f32_16x16x32_bf16 v[8:11], a[56:59], a[12:15], v[8:11]
    s_waitcnt vmcnt(27)
    v_mfma_f32_16x16x32_bf16 v[16:19], a[48:51], a[16:19], v[16:19]
    s_waitcnt vmcnt(26)
    buffer_load_dwordx4 a[124:127], v244, s[20:23], s28 offen offset:3072 sc1
    v_mfma_f32_16x16x32_bf16 v[16:19], a[56:59], a[20:23], v[16:19]
    s_waitcnt vmcnt(26)
    s_and_b32 s28, s56, 15
    v_mfma_f32_16x16x32_bf16 v[24:27], a[48:51], a[24:27], v[24:27]
    s_waitcnt vmcnt(25)
    s_lshr_b64 s[56:57], s[56:57], 4
    v_mfma_f32_16x16x32_bf16 v[24:27], a[56:59], a[28:31], v[24:27]
    s_waitcnt vmcnt(24)
    s_mul_i32 s28, s28, 20480
    v_mfma_f32_16x16x32_bf16 v[32:35], a[48:51], a[32:35], v[32:35]
    s_waitcnt vmcnt(23)
    s_add_u32 s28, s28, s43
    buffer_load_dwordx4 a[192:195], v245, s[16:19], s29 offen sc1
    v_mfma_f32_16x16x32_bf16 v[32:35], a[56:59], a[36:39], v[32:35]
    s_waitcnt vmcnt(23)
    v_mfma_f32_16x16x32_bf16 v[40:43], a[48:51], a[40:43], v[40:43]
    s_waitcnt vmcnt(22)
    v_mfma_f32_16x16x32_bf16 v[40:43], a[56:59], a[44:47], v[40:43]
    buffer_load_dwordx4 a[196:199], v245, s[16:19], s29 offen offset:1024 sc1
    v_mfma_f32_16x16x32_bf16 v[4:7], a[52:55], a[0:3], v[4:7]
    v_mfma_f32_16x16x32_bf16 v[4:7], a[60:63], a[4:7], v[4:7]
    v_mfma_f32_16x16x32_bf16 v[12:15], a[52:55], a[8:11], v[12:15]
    v_mfma_f32_16x16x32_bf16 v[12:15], a[60:63], a[12:15], v[12:15]
    buffer_load_dwordx4 a[200:203], v246, s[16:19], s29 offen sc1
    v_mfma_f32_16x16x32_bf16 v[20:23], a[52:55], a[16:19], v[20:23]
    v_mfma_f32_16x16x32_bf16 v[20:23], a[60:63], a[20:23], v[20:23]
    v_mfma_f32_16x16x32_bf16 v[28:31], a[52:55], a[24:27], v[28:31]
    v_mfma_f32_16x16x32_bf16 v[28:31], a[60:63], a[28:31], v[28:31]
    buffer_load_dwordx4 a[204:207], v246, s[16:19], s29 offen offset:1024 sc1
    v_mfma_f32_16x16x32_bf16 v[36:39], a[52:55], a[32:35], v[36:39]
    v_mfma_f32_16x16x32_bf16 v[36:39], a[60:63], a[36:39], v[36:39]
    v_mfma_f32_16x16x32_bf16 v[44:47], a[52:55], a[40:43], v[44:47]
    v_mfma_f32_16x16x32_bf16 v[44:47], a[60:63], a[44:47], v[44:47]
    buffer_load_dwordx4 a[208:211], v247, s[16:19], s29 offen sc1
    v_mfma_f32_16x16x32_bf16 v[48:51], a[128:131], a[0:3], v[48:51]
    v_mfma_f32_16x16x32_bf16 v[48:51], a[136:139], a[4:7], v[48:51]
    v_mfma_f32_16x16x32_bf16 v[56:59], a[128:131], a[8:11], v[56:59]
    buffer_load_dwordx4 a[212:215], v247, s[16:19], s29 offen offset:1024 sc1
    v_mfma_f32_16x16x32_bf16 v[56:59], a[136:139], a[12:15], v[56:59]
    v_mfma_f32_16x16x32_bf16 v[64:67], a[128:131], a[16:19], v[64:67]
    v_mfma_f32_16x16x32_bf16 v[64:67], a[136:139], a[20:23], v[64:67]
    v_mfma_f32_16x16x32_bf16 v[72:75], a[128:131], a[24:27], v[72:75]
    buffer_load_dwordx4 a[216:219], v248, s[16:19], s29 offen sc1
    v_mfma_f32_16x16x32_bf16 v[72:75], a[136:139], a[28:31], v[72:75]
    v_mfma_f32_16x16x32_bf16 v[80:83], a[128:131], a[32:35], v[80:83]
    v_mfma_f32_16x16x32_bf16 v[80:83], a[136:139], a[36:39], v[80:83]
    v_mfma_f32_16x16x32_bf16 v[88:91], a[128:131], a[40:43], v[88:91]
    buffer_load_dwordx4 a[220:223], v248, s[16:19], s29 offen offset:1024 sc1
    v_mfma_f32_16x16x32_bf16 v[88:91], a[136:139], a[44:47], v[88:91]
    v_mfma_f32_16x16x32_bf16 v[52:55], a[132:135], a[0:3], v[52:55]
    v_mfma_f32_16x16x32_bf16 v[52:55], a[140:143], a[4:7], v[52:55]
    v_mfma_f32_16x16x32_bf16 v[60:63], a[132:135], a[8:11], v[60:63]
    buffer_load_dwordx4 a[224:227], v249, s[16:19], s29 offen sc1
    v_mfma_f32_16x16x32_bf16 v[60:63], a[140:143], a[12:15], v[60:63]
    v_mfma_f32_16x16x32_bf16 v[68:71], a[132:135], a[16:19], v[68:71]
    v_mfma_f32_16x16x32_bf16 v[68:71], a[140:143], a[20:23], v[68:71]
    buffer_load_dwordx4 a[228:231], v249, s[16:19], s29 offen offset:1024 sc1
    v_mfma_f32_16x16x32_bf16 v[76:79], a[132:135], a[24:27], v[76:79]
    v_mfma_f32_16x16x32_bf16 v[76:79], a[140:143], a[28:31], v[76:79]
    v_mfma_f32_16x16x32_bf16 v[84:87], a[132:135], a[32:35], v[84:87]
    v_mfma_f32_16x16x32_bf16 v[84:87], a[140:143], a[36:39], v[84:87]
    buffer_load_dwordx4 a[232:235], v251, s[16:19], s29 offen sc1
    v_mfma_f32_16x16x32_bf16 v[92:95], a[132:135], a[40:43], v[92:95]
    v_mfma_f32_16x16x32_bf16 v[92:95], a[140:143], a[44:47], v[92:95]
    v_mfma_f32_16x16x32_bf16 v[96:99], a[144:147], a[0:3], v[96:99]
    v_mfma_f32_16x16x32_bf16 v[96:99], a[152:155], a[4:7], v[96:99]
    buffer_load_dwordx4 a[236:239], v251, s[16:19], s29 offen offset:1024 sc1
    v_mfma_f32_16x16x32_bf16 v[104:107], a[144:147], a[8:11], v[104:107]
    s_and_b32 s29, s62, 15
    v_mfma_f32_16x16x32_bf16 v[104:107], a[152:155], a[12:15], v[104:107]
    s_lshr_b64 s[62:63], s[62:63], 4
    v_mfma_f32_16x16x32_bf16 v[112:115], a[144:147], a[16:19], v[112:115]
    s_mul_i32 s29, s29, 12288
    v_mfma_f32_16x16x32_bf16 v[112:115], a[152:155], a[20:23], v[112:115]
    s_add_u32 s29, s29, s44
    buffer_load_dwordx4 a[48:51], v240, s[20:23], s28 offen sc1
    v_mfma_f32_16x16x32_bf16 v[120:123], a[144:147], a[24:27], v[120:123]
    v_mfma_f32_16x16x32_bf16 v[120:123], a[152:155], a[28:31], v[120:123]
    v_mfma_f32_16x16x32_bf16 v[128:131], a[144:147], a[32:35], v[128:131]
    buffer_load_dwordx4 a[56:59], v240, s[20:23], s28 offen offset:2048 sc1
    v_mfma_f32_16x16x32_bf16 v[128:131], a[152:155], a[36:39], v[128:131]
    v_mfma_f32_16x16x32_bf16 v[136:139], a[144:147], a[40:43], v[136:139]
    v_mfma_f32_16x16x32_bf16 v[136:139], a[152:155], a[44:47], v[136:139]
    v_mfma_f32_16x16x32_bf16 v[100:103], a[148:151], a[0:3], v[100:103]
    buffer_load_dwordx4 a[52:55], v240, s[20:23], s28 offen offset:1024 sc1
    v_mfma_f32_16x16x32_bf16 v[100:103], a[156:159], a[4:7], v[100:103]
    v_mfma_f32_16x16x32_bf16 v[108:111], a[148:151], a[8:11], v[108:111]
    v_mfma_f32_16x16x32_bf16 v[108:111], a[156:159], a[12:15], v[108:111]
    v_mfma_f32_16x16x32_bf16 v[116:119], a[148:151], a[16:19], v[116:119]
    buffer_load_dwordx4 a[60:63], v240, s[20:23], s28 offen offset:3072 sc1
    v_mfma_f32_16x16x32_bf16 v[116:119], a[156:159], a[20:23], v[116:119]
    v_mfma_f32_16x16x32_bf16 v[124:127], a[148:151], a[24:27], v[124:127]
    v_mfma_f32_16x16x32_bf16 v[124:127], a[156:159], a[28:31], v[124:127]
    v_mfma_f32_16x16x32_bf16 v[132:135], a[148:151], a[32:35], v[132:135]
    buffer_load_dwordx4 a[128:131], v241, s[20:23], s28 offen sc1
    v_mfma_f32_16x16x32_bf16 v[132:135], a[156:159], a[36:39], v[132:135]
    v_mfma_f32_16x16x32_bf16 v[140:143], a[148:151], a[40:43], v[140:143]
    v_mfma_f32_16x16x32_bf16 v[140:143], a[156:159], a[44:47], v[140:143]
    buffer_load_dwordx4 a[136:139], v241, s[20:23], s28 offen offset:2048 sc1
    v_mfma_f32_16x16x32_bf16 v[144:147], a[160:163], a[0:3], v[144:147]
    v_mfma_f32_16x16x32_bf16 v[144:147], a[168:171], a[4:7], v[144:147]
    v_mfma_f32_16x16x32_bf16 v[152:155], a[160:163], a[8:11], v[152:155]
    v_mfma_f32_16x16x32_bf16 v[152:155], a[168:171], a[12:15], v[152:155]
    buffer_load_dwordx4 a[132:135], v241, s[20:23], s28 offen offset:1024 sc1
    v_mfma_f32_16x16x32_bf16 v[160:163], a[160:163], a[16:19], v[160:163]
    v_mfma_f32_16x16x32_bf16 v[160:163], a[168:171], a[20:23], v[160:163]
    v_mfma_f32_16x16x32_bf16 v[168:171], a[160:163], a[24:27], v[168:171]
    v_mfma_f32_16x16x32_bf16 v[168:171], a[168:171], a[28:31], v[168:171]
    buffer_load_dwordx4 a[140:143], v241, s[20:23], s28 offen offset:3072 sc1
    v_mfma_f32_16x16x32_bf16 v[176:179], a[160:163], a[32:35], v[176:179]
    v_mfma_f32_16x16x32_bf16 v[176:179], a[168:171], a[36:39], v[176:179]
    v_mfma_f32_16x16x32_bf16 v[184:187], a[160:163], a[40:43], v[184:187]
    v_mfma_f32_16x16x32_bf16 v[184:187], a[168:171], a[44:47], v[184:187]
    buffer_load_dwordx4 a[144:147], v242, s[20:23], s28 offen sc1
    v_mfma_f32_16x16x32_bf16 v[148:151], a[164:167], a[0:3], v[148:151]
    v_mfma_f32_16x16x32_bf16 v[148:151], a[172:175], a[4:7], v[148:151]
    v_mfma_f32_16x16x32_bf16 v[156:159], a[164:167], a[8:11], v[156:159]
    buffer_load_dwordx4 a[152:155], v242, s[20:23], s28 offen offset:2048 sc1
    v_mfma_f32_16x16x32_bf16 v[156:159], a[172:175], a[12:15], v[156:159]
    v_mfma_f32_16x16x32_bf16 v[164:167], a[164:167], a[16:19], v[164:167]
    v_mfma_f32_16x16x32_bf16 v[164:167], a[172:175], a[20:23], v[164:167]
    v_mfma_f32_16x16x32_bf16 v[172:175], a[164:167], a[24:27], v[172:175]
    buffer_load_dwordx4 a[148:151], v242, s[20:23], s28 offen offset:1024 sc1
    v_mfma_f32_16x16x32_bf16 v[172:175], a[172:175], a[28:31], v[172:175]
    v_mfma_f32_16x16x32_bf16 v[180:183], a[164:167], a[32:35], v[180:183]
    v_mfma_f32_16x16x32_bf16 v[180:183], a[172:175], a[36:39], v[180:183]
    v_mfma_f32_16x16x32_bf16 v[188:191], a[164:167], a[40:43], v[188:191]
    buffer_load_dwordx4 a[156:159], v242, s[20:23], s28 offen offset:3072 sc1
    v_mfma_f32_16x16x32_bf16 v[188:191], a[172:175], a[44:47], v[188:191]
    v_mfma_f32_16x16x32_bf16 v[192:195], a[176:179], a[0:3], v[192:195]
    v_mfma_f32_16x16x32_bf16 v[192:195], a[184:187], a[4:7], v[192:195]
    v_mfma_f32_16x16x32_bf16 v[200:203], a[176:179], a[8:11], v[200:203]
    buffer_load_dwordx4 a[160:163], v243, s[20:23], s28 offen sc1
    v_mfma_f32_16x16x32_bf16 v[200:203], a[184:187], a[12:15], v[200:203]
    v_mfma_f32_16x16x32_bf16 v[208:211], a[176:179], a[16:19], v[208:211]
    v_mfma_f32_16x16x32_bf16 v[208:211], a[184:187], a[20:23], v[208:211]
    buffer_load_dwordx4 a[168:171], v243, s[20:23], s28 offen offset:2048 sc1
    v_mfma_f32_16x16x32_bf16 v[216:219], a[176:179], a[24:27], v[216:219]
    v_mfma_f32_16x16x32_bf16 v[216:219], a[184:187], a[28:31], v[216:219]
    v_mfma_f32_16x16x32_bf16 v[224:227], a[176:179], a[32:35], v[224:227]
    v_mfma_f32_16x16x32_bf16 v[224:227], a[184:187], a[36:39], v[224:227]
    buffer_load_dwordx4 a[164:167], v243, s[20:23], s28 offen offset:1024 sc1
    v_mfma_f32_16x16x32_bf16 v[232:235], a[176:179], a[40:43], v[232:235]
    v_mfma_f32_16x16x32_bf16 v[232:235], a[184:187], a[44:47], v[232:235]
    v_mfma_f32_16x16x32_bf16 v[196:199], a[180:183], a[0:3], v[196:199]
    v_mfma_f32_16x16x32_bf16 v[196:199], a[188:191], a[4:7], v[196:199]
    buffer_load_dwordx4 a[172:175], v243, s[20:23], s28 offen offset:3072 sc1
    v_mfma_f32_16x16x32_bf16 v[204:207], a[180:183], a[8:11], v[204:207]
    v_mfma_f32_16x16x32_bf16 v[204:207], a[188:191], a[12:15], v[204:207]
    v_mfma_f32_16x16x32_bf16 v[212:215], a[180:183], a[16:19], v[212:215]
    v_mfma_f32_16x16x32_bf16 v[212:215], a[188:191], a[20:23], v[212:215]
    buffer_load_dwordx4 a[176:179], v244, s[20:23], s28 offen sc1
    v_mfma_f32_16x16x32_bf16 v[220:223], a[180:183], a[24:27], v[220:223]
    v_mfma_f32_16x16x32_bf16 v[220:223], a[188:191], a[28:31], v[220:223]
    v_mfma_f32_16x16x32_bf16 v[228:231], a[180:183], a[32:35], v[228:231]
    buffer_load_dwordx4 a[184:187], v244, s[20:23], s28 offen offset:2048 sc1
    v_mfma_f32_16x16x32_bf16 v[228:231], a[188:191], a[36:39], v[228:231]
    s_sub_u32 s67, s67, 1
    v_mfma_f32_16x16x32_bf16 v[236:239], a[180:183], a[40:43], v[236:239]
    v_mfma_f32_16x16x32_bf16 v[236:239], a[188:191], a[44:47], v[236:239]
    s_cmp_lg_u32 s67, 0
    s_cbranch_scc1 L_k2
    s_waitcnt vmcnt(29)
    v_mfma_f32_16x16x32_bf16 v[0:3], a[240:243], a[192:195], v[0:3]
    s_waitcnt vmcnt(28)
    buffer_load_dwordx4 a[180:183], v244, s[20:23], s28 offen offset:1024 sc1
    v_mfma_f32_16x16x32_bf16 v[0:3], a[248:251], a[196:199], v[0:3]
    s_waitcnt vmcnt(28)
    v_mfma_f32_16x16x32_bf16 v[8:11], a[240:243], a[200:203], v[8:11]
    s_waitcnt vmcnt(27)
    v_mfma_f32_16x16x32_bf16 v[8:11], a[248:251], a[204:207], v[8:11]
    s_waitcnt vmcnt(26)
    v_mfma_f32_16x16x32_bf16 v[16:19], a[240:243], a[208:211], v[16:19]
    s_waitcnt vmcnt(25)
    buffer_load_dwordx4 a[188:191], v244, s[20:23], s28 offen offset:3072 sc1
    v_mfma_f32_16x16x32_bf16 v[16:19], a[248:251], a[212:215], v[16:19]
    s_waitcnt vmcnt(25)
    s_and_b32 s28, s56, 15
    v_mfma_f32_16x16x32_bf16 v[24:27], a[240:243], a[216:219], v[24:27]
    s_waitcnt vmcnt(24)
    s_lshr_b64 s[56:57], s[56:57], 4
    v_mfma_f32_16x16x32_bf16 v[24:27], a[248:251], a[220:223], v[24:27]
    s_waitcnt vmcnt(23)
    s_mul_i32 s28, s28, 20480
    v_mfma_f32_16x16x32_bf16 v[32:35], a[240:243], a[224:227], v[32:35]
    s_waitcnt vmcnt(22)
    s_add_u32 s28, s28, s43
    buffer_load_dwordx4 a[0:3], v245, s[16:19], s29 offen sc1
    v_mfma_f32_16x16x32_bf16 v[32:35], a[248:251], a[228:231], v[32:35]
    s_waitcnt vmcnt(22)
    v_mfma_f32_16x16x32_bf16 v[40:43], a[240:243], a[232:235], v[40:43]
    s_waitcnt vmcnt(21)
    v_mfma_f32_16x16x32_bf16 v[40:43], a[248:251], a[236:239], v[40:43]
    buffer_load_dwordx4 a[4:7], v245, s[16:19], s29 offen offset:1024 sc1
    v_mfma_f32_16x16x32_bf16 v[4:7], a[244:247], a[192:195], v[4:7]
    v_mfma_f32_16x16x32_bf16 v[4:7], a[252:255], a[196:199], v[4:7]
    v_mfma_f32_16x16x32_bf16 v[12:15], a[244:247], a[200:203], v[12:15]
    v_mfma_f32_16x16x32_bf16 v[12:15], a[252:255], a[204:207], v[12:15]
    buffer_load_dwordx4 a[8:11], v246, s[16:19], s29 offen sc1
    v_mfma_f32_16x16x32_bf16 v[20:23], a[244:247], a[208:211], v[20:23]
    v_mfma_f32_16x16x32_bf16 v[20:23], a[252:255], a[212:215], v[20:23]
    v_mfma_f32_16x16x32_bf16 v[28:31], a[244:247], a[216:219], v[28:31]
    v_mfma_f32_16x16x32_bf16 v[28:31], a[252:255], a[220:223], v[28:31]
    buffer_load_dwordx4 a[12:15], v246, s[16:19], s29 offen offset:1024 sc1
    v_mfma_f32_16x16x32_bf16 v[36:39], a[244:247], a[224:227], v[36:39]
    v_mfma_f32_16x16x32_bf16 v[36:39], a[252:255], a[228:231], v[36:39]
    v_mfma_f32_16x16x32_bf16 v[44:47], a[244:247], a[232:235], v[44:47]
    v_mfma_f32_16x16x32_bf16 v[44:47], a[252:255], a[236:239], v[44:47]
    buffer_load_dwordx4 a[16:19], v247, s[16:19], s29 offen sc1
    v_mfma_f32_16x16x32_bf16 v[48:51], a[64:67], a[192:195], v[48:51]
    v_mfma_f32_16x16x32_bf16 v[48:51], a[72:75], a[196:199], v[48:51]
    v_mfma_f32_16x16x32_bf16 v[56:59], a[64:67], a[200:203], v[56:59]
    buffer_load_dwordx4 a[20:23], v247, s[16:19], s29 offen offset:1024 sc1
    v_mfma_f32_16x16x32_bf16 v[56:59], a[72:75], a[204:207], v[56:59]
    v_mfma_f32_16x16x32_bf16 v[64:67], a[64:67], a[208:211], v[64:67]
    v_mfma_f32_16x16x32_bf16 v[64:67], a[72:75], a[212:215], v[64:67]
    v_mfma_f32_16x16x32_bf16 v[72:75], a[64:67], a[216:219], v[72:75]
    buffer_load_dwordx4 a[24:27], v248, s[16:19], s29 offen sc1
    v_mfma_f32_16x16x32_bf16 v[72:75], a[72:75], a[220:223], v[72:75]
    v_mfma_f32_16x16x32_bf16 v[80:83], a[64:67], a[224:227], v[80:83]
    v_mfma_f32_16x16x32_bf16 v[80:83], a[72:75], a[228:231], v[80:83]
    v_mfma_f32_16x16x32_bf16 v[88:91], a[64:67], a[232:235], v[88:91]
    buffer_load_dwordx4 a[28:31], v248, s[16:19], s29 offen offset:1024 sc1
    v_mfma_f32_16x16x32_bf16 v[88:91], a[72:75], a[236:239], v[88:91]
    v_mfma_f32_16x16x32_bf16 v[52:55], a[68:71], a[192:195], v[52:55]
    v_mfma_f32_16x16x32_bf16 v[52:55], a[76:79], a[196:199], v[52:55]
    v_mfma_f32_16x16x32_bf16 v[60:63], a[68:71], a[200:203], v[60:63]
    buffer_load_dwordx4 a[32:35], v249, s[16:19], s29 offen sc1
    v_mfma_f32_16x16x32_bf16 v[60:63], a[76:79], a[204:207], v[60:63]
    v_mfma_f32_16x16x32_bf16 v[68:71], a[68:71], a[208:211], v[68:71]
    v_mfma_f32_16x16x32_bf16 v[68:71], a[76:79], a[212:215], v[68:71]
    buffer_load_dwordx4 a[36:39], v249, s[16:19], s29 offen offset:1024 sc1
    v_mfma_f32_16x16x32_bf16 v[76:79], a[68:71], a[216:219], v[76:79]
    v_mfma_f32_16x16x32_bf16 v[76:79], a[76:79], a[220:223], v[76:79]
    v_mfma_f32_16x16x32_bf16 v[84:87], a[68:71], a[224:227], v[84:87]
    v_mfma_f32_16x16x32_bf16 v[84:87], a[76:79], a[228:231], v[84:87]
    buffer_load_dwordx4 a[40:43], v251, s[16:19], s29 offen sc1
    v_mfma_f32_16x16x32_bf16 v[92:95], a[68:71], a[232:235], v[92:95]
    v_mfma_f32_16x16x32_bf16 v[92:95], a[76:79], a[236:239], v[92:95]
    v_mfma_f32_16x16x32_bf16 v[96:99], a[80:83], a[192:195], v[96:99]
    v_mfma_f32_16x16x32_bf16 v[96:99], a[88:91], a[196:199], v[96:99]
    buffer_load_dwordx4 a[44:47], v251, s[16:19], s29 offen offset:1024 sc1
    v_mfma_f32_16x16x32_bf16 v[104:107], a[80:83], a[200:203], v[104:107]
    s_and_b32 s29, s62, 15
    v_mfma_f32_16x16x32_bf16 v[104:107], a[88:91], a[204:207], v[104:107]
    s_lshr_b64 s[62:63], s[62:63], 4
    v_mfma_f32_16x16x32_bf16 v[112:115], a[80:83], a[208:211], v[112:115]
    s_mul_i32 s29, s29, 12288
    v_mfma_f32_16x16x32_bf16 v[112:115], a[88:91], a[212:215], v[112:115]
    s_add_u32 s29, s29, s44
    v_mfma_f32_16x16x32_bf16 v[120:123], a[80:83], a[216:219], v[120:123]
    v_mfma_f32_16x16x32_bf16 v[120:123], a[88:91], a[220:223], v[120:123]
    v_mfma_f32_16x16x32_bf16 v[128:131], a[80:83], a[224:227], v[128:131]
    v_mfma_f32_16x16x32_bf16 v[128:131], a[88:91], a[228:231], v[128:131]
    v_mfma_f32_16x16x32_bf16 v[136:139], a[80:83], a[232:235], v[136:139]
    v_mfma_f32_16x16x32_bf16 v[136:139], a[88:91], a[236:239], v[136:139]
    v_mfma_f32_16x16x32_bf16 v[100:103], a[84:87], a[192:195], v[100:103]
    v_mfma_f32_16x16x32_bf16 v[100:103], a[92:95], a[196:199], v[100:103]
    v_mfma_f32_16x16x32_bf16 v[108:111], a[84:87], a[200:203], v[108:111]
    v_mfma_f32_16x16x32_bf16 v[108:111], a[92:95], a[204:207], v[108:111]
    v_mfma_f32_16x16x32_bf16 v[116:119], a[84:87], a[208:211], v[116:119]
    v_mfma_f32_16x16x32_bf16 v[116:119], a[92:95], a[212:215], v[116:119]
    v_mfma_f32_16x16x32_bf16 v[124:127], a[84:87], a[216:219], v[124:127]
    v_mfma_f32_16x16x32_bf16 v[124:127], a[92:95], a[220:223], v[124:127]
    v_mfma_f32_16x16x32_bf16 v[132:135], a[84:87], a[224:227], v[132:135]
    v_mfma_f32_16x16x32_bf16 v[132:135], a[92:95], a[228:231], v[132:135]
    v_mfma_f32_16x16x32_bf16 v[140:143], a[84:87], a[232:235], v[140:143]
    v_mfma_f32_16x16x32_bf16 v[140:143], a[92:95], a[236:239], v[140:143]
    v_mfma_f32_16x16x32_bf16 v[144:147], a[96:99], a[192:195], v[144:147]
    v_mfma_f32_16x16x32_bf16 v[144:147], a[104:107], a[196:199], v[144:147]
    v_mfma_f32_16x16x32_bf16 v[152:155], a[96:99], a[200:203], v[152:155]
    v_mfma_f32_16x16x32_bf16 v[152:155], a[104:107], a[204:207], v[152:155]
    v_mfma_f32_16x16x32_bf16 v[160:163], a[96:99], a[208:211], v[160:163]
    v_mfma_f32_16x16x32_bf16 v[160:163], a[104:107], a[212:215], v[160:163]
    v_mfma_f32_16x16x32_bf16 v[168:171], a[96:99], a[216:219], v[168:171]
    v_mfma_f32_16x16x32_bf16 v[168:171], a[104:107], a[220:223], v[168:171]
    v_mfma_f32_16x16x32_bf16 v[176:179], a[96:99], a[224:227], v[176:179]
    v_mfma_f32_16x16x32_bf16 v[176:179], a[104:107], a[228:231], v[176:179]
    v_mfma_f32_16x16x32_bf16 v[184:187], a[96:99], a[232:235], v[184:187]
    v_mfma_f32_16x16x32_bf16 v[184:187], a[104:107], a[236:239], v[184:187]
    v_mfma_f32_16x16x32_bf16 v[148:151], a[100:103], a[192:195], v[148:151]
    v_mfma_f32_16x16x32_bf16 v[148:151], a[108:111], a[196:199], v[148:151]
    v_mfma_f32_16x16x32_bf16 v[156:159], a[100:103], a[200:203], v[156:159]
    v_mfma_f32_16x16x32_bf16 v[156:159], a[108:111], a[204:207], v[156:159]
    v_mfma_f32_16x16x32_bf16 v[164:167], a[100:103], a[208:211], v[164:167]
    v_mfma_f32_16x16x32_bf16 v[164:167], a[108:111], a[212:215], v[164:167]
    v_mfma_f32_16x16x32_bf16 v[172:175], a[100:103], a[216:219], v[172:175]
    v_mfma_f32_16x16x32_bf16 v[172:175], a[108:111], a[220:223], v[172:175]
    v_mfma_f32_16x16x32_bf16 v[180:183], a[100:103], a[224:227], v[180:183]
    v_mfma_f32_16x16x32_bf16 v[180:183], a[108:111], a[228:231], v[180:183]
    v_mfma_f32_16x16x32_bf16 v[188:191], a[100:103], a[232:235], v[188:191]
    v_mfma_f32_16x16x32_bf16 v[188:191], a[108:111], a[236:239], v[188:191]
    v_mfma_f32_16x16x32_bf16 v[192:195], a[112:115], a[192:195], v[192:195]
    v_mfma_f32_16x16x32_bf16 v[192:195], a[120:123], a[196:199], v[192:195]
    v_mfma_f32_16x16x32_bf16 v[200:203], a[112:115], a[200:203], v[200:203]
    v_mfma_f32_16x16x32_bf16 v[200:203], a[120:123], a[204:207], v[200:203]
    v_mfma_f32_16x16x32_bf16 v[208:211], a[112:115], a[208:211], v[208:211]
    v_mfma_f32_16x16x32_bf16 v[208:211], a[120:123], a[212:215], v[208:211]
    v_mfma_f32_16x16x32_bf16 v[216:219], a[112:115], a[216:219], v[216:219]
    v_mfma_f32_16x16x32_bf16 v[216:219], a[120:123], a[220:223], v[216:219]
    v_mfma_f32_16x16x32_bf16 v[224:227], a[112:115], a[224:227], v[224:227]
    v_mfma_f32_16x16x32_bf16 v[224:227], a[120:123], a[228:231], v[224:227]
    v_mfma_f32_16x16x32_bf16 v[232:235], a[112:115], a[232:235], v[232:235]
    v_mfma_f32_16x16x32_bf16 v[232:235], a[120:123], a[236:239], v[232:235]
    v_mfma_f32_16x16x32_bf16 v[196:199], a[116:119], a[192:195], v[196:199]
    v_mfma_f32_16x16x32_bf16 v[196:199], a[124:127], a[196:199], v[196:199]
    v_mfma_f32_16x16x32_bf16 v[204:207], a[116:119], a[200:203], v[204:207]
    v_mfma_f32_16x16x32_bf16 v[204:207], a[124:127], a[204:207], v[204:207]
    v_mfma_f32_16x16x32_bf16 v[212:215], a[116:119], a[208:211], v[212:215]
    v_mfma_f32_16x16x32_bf16 v[212:215], a[124:127], a[212:215], v[212:215]
    v_mfma_f32_16x16x32_bf16 v[220:223], a[116:119], a[216:219], v[220:223]
    v_mfma_f32_16x16x32_bf16 v[220:223], a[124:127], a[220:223], v[220:223]
    v_mfma_f32_16x16x32_bf16 v[228:231], a[116:119], a[224:227], v[228:231]
    v_mfma_f32_16x16x32_bf16 v[228:231], a[124:127], a[228:231], v[228:231]
    v_mfma_f32_16x16x32_bf16 v[236:239], a[116:119], a[232:235], v[236:239]
    v_mfma_f32_16x16x32_bf16 v[236:239], a[124:127], a[236:239], v[236:239]
    s_waitcnt vmcnt(5)
    v_mfma_f32_16x16x32_bf16 v[24:27], a[48:51], a[24:27], v[24:27]
    s_waitcnt vmcnt(4)
    v_mfma_f32_16x16x32_bf16 v[24:27], a[56:59], a[28:31], v[24:27]
    s_waitcnt vmcnt(3)
    v_mfma_f32_16x16x32_bf16 v[32:35], a[48:51], a[32:35], v[32:35]
    s_waitcnt vmcnt(2)
    s_mul_i32 s7, s46, 30720
    v_mfma_f32_16x16x32_bf16 v[32:35], a[56:59], a[36:39], v[32:35]
    s_waitcnt vmcnt(1)
    v_add_u32 v254, s7, v252
    v_mfma_f32_16x16x32_bf16 v[40:43], a[48:51], a[40:43], v[40:43]
    s_waitcnt vmcnt(0)
    v_lshrrev_b32 v242, 4, v252
    v_mfma_f32_16x16x32_bf16 v[40:43], a[56:59], a[44:47], v[40:43]
    v_and_b32 v243, 15, v242
    v_mfma_f32_16x16x32_bf16 v[28:31], a[52:55], a[24:27], v[28:31]
    v_mul_u32_u24 v243, 2560, v243
    v_mfma_f32_16x16x32_bf16 v[28:31], a[60:63], a[28:31], v[28:31]
    v_lshrrev_b32 v242, 4, v242
    v_mfma_f32_16x16x32_bf16 v[36:39], a[52:55], a[32:35], v[36:39]
    v_lshl_add_u32 v244, v242, 4, v243
    v_mfma_f32_16x16x32_bf16 v[36:39], a[60:63], a[36:39], v[36:39]
    s_xor_b32 s30, s46, 1
    v_mfma_f32_16x16x32_bf16 v[44:47], a[52:55], a[40:43], v[44:47]
    s_sub_u32 s30, s30, s46
    v_mfma_f32_16x16x32_bf16 v[44:47], a[60:63], a[44:47], v[44:47]
    s_mul_i32 s7, s30, 30720
    v_mfma_f32_16x16x32_bf16 v[72:75], a[128:131], a[24:27], v[72:75]
    v_add_u32 v240, s7, v254
    v_mfma_f32_16x16x32_bf16 v[72:75], a[136:139], a[28:31], v[72:75]
    s_xor_b32 s30, s46, 3
    v_mfma_f32_16x16x32_bf16 v[80:83], a[128:131], a[32:35], v[80:83]
    s_sub_u32 s30, s30, s46
    v_mfma_f32_16x16x32_bf16 v[80:83], a[136:139], a[36:39], v[80:83]
    s_mul_i32 s7, s30, 30720
    v_mfma_f32_16x16x32_bf16 v[88:91], a[128:131], a[40:43], v[88:91]
    v_add_u32 v241, s7, v254
    v_mfma_f32_16x16x32_bf16 v[88:91], a[136:139], a[44:47], v[88:91]
    s_mul_i32 s7, s47, 40960
    v_mfma_f32_16x16x32_bf16 v[76:79], a[132:135], a[24:27], v[76:79]
    s_lshl_b32 s30, s36, 6
    v_mfma_f32_16x16x32_bf16 v[76:79], a[140:143], a[28:31], v[76:79]
    s_add_u32 s7, s7, s30
    v_mfma_f32_16x16x32_bf16 v[84:87], a[132:135], a[32:35], v[84:87]
    s_add_u32 s84, s7, s31
    v_mfma_f32_16x16x32_bf16 v[84:87], a[140:143], a[36:39], v[84:87]
    s_mul_i32 s7, s48, 40960
    v_mfma_f32_16x16x32_bf16 v[92:95], a[132:135], a[40:43], v[92:95]
    s_lshl_b32 s30, s36, 6
    v_mfma_f32_16x16x32_bf16 v[92:95], a[140:143], a[44:47], v[92:95]
    s_add_u32 s7, s7, s30
    v_mfma_f32_16x16x32_bf16 v[120:123], a[144:147], a[24:27], v[120:123]
    s_add_u32 s85, s7, s31
    v_mfma_f32_16x16x32_bf16 v[120:123], a[152:155], a[28:31], v[120:123]
    s_mul_i32 s7, s49, 40960
    v_mfma_f32_16x16x32_bf16 v[128:131], a[144:147], a[32:35], v[128:131]
    s_lshl_b32 s30, s36, 6
    v_mfma_f32_16x16x32_bf16 v[128:131], a[152:155], a[36:39], v[128:131]
    s_add_u32 s7, s7, s30
    v_mfma_f32_16x16x32_bf16 v[136:139], a[144:147], a[40:43], v[136:139]
    s_add_u32 s86, s7, s31
    v_mfma_f32_16x16x32_bf16 v[136:139], a[152:155], a[44:47], v[136:139]
    s_mul_i32 s7, s47, 40960
    v_mfma_f32_16x16x32_bf16 v[124:127], a[148:151], a[24:27], v[124:127]
    s_lshl_b32 s30, s37, 6
    v_mfma_f32_16x16x32_bf16 v[124:127], a[156:159], a[28:31], v[124:127]
    s_add_u32 s7, s7, s30
    v_mfma_f32_16x16x32_bf16 v[132:135], a[148:151], a[32:35], v[132:135]
    s_add_u32 s87, s7, s31
    v_mfma_f32_16x16x32_bf16 v[132:135], a[156:159], a[36:39], v[132:135]
    s_mul_i32 s7, s48, 40960
    v_mfma_f32_16x16x32_bf16 v[140:143], a[148:151], a[40:43], v[140:143]
    s_lshl_b32 s30, s37, 6
    v_mfma_f32_16x16x32_bf16 v[140:143], a[156:159], a[44:47], v[140:143]
    s_add_u32 s7, s7, s30
    v_mfma_f32_16x16x32_bf16 v[168:171], a[160:163], a[24:27], v[168:171]
    s_add_u32 s88, s7, s31
    v_mfma_f32_16x16x32_bf16 v[168:171], a[168:171], a[28:31], v[168:171]
    s_mul_i32 s7, s49, 40960
    v_mfma_f32_16x16x32_bf16 v[176:179], a[160:163], a[32:35], v[176:179]
    s_lshl_b32 s30, s37, 6
    v_mfma_f32_16x16x32_bf16 v[176:179], a[168:171], a[36:39], v[176:179]
    s_add_u32 s7, s7, s30
    v_mfma_f32_16x16x32_bf16 v[184:187], a[160:163], a[40:43], v[184:187]
    s_add_u32 s89, s7, s31
    v_mfma_f32_16x16x32_bf16 v[184:187], a[168:171], a[44:47], v[184:187]
    s_mul_i32 s7, s47, 40960
    v_mfma_f32_16x16x32_bf16 v[172:175], a[164:167], a[24:27], v[172:175]
    s_lshl_b32 s30, s38, 6
    v_mfma_f32_16x16x32_bf16 v[172:175], a[172:175], a[28:31], v[172:175]
    s_add_u32 s7, s7, s30
    v_mfma_f32_16x16x32_bf16 v[180:183], a[164:167], a[32:35], v[180:183]
    s_add_u32 s90, s7, s31
    v_mfma_f32_16x16x32_bf16 v[180:183], a[172:175], a[36:39], v[180:183]
    s_mul_i32 s7, s48, 40960
    v_mfma_f32_16x16x32_bf16 v[188:191], a[164:167], a[40:43], v[188:191]
    s_lshl_b32 s30, s38, 6
    v_mfma_f32_16x16x32_bf16 v[188:191], a[172:175], a[44:47], v[188:191]
    s_add_u32 s7, s7, s30
    v_mfma_f32_16x16x32_bf16 v[216:219], a[176:179], a[24:27], v[216:219]
    s_add_u32 s91, s7, s31
    v_mfma_f32_16x16x32_bf16 v[216:219], a[184:187], a[28:31], v[216:219]
    v_mfma_f32_16x16x32_bf16 v[224:227], a[176:179], a[32:35], v[224:227]
    v_mfma_f32_16x16x32_bf16 v[224:227], a[184:187], a[36:39], v[224:227]
    v_mfma_f32_16x16x32_bf16 v[232:235], a[176:179], a[40:43], v[232:235]
    v_mfma_f32_16x16x32_bf16 v[232:235], a[184:187], a[44:47], v[232:235]
    v_mfma_f32_16x16x32_bf16 v[220:223], a[180:183], a[24:27], v[220:223]
    v_mfma_f32_16x16x32_bf16 v[220:223], a[188:191], a[28:31], v[220:223]
    v_mfma_f32_16x16x32_bf16 v[228:231], a[180:183], a[32:35], v[228:231]
    v_mfma_f32_16x16x32_bf16 v[228:231], a[188:191], a[36:39], v[228:231]
    v_mfma_f32_16x16x32_bf16 v[236:239], a[180:183], a[40:43], v[236:239]
    v_mfma_f32_16x16x32_bf16 v[236:239], a[188:191], a[44:47], v[236:239]
    v_mfma_f32_16x16x32_bf16 v[0:3], a[48:51], a[0:3], v[0:3]
    v_mfma_f32_16x16x32_bf16 v[0:3], a[56:59], a[4:7], v[0:3]
    ds_write_b128 v254, v[24:27]
    v_mfma_f32_16x16x32_bf16 v[8:11], a[48:51], a[8:11], v[8:11]
    v_mfma_f32_16x16x32_bf16 v[8:11], a[56:59], a[12:15], v[8:11]
    ds_write_b128 v254, v[32:35] offset:2048
    v_mfma_f32_16x16x32_bf16 v[16:19], a[48:51], a[16:19], v[16:19]
    v_mfma_f32_16x16x32_bf16 v[16:19], a[56:59], a[20:23], v[16:19]
    ds_write_b128 v254, v[40:43] offset:4096
    v_mfma_f32_16x16x32_bf16 v[4:7], a[52:55], a[0:3], v[4:7]
    v_mfma_f32_16x16x32_bf16 v[4:7], a[60:63], a[4:7], v[4:7]
    ds_write_b128 v254, v[28:31] offset:1024
    v_mfma_f32_16x16x32_bf16 v[12:15], a[52:55], a[8:11], v[12:15]
    v_mfma_f32_16x16x32_bf16 v[12:15], a[60:63], a[12:15], v[12:15]
    ds_write_b128 v254, v[36:39] offset:3072
    v_mfma_f32_16x16x32_bf16 v[20:23], a[52:55], a[16:19], v[20:23]
    v_mfma_f32_16x16x32_bf16 v[20:23], a[60:63], a[20:23], v[20:23]
    ds_write_b128 v254, v[44:47] offset:5120
    v_mfma_f32_16x16x32_bf16 v[48:51], a[128:131], a[0:3], v[48:51]
    v_mfma_f32_16x16x32_bf16 v[48:51], a[136:139], a[4:7], v[48:51]
    ds_write_b128 v254, v[72:75] offset:6144
    v_mfma_f32_16x16x32_bf16 v[56:59], a[128:131], a[8:11], v[56:59]
    v_mfma_f32_16x16x32_bf16 v[56:59], a[136:139], a[12:15], v[56:59]
    ds_write_b128 v254, v[80:83] offset:8192
    v_mfma_f32_16x16x32_bf16 v[64:67], a[128:131], a[16:19], v[64:67]
    v_mfma_f32_16x16x32_bf16 v[64:67], a[136:139], a[20:23], v[64:67]
    ds_write_b128 v254, v[88:91] offset:10240
    v_mfma_f32_16x16x32_bf16 v[52:55], a[132:135], a[0:3], v[52:55]
    v_mfma_f32_16x16x32_bf16 v[52:55], a[140:143], a[4:7], v[52:55]
    ds_write_b128 v254, v[76:79] offset:7168
    v_mfma_f32_16x16x32_bf16 v[60:63], a[132:135], a[8:11], v[60:63]
    v_mfma_f32_16x16x32_bf16 v[60:63], a[140:143], a[12:15], v[60:63]
    ds_write_b128 v254, v[84:87] offset:9216
    v_mfma_f32_16x16x32_bf16 v[68:71], a[132:135], a[16:19], v[68:71]
    v_mfma_f32_16x16x32_bf16 v[68:71], a[140:143], a[20:23], v[68:71]
    ds_write_b128 v254, v[92:95] offset:11264
    v_mfma_f32_16x16x32_bf16 v[96:99], a[144:147], a[0:3], v[96:99]
    v_mfma_f32_16x16x32_bf16 v[96:99], a[152:155], a[4:7], v[96:99]
    ds_write_b128 v254, v[120:123] offset:12288
    v_mfma_f32_16x16x32_bf16 v[104:107], a[144:147], a[8:11], v[104:107]
    v_mfma_f32_16x16x32_bf16 v[104:107], a[152:155], a[12:15], v[104:107]
    ds_write_b128 v254, v[128:131] offset:14336
    v_mfma_f32_16x16x32_bf16 v[112:115], a[144:147], a[16:19], v[112:115]
    v_mfma_f32_16x16x32_bf16 v[112:115], a[152:155], a[20:23], v[112:115]
    ds_write_b128 v254, v[136:139] offset:16384
    v_mfma_f32_16x16x32_bf16 v[100:103], a[148:151], a[0:3], v[100:103]
    v_mfma_f32_16x16x32_bf16 v[100:103], a[156:159], a[4:7], v[100:103]
    ds_write_b128 v254, v[124:127] offset:13312
    v_mfma_f32_16x16x32_bf16 v[108:111], a[148:151], a[8:11], v[108:111]
    v_mfma_f32_16x16x32_bf16 v[108:111], a[156:159], a[12:15], v[108:111]
    ds_write_b128 v254, v[132:135] offset:15360
    v_mfma_f32_16x16x32_bf16 v[116:119], a[148:151], a[16:19], v[116:119]
    v_mfma_f32_16x16x32_bf16 v[116:119], a[156:159], a[20:23], v[116:119]
    ds_write_b128 v254, v[140:143] offset:17408
    v_mfma_f32_16x16x32_bf16 v[144:147], a[160:163], a[0:3], v[144:147]
    v_mfma_f32_16x16x32_bf16 v[144:147], a[168:171], a[4:7], v[144:147]
    ds_write_b128 v254, v[168:171] offset:18432
    v_mfma_f32_16x16x32_bf16 v[152:155], a[160:163], a[8:11], v[152:155]
    v_mfma_f32_16x16x32_bf16 v[152:155], a[168:171], a[12:15], v[152:155]
    ds_write_b128 v254, v[176:179] offset:20480
    v_mfma_f32_16x16x32_bf16 v[160:163], a[160:163], a[16:19], v[160:163]
    v_mfma_f32_16x16x32_bf16 v[160:163], a[168:171], a[20:23], v[160:163]
    ds_write_b128 v254, v[184:187] offset:22528
    v_mfma_f32_16x16x32_bf16 v[148:151], a[164:167], a[0:3], v[148:151]
    v_mfma_f32_16x16x32_bf16 v[148:151], a[172:175], a[4:7], v[148:151]
    ds_write_b128 v254, v[172:175] offset:19456
    v_mfma_f32_16x16x32_bf16 v[156:159], a[164:167], a[8:11], v[156:159]
    v_mfma_f32_16x16x32_bf16 v[156:159], a[172:175], a[12:15], v[156:159]
    ds_write_b128 v254, v[180:183] offset:21504
    v_mfma_f32_16x16x32_bf16 v[164:167], a[164:167], a[16:19], v[164:167]
    v_mfma_f32_16x16x32_bf16 v[164:167], a[172:175], a[20:23], v[164:167]
    ds_write_b128 v254, v[188:191] offset:23552
    v_mfma_f32_16x16x32_bf16 v[192:195], a[176:179], a[0:3], v[192:195]
    v_mfma_f32_16x16x32_bf16 v[192:195], a[184:187], a[4:7], v[192:195]
    ds_write_b128 v254, v[216:219] offset:24576
    v_mfma_f32_16x16x32_bf16 v[200:203], a[176:179], a[8:11], v[200:203]
    v_mfma_f32_16x16x32_bf16 v[200:203], a[184:187], a[12:15], v[200:203]
    ds_write_b128 v254, v[224:227] offset:26624
    v_mfma_f32_16x16x32_bf16 v[208:211], a[176:179], a[16:19], v[208:211]
    v_mfma_f32_16x16x32_bf16 v[208:211], a[184:187], a[20:23], v[208:211]
    ds_write_b128 v254, v[232:235] offset:28672
    v_mfma_f32_16x16x32_bf16 v[196:199], a[180:183], a[0:3], v[196:199]
    v_mfma_f32_16x16x32_bf16 v[196:199], a[188:191], a[4:7], v[196:199]
    ds_write_b128 v254, v[220:223] offset:25600
    v_mfma_f32_16x16x32_bf16 v[204:207], a[180:183], a[8:11], v[204:207]
    v_mfma_f32_16x16x32_bf16 v[204:207], a[188:191], a[12:15], v[204:207]
    ds_write_b128 v254, v[228:231] offset:27648
    v_mfma_f32_16x16x32_bf16 v[212:215], a[180:183], a[16:19], v[212:215]
    v_mfma_f32_16x16x32_bf16 v[212:215], a[188:191], a[20:23], v[212:215]
    ds_write_b128 v254, v[236:239] offset:29696
    s_waitcnt lgkmcnt(0)
    s_barrier
    ds_read_b128 v[128:131], v240 offset:14336
    ds_read_b128 v[132:135], v240 offset:15360
    ds_read_b128 v[136:139], v240 offset:16384
    ds_read_b128 v[140:143], v240 offset:17408
    ds_read_b128 v[168:171], v240 offset:18432
    ds_read_b128 v[172:175], v240 offset:19456
    ds_read_b128 v[176:179], v240 offset:20480
    ds_read_b128 v[180:183], v240 offset:21504
    ds_read_b128 v[184:187], v240 offset:22528
    ds_read_b128 v[188:191], v240 offset:23552
    ds_read_b128 v[216:219], v240 offset:24576
    ds_read_b128 v[220:223], v240 offset:25600
    ds_read_b128 v[224:227], v240 offset:26624
    ds_read_b128 v[228:231], v240 offset:27648
    ds_read_b128 v[232:235], v240 offset:28672
    ds_read_b128 v[236:239], v240 offset:29696
    ds_read_b128 v[24:27], v240
    ds_read_b128 v[28:31], v240 offset:1024
    ds_read_b128 v[32:35], v240 offset:2048
    ds_read_b128 v[36:39], v240 offset:3072
    ds_read_b128 v[40:43], v240 offset:4096
    ds_read_b128 v[44:47], v240 offset:5120
    ds_read_b128 v[72:75], v240 offset:6144
    ds_read_b128 v[76:79], v240 offset:7168
    ds_read_b128 v[80:83], v240 offset:8192
    ds_read_b128 v[84:87], v240 offset:9216
    ds_read_b128 v[88:91], v240 offset:10240
    ds_read_b128 v[92:95], v240 offset:11264
    ds_read_b128 v[120:123], v240 offset:12288
    ds_read_b128 v[124:127], v240 offset:13312
    s_waitcnt lgkmcnt(15)
    v_pk_add_f32 v[104:105], v[104:105], v[128:129]
    v_pk_add_f32 v[106:107], v[106:107], v[130:131]
    v_pk_add_f32 v[108:109], v[108:109], v[132:133]
    v_pk_add_f32 v[110:111], v[110:111], v[134:135]
    ds_write_b128 v240, v[104:107] offset:14336
    ds_write_b128 v240, v[108:111] offset:15360
    v_pk_add_f32 v[112:113], v[112:113], v[136:137]
    v_pk_add_f32 v[114:115], v[114:115], v[138:139]
    v_pk_add_f32 v[116:117], v[116:117], v[140:141]
    v_pk_add_f32 v[118:119], v[118:119], v[142:143]
    ds_write_b128 v240, v[112:115] offset:16384
    ds_write_b128 v240, v[116:119] offset:17408
    v_pk_add_f32 v[144:145], v[144:145], v[168:169]
    v_pk_add_f32 v[146:147], v[146:147], v[170:171]
    v_pk_add_f32 v[148:149], v[148:149], v[172:173]
    v_pk_add_f32 v[150:151], v[150:151], v[174:175]
    ds_write_b128 v240, v[144:147] offset:18432
    ds_write_b128 v240, v[148:151] offset:19456
    v_pk_add_f32 v[152:153], v[152:153], v[176:177]
    v_pk_add_f32 v[154:155], v[154:155], v[178:179]
    v_pk_add_f32 v[156:157], v[156:157], v[180:181]
    v_pk_add_f32 v[158:159], v[158:159], v[182:183]
    ds_write_b128 v240, v[152:155] offset:20480
    ds_write_b128 v240, v[156:159] offset:21504
    v_pk_add_f32 v[160:161], v[160:161], v[184:185]
    v_pk_add_f32 v[162:163], v[162:163], v[186:187]
    v_pk_add_f32 v[164:165], v[164:165], v[188:189]
    v_pk_add_f32 v[166:167], v[166:167], v[190:191]
    ds_write_b128 v240, v[160:163] offset:22528
    ds_write_b128 v240, v[164:167] offset:23552
    v_pk_add_f32 v[192:193], v[192:193], v[216:217]
    v_pk_add_f32 v[194:195], v[194:195], v[218:219]
    v_pk_add_f32 v[196:197], v[196:197], v[220:221]
    v_pk_add_f32 v[198:199], v[198:199], v[222:223]
    ds_write_b128 v240, v[192:195] offset:24576
    ds_write_b128 v240, v[196:199] offset:25600
    v_pk_add_f32 v[200:201], v[200:201], v[224:225]
    v_pk_add_f32 v[202:203], v[202:203], v[226:227]
    v_pk_add_f32 v[204:205], v[204:205], v[228:229]
    v_pk_add_f32 v[206:207], v[206:207], v[230:231]
    ds_write_b128 v240, v[200:203] offset:26624
    ds_write_b128 v240, v[204:207] offset:27648
    v_pk_add_f32 v[208:209], v[208:209], v[232:233]
    v_pk_add_f32 v[210:211], v[210:211], v[234:235]
    s_waitcnt lgkmcnt(9)
    v_pk_add_f32 v[212:213], v[212:213], v[236:237]
    v_pk_add_f32 v[214:215], v[214:215], v[238:239]
    ds_write_b128 v240, v[208:211] offset:28672
    ds_write_b128 v240, v[212:215] offset:29696
    v_pk_add_f32 v[0:1], v[0:1], v[24:25]
    v_pk_add_f32 v[2:3], v[2:3], v[26:27]
    v_pk_add_f32 v[4:5], v[4:5], v[28:29]
    v_pk_add_f32 v[6:7], v[6:7], v[30:31]
    v_pk_add_f32 v[8:9], v[8:9], v[32:33]
    v_pk_add_f32 v[10:11], v[10:11], v[34:35]
    v_pk_add_f32 v[12:13], v[12:13], v[36:37]
    v_pk_add_f32 v[14:15], v[14:15], v[38:39]
    v_pk_add_f32 v[16:17], v[16:17], v[40:41]
    v_pk_add_f32 v[18:19], v[18:19], v[42:43]
    v_pk_add_f32 v[20:21], v[20:21], v[44:45]
    v_pk_add_f32 v[22:23], v[22:23], v[46:47]
    v_pk_add_f32 v[48:49], v[48:49], v[72:73]
    v_pk_add_f32 v[50:51], v[50:51], v[74:75]
    v_pk_add_f32 v[52:53], v[52:53], v[76:77]
    v_pk_add_f32 v[54:55], v[54:55], v[78:79]
    v_pk_add_f32 v[56:57], v[56:57], v[80:81]
    v_pk_add_f32 v[58:59], v[58:59], v[82:83]
    v_pk_add_f32 v[60:61], v[60:61], v[84:85]
    v_pk_add_f32 v[62:63], v[62:63], v[86:87]
    v_pk_add_f32 v[64:65], v[64:65], v[88:89]
    v_pk_add_f32 v[66:67], v[66:67], v[90:91]
    v_pk_add_f32 v[68:69], v[68:69], v[92:93]
    v_pk_add_f32 v[70:71], v[70:71], v[94:95]
    v_pk_add_f32 v[96:97], v[96:97], v[120:121]
    v_pk_add_f32 v[98:99], v[98:99], v[122:123]
    v_pk_add_f32 v[100:101], v[100:101], v[124:125]
    v_pk_add_f32 v[102:103], v[102:103], v[126:127]
    s_waitcnt lgkmcnt(0)
    s_barrier
    ds_read_b128 v[24:27], v241 offset:28672
    ds_read_b128 v[28:31], v241 offset:29696
    ds_read_b128 v[32:35], v241 offset:26624
    ds_read_b128 v[36:39], v241 offset:27648
    ds_read_b128 v[40:43], v241 offset:24576
    ds_read_b128 v[44:47], v241 offset:25600
    ds_read_b128 v[72:75], v241 offset:22528
    ds_read_b128 v[76:79], v241 offset:23552
    ds_read_b128 v[80:83], v241 offset:20480
    ds_read_b128 v[84:87], v241 offset:21504
    ds_read_b128 v[88:91], v241 offset:18432
    ds_read_b128 v[92:95], v241 offset:19456
    ds_read_b128 v[120:123], v241 offset:16384
    ds_read_b128 v[124:127], v241 offset:17408
    ds_read_b128 v[128:131], v241 offset:14336
    ds_read_b128 v[132:135], v241 offset:15360
    s_waitcnt lgkmcnt(15)
    v_pk_add_f32 v[0:1], v[0:1], v[24:25]
    v_pk_add_f32 v[2:3], v[2:3], v[26:27]
    s_waitcnt lgkmcnt(14)
    v_pk_add_f32 v[4:5], v[4:5], v[28:29]
    v_pk_add_f32 v[6:7], v[6:7], v[30:31]
    v_cvt_pk_bf16_f32 v0, v0, v1
    v_cvt_pk_bf16_f32 v1, v2, v3
    v_cvt_pk_bf16_f32 v2, v4, v5
    v_cvt_pk_bf16_f32 v3, v6, v7
    buffer_store_dwordx4 v[0:3], v244, s[8:11], s84 offen sc1
    s_waitcnt lgkmcnt(13)
    v_pk_add_f32 v[8:9], v[8:9], v[32:33]
    v_pk_add_f32 v[10:11], v[10:11], v[34:35]
    s_waitcnt lgkmcnt(12)
    v_pk_add_f32 v[12:13], v[12:13], v[36:37]
    v_pk_add_f32 v[14:15], v[14:15], v[38:39]
    v_cvt_pk_bf16_f32 v8, v8, v9
    v_cvt_pk_bf16_f32 v9, v10, v11
    v_cvt_pk_bf16_f32 v10, v12, v13
    v_cvt_pk_bf16_f32 v11, v14, v15
    buffer_store_dwordx4 v[8:11], v244, s[8:11], s85 offen sc1
    s_waitcnt lgkmcnt(9)
    v_pk_add_f32 v[16:17], v[16:17], v[40:41]
    v_pk_add_f32 v[18:19], v[18:19], v[42:43]
    v_pk_add_f32 v[20:21], v[20:21], v[44:45]
    v_pk_add_f32 v[22:23], v[22:23], v[46:47]
    v_cvt_pk_bf16_f32 v16, v16, v17
    v_cvt_pk_bf16_f32 v17, v18, v19
    v_cvt_pk_bf16_f32 v18, v20, v21
    v_cvt_pk_bf16_f32 v19, v22, v23
    buffer_store_dwordx4 v[16:19], v244, s[8:11], s86 offen sc1
    v_pk_add_f32 v[48:49], v[48:49], v[72:73]
    v_pk_add_f32 v[50:51], v[50:51], v[74:75]
    s_waitcnt lgkmcnt(0)
    v_pk_add_f32 v[52:53], v[52:53], v[76:77]
    v_pk_add_f32 v[54:55], v[54:55], v[78:79]
    v_cvt_pk_bf16_f32 v48, v48, v49
    v_cvt_pk_bf16_f32 v49, v50, v51
    v_cvt_pk_bf16_f32 v50, v52, v53
    v_cvt_pk_bf16_f32 v51, v54, v55
    buffer_store_dwordx4 v[48:51], v244, s[8:11], s87 offen sc1
    v_pk_add_f32 v[56:57], v[56:57], v[80:81]
    v_pk_add_f32 v[58:59], v[58:59], v[82:83]
    v_pk_add_f32 v[60:61], v[60:61], v[84:85]
    v_pk_add_f32 v[62:63], v[62:63], v[86:87]
    v_cvt_pk_bf16_f32 v56, v56, v57
    v_cvt_pk_bf16_f32 v57, v58, v59
    v_cvt_pk_bf16_f32 v58, v60, v61
    v_cvt_pk_bf16_f32 v59, v62, v63
    buffer_store_dwordx4 v[56:59], v244, s[8:11], s88 offen sc1
    v_pk_add_f32 v[64:65], v[64:65], v[88:89]
    v_pk_add_f32 v[66:67], v[66:67], v[90:91]
    v_pk_add_f32 v[68:69], v[68:69], v[92:93]
    v_pk_add_f32 v[70:71], v[70:71], v[94:95]
    v_cvt_pk_bf16_f32 v64, v64, v65
    v_cvt_pk_bf16_f32 v65, v66, v67
    v_cvt_pk_bf16_f32 v66, v68, v69
    v_cvt_pk_bf16_f32 v67, v70, v71
    buffer_store_dwordx4 v[64:67], v244, s[8:11], s89 offen sc1
    v_pk_add_f32 v[96:97], v[96:97], v[120:121]
    v_pk_add_f32 v[98:99], v[98:99], v[122:123]
    v_pk_add_f32 v[100:101], v[100:101], v[124:125]
    v_pk_add_f32 v[102:103], v[102:103], v[126:127]
    v_cvt_pk_bf16_f32 v96, v96, v97
    v_cvt_pk_bf16_f32 v97, v98, v99
    v_cvt_pk_bf16_f32 v98, v100, v101
    v_cvt_pk_bf16_f32 v99, v102, v103
    buffer_store_dwordx4 v[96:99], v244, s[8:11], s90 offen sc1
    v_pk_add_f32 v[104:105], v[104:105], v[128:129]
    v_pk_add_f32 v[106:107], v[106:107], v[130:131]
    v_pk_add_f32 v[108:109], v[108:109], v[132:133]
    v_pk_add_f32 v[110:111], v[110:111], v[134:135]
    v_cvt_pk_bf16_f32 v104, v104, v105
    v_cvt_pk_bf16_f32 v105, v106, v107
    v_cvt_pk_bf16_f32 v106, v108, v109
    v_cvt_pk_bf16_f32 v107, v110, v111
    buffer_store_dwordx4 v[104:107], v244, s[8:11], s91 offen sc1
L_end:
    s_endpgm
L_slow:
    s_waitcnt vmcnt(0) lgkmcnt(0)
    s_nop 15
    v_lshrrev_b32 v62, 4, v223
    v_and_b32 v63, 15, v62
    v_lshrrev_b32 v62, 4, v62
    v_lshlrev_b32 v60, 8, v63
    v_lshl_add_u32 v60, v62, 4, v60
    v_lshlrev_b32 v61, 10, v62
    v_lshl_add_u32 v61, v63, 1, v61
    s_sub_u32 s58, s36, 262144
    v_mov_b32 v120, 0xff800000
    v_mov_b32 v121, 0xff800000
    v_mov_b32 v122, 0xff800000
    v_mov_b32 v123, 0xff800000
    v_mov_b32 v124, 0xff800000
    v_mov_b32 v125, 0xff800000
    s_mov_b32 s59, s58
    s_mov_b32 s60, 16
L_slow1:
    s_add_u32 s61, s59, 0
    buffer_load_dwordx4 v[228:231], v60, s[8:11], s61 offen
    buffer_load_dwordx4 v[232:235], v60, s[8:11], s61 offen offset:64
    buffer_load_dwordx4 v[236:239], v60, s[8:11], s61 offen offset:128
    buffer_load_dwordx4 v[240:243], v60, s[8:11], s61 offen offset:192
    s_waitcnt vmcnt(0) lgkmcnt(0)
    v_mfma_f32_16x16x32_bf16 v[32:35], v[228:231], v[0:3], 0
    v_mfma_f32_16x16x32_bf16 v[32:35], v[232:235], v[8:11], v[32:35]
    v_mfma_f32_16x16x32_bf16 v[32:35], v[236:239], v[16:19], v[32:35]
    v_mfma_f32_16x16x32_bf16 v[32:35], v[240:243], v[24:27], v[32:35]
    v_mfma_f32_16x16x32_bf16 v[40:43], v[228:231], v[4:7], 0
    v_mfma_f32_16x16x32_bf16 v[40:43], v[232:235], v[12:15], v[40:43]
    v_mfma_f32_16x16x32_bf16 v[40:43], v[236:239], v[20:23], v[40:43]
    v_mfma_f32_16x16x32_bf16 v[40:43], v[240:243], v[28:31], v[40:43]
    v_mfma_f32_16x16x32_bf16 v[96:99], v[228:231], v[64:67], 0
    v_mfma_f32_16x16x32_bf16 v[96:99], v[232:235], v[72:75], v[96:99]
    v_mfma_f32_16x16x32_bf16 v[96:99], v[236:239], v[80:83], v[96:99]
    v_mfma_f32_16x16x32_bf16 v[96:99], v[240:243], v[88:91], v[96:99]
    v_mfma_f32_16x16x32_bf16 v[104:107], v[228:231], v[68:71], 0
    v_mfma_f32_16x16x32_bf16 v[104:107], v[232:235], v[76:79], v[104:107]
    v_mfma_f32_16x16x32_bf16 v[104:107], v[236:239], v[84:87], v[104:107]
    v_mfma_f32_16x16x32_bf16 v[104:107], v[240:243], v[92:95], v[104:107]
    v_mfma_f32_16x16x32_bf16 v[160:163], v[228:231], v[128:131], 0
    v_mfma_f32_16x16x32_bf16 v[160:163], v[232:235], v[136:139], v[160:163]
    v_mfma_f32_16x16x32_bf16 v[160:163], v[236:239], v[144:147], v[160:163]
    v_mfma_f32_16x16x32_bf16 v[160:163], v[240:243], v[152:155], v[160:163]
    v_mfma_f32_16x16x32_bf16 v[168:171], v[228:231], v[132:135], 0
    v_mfma_f32_16x16x32_bf16 v[168:171], v[232:235], v[140:143], v[168:171]
    v_mfma_f32_16x16x32_bf16 v[168:171], v[236:239], v[148:151], v[168:171]
    v_mfma_f32_16x16x32_bf16 v[168:171], v[240:243], v[156:159], v[168:171]
    s_nop 15
    s_add_u32 s61, s59, 4096
    buffer_load_dwordx4 v[228:231], v60, s[8:11], s61 offen
    buffer_load_dwordx4 v[232:235], v60, s[8:11], s61 offen offset:64
    buffer_load_dwordx4 v[236:239], v60, s[8:11], s61 offen offset:128
    buffer_load_dwordx4 v[240:243], v60, s[8:11], s61 offen offset:192
    s_waitcnt vmcnt(0) lgkmcnt(0)
    v_mfma_f32_16x16x32_bf16 v[36:39], v[228:231], v[0:3], 0
    v_mfma_f32_16x16x32_bf16 v[36:39], v[232:235], v[8:11], v[36:39]
    v_mfma_f32_16x16x32_bf16 v[36:39], v[236:239], v[16:19], v[36:39]
    v_mfma_f32_16x16x32_bf16 v[36:39], v[240:243], v[24:27], v[36:39]
    v_mfma_f32_16x16x32_bf16 v[44:47], v[228:231], v[4:7], 0
    v_mfma_f32_16x16x32_bf16 v[44:47], v[232:235], v[12:15], v[44:47]
    v_mfma_f32_16x16x32_bf16 v[44:47], v[236:239], v[20:23], v[44:47]
    v_mfma_f32_16x16x32_bf16 v[44:47], v[240:243], v[28:31], v[44:47]
    v_mfma_f32_16x16x32_bf16 v[100:103], v[228:231], v[64:67], 0
    v_mfma_f32_16x16x32_bf16 v[100:103], v[232:235], v[72:75], v[100:103]
    v_mfma_f32_16x16x32_bf16 v[100:103], v[236:239], v[80:83], v[100:103]
    v_mfma_f32_16x16x32_bf16 v[100:103], v[240:243], v[88:91], v[100:103]
    v_mfma_f32_16x16x32_bf16 v[108:111], v[228:231], v[68:71], 0
    v_mfma_f32_16x16x32_bf16 v[108:111], v[232:235], v[76:79], v[108:111]
    v_mfma_f32_16x16x32_bf16 v[108:111], v[236:239], v[84:87], v[108:111]
    v_mfma_f32_16x16x32_bf16 v[108:111], v[240:243], v[92:95], v[108:111]
    v_mfma_f32_16x16x32_bf16 v[164:167], v[228:231], v[128:131], 0
    v_mfma_f32_16x16x32_bf16 v[164:167], v[232:235], v[136:139], v[164:167]
    v_mfma_f32_16x16x32_bf16 v[164:167], v[236:239], v[144:147], v[164:167]
    v_mfma_f32_16x16x32_bf16 v[164:167], v[240:243], v[152:155], v[164:167]
    v_mfma_f32_16x16x32_bf16 v[172:175], v[228:231], v[132:135], 0
    v_mfma_f32_16x16x32_bf16 v[172:175], v[232:235], v[140:143], v[172:175]
    v_mfma_f32_16x16x32_bf16 v[172:175], v[236:239], v[148:151], v[172:175]
    v_mfma_f32_16x16x32_bf16 v[172:175], v[240:243], v[156:159], v[172:175]
    s_nop 15
    v_max3_f32 v120, v120, v32, v33
    v_max3_f32 v120, v120, v34, v35
    v_max3_f32 v120, v120, v36, v37
    v_max3_f32 v120, v120, v38, v39
    v_max3_f32 v121, v121, v40, v41
    v_max3_f32 v121, v121, v42, v43
    v_max3_f32 v121, v121, v44, v45
    v_max3_f32 v121, v121, v46, v47
    v_max3_f32 v122, v122, v96, v97
    v_max3_f32 v122, v122, v98, v99
    v_max3_f32 v122, v122, v100, v101
    v_max3_f32 v122, v122, v102, v103
    v_max3_f32 v123, v123, v104, v105
    v_max3_f32 v123, v123, v106, v107
    v_max3_f32 v123, v123, v108, v109
    v_max3_f32 v123, v123, v110, v111
    v_max3_f32 v124, v124, v160, v161
    v_max3_f32 v124, v124, v162, v163
    v_max3_f32 v124, v124, v164, v165
    v_max3_f32 v124, v124, v166, v167
    v_max3_f32 v125, v125, v168, v169
    v_max3_f32 v125, v125, v170, v171
    v_max3_f32 v125, v125, v172, v173
    v_max3_f32 v125, v125, v174, v175
    s_add_u32 s59, s59, 8192
    s_sub_u32 s60, s60, 1
    s_cmp_lg_u32 s60, 0
    s_cbranch_scc1 L_slow1
    v_mov_b32 v62, v120
    s_nop 1
    v_permlane32_swap_b32 v62, v120
    v_max_f32 v120, v120, v62
    v_mov_b32 v62, v120
    s_nop 1
    v_permlane16_swap_b32 v62, v120
    v_max_f32 v120, v120, v62
    v_mov_b32 v48, 0
    v_mov_b32 v49, 0
    v_mov_b32 v50, 0
    v_mov_b32 v51, 0
    v_mov_b32 v62, v121
    s_nop 1
    v_permlane32_swap_b32 v62, v121
    v_max_f32 v121, v121, v62
    v_mov_b32 v62, v121
    s_nop 1
    v_permlane16_swap_b32 v62, v121
    v_max_f32 v121, v121, v62
    v_mov_b32 v52, 0
    v_mov_b32 v53, 0
    v_mov_b32 v54, 0
    v_mov_b32 v55, 0
    v_mov_b32 v62, v122
    s_nop 1
    v_permlane32_swap_b32 v62, v122
    v_max_f32 v122, v122, v62
    v_mov_b32 v62, v122
    s_nop 1
    v_permlane16_swap_b32 v62, v122
    v_max_f32 v122, v122, v62
    v_mov_b32 v112, 0
    v_mov_b32 v113, 0
    v_mov_b32 v114, 0
    v_mov_b32 v115, 0
    v_mov_b32 v62, v123
    s_nop 1
    v_permlane32_swap_b32 v62, v123
    v_max_f32 v123, v123, v62
    v_mov_b32 v62, v123
    s_nop 1
    v_permlane16_swap_b32 v62, v123
    v_max_f32 v123, v123, v62
    v_mov_b32 v116, 0
    v_mov_b32 v117, 0
    v_mov_b32 v118, 0
    v_mov_b32 v119, 0
    v_mov_b32 v62, v124
    s_nop 1
    v_permlane32_swap_b32 v62, v124
    v_max_f32 v124, v124, v62
    v_mov_b32 v62, v124
    s_nop 1
    v_permlane16_swap_b32 v62, v124
    v_max_f32 v124, v124, v62
    v_mov_b32 v176, 0
    v_mov_b32 v177, 0
    v_mov_b32 v178, 0
    v_mov_b32 v179, 0
    v_mov_b32 v62, v125
    s_nop 1
    v_permlane32_swap_b32 v62, v125
    v_max_f32 v125, v125, v62
    v_mov_b32 v62, v125
    s_nop 1
    v_permlane16_swap_b32 v62, v125
    v_max_f32 v125, v125, v62
    v_mov_b32 v180, 0
    v_mov_b32 v181, 0
    v_mov_b32 v182, 0
    v_mov_b32 v183, 0
    v_accvgpr_write_b32 a0, 0
    v_accvgpr_write_b32 a1, 0
    v_accvgpr_write_b32 a2, 0
    v_accvgpr_write_b32 a3, 0
    v_accvgpr_write_b32 a4, 0
    v_accvgpr_write_b32 a5, 0
    v_accvgpr_write_b32 a6, 0
    v_accvgpr_write_b32 a7, 0
    v_accvgpr_write_b32 a8, 0
    v_accvgpr_write_b32 a9, 0
    v_accvgpr_write_b32 a10, 0
    v_accvgpr_write_b32 a11, 0
    v_accvgpr_write_b32 a12, 0
    v_accvgpr_write_b32 a13, 0
    v_accvgpr_write_b32 a14, 0
    v_accvgpr_write_b32 a15, 0
    v_accvgpr_write_b32 a16, 0
    v_accvgpr_write_b32 a17, 0
    v_accvgpr_write_b32 a18, 0
    v_accvgpr_write_b32 a19, 0
    v_accvgpr_write_b32 a20, 0
    v_accvgpr_write_b32 a21, 0
    v_accvgpr_write_b32 a22, 0
    v_accvgpr_write_b32 a23, 0
    v_accvgpr_write_b32 a24, 0
    v_accvgpr_write_b32 a25, 0
    v_accvgpr_write_b32 a26, 0
    v_accvgpr_write_b32 a27, 0
    v_accvgpr_write_b32 a28, 0
    v_accvgpr_write_b32 a29, 0
    v_accvgpr_write_b32 a30, 0
    v_accvgpr_write_b32 a31, 0
    v_accvgpr_write_b32 a32, 0
    v_accvgpr_write_b32 a33, 0
    v_accvgpr_write_b32 a34, 0
    v_accvgpr_write_b32 a35, 0
    v_accvgpr_write_b32 a36, 0
    v_accvgpr_write_b32 a37, 0
    v_accvgpr_write_b32 a38, 0
    v_accvgpr_write_b32 a39, 0
    v_accvgpr_write_b32 a40, 0
    v_accvgpr_write_b32 a41, 0
    v_accvgpr_write_b32 a42, 0
    v_accvgpr_write_b32 a43, 0
    v_accvgpr_write_b32 a44, 0
    v_accvgpr_write_b32 a45, 0
    v_accvgpr_write_b32 a46, 0
    v_accvgpr_write_b32 a47, 0
    v_accvgpr_write_b32 a48, 0
    v_accvgpr_write_b32 a49, 0
    v_accvgpr_write_b32 a50, 0
    v_accvgpr_write_b32 a51, 0
    v_accvgpr_write_b32 a52, 0
    v_accvgpr_write_b32 a53, 0
    v_accvgpr_write_b32 a54, 0
    v_accvgpr_write_b32 a55, 0
    v_accvgpr_write_b32 a56, 0
    v_accvgpr_write_b32 a57, 0
    v_accvgpr_write_b32 a58, 0
    v_accvgpr_write_b32 a59, 0
    v_accvgpr_write_b32 a60, 0
    v_accvgpr_write_b32 a61, 0
    v_accvgpr_write_b32 a62, 0
    v_accvgpr_write_b32 a63, 0
    v_accvgpr_write_b32 a64, 0
    v_accvgpr_write_b32 a65, 0
    v_accvgpr_write_b32 a66, 0
    v_accvgpr_write_b32 a67, 0
    v_accvgpr_write_b32 a68, 0
    v_accvgpr_write_b32 a69, 0
    v_accvgpr_write_b32 a70, 0
    v_accvgpr_write_b32 a71, 0
    v_accvgpr_write_b32 a72, 0
    v_accvgpr_write_b32 a73, 0
    v_accvgpr_write_b32 a74, 0
    v_accvgpr_write_b32 a75, 0
    v_accvgpr_write_b32 a76, 0
    v_accvgpr_write_b32 a77, 0
    v_accvgpr_write_b32 a78, 0
    v_accvgpr_write_b32 a79, 0
    v_accvgpr_write_b32 a80, 0
    v_accvgpr_write_b32 a81, 0
    v_accvgpr_write_b32 a82, 0
    v_accvgpr_write_b32 a83, 0
    v_accvgpr_write_b32 a84, 0
    v_accvgpr_write_b32 a85, 0
    v_accvgpr_write_b32 a86, 0
    v_accvgpr_write_b32 a87, 0
    v_accvgpr_write_b32 a88, 0
    v_accvgpr_write_b32 a89, 0
    v_accvgpr_write_b32 a90, 0
    v_accvgpr_write_b32 a91, 0
    v_accvgpr_write_b32 a92, 0
    v_accvgpr_write_b32 a93, 0
    v_accvgpr_write_b32 a94, 0
    v_accvgpr_write_b32 a95, 0
    v_accvgpr_write_b32 a96, 0
    v_accvgpr_write_b32 a97, 0
    v_accvgpr_write_b32 a98, 0
    v_accvgpr_write_b32 a99, 0
    v_accvgpr_write_b32 a100, 0
    v_accvgpr_write_b32 a101, 0
    v_accvgpr_write_b32 a102, 0
    v_accvgpr_write_b32 a103, 0
    v_accvgpr_write_b32 a104, 0
    v_accvgpr_write_b32 a105, 0
    v_accvgpr_write_b32 a106, 0
    v_accvgpr_write_b32 a107, 0
    v_accvgpr_write_b32 a108, 0
    v_accvgpr_write_b32 a109, 0
    v_accvgpr_write_b32 a110, 0
    v_accvgpr_write_b32 a111, 0
    v_accvgpr_write_b32 a112, 0
    v_accvgpr_write_b32 a113, 0
    v_accvgpr_write_b32 a114, 0
    v_accvgpr_write_b32 a115, 0
    v_accvgpr_write_b32 a116, 0
    v_accvgpr_write_b32 a117, 0
    v_accvgpr_write_b32 a118, 0
    v_accvgpr_write_b32 a119, 0
    v_accvgpr_write_b32 a120, 0
    v_accvgpr_write_b32 a121, 0
    v_accvgpr_write_b32 a122, 0
    v_accvgpr_write_b32 a123, 0
    v_accvgpr_write_b32 a124, 0
    v_accvgpr_write_b32 a125, 0
    v_accvgpr_write_b32 a126, 0
    v_accvgpr_write_b32 a127, 0
    v_accvgpr_write_b32 a128, 0
    v_accvgpr_write_b32 a129, 0
    v_accvgpr_write_b32 a130, 0
    v_accvgpr_write_b32 a131, 0
    v_accvgpr_write_b32 a132, 0
    v_accvgpr_write_b32 a133, 0
    v_accvgpr_write_b32 a134, 0
    v_accvgpr_write_b32 a135, 0
    v_accvgpr_write_b32 a136, 0
    v_accvgpr_write_b32 a137, 0
    v_accvgpr_write_b32 a138, 0
    v_accvgpr_write_b32 a139, 0
    v_accvgpr_write_b32 a140, 0
    v_accvgpr_write_b32 a141, 0
    v_accvgpr_write_b32 a142, 0
    v_accvgpr_write_b32 a143, 0
    v_accvgpr_write_b32 a144, 0
    v_accvgpr_write_b32 a145, 0
    v_accvgpr_write_b32 a146, 0
    v_accvgpr_write_b32 a147, 0
    v_accvgpr_write_b32 a148, 0
    v_accvgpr_write_b32 a149, 0
    v_accvgpr_write_b32 a150, 0
    v_accvgpr_write_b32 a151, 0
    v_accvgpr_write_b32 a152, 0
    v_accvgpr_write_b32 a153, 0
    v_accvgpr_write_b32 a154, 0
    v_accvgpr_write_b32 a155, 0
    v_accvgpr_write_b32 a156, 0
    v_accvgpr_write_b32 a157, 0
    v_accvgpr_write_b32 a158, 0
    v_accvgpr_write_b32 a159, 0
    v_accvgpr_write_b32 a160, 0
    v_accvgpr_write_b32 a161, 0
    v_accvgpr_write_b32 a162, 0
    v_accvgpr_write_b32 a163, 0
    v_accvgpr_write_b32 a164, 0
    v_accvgpr_write_b32 a165, 0
    v_accvgpr_write_b32 a166, 0
    v_accvgpr_write_b32 a167, 0
    v_accvgpr_write_b32 a168, 0
    v_accvgpr_write_b32 a169, 0
    v_accvgpr_write_b32 a170, 0
    v_accvgpr_write_b32 a171, 0
    v_accvgpr_write_b32 a172, 0
    v_accvgpr_write_b32 a173, 0
    v_accvgpr_write_b32 a174, 0
    v_accvgpr_write_b32 a175, 0
    v_accvgpr_write_b32 a176, 0
    v_accvgpr_write_b32 a177, 0
    v_accvgpr_write_b32 a178, 0
    v_accvgpr_write_b32 a179, 0
    v_accvgpr_write_b32 a180, 0
    v_accvgpr_write_b32 a181, 0
    v_accvgpr_write_b32 a182, 0
    v_accvgpr_write_b32 a183, 0
    v_accvgpr_write_b32 a184, 0
    v_accvgpr_write_b32 a185, 0
    v_accvgpr_write_b32 a186, 0
    v_accvgpr_write_b32 a187, 0
    v_accvgpr_write_b32 a188, 0
    v_accvgpr_write_b32 a189, 0
    v_accvgpr_write_b32 a190, 0
    v_accvgpr_write_b32 a191, 0
    s_mov_b32 s59, s58
    s_mov_b32 s60, 16
L_slow2:
    s_add_u32 s61, s59, 0
    buffer_load_dwordx4 v[228:231], v60, s[8:11], s61 offen
    buffer_load_dwordx4 v[232:235], v60, s[8:11], s61 offen offset:64
    buffer_load_dwordx4 v[236:239], v60, s[8:11], s61 offen offset:128
    buffer_load_dwordx4 v[240:243], v60, s[8:11], s61 offen offset:192
    s_waitcnt vmcnt(0) lgkmcnt(0)
    v_mfma_f32_16x16x32_bf16 v[32:35], v[228:231], v[0:3], 0
    v_mfma_f32_16x16x32_bf16 v[32:35], v[232:235], v[8:11], v[32:35]
    v_mfma_f32_16x16x32_bf16 v[32:35], v[236:239], v[16:19], v[32:35]
    v_mfma_f32_16x16x32_bf16 v[32:35], v[240:243], v[24:27], v[32:35]
    v_mfma_f32_16x16x32_bf16 v[40:43], v[228:231], v[4:7], 0
    v_mfma_f32_16x16x32_bf16 v[40:43], v[232:235], v[12:15], v[40:43]
    v_mfma_f32_16x16x32_bf16 v[40:43], v[236:239], v[20:23], v[40:43]
    v_mfma_f32_16x16x32_bf16 v[40:43], v[240:243], v[28:31], v[40:43]
    v_mfma_f32_16x16x32_bf16 v[96:99], v[228:231], v[64:67], 0
    v_mfma_f32_16x16x32_bf16 v[96:99], v[232:235], v[72:75], v[96:99]
    v_mfma_f32_16x16x32_bf16 v[96:99], v[236:239], v[80:83], v[96:99]
    v_mfma_f32_16x16x32_bf16 v[96:99], v[240:243], v[88:91], v[96:99]
    v_mfma_f32_16x16x32_bf16 v[104:107], v[228:231], v[68:71], 0
    v_mfma_f32_16x16x32_bf16 v[104:107], v[232:235], v[76:79], v[104:107]
    v_mfma_f32_16x16x32_bf16 v[104:107], v[236:239], v[84:87], v[104:107]
    v_mfma_f32_16x16x32_bf16 v[104:107], v[240:243], v[92:95], v[104:107]
    v_mfma_f32_16x16x32_bf16 v[160:163], v[228:231], v[128:131], 0
    v_mfma_f32_16x16x32_bf16 v[160:163], v[232:235], v[136:139], v[160:163]
    v_mfma_f32_16x16x32_bf16 v[160:163], v[236:239], v[144:147], v[160:163]
    v_mfma_f32_16x16x32_bf16 v[160:163], v[240:243], v[152:155], v[160:163]
    v_mfma_f32_16x16x32_bf16 v[168:171], v[228:231], v[132:135], 0
    v_mfma_f32_16x16x32_bf16 v[168:171], v[232:235], v[140:143], v[168:171]
    v_mfma_f32_16x16x32_bf16 v[168:171], v[236:239], v[148:151], v[168:171]
    v_mfma_f32_16x16x32_bf16 v[168:171], v[240:243], v[156:159], v[168:171]
    s_nop 15
    s_add_u32 s61, s59, 4096
    buffer_load_dwordx4 v[228:231], v60, s[8:11], s61 offen
    buffer_load_dwordx4 v[232:235], v60, s[8:11], s61 offen offset:64
    buffer_load_dwordx4 v[236:239], v60, s[8:11], s61 offen offset:128
    buffer_load_dwordx4 v[240:243], v60, s[8:11], s61 offen offset:192
    s_waitcnt vmcnt(0) lgkmcnt(0)
    v_mfma_f32_16x16x32_bf16 v[36:39], v[228:231], v[0:3], 0
    v_mfma_f32_16x16x32_bf16 v[36:39], v[232:235], v[8:11], v[36:39]
    v_mfma_f32_16x16x32_bf16 v[36:39], v[236:239], v[16:19], v[36:39]
    v_mfma_f32_16x16x32_bf16 v[36:39], v[240:243], v[24:27], v[36:39]
    v_mfma_f32_16x16x32_bf16 v[44:47], v[228:231], v[4:7], 0
    v_mfma_f32_16x16x32_bf16 v[44:47], v[232:235], v[12:15], v[44:47]
    v_mfma_f32_16x16x32_bf16 v[44:47], v[236:239], v[20:23], v[44:47]
    v_mfma_f32_16x16x32_bf16 v[44:47], v[240:243], v[28:31], v[44:47]
    v_mfma_f32_16x16x32_bf16 v[100:103], v[228:231], v[64:67], 0
    v_mfma_f32_16x16x32_bf16 v[100:103], v[232:235], v[72:75], v[100:103]
    v_mfma_f32_16x16x32_bf16 v[100:103], v[236:239], v[80:83], v[100:103]
    v_mfma_f32_16x16x32_bf16 v[100:103], v[240:243], v[88:91], v[100:103]
    v_mfma_f32_16x16x32_bf16 v[108:111], v[228:231], v[68:71], 0
    v_mfma_f32_16x16x32_bf16 v[108:111], v[232:235], v[76:79], v[108:111]
    v_mfma_f32_16x16x32_bf16 v[108:111], v[236:239], v[84:87], v[108:111]
    v_mfma_f32_16x16x32_bf16 v[108:111], v[240:243], v[92:95], v[108:111]
    v_mfma_f32_16x16x32_bf16 v[164:167], v[228:231], v[128:131], 0
    v_mfma_f32_16x16x32_bf16 v[164:167], v[232:235], v[136:139], v[164:167]
    v_mfma_f32_16x16x32_bf16 v[164:167], v[236:239], v[144:147], v[164:167]
    v_mfma_f32_16x16x32_bf16 v[164:167], v[240:243], v[152:155], v[164:167]
    v_mfma_f32_16x16x32_bf16 v[172:175], v[228:231], v[132:135], 0
    v_mfma_f32_16x16x32_bf16 v[172:175], v[232:235], v[140:143], v[172:175]
    v_mfma_f32_16x16x32_bf16 v[172:175], v[236:239], v[148:151], v[172:175]
    v_mfma_f32_16x16x32_bf16 v[172:175], v[240:243], v[156:159], v[172:175]
    s_nop 15
    v_sub_f32 v32, v32, v120
    v_sub_f32 v33, v33, v120
    v_sub_f32 v34, v34, v120
    v_sub_f32 v35, v35, v120
    v_sub_f32 v36, v36, v120
    v_sub_f32 v37, v37, v120
    v_sub_f32 v38, v38, v120
    v_sub_f32 v39, v39, v120
    v_mul_f32 v32, s45, v32
    v_mul_f32 v33, s45, v33
    v_mul_f32 v34, s45, v34
    v_mul_f32 v35, s45, v35
    v_mul_f32 v36, s45, v36
    v_mul_f32 v37, s45, v37
    v_mul_f32 v38, s45, v38
    v_mul_f32 v39, s45, v39
    v_exp_f32 v32, v32
    v_exp_f32 v33, v33
    v_exp_f32 v34, v34
    v_exp_f32 v35, v35
    v_exp_f32 v36, v36
    v_exp_f32 v37, v37
    v_exp_f32 v38, v38
    v_exp_f32 v39, v39
    v_cvt_pk_bf16_f32 v32, v32, v33
    v_cvt_pk_bf16_f32 v33, v34, v35
    v_cvt_pk_bf16_f32 v34, v36, v37
    v_cvt_pk_bf16_f32 v35, v38, v39
    v_sub_f32 v40, v40, v121
    v_sub_f32 v41, v41, v121
    v_sub_f32 v42, v42, v121
    v_sub_f32 v43, v43, v121
    v_sub_f32 v44, v44, v121
    v_sub_f32 v45, v45, v121
    v_sub_f32 v46, v46, v121
    v_sub_f32 v47, v47, v121
    v_mul_f32 v40, s45, v40
    v_mul_f32 v41, s45, v41
    v_mul_f32 v42, s45, v42
    v_mul_f32 v43, s45, v43
    v_mul_f32 v44, s45, v44
    v_mul_f32 v45, s45, v45
    v_mul_f32 v46, s45, v46
    v_mul_f32 v47, s45, v47
    v_exp_f32 v40, v40
    v_exp_f32 v41, v41
    v_exp_f32 v42, v42
    v_exp_f32 v43, v43
    v_exp_f32 v44, v44
    v_exp_f32 v45, v45
    v_exp_f32 v46, v46
    v_exp_f32 v47, v47
    v_cvt_pk_bf16_f32 v40, v40, v41
    v_cvt_pk_bf16_f32 v41, v42, v43
    v_cvt_pk_bf16_f32 v42, v44, v45
    v_cvt_pk_bf16_f32 v43, v46, v47
    v_sub_f32 v96, v96, v122
    v_sub_f32 v97, v97, v122
    v_sub_f32 v98, v98, v122
    v_sub_f32 v99, v99, v122
    v_sub_f32 v100, v100, v122
    v_sub_f32 v101, v101, v122
    v_sub_f32 v102, v102, v122
    v_sub_f32 v103, v103, v122
    v_mul_f32 v96, s45, v96
    v_mul_f32 v97, s45, v97
    v_mul_f32 v98, s45, v98
    v_mul_f32 v99, s45, v99
    v_mul_f32 v100, s45, v100
    v_mul_f32 v101, s45, v101
    v_mul_f32 v102, s45, v102
    v_mul_f32 v103, s45, v103
    v_exp_f32 v96, v96
    v_exp_f32 v97, v97
    v_exp_f32 v98, v98
    v_exp_f32 v99, v99
    v_exp_f32 v100, v100
    v_exp_f32 v101, v101
    v_exp_f32 v102, v102
    v_exp_f32 v103, v103
    v_cvt_pk_bf16_f32 v96, v96, v97
    v_cvt_pk_bf16_f32 v97, v98, v99
    v_cvt_pk_bf16_f32 v98, v100, v101
    v_cvt_pk_bf16_f32 v99, v102, v103
    v_sub_f32 v104, v104, v123
    v_sub_f32 v105, v105, v123
    v_sub_f32 v106, v106, v123
    v_sub_f32 v107, v107, v123
    v_sub_f32 v108, v108, v123
    v_sub_f32 v109, v109, v123
    v_sub_f32 v110, v110, v123
    v_sub_f32 v111, v111, v123
    v_mul_f32 v104, s45, v104
    v_mul_f32 v105, s45, v105
    v_mul_f32 v106, s45, v106
    v_mul_f32 v107, s45, v107
    v_mul_f32 v108, s45, v108
    v_mul_f32 v109, s45, v109
    v_mul_f32 v110, s45, v110
    v_mul_f32 v111, s45, v111
    v_exp_f32 v104, v104
    v_exp_f32 v105, v105
    v_exp_f32 v106, v106
    v_exp_f32 v107, v107
    v_exp_f32 v108, v108
    v_exp_f32 v109, v109
    v_exp_f32 v110, v110
    v_exp_f32 v111, v111
    v_cvt_pk_bf16_f32 v104, v104, v105
    v_cvt_pk_bf16_f32 v105, v106, v107
    v_cvt_pk_bf16_f32 v106, v108, v109
    v_cvt_pk_bf16_f32 v107, v110, v111
    v_sub_f32 v160, v160, v124
    v_sub_f32 v161, v161, v124
    v_sub_f32 v162, v162, v124
    v_sub_f32 v163, v163, v124
    v_sub_f32 v164, v164, v124
    v_sub_f32 v165, v165, v124
    v_sub_f32 v166, v166, v124
    v_sub_f32 v167, v167, v124
    v_mul_f32 v160, s45, v160
    v_mul_f32 v161, s45, v161
    v_mul_f32 v162, s45, v162
    v_mul_f32 v163, s45, v163
    v_mul_f32 v164, s45, v164
    v_mul_f32 v165, s45, v165
    v_mul_f32 v166, s45, v166
    v_mul_f32 v167, s45, v167
    v_exp_f32 v160, v160
    v_exp_f32 v161, v161
    v_exp_f32 v162, v162
    v_exp_f32 v163, v163
    v_exp_f32 v164, v164
    v_exp_f32 v165, v165
    v_exp_f32 v166, v166
    v_exp_f32 v167, v167
    v_cvt_pk_bf16_f32 v160, v160, v161
    v_cvt_pk_bf16_f32 v161, v162, v163
    v_cvt_pk_bf16_f32 v162, v164, v165
    v_cvt_pk_bf16_f32 v163, v166, v167
    v_sub_f32 v168, v168, v125
    v_sub_f32 v169, v169, v125
    v_sub_f32 v170, v170, v125
    v_sub_f32 v171, v171, v125
    v_sub_f32 v172, v172, v125
    v_sub_f32 v173, v173, v125
    v_sub_f32 v174, v174, v125
    v_sub_f32 v175, v175, v125
    v_mul_f32 v168, s45, v168
    v_mul_f32 v169, s45, v169
    v_mul_f32 v170, s45, v170
    v_mul_f32 v171, s45, v171
    v_mul_f32 v172, s45, v172
    v_mul_f32 v173, s45, v173
    v_mul_f32 v174, s45, v174
    v_mul_f32 v175, s45, v175
    v_exp_f32 v168, v168
    v_exp_f32 v169, v169
    v_exp_f32 v170, v170
    v_exp_f32 v171, v171
    v_exp_f32 v172, v172
    v_exp_f32 v173, v173
    v_exp_f32 v174, v174
    v_exp_f32 v175, v175
    v_cvt_pk_bf16_f32 v168, v168, v169
    v_cvt_pk_bf16_f32 v169, v170, v171
    v_cvt_pk_bf16_f32 v170, v172, v173
    v_cvt_pk_bf16_f32 v171, v174, v175
    s_add_u32 s57, s59, 4096
    buffer_load_ushort v184, v61, s[12:15], s59 offen
    buffer_load_ushort v185, v61, s[12:15], s59 offen offset:256
    buffer_load_ushort v186, v61, s[12:15], s59 offen offset:512
    buffer_load_ushort v187, v61, s[12:15], s59 offen offset:768
    buffer_load_ushort v188, v61, s[12:15], s57 offen
    buffer_load_ushort v189, v61, s[12:15], s57 offen offset:256
    buffer_load_ushort v190, v61, s[12:15], s57 offen offset:512
    buffer_load_ushort v191, v61, s[12:15], s57 offen offset:768
    s_waitcnt vmcnt(0) lgkmcnt(0)
    v_lshl_or_b32 v56, v185, 16, v184
    v_lshl_or_b32 v57, v187, 16, v186
    v_lshl_or_b32 v58, v189, 16, v188
    v_lshl_or_b32 v59, v191, 16, v190
    s_nop 1
    v_mfma_f32_16x16x32_bf16 a[0:3], v[56:59], v[32:35], a[0:3]
    v_mfma_f32_16x16x32_bf16 a[32:35], v[56:59], v[40:43], a[32:35]
    v_mfma_f32_16x16x32_bf16 a[64:67], v[56:59], v[96:99], a[64:67]
    v_mfma_f32_16x16x32_bf16 a[96:99], v[56:59], v[104:107], a[96:99]
    v_mfma_f32_16x16x32_bf16 a[128:131], v[56:59], v[160:163], a[128:131]
    v_mfma_f32_16x16x32_bf16 a[160:163], v[56:59], v[168:171], a[160:163]
    s_nop 7
    buffer_load_ushort v184, v61, s[12:15], s59 offen offset:32
    buffer_load_ushort v185, v61, s[12:15], s59 offen offset:288
    buffer_load_ushort v186, v61, s[12:15], s59 offen offset:544
    buffer_load_ushort v187, v61, s[12:15], s59 offen offset:800
    buffer_load_ushort v188, v61, s[12:15], s57 offen offset:32
    buffer_load_ushort v189, v61, s[12:15], s57 offen offset:288
    buffer_load_ushort v190, v61, s[12:15], s57 offen offset:544
    buffer_load_ushort v191, v61, s[12:15], s57 offen offset:800
    s_waitcnt vmcnt(0) lgkmcnt(0)
    v_lshl_or_b32 v56, v185, 16, v184
    v_lshl_or_b32 v57, v187, 16, v186
    v_lshl_or_b32 v58, v189, 16, v188
    v_lshl_or_b32 v59, v191, 16, v190
    s_nop 1
    v_mfma_f32_16x16x32_bf16 a[4:7], v[56:59], v[32:35], a[4:7]
    v_mfma_f32_16x16x32_bf16 a[36:39], v[56:59], v[40:43], a[36:39]
    v_mfma_f32_16x16x32_bf16 a[68:71], v[56:59], v[96:99], a[68:71]
    v_mfma_f32_16x16x32_bf16 a[100:103], v[56:59], v[104:107], a[100:103]
    v_mfma_f32_16x16x32_bf16 a[132:135], v[56:59], v[160:163], a[132:135]
    v_mfma_f32_16x16x32_bf16 a[164:167], v[56:59], v[168:171], a[164:167]
    s_nop 7
    buffer_load_ushort v184, v61, s[12:15], s59 offen offset:64
    buffer_load_ushort v185, v61, s[12:15], s59 offen offset:320
    buffer_load_ushort v186, v61, s[12:15], s59 offen offset:576
    buffer_load_ushort v187, v61, s[12:15], s59 offen offset:832
    buffer_load_ushort v188, v61, s[12:15], s57 offen offset:64
    buffer_load_ushort v189, v61, s[12:15], s57 offen offset:320
    buffer_load_ushort v190, v61, s[12:15], s57 offen offset:576
    buffer_load_ushort v191, v61, s[12:15], s57 offen offset:832
    s_waitcnt vmcnt(0) lgkmcnt(0)
    v_lshl_or_b32 v56, v185, 16, v184
    v_lshl_or_b32 v57, v187, 16, v186
    v_lshl_or_b32 v58, v189, 16, v188
    v_lshl_or_b32 v59, v191, 16, v190
    s_nop 1
    v_mfma_f32_16x16x32_bf16 a[8:11], v[56:59], v[32:35], a[8:11]
    v_mfma_f32_16x16x32_bf16 a[40:43], v[56:59], v[40:43], a[40:43]
    v_mfma_f32_16x16x32_bf16 a[72:75], v[56:59], v[96:99], a[72:75]
    v_mfma_f32_16x16x32_bf16 a[104:107], v[56:59], v[104:107], a[104:107]
    v_mfma_f32_16x16x32_bf16 a[136:139], v[56:59], v[160:163], a[136:139]
    v_mfma_f32_16x16x32_bf16 a[168:171], v[56:59], v[168:171], a[168:171]
    s_nop 7
    buffer_load_ushort v184, v61, s[12:15], s59 offen offset:96
    buffer_load_ushort v185, v61, s[12:15], s59 offen offset:352
    buffer_load_ushort v186, v61, s[12:15], s59 offen offset:608
    buffer_load_ushort v187, v61, s[12:15], s59 offen offset:864
    buffer_load_ushort v188, v61, s[12:15], s57 offen offset:96
    buffer_load_ushort v189, v61, s[12:15], s57 offen offset:352
    buffer_load_ushort v190, v61, s[12:15], s57 offen offset:608
    buffer_load_ushort v191, v61, s[12:15], s57 offen offset:864
    s_waitcnt vmcnt(0) lgkmcnt(0)
    v_lshl_or_b32 v56, v185, 16, v184
    v_lshl_or_b32 v57, v187, 16, v186
    v_lshl_or_b32 v58, v189, 16, v188
    v_lshl_or_b32 v59, v191, 16, v190
    s_nop 1
    v_mfma_f32_16x16x32_bf16 a[12:15], v[56:59], v[32:35], a[12:15]
    v_mfma_f32_16x16x32_bf16 a[44:47], v[56:59], v[40:43], a[44:47]
    v_mfma_f32_16x16x32_bf16 a[76:79], v[56:59], v[96:99], a[76:79]
    v_mfma_f32_16x16x32_bf16 a[108:111], v[56:59], v[104:107], a[108:111]
    v_mfma_f32_16x16x32_bf16 a[140:143], v[56:59], v[160:163], a[140:143]
    v_mfma_f32_16x16x32_bf16 a[172:175], v[56:59], v[168:171], a[172:175]
    s_nop 7
    buffer_load_ushort v184, v61, s[12:15], s59 offen offset:128
    buffer_load_ushort v185, v61, s[12:15], s59 offen offset:384
    buffer_load_ushort v186, v61, s[12:15], s59 offen offset:640
    buffer_load_ushort v187, v61, s[12:15], s59 offen offset:896
    buffer_load_ushort v188, v61, s[12:15], s57 offen offset:128
    buffer_load_ushort v189, v61, s[12:15], s57 offen offset:384
    buffer_load_ushort v190, v61, s[12:15], s57 offen offset:640
    buffer_load_ushort v191, v61, s[12:15], s57 offen offset:896
    s_waitcnt vmcnt(0) lgkmcnt(0)
    v_lshl_or_b32 v56, v185, 16, v184
    v_lshl_or_b32 v57, v187, 16, v186
    v_lshl_or_b32 v58, v189, 16, v188
    v_lshl_or_b32 v59, v191, 16, v190
    s_nop 1
    v_mfma_f32_16x16x32_bf16 a[16:19], v[56:59], v[32:35], a[16:19]
    v_mfma_f32_16x16x32_bf16 a[48:51], v[56:59], v[40:43], a[48:51]
    v_mfma_f32_16x16x32_bf16 a[80:83], v[56:59], v[96:99], a[80:83]
    v_mfma_f32_16x16x32_bf16 a[112:115], v[56:59], v[104:107], a[112:115]
    v_mfma_f32_16x16x32_bf16 a[144:147], v[56:59], v[160:163], a[144:147]
    v_mfma_f32_16x16x32_bf16 a[176:179], v[56:59], v[168:171], a[176:179]
    s_nop 7
    buffer_load_ushort v184, v61, s[12:15], s59 offen offset:160
    buffer_load_ushort v185, v61, s[12:15], s59 offen offset:416
    buffer_load_ushort v186, v61, s[12:15], s59 offen offset:672
    buffer_load_ushort v187, v61, s[12:15], s59 offen offset:928
    buffer_load_ushort v188, v61, s[12:15], s57 offen offset:160
    buffer_load_ushort v189, v61, s[12:15], s57 offen offset:416
    buffer_load_ushort v190, v61, s[12:15], s57 offen offset:672
    buffer_load_ushort v191, v61, s[12:15], s57 offen offset:928
    s_waitcnt vmcnt(0) lgkmcnt(0)
    v_lshl_or_b32 v56, v185, 16, v184
    v_lshl_or_b32 v57, v187, 16, v186
    v_lshl_or_b32 v58, v189, 16, v188
    v_lshl_or_b32 v59, v191, 16, v190
    s_nop 1
    v_mfma_f32_16x16x32_bf16 a[20:23], v[56:59], v[32:35], a[20:23]
    v_mfma_f32_16x16x32_bf16 a[52:55], v[56:59], v[40:43], a[52:55]
    v_mfma_f32_16x16x32_bf16 a[84:87], v[56:59], v[96:99], a[84:87]
    v_mfma_f32_16x16x32_bf16 a[116:119], v[56:59], v[104:107], a[116:119]
    v_mfma_f32_16x16x32_bf16 a[148:151], v[56:59], v[160:163], a[148:151]
    v_mfma_f32_16x16x32_bf16 a[180:183], v[56:59], v[168:171], a[180:183]
    s_nop 7
    buffer_load_ushort v184, v61, s[12:15], s59 offen offset:192
    buffer_load_ushort v185, v61, s[12:15], s59 offen offset:448
    buffer_load_ushort v186, v61, s[12:15], s59 offen offset:704
    buffer_load_ushort v187, v61, s[12:15], s59 offen offset:960
    buffer_load_ushort v188, v61, s[12:15], s57 offen offset:192
    buffer_load_ushort v189, v61, s[12:15], s57 offen offset:448
    buffer_load_ushort v190, v61, s[12:15], s57 offen offset:704
    buffer_load_ushort v191, v61, s[12:15], s57 offen offset:960
    s_waitcnt vmcnt(0) lgkmcnt(0)
    v_lshl_or_b32 v56, v185, 16, v184
    v_lshl_or_b32 v57, v187, 16, v186
    v_lshl_or_b32 v58, v189, 16, v188
    v_lshl_or_b32 v59, v191, 16, v190
    s_nop 1
    v_mfma_f32_16x16x32_bf16 a[24:27], v[56:59], v[32:35], a[24:27]
    v_mfma_f32_16x16x32_bf16 a[56:59], v[56:59], v[40:43], a[56:59]
    v_mfma_f32_16x16x32_bf16 a[88:91], v[56:59], v[96:99], a[88:91]
    v_mfma_f32_16x16x32_bf16 a[120:123], v[56:59], v[104:107], a[120:123]
    v_mfma_f32_16x16x32_bf16 a[152:155], v[56:59], v[160:163], a[152:155]
    v_mfma_f32_16x16x32_bf16 a[184:187], v[56:59], v[168:171], a[184:187]
    s_nop 7
    buffer_load_ushort v184, v61, s[12:15], s59 offen offset:224
    buffer_load_ushort v185, v61, s[12:15], s59 offen offset:480
    buffer_load_ushort v186, v61, s[12:15], s59 offen offset:736
    buffer_load_ushort v187, v61, s[12:15], s59 offen offset:992
    buffer_load_ushort v188, v61, s[12:15], s57 offen offset:224
    buffer_load_ushort v189, v61, s[12:15], s57 offen offset:480
    buffer_load_ushort v190, v61, s[12:15], s57 offen offset:736
    buffer_load_ushort v191, v61, s[12:15], s57 offen offset:992
    s_waitcnt vmcnt(0) lgkmcnt(0)
    v_lshl_or_b32 v56, v185, 16, v184
    v_lshl_or_b32 v57, v187, 16, v186
    v_lshl_or_b32 v58, v189, 16, v188
    v_lshl_or_b32 v59, v191, 16, v190
    s_nop 1
    v_mfma_f32_16x16x32_bf16 a[28:31], v[56:59], v[32:35], a[28:31]
    v_mfma_f32_16x16x32_bf16 a[60:63], v[56:59], v[40:43], a[60:63]
    v_mfma_f32_16x16x32_bf16 a[92:95], v[56:59], v[96:99], a[92:95]
    v_mfma_f32_16x16x32_bf16 a[124:127], v[56:59], v[104:107], a[124:127]
    v_mfma_f32_16x16x32_bf16 a[156:159], v[56:59], v[160:163], a[156:159]
    v_mfma_f32_16x16x32_bf16 a[188:191], v[56:59], v[168:171], a[188:191]
    s_nop 7
    v_mfma_f32_16x16x32_bf16 v[48:51], v[224:227], v[32:35], v[48:51]
    v_mfma_f32_16x16x32_bf16 v[52:55], v[224:227], v[40:43], v[52:55]
    v_mfma_f32_16x16x32_bf16 v[112:115], v[224:227], v[96:99], v[112:115]
    v_mfma_f32_16x16x32_bf16 v[116:119], v[224:227], v[104:107], v[116:119]
    v_mfma_f32_16x16x32_bf16 v[176:179], v[224:227], v[160:163], v[176:179]
    v_mfma_f32_16x16x32_bf16 v[180:183], v[224:227], v[168:171], v[180:183]
    s_nop 15
    s_add_u32 s59, s59, 8192
    s_sub_u32 s60, s60, 1
    s_cmp_lg_u32 s60, 0
    s_cbranch_scc1 L_slow2
    s_nop 15
    v_mov_b32 v62, v48
    s_nop 1
    v_permlane32_swap_b32 v62, v48
    v_add_f32 v48, v48, v62
    v_mov_b32 v62, v48
    s_nop 1
    v_permlane16_swap_b32 v62, v48
    v_add_f32 v48, v48, v62
    v_mov_b32 v62, v52
    s_nop 1
    v_permlane32_swap_b32 v62, v52
    v_add_f32 v52, v52, v62
    v_mov_b32 v62, v52
    s_nop 1
    v_permlane16_swap_b32 v62, v52
    v_add_f32 v52, v52, v62
    v_mov_b32 v62, v112
    s_nop 1
    v_permlane32_swap_b32 v62, v112
    v_add_f32 v112, v112, v62
    v_mov_b32 v62, v112
    s_nop 1
    v_permlane16_swap_b32 v62, v112
    v_add_f32 v112, v112, v62
    v_mov_b32 v62, v116
    s_nop 1
    v_permlane32_swap_b32 v62, v116
    v_add_f32 v116, v116, v62
    v_mov_b32 v62, v116
    s_nop 1
    v_permlane16_swap_b32 v62, v116
    v_add_f32 v116, v116, v62
    v_mov_b32 v62, v176
    s_nop 1
    v_permlane32_swap_b32 v62, v176
    v_add_f32 v176, v176, v62
    v_mov_b32 v62, v176
    s_nop 1
    v_permlane16_swap_b32 v62, v176
    v_add_f32 v176, v176, v62
    v_mov_b32 v62, v180
    s_nop 1
    v_permlane32_swap_b32 v62, v180
    v_add_f32 v180, v180, v62
    v_mov_b32 v62, v180
    s_nop 1
    v_permlane16_swap_b32 v62, v180
    v_add_f32 v180, v180, v62
    s_waitcnt vmcnt(0) lgkmcnt(0)
    s_cmp_eq_u32 s42, 1
    s_cbranch_scc1 L_back2
    s_branch L_back1
L_spin1:
    s_mov_b32 s94, 0
L_spin1_loop:
    s_sleep 8
    buffer_load_dword v254, off, s[80:83], s65 sc1
    s_waitcnt vmcnt(0) lgkmcnt(0)
    s_add_u32 s94, s94, 1
    s_cmp_gt_u32 s94, 0x20000
    s_cbranch_scc1 L_spin1_back
    v_readfirstlane_b32 s69, v254
    s_nop 3
    s_and_b32 s69, s69, 0xff
    s_cmp_lt_u32 s69, 8
    s_cbranch_scc1 L_spin1_loop
    s_branch L_spin1_back
L_spin3:
    s_mov_b32 s94, 0
L_spin3_loop:
    s_sleep 8
    buffer_load_dword v255, off, s[80:83], s66 sc1
    s_waitcnt vmcnt(0) lgkmcnt(0)
    s_add_u32 s94, s94, 1
    s_cmp_gt_u32 s94, 0x20000
    s_cbranch_scc1 L_spin3_back
    v_readfirstlane_b32 s69, v255
    s_nop 3
    s_lshr_b32 s69, s69, 16
    s_cmp_lt_u32 s69, 128
    s_cbranch_scc1 L_spin3_loop
    s_branch L_spin3_back
L_spin2:
    s_mov_b32 s94, 0
L_spin2_loop:
    s_sleep 8
    buffer_load_dword v255, off, s[80:83], s65 sc1
    s_waitcnt vmcnt(0) lgkmcnt(0)
    s_add_u32 s94, s94, 1
    s_cmp_gt_u32 s94, 0x20000
    s_cbranch_scc1 L_spin2_back
    v_readfirstlane_b32 s69, v255
    s_nop 3
    s_lshr_b32 s69, s69, 8
    s_and_b32 s69, s69, 0xff
    s_cmp_lt_u32 s69, 8
    s_cbranch_scc1 L_spin2_loop
    s_branch L_spin2_back
L_endcode:
.section .rodata,"a"
.p2align 6
.amdhsa_kernel concat_heads__mha_block_cached__mha_block_cached__near_ridge_kernel
  .amdhsa_next_free_vgpr 512
  .amdhsa_next_free_sgpr 102
  .amdhsa_accum_offset 256
  .amdhsa_group_segment_fixed_size 0
  .amdhsa_kernarg_size 104
  .amdhsa_user_sgpr_count 2
  .amdhsa_user_sgpr_kernarg_segment_ptr 1
  .amdhsa_system_sgpr_workgroup_id_x 1
.end_amdhsa_kernel
```
